```python
import torch

def _softmax(x, axis=-1):
    return torch.softmax(x, dim=axis)

def _gelu(x):
    return torch.nn.functional.gelu(x, approximate='tanh')

def _silu(x):
    return torch.nn.functional.silu(x)

def _sigmoid(x):
    return torch.sigmoid(x)

def _layernorm(x, axis=-1, eps=1e-05):
    m = x.mean(dim=axis, keepdim=True)
    v = x.var(dim=axis, keepdim=True, unbiased=False)
    return (x - m) / torch.sqrt(v + eps)

def _scatter_add(tgt, idx, src, axis=0):
    return tgt.clone().index_add_(axis, idx, src)

def _segment_sum(src, seg, n):
    out = torch.zeros((n,) + src.shape[1:], dtype=src.dtype)
    return out.index_add_(0, seg, src)

def _pad(x, pw):
    flat = tuple((v for pair in reversed(pw) for v in pair))
    return torch.nn.functional.pad(x, flat)
kernel_name = 'recurrent_scan__memory_aug_recurrent_mem_tr__mixer_s_mlp__prompt'

def setup_inputs():

    _w = lambda a: (lambda t: t.to(torch.bfloat16) if t.is_floating_point() else t)(torch.as_tensor(a))

    def _A_setup():
        B, S, Dm = (1, 2048, 512)
        H, Dh = (32, 128)
        M, seg = (8, 32)
        seg = min(seg, S)
        S = S // seg * seg
        return {'x': _w((lambda *s: torch.randn(*s, dtype=torch.bfloat16) * 0.05)(B, S, Dm)), 'mem0': _w((lambda *s: torch.randn(*s, dtype=torch.bfloat16) * 0.2)(B, M, Dm)), 'Wq': _w((lambda *s: torch.randn(*s, dtype=torch.bfloat16) * 1.6)(Dm, H, Dh) * Dm ** (-0.5)), 'Wk': _w((lambda *s: torch.randn(*s, dtype=torch.bfloat16) * 1.6)(Dm, H, Dh) * Dm ** (-0.5)), 'Wv': _w((lambda *s: torch.randn(*s, dtype=torch.bfloat16) * 0.2)(Dm, H, Dh) * Dm ** (-0.5)), 'Wo': _w((lambda *s: torch.randn(*s, dtype=torch.bfloat16) * 0.2)(H, Dh, Dm) * (H * Dh) ** (-0.5)), 'seg_len': seg}
    _A_in = _A_setup()

    def _B_setup():
        B, S, D, F = (1, 2048, 512, 1376)
        return {'x': _w((lambda *s: torch.randn(*s, dtype=torch.bfloat16) * 0.05)(B, S, D)), 'w1': _w((lambda *s: torch.randn(*s, dtype=torch.bfloat16) * 3.2)(D, D) * D ** (-0.5)), 'w2': _w((lambda *s: torch.randn(*s, dtype=torch.bfloat16) * 3.2)(D, D) * D ** (-0.5)), 'w3': _w((lambda *s: torch.randn(*s, dtype=torch.bfloat16) * 3.2)(D, F) * D ** (-0.5)), 'w4': _w((lambda *s: torch.randn(*s, dtype=torch.bfloat16) * 3.2)(F, D) * F ** (-0.5))}
    _B_in = _B_setup()
    return {'A_x': _A_in['x'], 'A_mem0': _A_in['mem0'], 'A_Wq': _A_in['Wq'], 'A_Wk': _A_in['Wk'], 'A_Wv': _A_in['Wv'], 'A_Wo': _A_in['Wo'], 'A_seg_len': _A_in['seg_len'], 'B_x': _B_in['x'], 'B_w1': _B_in['w1'], 'B_w2': _B_in['w2'], 'B_w3': _B_in['w3'], 'B_w4': _B_in['w4']}

def reference(A_x, A_mem0, A_Wq, A_Wk, A_Wv, A_Wo, A_seg_len, B_x, B_w1, B_w2, B_w3, B_w4):

    def _A_ref(x, mem0, Wq, Wk, Wv, Wo, seg_len):
        B, S, Dm = x.shape
        H, Dh = (Wq.shape[1], Wq.shape[2])
        M = mem0.shape[1]
        scale = Dh ** (-0.5)
        n_seg = S // seg_len
        L = M + seg_len
        idx = torch.arange(L)
        mask = (idx[:, None] < M) | (idx[:, None] >= idx[None, :])
        mem = mem0
        outs = []
        for s in range(n_seg):
            xs = x[:, s * seg_len:(s + 1) * seg_len, :].clone()
            h = torch.concatenate([mem, xs], axis=1)
            q = torch.einsum('btd,dhe->bhte', h, Wq)
            k = torch.einsum('btd,dhe->bhte', h, Wk)
            v = torch.einsum('btd,dhe->bhte', h, Wv)
            scores = torch.einsum('bhqe,bhke->bhqk', q, k) * scale
            scores = torch.where(mask[None, None], scores, -1000000000.0)
            p = _softmax(scores, axis=-1)
            o = torch.einsum('bhqk,bhke->bhqe', p, v)
            o = torch.einsum('bhte,hed->btd', o, Wo)
            mem = o[:, :M, :].clone()
            outs.append(o[:, M:, :])
        return torch.concatenate(outs, axis=1)

    def _B_ref(x, w1, w2, w3, w4):
        B, S, D = x.shape
        h = _gelu(_layernorm(x, axis=-1) @ w1)
        c = D // 4
        g0 = _pad(h[:, :, 0 * c:1 * c], ((0, 0), (1, 0), (0, 0)))[:, :S, :]
        g1 = _pad(h[:, :, 1 * c:2 * c], ((0, 0), (0, 1), (0, 0)))[:, 1:, :]
        g2 = _pad(h[:, :, 2 * c:3 * c], ((0, 0), (2, 0), (0, 0)))[:, :S, :]
        g3 = _pad(h[:, :, 3 * c:], ((0, 0), (0, 2), (0, 0)))[:, 2:, :]
        hs = torch.concatenate([g0, g1, g2, g3], axis=-1) @ w2
        x1 = x + hs
        h2 = _gelu(_layernorm(x1, axis=-1) @ w3) @ w4
        return x1 + h2
    x = A_x
    xn = _layernorm(x, axis=-1)
    s = _A_ref(xn, A_mem0, A_Wq, A_Wk, A_Wv, A_Wo, A_seg_len)
    g = _silu(_B_ref(xn, B_w1, B_w2, B_w3, B_w4))
    return x + s * g
```

```asm
; @launch grid=(256,1,1) block=(256,1,1) lds=163840
.amdgcn_target "amdgcn-amd-amdhsa--gfx950"
.text
.globl recurrent_scan__memory_aug_recurrent_mem_tr__mixer_s_mlp__prompt_kernel
.p2align 8
.type recurrent_scan__memory_aug_recurrent_mem_tr__mixer_s_mlp__prompt_kernel,@function
recurrent_scan__memory_aug_recurrent_mem_tr__mixer_s_mlp__prompt_kernel:
 s_cmp_ge_u32 s2, 256
 s_cbranch_scc1 L_EXIT
 s_load_dwordx16 s[4:19], s[0:1], 0
 s_load_dwordx8 s[20:27], s[0:1], 64
 s_load_dwordx4 s[28:31], s[0:1], 96
 s_load_dwordx2 s[32:33], s[0:1], 112
 s_getreg_b32 s72, hwreg(HW_REG_XCC_ID, 0, 3)
 v_lshrrev_b32 v66, 6, v0
 s_nop 0
 v_readfirstlane_b32 s47, v66
 s_waitcnt lgkmcnt(0)
 s_mov_b32 s36, s32
 s_mov_b32 s37, s33
 s_mov_b32 s38, 268435456
 s_mov_b32 s39, 0x20000
 s_lshl_b32 s3, s72, 2
 s_lshr_b32 s72, 321348928, s3
 s_and_b32 s72, s72, 7
 s_lshl_b32 s3, s72, 5
 v_mov_b32 v1, s3
 v_mov_b32 v2, 1
 v_mov_b32 v4, 0
 v_cmp_eq_u32 vcc, 0, v0
 s_nop 0
 s_and_saveexec_b64 s[34:35], vcc
 s_cbranch_execz L_reg_skip
 global_atomic_add v3, v1, v2, s[30:31] sc0
L_reg_skip:
 s_mov_b64 exec, s[34:35]
 s_mov_b32 s68, s14
 s_mov_b32 s69, s15
 s_cmp_eq_u32 s72, 0
 s_cselect_b32 s70, 0x400000, 0
 s_cmp_eq_u32 s2, 1
 s_cselect_b32 s70, 0, s70
 s_mov_b32 s71, 0x20000
 s_lshr_b32 s3, s2, 3
 s_and_b32 s3, s3, 31
 s_lshl_b32 s3, s3, 17
 s_add_u32 s3, s3, 0x10000
 v_lshlrev_b32 v6, 7, v0
 buffer_load_dword v7, v6, s[68:71], s3 offen
 s_add_u32 s3, s3, 0x8000
 buffer_load_dword v7, v6, s[68:71], s3 offen
 s_cmp_lg_u32 s2, 1
 s_cbranch_scc1 L_noclear
 v_mov_b32 v8, 0
 v_mov_b32 v9, 0
 v_mov_b32 v10, 0
 v_mov_b32 v11, 0
 v_lshlrev_b32 v5, 4, v0
 buffer_store_dwordx4 v[8:11], v5, s[36:39], 0 offen sc1
 v_add_u32 v5, 0x1000, v5
 buffer_store_dwordx4 v[8:11], v5, s[36:39], 0 offen sc1
 v_add_u32 v5, 0x1000, v5
 buffer_store_dwordx4 v[8:11], v5, s[36:39], 0 offen sc1
 v_add_u32 v5, 0x1000, v5
 buffer_store_dwordx4 v[8:11], v5, s[36:39], 0 offen sc1
 s_waitcnt vmcnt(0)
 s_barrier
 v_mov_b32 v5, 36
 s_mov_b64 exec, 1
 global_store_dword v5, v2, s[30:31] sc1
 s_mov_b64 exec, -1
L_noclear:
 v_cmp_eq_u32 vcc, 0, v0
 s_nop 0
 s_and_saveexec_b64 s[34:35], vcc
 s_cbranch_execz L_reg_skip2
 s_waitcnt vmcnt(2)
 ds_write_b32 v4, v3
 s_waitcnt lgkmcnt(0)
L_reg_skip2:
 s_mov_b64 exec, s[34:35]
 s_barrier
 ds_read_b32 v3, v4
 s_waitcnt lgkmcnt(0)
 v_readfirstlane_b32 s40, v3
 s_barrier
 s_cmp_ge_u32 s40, 32
 s_cbranch_scc1 L_EXIT
 s_cmp_eq_u32 s72, 0
 s_cbranch_scc1 R_CHAIN
 s_waitcnt vmcnt(0)
 s_cmp_eq_u32 s72, 1
 s_cbranch_scc1 R_BPATH
 s_sub_u32 s3, s72, 2
 s_lshl_b32 s3, s3, 5
 s_add_u32 s3, s3, s40
 s_mul_i32 s52, s3, 21846
 s_lshr_b32 s52, s52, 16
 s_mul_i32 s34, s52, 3
 s_cmp_lg_u32 s34, s3
 s_cbranch_scc1 L_noS0
 v_and_b32 v1, 63, v0
 v_lshrrev_b32 v2, 3, v0
 v_and_b32 v3, 7, v0
 v_lshrrev_b32 v4, 1, v3
 v_and_b32 v5, 1, v3
 v_lshlrev_b32 v6, 10, v2
 v_lshl_add_u32 v6, v4, 5, v6
 v_lshl_add_u32 v6, v5, 3, v6
 s_lshl_b32 s3, s52, 15
 v_add_u32 v6, s3, v6
 v_lshlrev_b32 v7, 10, v4
 v_lshl_add_u32 v7, v5, 9, v7
 v_lshl_add_u32 v7, v2, 4, v7
 s_add_u32 s35, s3, 14680064
 global_load_dwordx2 v[32:33], v6, s[4:5] offset:0
 global_load_dwordx2 v[34:35], v6, s[4:5] offset:16
 global_load_dwordx2 v[36:37], v6, s[4:5] offset:128
 global_load_dwordx2 v[38:39], v6, s[4:5] offset:144
 global_load_dwordx2 v[40:41], v6, s[4:5] offset:256
 global_load_dwordx2 v[42:43], v6, s[4:5] offset:272
 global_load_dwordx2 v[44:45], v6, s[4:5] offset:384
 global_load_dwordx2 v[46:47], v6, s[4:5] offset:400
 global_load_dwordx2 v[48:49], v6, s[4:5] offset:512
 global_load_dwordx2 v[50:51], v6, s[4:5] offset:528
 global_load_dwordx2 v[52:53], v6, s[4:5] offset:640
 global_load_dwordx2 v[54:55], v6, s[4:5] offset:656
 global_load_dwordx2 v[56:57], v6, s[4:5] offset:768
 global_load_dwordx2 v[58:59], v6, s[4:5] offset:784
 global_load_dwordx2 v[60:61], v6, s[4:5] offset:896
 global_load_dwordx2 v[62:63], v6, s[4:5] offset:912
 s_waitcnt vmcnt(15)
 v_lshlrev_b32 v64, 16, v32
 v_and_b32 v65, 0xffff0000, v32
 v_lshlrev_b32 v66, 16, v33
 v_and_b32 v67, 0xffff0000, v33
 s_waitcnt vmcnt(14)
 v_lshlrev_b32 v68, 16, v34
 v_and_b32 v69, 0xffff0000, v34
 v_lshlrev_b32 v70, 16, v35
 v_and_b32 v71, 0xffff0000, v35
 s_waitcnt vmcnt(13)
 v_lshlrev_b32 v72, 16, v36
 v_and_b32 v73, 0xffff0000, v36
 v_lshlrev_b32 v74, 16, v37
 v_and_b32 v75, 0xffff0000, v37
 s_waitcnt vmcnt(12)
 v_lshlrev_b32 v76, 16, v38
 v_and_b32 v77, 0xffff0000, v38
 v_lshlrev_b32 v78, 16, v39
 v_and_b32 v79, 0xffff0000, v39
 s_waitcnt vmcnt(11)
 v_lshlrev_b32 v80, 16, v40
 v_and_b32 v81, 0xffff0000, v40
 v_lshlrev_b32 v82, 16, v41
 v_and_b32 v83, 0xffff0000, v41
 s_waitcnt vmcnt(10)
 v_lshlrev_b32 v84, 16, v42
 v_and_b32 v85, 0xffff0000, v42
 v_lshlrev_b32 v86, 16, v43
 v_and_b32 v87, 0xffff0000, v43
 s_waitcnt vmcnt(9)
 v_lshlrev_b32 v88, 16, v44
 v_and_b32 v89, 0xffff0000, v44
 v_lshlrev_b32 v90, 16, v45
 v_and_b32 v91, 0xffff0000, v45
 s_waitcnt vmcnt(8)
 v_lshlrev_b32 v92, 16, v46
 v_and_b32 v93, 0xffff0000, v46
 v_lshlrev_b32 v94, 16, v47
 v_and_b32 v95, 0xffff0000, v47
 s_waitcnt vmcnt(7)
 v_lshlrev_b32 v96, 16, v48
 v_and_b32 v97, 0xffff0000, v48
 v_lshlrev_b32 v98, 16, v49
 v_and_b32 v99, 0xffff0000, v49
 s_waitcnt vmcnt(6)
 v_lshlrev_b32 v100, 16, v50
 v_and_b32 v101, 0xffff0000, v50
 v_lshlrev_b32 v102, 16, v51
 v_and_b32 v103, 0xffff0000, v51
 s_waitcnt vmcnt(5)
 v_lshlrev_b32 v104, 16, v52
 v_and_b32 v105, 0xffff0000, v52
 v_lshlrev_b32 v106, 16, v53
 v_and_b32 v107, 0xffff0000, v53
 s_waitcnt vmcnt(4)
 v_lshlrev_b32 v108, 16, v54
 v_and_b32 v109, 0xffff0000, v54
 v_lshlrev_b32 v110, 16, v55
 v_and_b32 v111, 0xffff0000, v55
 s_waitcnt vmcnt(3)
 v_lshlrev_b32 v112, 16, v56
 v_and_b32 v113, 0xffff0000, v56
 v_lshlrev_b32 v114, 16, v57
 v_and_b32 v115, 0xffff0000, v57
 s_waitcnt vmcnt(2)
 v_lshlrev_b32 v116, 16, v58
 v_and_b32 v117, 0xffff0000, v58
 v_lshlrev_b32 v118, 16, v59
 v_and_b32 v119, 0xffff0000, v59
 s_waitcnt vmcnt(1)
 v_lshlrev_b32 v120, 16, v60
 v_and_b32 v121, 0xffff0000, v60
 v_lshlrev_b32 v122, 16, v61
 v_and_b32 v123, 0xffff0000, v61
 s_waitcnt vmcnt(0)
 v_lshlrev_b32 v124, 16, v62
 v_and_b32 v125, 0xffff0000, v62
 v_lshlrev_b32 v126, 16, v63
 v_and_b32 v127, 0xffff0000, v63
 v_add_f32 v8, v64, v65
 v_add_f32 v8, v8, v66
 v_add_f32 v8, v8, v67
 v_add_f32 v8, v8, v68
 v_add_f32 v8, v8, v69
 v_add_f32 v8, v8, v70
 v_add_f32 v8, v8, v71
 v_add_f32 v8, v8, v72
 v_add_f32 v8, v8, v73
 v_add_f32 v8, v8, v74
 v_add_f32 v8, v8, v75
 v_add_f32 v8, v8, v76
 v_add_f32 v8, v8, v77
 v_add_f32 v8, v8, v78
 v_add_f32 v8, v8, v79
 v_add_f32 v8, v8, v80
 v_add_f32 v8, v8, v81
 v_add_f32 v8, v8, v82
 v_add_f32 v8, v8, v83
 v_add_f32 v8, v8, v84
 v_add_f32 v8, v8, v85
 v_add_f32 v8, v8, v86
 v_add_f32 v8, v8, v87
 v_add_f32 v8, v8, v88
 v_add_f32 v8, v8, v89
 v_add_f32 v8, v8, v90
 v_add_f32 v8, v8, v91
 v_add_f32 v8, v8, v92
 v_add_f32 v8, v8, v93
 v_add_f32 v8, v8, v94
 v_add_f32 v8, v8, v95
 v_add_f32 v8, v8, v96
 v_add_f32 v8, v8, v97
 v_add_f32 v8, v8, v98
 v_add_f32 v8, v8, v99
 v_add_f32 v8, v8, v100
 v_add_f32 v8, v8, v101
 v_add_f32 v8, v8, v102
 v_add_f32 v8, v8, v103
 v_add_f32 v8, v8, v104
 v_add_f32 v8, v8, v105
 v_add_f32 v8, v8, v106
 v_add_f32 v8, v8, v107
 v_add_f32 v8, v8, v108
 v_add_f32 v8, v8, v109
 v_add_f32 v8, v8, v110
 v_add_f32 v8, v8, v111
 v_add_f32 v8, v8, v112
 v_add_f32 v8, v8, v113
 v_add_f32 v8, v8, v114
 v_add_f32 v8, v8, v115
 v_add_f32 v8, v8, v116
 v_add_f32 v8, v8, v117
 v_add_f32 v8, v8, v118
 v_add_f32 v8, v8, v119
 v_add_f32 v8, v8, v120
 v_add_f32 v8, v8, v121
 v_add_f32 v8, v8, v122
 v_add_f32 v8, v8, v123
 v_add_f32 v8, v8, v124
 v_add_f32 v8, v8, v125
 v_add_f32 v8, v8, v126
 v_add_f32 v8, v8, v127
 s_nop 1
 v_add_f32_dpp v8, v8, v8 quad_perm:[1,0,3,2] row_mask:0xf bank_mask:0xf
 s_nop 1
 v_add_f32_dpp v8, v8, v8 quad_perm:[2,3,0,1] row_mask:0xf bank_mask:0xf
 s_nop 1
 v_add_f32_dpp v8, v8, v8 row_half_mirror row_mask:0xf bank_mask:0xf
 v_mul_f32 v8, 0x3b000000, v8
 v_mov_b32 v9, 0
 v_sub_f32 v11, v64, v8
 v_fmac_f32 v9, v11, v11
 v_sub_f32 v11, v65, v8
 v_fmac_f32 v9, v11, v11
 v_sub_f32 v11, v66, v8
 v_fmac_f32 v9, v11, v11
 v_sub_f32 v11, v67, v8
 v_fmac_f32 v9, v11, v11
 v_sub_f32 v11, v68, v8
 v_fmac_f32 v9, v11, v11
 v_sub_f32 v11, v69, v8
 v_fmac_f32 v9, v11, v11
 v_sub_f32 v11, v70, v8
 v_fmac_f32 v9, v11, v11
 v_sub_f32 v11, v71, v8
 v_fmac_f32 v9, v11, v11
 v_sub_f32 v11, v72, v8
 v_fmac_f32 v9, v11, v11
 v_sub_f32 v11, v73, v8
 v_fmac_f32 v9, v11, v11
 v_sub_f32 v11, v74, v8
 v_fmac_f32 v9, v11, v11
 v_sub_f32 v11, v75, v8
 v_fmac_f32 v9, v11, v11
 v_sub_f32 v11, v76, v8
 v_fmac_f32 v9, v11, v11
 v_sub_f32 v11, v77, v8
 v_fmac_f32 v9, v11, v11
 v_sub_f32 v11, v78, v8
 v_fmac_f32 v9, v11, v11
 v_sub_f32 v11, v79, v8
 v_fmac_f32 v9, v11, v11
 v_sub_f32 v11, v80, v8
 v_fmac_f32 v9, v11, v11
 v_sub_f32 v11, v81, v8
 v_fmac_f32 v9, v11, v11
 v_sub_f32 v11, v82, v8
 v_fmac_f32 v9, v11, v11
 v_sub_f32 v11, v83, v8
 v_fmac_f32 v9, v11, v11
 v_sub_f32 v11, v84, v8
 v_fmac_f32 v9, v11, v11
 v_sub_f32 v11, v85, v8
 v_fmac_f32 v9, v11, v11
 v_sub_f32 v11, v86, v8
 v_fmac_f32 v9, v11, v11
 v_sub_f32 v11, v87, v8
 v_fmac_f32 v9, v11, v11
 v_sub_f32 v11, v88, v8
 v_fmac_f32 v9, v11, v11
 v_sub_f32 v11, v89, v8
 v_fmac_f32 v9, v11, v11
 v_sub_f32 v11, v90, v8
 v_fmac_f32 v9, v11, v11
 v_sub_f32 v11, v91, v8
 v_fmac_f32 v9, v11, v11
 v_sub_f32 v11, v92, v8
 v_fmac_f32 v9, v11, v11
 v_sub_f32 v11, v93, v8
 v_fmac_f32 v9, v11, v11
 v_sub_f32 v11, v94, v8
 v_fmac_f32 v9, v11, v11
 v_sub_f32 v11, v95, v8
 v_fmac_f32 v9, v11, v11
 v_sub_f32 v11, v96, v8
 v_fmac_f32 v9, v11, v11
 v_sub_f32 v11, v97, v8
 v_fmac_f32 v9, v11, v11
 v_sub_f32 v11, v98, v8
 v_fmac_f32 v9, v11, v11
 v_sub_f32 v11, v99, v8
 v_fmac_f32 v9, v11, v11
 v_sub_f32 v11, v100, v8
 v_fmac_f32 v9, v11, v11
 v_sub_f32 v11, v101, v8
 v_fmac_f32 v9, v11, v11
 v_sub_f32 v11, v102, v8
 v_fmac_f32 v9, v11, v11
 v_sub_f32 v11, v103, v8
 v_fmac_f32 v9, v11, v11
 v_sub_f32 v11, v104, v8
 v_fmac_f32 v9, v11, v11
 v_sub_f32 v11, v105, v8
 v_fmac_f32 v9, v11, v11
 v_sub_f32 v11, v106, v8
 v_fmac_f32 v9, v11, v11
 v_sub_f32 v11, v107, v8
 v_fmac_f32 v9, v11, v11
 v_sub_f32 v11, v108, v8
 v_fmac_f32 v9, v11, v11
 v_sub_f32 v11, v109, v8
 v_fmac_f32 v9, v11, v11
 v_sub_f32 v11, v110, v8
 v_fmac_f32 v9, v11, v11
 v_sub_f32 v11, v111, v8
 v_fmac_f32 v9, v11, v11
 v_sub_f32 v11, v112, v8
 v_fmac_f32 v9, v11, v11
 v_sub_f32 v11, v113, v8
 v_fmac_f32 v9, v11, v11
 v_sub_f32 v11, v114, v8
 v_fmac_f32 v9, v11, v11
 v_sub_f32 v11, v115, v8
 v_fmac_f32 v9, v11, v11
 v_sub_f32 v11, v116, v8
 v_fmac_f32 v9, v11, v11
 v_sub_f32 v11, v117, v8
 v_fmac_f32 v9, v11, v11
 v_sub_f32 v11, v118, v8
 v_fmac_f32 v9, v11, v11
 v_sub_f32 v11, v119, v8
 v_fmac_f32 v9, v11, v11
 v_sub_f32 v11, v120, v8
 v_fmac_f32 v9, v11, v11
 v_sub_f32 v11, v121, v8
 v_fmac_f32 v9, v11, v11
 v_sub_f32 v11, v122, v8
 v_fmac_f32 v9, v11, v11
 v_sub_f32 v11, v123, v8
 v_fmac_f32 v9, v11, v11
 v_sub_f32 v11, v124, v8
 v_fmac_f32 v9, v11, v11
 v_sub_f32 v11, v125, v8
 v_fmac_f32 v9, v11, v11
 v_sub_f32 v11, v126, v8
 v_fmac_f32 v9, v11, v11
 v_sub_f32 v11, v127, v8
 v_fmac_f32 v9, v11, v11
 s_nop 1
 v_add_f32_dpp v9, v9, v9 quad_perm:[1,0,3,2] row_mask:0xf bank_mask:0xf
 s_nop 1
 v_add_f32_dpp v9, v9, v9 quad_perm:[2,3,0,1] row_mask:0xf bank_mask:0xf
 s_nop 1
 v_add_f32_dpp v9, v9, v9 row_half_mirror row_mask:0xf bank_mask:0xf
 v_mul_f32 v9, 0x3b000000, v9
 v_cvt_pk_bf16_f32 v8, v8, v8
 v_and_b32 v8, 0xffff0000, v8
 v_cvt_pk_bf16_f32 v9, v9, v9
 v_and_b32 v9, 0xffff0000, v9
 v_add_f32 v9, 0x3727c5ac, v9
 v_cvt_pk_bf16_f32 v9, v9, v9
 v_and_b32 v9, 0xffff0000, v9
 v_sqrt_f32 v9, v9
 s_nop 0
 v_cvt_pk_bf16_f32 v9, v9, v9
 v_and_b32 v9, 0xffff0000, v9
 v_rcp_f32 v10, v9
 v_sub_f32 v64, v64, v8
 v_sub_f32 v65, v65, v8
 v_cvt_pk_bf16_f32 v65, v64, v65
 v_lshlrev_b32 v64, 16, v65
 v_and_b32 v65, 0xffff0000, v65
 v_mul_f32 v64, v64, v10
 v_mul_f32 v65, v65, v10
 v_cvt_pk_bf16_f32 v32, v64, v65
 v_sub_f32 v66, v66, v8
 v_sub_f32 v67, v67, v8
 v_cvt_pk_bf16_f32 v67, v66, v67
 v_lshlrev_b32 v66, 16, v67
 v_and_b32 v67, 0xffff0000, v67
 v_mul_f32 v66, v66, v10
 v_mul_f32 v67, v67, v10
 v_cvt_pk_bf16_f32 v33, v66, v67
 v_sub_f32 v68, v68, v8
 v_sub_f32 v69, v69, v8
 v_cvt_pk_bf16_f32 v69, v68, v69
 v_lshlrev_b32 v68, 16, v69
 v_and_b32 v69, 0xffff0000, v69
 v_mul_f32 v68, v68, v10
 v_mul_f32 v69, v69, v10
 v_cvt_pk_bf16_f32 v34, v68, v69
 v_sub_f32 v70, v70, v8
 v_sub_f32 v71, v71, v8
 v_cvt_pk_bf16_f32 v71, v70, v71
 v_lshlrev_b32 v70, 16, v71
 v_and_b32 v71, 0xffff0000, v71
 v_mul_f32 v70, v70, v10
 v_mul_f32 v71, v71, v10
 v_cvt_pk_bf16_f32 v35, v70, v71
 v_sub_f32 v72, v72, v8
 v_sub_f32 v73, v73, v8
 v_cvt_pk_bf16_f32 v73, v72, v73
 v_lshlrev_b32 v72, 16, v73
 v_and_b32 v73, 0xffff0000, v73
 v_mul_f32 v72, v72, v10
 v_mul_f32 v73, v73, v10
 v_cvt_pk_bf16_f32 v36, v72, v73
 v_sub_f32 v74, v74, v8
 v_sub_f32 v75, v75, v8
 v_cvt_pk_bf16_f32 v75, v74, v75
 v_lshlrev_b32 v74, 16, v75
 v_and_b32 v75, 0xffff0000, v75
 v_mul_f32 v74, v74, v10
 v_mul_f32 v75, v75, v10
 v_cvt_pk_bf16_f32 v37, v74, v75
 v_sub_f32 v76, v76, v8
 v_sub_f32 v77, v77, v8
 v_cvt_pk_bf16_f32 v77, v76, v77
 v_lshlrev_b32 v76, 16, v77
 v_and_b32 v77, 0xffff0000, v77
 v_mul_f32 v76, v76, v10
 v_mul_f32 v77, v77, v10
 v_cvt_pk_bf16_f32 v38, v76, v77
 v_sub_f32 v78, v78, v8
 v_sub_f32 v79, v79, v8
 v_cvt_pk_bf16_f32 v79, v78, v79
 v_lshlrev_b32 v78, 16, v79
 v_and_b32 v79, 0xffff0000, v79
 v_mul_f32 v78, v78, v10
 v_mul_f32 v79, v79, v10
 v_cvt_pk_bf16_f32 v39, v78, v79
 v_sub_f32 v80, v80, v8
 v_sub_f32 v81, v81, v8
 v_cvt_pk_bf16_f32 v81, v80, v81
 v_lshlrev_b32 v80, 16, v81
 v_and_b32 v81, 0xffff0000, v81
 v_mul_f32 v80, v80, v10
 v_mul_f32 v81, v81, v10
 v_cvt_pk_bf16_f32 v40, v80, v81
 v_sub_f32 v82, v82, v8
 v_sub_f32 v83, v83, v8
 v_cvt_pk_bf16_f32 v83, v82, v83
 v_lshlrev_b32 v82, 16, v83
 v_and_b32 v83, 0xffff0000, v83
 v_mul_f32 v82, v82, v10
 v_mul_f32 v83, v83, v10
 v_cvt_pk_bf16_f32 v41, v82, v83
 v_sub_f32 v84, v84, v8
 v_sub_f32 v85, v85, v8
 v_cvt_pk_bf16_f32 v85, v84, v85
 v_lshlrev_b32 v84, 16, v85
 v_and_b32 v85, 0xffff0000, v85
 v_mul_f32 v84, v84, v10
 v_mul_f32 v85, v85, v10
 v_cvt_pk_bf16_f32 v42, v84, v85
 v_sub_f32 v86, v86, v8
 v_sub_f32 v87, v87, v8
 v_cvt_pk_bf16_f32 v87, v86, v87
 v_lshlrev_b32 v86, 16, v87
 v_and_b32 v87, 0xffff0000, v87
 v_mul_f32 v86, v86, v10
 v_mul_f32 v87, v87, v10
 v_cvt_pk_bf16_f32 v43, v86, v87
 v_sub_f32 v88, v88, v8
 v_sub_f32 v89, v89, v8
 v_cvt_pk_bf16_f32 v89, v88, v89
 v_lshlrev_b32 v88, 16, v89
 v_and_b32 v89, 0xffff0000, v89
 v_mul_f32 v88, v88, v10
 v_mul_f32 v89, v89, v10
 v_cvt_pk_bf16_f32 v44, v88, v89
 v_sub_f32 v90, v90, v8
 v_sub_f32 v91, v91, v8
 v_cvt_pk_bf16_f32 v91, v90, v91
 v_lshlrev_b32 v90, 16, v91
 v_and_b32 v91, 0xffff0000, v91
 v_mul_f32 v90, v90, v10
 v_mul_f32 v91, v91, v10
 v_cvt_pk_bf16_f32 v45, v90, v91
 v_sub_f32 v92, v92, v8
 v_sub_f32 v93, v93, v8
 v_cvt_pk_bf16_f32 v93, v92, v93
 v_lshlrev_b32 v92, 16, v93
 v_and_b32 v93, 0xffff0000, v93
 v_mul_f32 v92, v92, v10
 v_mul_f32 v93, v93, v10
 v_cvt_pk_bf16_f32 v46, v92, v93
 v_sub_f32 v94, v94, v8
 v_sub_f32 v95, v95, v8
 v_cvt_pk_bf16_f32 v95, v94, v95
 v_lshlrev_b32 v94, 16, v95
 v_and_b32 v95, 0xffff0000, v95
 v_mul_f32 v94, v94, v10
 v_mul_f32 v95, v95, v10
 v_cvt_pk_bf16_f32 v47, v94, v95
 v_sub_f32 v96, v96, v8
 v_sub_f32 v97, v97, v8
 v_cvt_pk_bf16_f32 v97, v96, v97
 v_lshlrev_b32 v96, 16, v97
 v_and_b32 v97, 0xffff0000, v97
 v_mul_f32 v96, v96, v10
 v_mul_f32 v97, v97, v10
 v_cvt_pk_bf16_f32 v48, v96, v97
 v_sub_f32 v98, v98, v8
 v_sub_f32 v99, v99, v8
 v_cvt_pk_bf16_f32 v99, v98, v99
 v_lshlrev_b32 v98, 16, v99
 v_and_b32 v99, 0xffff0000, v99
 v_mul_f32 v98, v98, v10
 v_mul_f32 v99, v99, v10
 v_cvt_pk_bf16_f32 v49, v98, v99
 v_sub_f32 v100, v100, v8
 v_sub_f32 v101, v101, v8
 v_cvt_pk_bf16_f32 v101, v100, v101
 v_lshlrev_b32 v100, 16, v101
 v_and_b32 v101, 0xffff0000, v101
 v_mul_f32 v100, v100, v10
 v_mul_f32 v101, v101, v10
 v_cvt_pk_bf16_f32 v50, v100, v101
 v_sub_f32 v102, v102, v8
 v_sub_f32 v103, v103, v8
 v_cvt_pk_bf16_f32 v103, v102, v103
 v_lshlrev_b32 v102, 16, v103
 v_and_b32 v103, 0xffff0000, v103
 v_mul_f32 v102, v102, v10
 v_mul_f32 v103, v103, v10
 v_cvt_pk_bf16_f32 v51, v102, v103
 v_sub_f32 v104, v104, v8
 v_sub_f32 v105, v105, v8
 v_cvt_pk_bf16_f32 v105, v104, v105
 v_lshlrev_b32 v104, 16, v105
 v_and_b32 v105, 0xffff0000, v105
 v_mul_f32 v104, v104, v10
 v_mul_f32 v105, v105, v10
 v_cvt_pk_bf16_f32 v52, v104, v105
 v_sub_f32 v106, v106, v8
 v_sub_f32 v107, v107, v8
 v_cvt_pk_bf16_f32 v107, v106, v107
 v_lshlrev_b32 v106, 16, v107
 v_and_b32 v107, 0xffff0000, v107
 v_mul_f32 v106, v106, v10
 v_mul_f32 v107, v107, v10
 v_cvt_pk_bf16_f32 v53, v106, v107
 v_sub_f32 v108, v108, v8
 v_sub_f32 v109, v109, v8
 v_cvt_pk_bf16_f32 v109, v108, v109
 v_lshlrev_b32 v108, 16, v109
 v_and_b32 v109, 0xffff0000, v109
 v_mul_f32 v108, v108, v10
 v_mul_f32 v109, v109, v10
 v_cvt_pk_bf16_f32 v54, v108, v109
 v_sub_f32 v110, v110, v8
 v_sub_f32 v111, v111, v8
 v_cvt_pk_bf16_f32 v111, v110, v111
 v_lshlrev_b32 v110, 16, v111
 v_and_b32 v111, 0xffff0000, v111
 v_mul_f32 v110, v110, v10
 v_mul_f32 v111, v111, v10
 v_cvt_pk_bf16_f32 v55, v110, v111
 v_sub_f32 v112, v112, v8
 v_sub_f32 v113, v113, v8
 v_cvt_pk_bf16_f32 v113, v112, v113
 v_lshlrev_b32 v112, 16, v113
 v_and_b32 v113, 0xffff0000, v113
 v_mul_f32 v112, v112, v10
 v_mul_f32 v113, v113, v10
 v_cvt_pk_bf16_f32 v56, v112, v113
 v_sub_f32 v114, v114, v8
 v_sub_f32 v115, v115, v8
 v_cvt_pk_bf16_f32 v115, v114, v115
 v_lshlrev_b32 v114, 16, v115
 v_and_b32 v115, 0xffff0000, v115
 v_mul_f32 v114, v114, v10
 v_mul_f32 v115, v115, v10
 v_cvt_pk_bf16_f32 v57, v114, v115
 v_sub_f32 v116, v116, v8
 v_sub_f32 v117, v117, v8
 v_cvt_pk_bf16_f32 v117, v116, v117
 v_lshlrev_b32 v116, 16, v117
 v_and_b32 v117, 0xffff0000, v117
 v_mul_f32 v116, v116, v10
 v_mul_f32 v117, v117, v10
 v_cvt_pk_bf16_f32 v58, v116, v117
 v_sub_f32 v118, v118, v8
 v_sub_f32 v119, v119, v8
 v_cvt_pk_bf16_f32 v119, v118, v119
 v_lshlrev_b32 v118, 16, v119
 v_and_b32 v119, 0xffff0000, v119
 v_mul_f32 v118, v118, v10
 v_mul_f32 v119, v119, v10
 v_cvt_pk_bf16_f32 v59, v118, v119
 v_sub_f32 v120, v120, v8
 v_sub_f32 v121, v121, v8
 v_cvt_pk_bf16_f32 v121, v120, v121
 v_lshlrev_b32 v120, 16, v121
 v_and_b32 v121, 0xffff0000, v121
 v_mul_f32 v120, v120, v10
 v_mul_f32 v121, v121, v10
 v_cvt_pk_bf16_f32 v60, v120, v121
 v_sub_f32 v122, v122, v8
 v_sub_f32 v123, v123, v8
 v_cvt_pk_bf16_f32 v123, v122, v123
 v_lshlrev_b32 v122, 16, v123
 v_and_b32 v123, 0xffff0000, v123
 v_mul_f32 v122, v122, v10
 v_mul_f32 v123, v123, v10
 v_cvt_pk_bf16_f32 v61, v122, v123
 v_sub_f32 v124, v124, v8
 v_sub_f32 v125, v125, v8
 v_cvt_pk_bf16_f32 v125, v124, v125
 v_lshlrev_b32 v124, 16, v125
 v_and_b32 v125, 0xffff0000, v125
 v_mul_f32 v124, v124, v10
 v_mul_f32 v125, v125, v10
 v_cvt_pk_bf16_f32 v62, v124, v125
 v_sub_f32 v126, v126, v8
 v_sub_f32 v127, v127, v8
 v_cvt_pk_bf16_f32 v127, v126, v127
 v_lshlrev_b32 v126, 16, v127
 v_and_b32 v127, 0xffff0000, v127
 v_mul_f32 v126, v126, v10
 v_mul_f32 v127, v127, v10
 v_cvt_pk_bf16_f32 v63, v126, v127
 buffer_store_dwordx4 v[32:35], v7, s[36:39], s35 offen sc1
 s_add_u32 s35, s35, 4096
 buffer_store_dwordx4 v[36:39], v7, s[36:39], s35 offen sc1
 s_add_u32 s35, s35, 4096
 buffer_store_dwordx4 v[40:43], v7, s[36:39], s35 offen sc1
 s_add_u32 s35, s35, 4096
 buffer_store_dwordx4 v[44:47], v7, s[36:39], s35 offen sc1
 s_add_u32 s35, s35, 4096
 buffer_store_dwordx4 v[48:51], v7, s[36:39], s35 offen sc1
 s_add_u32 s35, s35, 4096
 buffer_store_dwordx4 v[52:55], v7, s[36:39], s35 offen sc1
 s_add_u32 s35, s35, 4096
 buffer_store_dwordx4 v[56:59], v7, s[36:39], s35 offen sc1
 s_add_u32 s35, s35, 4096
 buffer_store_dwordx4 v[60:63], v7, s[36:39], s35 offen sc1
 s_add_u32 s35, s35, 4096
 v_mov_b32 v12, 36
 s_mov_b32 s3, 0
S0_init:
 global_load_dword v13, v12, s[30:31] sc1
 s_add_u32 s3, s3, 1
 s_cmp_gt_u32 s3, 131072
 s_cbranch_scc1 L_ABORT
 s_waitcnt vmcnt(0)
 v_readfirstlane_b32 s34, v13
 s_nop 0
 s_cmp_lt_u32 s34, 1
 s_cbranch_scc1 S0_init
 s_barrier
 s_cmp_lg_u32 s47, 0
 s_cbranch_scc1 S0_done
 v_mov_b32 v12, 0
 v_mov_b32 v13, 1
 s_lshl_b32 s3, s52, 2
 s_mov_b64 exec, 1
 buffer_store_dword v13, v12, s[36:39], s3 offen sc1
 s_mov_b64 exec, -1
S0_done:
L_noS0:
 s_sub_u32 s3, s72, 2
 s_lshr_b32 s41, s3, 1
 s_and_b32 s3, s3, 1
 s_lshl_b32 s3, s3, 3
 s_lshr_b32 s34, s40, 2
 s_add_u32 s42, s3, s34
 s_and_b32 s43, s40, 3
 s_mov_b32 s68, s10
 s_mov_b32 s69, s11
 s_cmp_eq_u32 s41, 1
 s_cselect_b32 s68, s12, s68
 s_cselect_b32 s69, s13, s69
 s_cmp_eq_u32 s41, 2
 s_cselect_b32 s68, s8, s68
 s_cselect_b32 s69, s9, s69
 s_mov_b32 s70, 0x400000
 s_mov_b32 s71, 0x20000
 s_lshl_b32 s67, s42, 9
 s_lshl_b32 s3, s47, 7
 s_add_u32 s67, s67, s3
 s_lshl_b32 s66, s47, 15
 v_and_b32 v20, 63, v0
 v_lshrrev_b32 v21, 3, v20
 v_and_b32 v22, 7, v20
 v_lshrrev_b32 v23, 4, v20
 v_and_b32 v24, 1, v23
 v_lshlrev_b32 v25, 2, v24
 v_xor_b32 v22, v22, v25
 v_lshlrev_b32 v22, 4, v22
 v_lshl_add_u32 v14, v21, 13, v22
 v_and_b32 v25, 15, v20
 v_lshrrev_b32 v26, 2, v25
 v_and_b32 v25, 3, v25
 v_lshrrev_b32 v27, 1, v23
 v_lshl_add_u32 v27, v27, 2, v26
 v_lshlrev_b32 v27, 7, v27
 v_lshrrev_b32 v26, 1, v26
 v_lshl_add_u32 v27, v26, 6, v27
 v_lshl_add_u32 v27, v24, 5, v27
 v_lshl_add_u32 v27, v25, 3, v27
 v_add_u32 v15, s66, v27
 v_xor_b32 v16, 64, v15
 s_add_u32 m0, s66, 0
 s_add_u32 s3, s67, 0
 buffer_load_dwordx4 v14, s[68:71], s3 offen lds
 s_add_u32 m0, s66, 1024
 s_add_u32 s3, s67, 65536
 buffer_load_dwordx4 v14, s[68:71], s3 offen lds
 s_add_u32 m0, s66, 2048
 s_add_u32 s3, s67, 131072
 buffer_load_dwordx4 v14, s[68:71], s3 offen lds
 s_add_u32 m0, s66, 3072
 s_add_u32 s3, s67, 196608
 buffer_load_dwordx4 v14, s[68:71], s3 offen lds
 s_add_u32 m0, s66, 4096
 s_add_u32 s3, s67, 262144
 buffer_load_dwordx4 v14, s[68:71], s3 offen lds
 s_add_u32 m0, s66, 5120
 s_add_u32 s3, s67, 327680
 buffer_load_dwordx4 v14, s[68:71], s3 offen lds
 s_add_u32 m0, s66, 6144
 s_add_u32 s3, s67, 393216
 buffer_load_dwordx4 v14, s[68:71], s3 offen lds
 s_add_u32 m0, s66, 7168
 s_add_u32 s3, s67, 458752
 buffer_load_dwordx4 v14, s[68:71], s3 offen lds
 s_add_u32 m0, s66, 8192
 s_add_u32 s3, s67, 524288
 buffer_load_dwordx4 v14, s[68:71], s3 offen lds
 s_add_u32 m0, s66, 9216
 s_add_u32 s3, s67, 589824
 buffer_load_dwordx4 v14, s[68:71], s3 offen lds
 s_add_u32 m0, s66, 10240
 s_add_u32 s3, s67, 655360
 buffer_load_dwordx4 v14, s[68:71], s3 offen lds
 s_add_u32 m0, s66, 11264
 s_add_u32 s3, s67, 720896
 buffer_load_dwordx4 v14, s[68:71], s3 offen lds
 s_add_u32 m0, s66, 12288
 s_add_u32 s3, s67, 786432
 buffer_load_dwordx4 v14, s[68:71], s3 offen lds
 s_add_u32 m0, s66, 13312
 s_add_u32 s3, s67, 851968
 buffer_load_dwordx4 v14, s[68:71], s3 offen lds
 s_add_u32 m0, s66, 14336
 s_add_u32 s3, s67, 917504
 buffer_load_dwordx4 v14, s[68:71], s3 offen lds
 s_add_u32 m0, s66, 15360
 s_add_u32 s3, s67, 983040
 buffer_load_dwordx4 v14, s[68:71], s3 offen lds
 s_add_u32 m0, s66, 16384
 s_add_u32 s3, s67, 1048576
 buffer_load_dwordx4 v14, s[68:71], s3 offen lds
 s_add_u32 m0, s66, 17408
 s_add_u32 s3, s67, 1114112
 buffer_load_dwordx4 v14, s[68:71], s3 offen lds
 s_add_u32 m0, s66, 18432
 s_add_u32 s3, s67, 1179648
 buffer_load_dwordx4 v14, s[68:71], s3 offen lds
 s_add_u32 m0, s66, 19456
 s_add_u32 s3, s67, 1245184
 buffer_load_dwordx4 v14, s[68:71], s3 offen lds
 s_add_u32 m0, s66, 20480
 s_add_u32 s3, s67, 1310720
 buffer_load_dwordx4 v14, s[68:71], s3 offen lds
 s_add_u32 m0, s66, 21504
 s_add_u32 s3, s67, 1376256
 buffer_load_dwordx4 v14, s[68:71], s3 offen lds
 s_add_u32 m0, s66, 22528
 s_add_u32 s3, s67, 1441792
 buffer_load_dwordx4 v14, s[68:71], s3 offen lds
 s_add_u32 m0, s66, 23552
 s_add_u32 s3, s67, 1507328
 buffer_load_dwordx4 v14, s[68:71], s3 offen lds
 s_add_u32 m0, s66, 24576
 s_add_u32 s3, s67, 1572864
 buffer_load_dwordx4 v14, s[68:71], s3 offen lds
 s_add_u32 m0, s66, 25600
 s_add_u32 s3, s67, 1638400
 buffer_load_dwordx4 v14, s[68:71], s3 offen lds
 s_add_u32 m0, s66, 26624
 s_add_u32 s3, s67, 1703936
 buffer_load_dwordx4 v14, s[68:71], s3 offen lds
 s_add_u32 m0, s66, 27648
 s_add_u32 s3, s67, 1769472
 buffer_load_dwordx4 v14, s[68:71], s3 offen lds
 s_add_u32 m0, s66, 28672
 s_add_u32 s3, s67, 1835008
 buffer_load_dwordx4 v14, s[68:71], s3 offen lds
 s_add_u32 m0, s66, 29696
 s_add_u32 s3, s67, 1900544
 buffer_load_dwordx4 v14, s[68:71], s3 offen lds
 s_add_u32 m0, s66, 30720
 s_add_u32 s3, s67, 1966080
 buffer_load_dwordx4 v14, s[68:71], s3 offen lds
 s_add_u32 m0, s66, 31744
 s_add_u32 s3, s67, 2031616
 buffer_load_dwordx4 v14, s[68:71], s3 offen lds
 s_waitcnt vmcnt(24)
 ds_read_b64_tr_b16 a[0:1], v15 offset:0
 ds_read_b64_tr_b16 a[2:3], v15 offset:1024
 ds_read_b64_tr_b16 a[4:5], v15 offset:2048
 ds_read_b64_tr_b16 a[6:7], v15 offset:3072
 ds_read_b64_tr_b16 a[8:9], v15 offset:4096
 ds_read_b64_tr_b16 a[10:11], v15 offset:5120
 ds_read_b64_tr_b16 a[12:13], v15 offset:6144
 ds_read_b64_tr_b16 a[14:15], v15 offset:7168
 s_waitcnt lgkmcnt(0)
 ds_read_b64_tr_b16 a[128:129], v16 offset:0
 ds_read_b64_tr_b16 a[130:131], v16 offset:1024
 ds_read_b64_tr_b16 a[132:133], v16 offset:2048
 ds_read_b64_tr_b16 a[134:135], v16 offset:3072
 ds_read_b64_tr_b16 a[136:137], v16 offset:4096
 ds_read_b64_tr_b16 a[138:139], v16 offset:5120
 ds_read_b64_tr_b16 a[140:141], v16 offset:6144
 ds_read_b64_tr_b16 a[142:143], v16 offset:7168
 s_waitcnt lgkmcnt(0)
 s_add_u32 m0, s66, 0
 s_add_u32 s3, s67, 2097152
 buffer_load_dwordx4 v14, s[68:71], s3 offen lds
 s_add_u32 m0, s66, 1024
 s_add_u32 s3, s67, 2162688
 buffer_load_dwordx4 v14, s[68:71], s3 offen lds
 s_add_u32 m0, s66, 2048
 s_add_u32 s3, s67, 2228224
 buffer_load_dwordx4 v14, s[68:71], s3 offen lds
 s_add_u32 m0, s66, 3072
 s_add_u32 s3, s67, 2293760
 buffer_load_dwordx4 v14, s[68:71], s3 offen lds
 s_add_u32 m0, s66, 4096
 s_add_u32 s3, s67, 2359296
 buffer_load_dwordx4 v14, s[68:71], s3 offen lds
 s_add_u32 m0, s66, 5120
 s_add_u32 s3, s67, 2424832
 buffer_load_dwordx4 v14, s[68:71], s3 offen lds
 s_add_u32 m0, s66, 6144
 s_add_u32 s3, s67, 2490368
 buffer_load_dwordx4 v14, s[68:71], s3 offen lds
 s_add_u32 m0, s66, 7168
 s_add_u32 s3, s67, 2555904
 buffer_load_dwordx4 v14, s[68:71], s3 offen lds
 s_waitcnt vmcnt(24)
 ds_read_b64_tr_b16 a[16:17], v15 offset:8192
 ds_read_b64_tr_b16 a[18:19], v15 offset:9216
 ds_read_b64_tr_b16 a[20:21], v15 offset:10240
 ds_read_b64_tr_b16 a[22:23], v15 offset:11264
 ds_read_b64_tr_b16 a[24:25], v15 offset:12288
 ds_read_b64_tr_b16 a[26:27], v15 offset:13312
 ds_read_b64_tr_b16 a[28:29], v15 offset:14336
 ds_read_b64_tr_b16 a[30:31], v15 offset:15360
 s_waitcnt lgkmcnt(0)
 ds_read_b64_tr_b16 a[144:145], v16 offset:8192
 ds_read_b64_tr_b16 a[146:147], v16 offset:9216
 ds_read_b64_tr_b16 a[148:149], v16 offset:10240
 ds_read_b64_tr_b16 a[150:151], v16 offset:11264
 ds_read_b64_tr_b16 a[152:153], v16 offset:12288
 ds_read_b64_tr_b16 a[154:155], v16 offset:13312
 ds_read_b64_tr_b16 a[156:157], v16 offset:14336
 ds_read_b64_tr_b16 a[158:159], v16 offset:15360
 s_waitcnt lgkmcnt(0)
 s_add_u32 m0, s66, 8192
 s_add_u32 s3, s67, 2621440
 buffer_load_dwordx4 v14, s[68:71], s3 offen lds
 s_add_u32 m0, s66, 9216
 s_add_u32 s3, s67, 2686976
 buffer_load_dwordx4 v14, s[68:71], s3 offen lds
 s_add_u32 m0, s66, 10240
 s_add_u32 s3, s67, 2752512
 buffer_load_dwordx4 v14, s[68:71], s3 offen lds
 s_add_u32 m0, s66, 11264
 s_add_u32 s3, s67, 2818048
 buffer_load_dwordx4 v14, s[68:71], s3 offen lds
 s_add_u32 m0, s66, 12288
 s_add_u32 s3, s67, 2883584
 buffer_load_dwordx4 v14, s[68:71], s3 offen lds
 s_add_u32 m0, s66, 13312
 s_add_u32 s3, s67, 2949120
 buffer_load_dwordx4 v14, s[68:71], s3 offen lds
 s_add_u32 m0, s66, 14336
 s_add_u32 s3, s67, 3014656
 buffer_load_dwordx4 v14, s[68:71], s3 offen lds
 s_add_u32 m0, s66, 15360
 s_add_u32 s3, s67, 3080192
 buffer_load_dwordx4 v14, s[68:71], s3 offen lds
 s_waitcnt vmcnt(24)
 ds_read_b64_tr_b16 a[32:33], v15 offset:16384
 ds_read_b64_tr_b16 a[34:35], v15 offset:17408
 ds_read_b64_tr_b16 a[36:37], v15 offset:18432
 ds_read_b64_tr_b16 a[38:39], v15 offset:19456
 ds_read_b64_tr_b16 a[40:41], v15 offset:20480
 ds_read_b64_tr_b16 a[42:43], v15 offset:21504
 ds_read_b64_tr_b16 a[44:45], v15 offset:22528
 ds_read_b64_tr_b16 a[46:47], v15 offset:23552
 s_waitcnt lgkmcnt(0)
 ds_read_b64_tr_b16 a[160:161], v16 offset:16384
 ds_read_b64_tr_b16 a[162:163], v16 offset:17408
 ds_read_b64_tr_b16 a[164:165], v16 offset:18432
 ds_read_b64_tr_b16 a[166:167], v16 offset:19456
 ds_read_b64_tr_b16 a[168:169], v16 offset:20480
 ds_read_b64_tr_b16 a[170:171], v16 offset:21504
 ds_read_b64_tr_b16 a[172:173], v16 offset:22528
 ds_read_b64_tr_b16 a[174:175], v16 offset:23552
 s_waitcnt lgkmcnt(0)
 s_add_u32 m0, s66, 16384
 s_add_u32 s3, s67, 3145728
 buffer_load_dwordx4 v14, s[68:71], s3 offen lds
 s_add_u32 m0, s66, 17408
 s_add_u32 s3, s67, 3211264
 buffer_load_dwordx4 v14, s[68:71], s3 offen lds
 s_add_u32 m0, s66, 18432
 s_add_u32 s3, s67, 3276800
 buffer_load_dwordx4 v14, s[68:71], s3 offen lds
 s_add_u32 m0, s66, 19456
 s_add_u32 s3, s67, 3342336
 buffer_load_dwordx4 v14, s[68:71], s3 offen lds
 s_add_u32 m0, s66, 20480
 s_add_u32 s3, s67, 3407872
 buffer_load_dwordx4 v14, s[68:71], s3 offen lds
 s_add_u32 m0, s66, 21504
 s_add_u32 s3, s67, 3473408
 buffer_load_dwordx4 v14, s[68:71], s3 offen lds
 s_add_u32 m0, s66, 22528
 s_add_u32 s3, s67, 3538944
 buffer_load_dwordx4 v14, s[68:71], s3 offen lds
 s_add_u32 m0, s66, 23552
 s_add_u32 s3, s67, 3604480
 buffer_load_dwordx4 v14, s[68:71], s3 offen lds
 s_waitcnt vmcnt(24)
 ds_read_b64_tr_b16 a[48:49], v15 offset:24576
 ds_read_b64_tr_b16 a[50:51], v15 offset:25600
 ds_read_b64_tr_b16 a[52:53], v15 offset:26624
 ds_read_b64_tr_b16 a[54:55], v15 offset:27648
 ds_read_b64_tr_b16 a[56:57], v15 offset:28672
 ds_read_b64_tr_b16 a[58:59], v15 offset:29696
 ds_read_b64_tr_b16 a[60:61], v15 offset:30720
 ds_read_b64_tr_b16 a[62:63], v15 offset:31744
 s_waitcnt lgkmcnt(0)
 ds_read_b64_tr_b16 a[176:177], v16 offset:24576
 ds_read_b64_tr_b16 a[178:179], v16 offset:25600
 ds_read_b64_tr_b16 a[180:181], v16 offset:26624
 ds_read_b64_tr_b16 a[182:183], v16 offset:27648
 ds_read_b64_tr_b16 a[184:185], v16 offset:28672
 ds_read_b64_tr_b16 a[186:187], v16 offset:29696
 ds_read_b64_tr_b16 a[188:189], v16 offset:30720
 ds_read_b64_tr_b16 a[190:191], v16 offset:31744
 s_waitcnt lgkmcnt(0)
 s_add_u32 m0, s66, 24576
 s_add_u32 s3, s67, 3670016
 buffer_load_dwordx4 v14, s[68:71], s3 offen lds
 s_add_u32 m0, s66, 25600
 s_add_u32 s3, s67, 3735552
 buffer_load_dwordx4 v14, s[68:71], s3 offen lds
 s_add_u32 m0, s66, 26624
 s_add_u32 s3, s67, 3801088
 buffer_load_dwordx4 v14, s[68:71], s3 offen lds
 s_add_u32 m0, s66, 27648
 s_add_u32 s3, s67, 3866624
 buffer_load_dwordx4 v14, s[68:71], s3 offen lds
 s_add_u32 m0, s66, 28672
 s_add_u32 s3, s67, 3932160
 buffer_load_dwordx4 v14, s[68:71], s3 offen lds
 s_add_u32 m0, s66, 29696
 s_add_u32 s3, s67, 3997696
 buffer_load_dwordx4 v14, s[68:71], s3 offen lds
 s_add_u32 m0, s66, 30720
 s_add_u32 s3, s67, 4063232
 buffer_load_dwordx4 v14, s[68:71], s3 offen lds
 s_add_u32 m0, s66, 31744
 s_add_u32 s3, s67, 4128768
 buffer_load_dwordx4 v14, s[68:71], s3 offen lds
 s_waitcnt vmcnt(24)
 ds_read_b64_tr_b16 a[64:65], v15 offset:0
 ds_read_b64_tr_b16 a[66:67], v15 offset:1024
 ds_read_b64_tr_b16 a[68:69], v15 offset:2048
 ds_read_b64_tr_b16 a[70:71], v15 offset:3072
 ds_read_b64_tr_b16 a[72:73], v15 offset:4096
 ds_read_b64_tr_b16 a[74:75], v15 offset:5120
 ds_read_b64_tr_b16 a[76:77], v15 offset:6144
 ds_read_b64_tr_b16 a[78:79], v15 offset:7168
 s_waitcnt lgkmcnt(0)
 ds_read_b64_tr_b16 a[192:193], v16 offset:0
 ds_read_b64_tr_b16 a[194:195], v16 offset:1024
 ds_read_b64_tr_b16 a[196:197], v16 offset:2048
 ds_read_b64_tr_b16 a[198:199], v16 offset:3072
 ds_read_b64_tr_b16 a[200:201], v16 offset:4096
 ds_read_b64_tr_b16 a[202:203], v16 offset:5120
 ds_read_b64_tr_b16 a[204:205], v16 offset:6144
 ds_read_b64_tr_b16 a[206:207], v16 offset:7168
 s_waitcnt lgkmcnt(0)
 s_waitcnt vmcnt(16)
 ds_read_b64_tr_b16 a[80:81], v15 offset:8192
 ds_read_b64_tr_b16 a[82:83], v15 offset:9216
 ds_read_b64_tr_b16 a[84:85], v15 offset:10240
 ds_read_b64_tr_b16 a[86:87], v15 offset:11264
 ds_read_b64_tr_b16 a[88:89], v15 offset:12288
 ds_read_b64_tr_b16 a[90:91], v15 offset:13312
 ds_read_b64_tr_b16 a[92:93], v15 offset:14336
 ds_read_b64_tr_b16 a[94:95], v15 offset:15360
 s_waitcnt lgkmcnt(0)
 ds_read_b64_tr_b16 a[208:209], v16 offset:8192
 ds_read_b64_tr_b16 a[210:211], v16 offset:9216
 ds_read_b64_tr_b16 a[212:213], v16 offset:10240
 ds_read_b64_tr_b16 a[214:215], v16 offset:11264
 ds_read_b64_tr_b16 a[216:217], v16 offset:12288
 ds_read_b64_tr_b16 a[218:219], v16 offset:13312
 ds_read_b64_tr_b16 a[220:221], v16 offset:14336
 ds_read_b64_tr_b16 a[222:223], v16 offset:15360
 s_waitcnt lgkmcnt(0)
 s_waitcnt vmcnt(8)
 ds_read_b64_tr_b16 a[96:97], v15 offset:16384
 ds_read_b64_tr_b16 a[98:99], v15 offset:17408
 ds_read_b64_tr_b16 a[100:101], v15 offset:18432
 ds_read_b64_tr_b16 a[102:103], v15 offset:19456
 ds_read_b64_tr_b16 a[104:105], v15 offset:20480
 ds_read_b64_tr_b16 a[106:107], v15 offset:21504
 ds_read_b64_tr_b16 a[108:109], v15 offset:22528
 ds_read_b64_tr_b16 a[110:111], v15 offset:23552
 s_waitcnt lgkmcnt(0)
 ds_read_b64_tr_b16 a[224:225], v16 offset:16384
 ds_read_b64_tr_b16 a[226:227], v16 offset:17408
 ds_read_b64_tr_b16 a[228:229], v16 offset:18432
 ds_read_b64_tr_b16 a[230:231], v16 offset:19456
 ds_read_b64_tr_b16 a[232:233], v16 offset:20480
 ds_read_b64_tr_b16 a[234:235], v16 offset:21504
 ds_read_b64_tr_b16 a[236:237], v16 offset:22528
 ds_read_b64_tr_b16 a[238:239], v16 offset:23552
 s_waitcnt lgkmcnt(0)
 s_waitcnt vmcnt(0)
 ds_read_b64_tr_b16 a[112:113], v15 offset:24576
 ds_read_b64_tr_b16 a[114:115], v15 offset:25600
 ds_read_b64_tr_b16 a[116:117], v15 offset:26624
 ds_read_b64_tr_b16 a[118:119], v15 offset:27648
 ds_read_b64_tr_b16 a[120:121], v15 offset:28672
 ds_read_b64_tr_b16 a[122:123], v15 offset:29696
 ds_read_b64_tr_b16 a[124:125], v15 offset:30720
 ds_read_b64_tr_b16 a[126:127], v15 offset:31744
 s_waitcnt lgkmcnt(0)
 ds_read_b64_tr_b16 a[240:241], v16 offset:24576
 ds_read_b64_tr_b16 a[242:243], v16 offset:25600
 ds_read_b64_tr_b16 a[244:245], v16 offset:26624
 ds_read_b64_tr_b16 a[246:247], v16 offset:27648
 ds_read_b64_tr_b16 a[248:249], v16 offset:28672
 ds_read_b64_tr_b16 a[250:251], v16 offset:29696
 ds_read_b64_tr_b16 a[252:253], v16 offset:30720
 ds_read_b64_tr_b16 a[254:255], v16 offset:31744
 s_waitcnt lgkmcnt(0)
 v_and_b32 v20, 63, v0
 v_lshlrev_b32 v10, 4, v20
 v_lshlrev_b32 v21, 2, v20
 v_mov_b32 v12, 0
 s_cmp_lg_u32 s47, 0
 s_cbranch_scc1 S1_xok
 v_mov_b32 v22, 36
 s_mov_b32 s3, 0
S1_init:
 global_load_dword v23, v22, s[30:31] sc1
 s_add_u32 s3, s3, 1
 s_cmp_gt_u32 s3, 131072
 s_cbranch_scc1 L_ABORT
 s_waitcnt vmcnt(0)
 v_readfirstlane_b32 s34, v23
 s_nop 0
 s_cmp_lt_u32 s34, 1
 s_cbranch_scc1 S1_init
 s_mov_b32 s3, 0
 s_branch S1_xn_go
S1_xn:
 s_sleep 1
S1_xn_go:
 buffer_load_dword v22, v21, s[36:39], 0 offen sc1
 s_add_u32 s3, s3, 1
 s_cmp_gt_u32 s3, 131072
 s_cbranch_scc1 L_ABORT
 s_waitcnt vmcnt(0)
 v_cmp_gt_u32 vcc, 1, v22
 s_cbranch_vccnz S1_xn
 buffer_inv sc1
 s_waitcnt vmcnt(0)
S1_xok:
 s_barrier
 s_lshl_b32 s3, s43, 15
 s_add_u32 s44, s3, 14680064
 s_mov_b32 s49, 0
 s_mov_b32 s50, 0x3e0293ee
 s_lshr_b32 s34, s47, 1
 s_lshl_b32 s35, s42, 1
 s_add_u32 s34, s34, s35
 s_lshl_b32 s35, s43, 5
 s_add_u32 s35, s35, s34
 s_and_b32 s51, s47, 1
 v_and_b32 v21, 15, v20
 v_lshlrev_b32 v21, 4, v21
 v_lshrrev_b32 v22, 5, v20
 v_lshl_add_u32 v21, v22, 8, v21
 v_bfe_u32 v22, v20, 4, 1
 s_add_u32 s3, s44, 0
 buffer_load_dwordx4 v[64:67], v10, s[36:39], s3 offen offset:0
 buffer_load_dwordx4 v[68:71], v10, s[36:39], s3 offen offset:1024
 buffer_load_dwordx4 v[72:75], v10, s[36:39], s3 offen offset:2048
 buffer_load_dwordx4 v[76:79], v10, s[36:39], s3 offen offset:3072
 s_add_u32 s3, s44, 4096
 buffer_load_dwordx4 v[80:83], v10, s[36:39], s3 offen offset:0
 buffer_load_dwordx4 v[84:87], v10, s[36:39], s3 offen offset:1024
 buffer_load_dwordx4 v[88:91], v10, s[36:39], s3 offen offset:2048
 buffer_load_dwordx4 v[92:95], v10, s[36:39], s3 offen offset:3072
 s_add_u32 s3, s44, 8192
 buffer_load_dwordx4 v[96:99], v10, s[36:39], s3 offen offset:0
 buffer_load_dwordx4 v[100:103], v10, s[36:39], s3 offen offset:1024
 buffer_load_dwordx4 v[104:107], v10, s[36:39], s3 offen offset:2048
 buffer_load_dwordx4 v[108:111], v10, s[36:39], s3 offen offset:3072
 s_add_u32 s3, s44, 12288
 buffer_load_dwordx4 v[112:115], v10, s[36:39], s3 offen offset:0
 buffer_load_dwordx4 v[116:119], v10, s[36:39], s3 offen offset:1024
 buffer_load_dwordx4 v[120:123], v10, s[36:39], s3 offen offset:2048
 buffer_load_dwordx4 v[124:127], v10, s[36:39], s3 offen offset:3072
 s_cmp_eq_u32 s41, 1
 s_cbranch_scc1 S1_V
 v_lshl_add_u32 v11, v22, 12, v21
 s_cmp_eq_u32 s41, 2
 s_cbranch_scc1 S1_Q
 s_lshl_b32 s46, s35, 14
 s_lshl_b32 s3, s51, 11
 s_add_u32 s46, s46, s3
 s_add_u32 s46, s46, 16777216
 s_lshl_b32 s48, s34, 6
 s_lshl_b32 s3, s43, 4
 s_add_u32 s48, s48, s3
 s_lshl_b32 s3, s51, 2
 s_add_u32 s48, s48, s3
 s_add_u32 s48, s48, 1024
 s_branch S1_LK
S1_Q:
 s_lshl_b32 s46, s35, 13
 s_lshl_b32 s3, s51, 11
 s_add_u32 s46, s46, s3
 s_add_u32 s46, s46, 50331648
 s_lshl_b32 s48, s34, 5
 s_lshl_b32 s3, s43, 3
 s_add_u32 s48, s48, s3
 s_lshl_b32 s3, s51, 2
 s_add_u32 s48, s48, s3
 s_add_u32 s48, s48, 3072
 s_branch S1_LQ
S1_V:
 v_lshl_add_u32 v11, v22, 10, v21
 s_lshl_b32 s46, s35, 14
 s_lshl_b32 s3, s51, 12
 s_add_u32 s46, s46, s3
 s_add_u32 s46, s46, 16785408
 s_lshl_b32 s48, s34, 6
 s_lshl_b32 s3, s43, 4
 s_add_u32 s48, s48, s3
 s_lshl_b32 s3, s51, 2
 s_add_u32 s48, s48, s3
 s_add_u32 s48, s48, 1032
 s_branch S1_LV
 .p2align 6
S1_LK:
 s_add_u32 s45, s44, 131072
 s_cmp_eq_u32 s49, 15
 s_cselect_b32 s45, s44, s45
 s_waitcnt vmcnt(15)
 v_mfma_f32_32x32x16_bf16 v[128:143], a[0:3], v[64:67], 0
 v_mfma_f32_32x32x16_bf16 v[144:159], a[128:131], v[64:67], 0
 s_add_u32 s3, s44, 16384
 buffer_load_dwordx4 v[64:67], v10, s[36:39], s3 offen offset:0
 s_waitcnt vmcnt(15)
 v_mfma_f32_32x32x16_bf16 v[128:143], a[4:7], v[68:71], v[128:143]
 v_mfma_f32_32x32x16_bf16 v[144:159], a[132:135], v[68:71], v[144:159]
 buffer_load_dwordx4 v[68:71], v10, s[36:39], s3 offen offset:1024
 s_waitcnt vmcnt(15)
 v_mfma_f32_32x32x16_bf16 v[128:143], a[8:11], v[72:75], v[128:143]
 v_mfma_f32_32x32x16_bf16 v[144:159], a[136:139], v[72:75], v[144:159]
 buffer_load_dwordx4 v[72:75], v10, s[36:39], s3 offen offset:2048
 s_waitcnt vmcnt(15)
 v_mfma_f32_32x32x16_bf16 v[128:143], a[12:15], v[76:79], v[128:143]
 v_mfma_f32_32x32x16_bf16 v[144:159], a[140:143], v[76:79], v[144:159]
 buffer_load_dwordx4 v[76:79], v10, s[36:39], s3 offen offset:3072
 s_waitcnt vmcnt(15)
 v_mfma_f32_32x32x16_bf16 v[128:143], a[16:19], v[80:83], v[128:143]
 v_mfma_f32_32x32x16_bf16 v[144:159], a[144:147], v[80:83], v[144:159]
 s_add_u32 s3, s44, 20480
 buffer_load_dwordx4 v[80:83], v10, s[36:39], s3 offen offset:0
 s_waitcnt vmcnt(15)
 v_mfma_f32_32x32x16_bf16 v[128:143], a[20:23], v[84:87], v[128:143]
 v_mfma_f32_32x32x16_bf16 v[144:159], a[148:151], v[84:87], v[144:159]
 buffer_load_dwordx4 v[84:87], v10, s[36:39], s3 offen offset:1024
 s_waitcnt vmcnt(15)
 v_mfma_f32_32x32x16_bf16 v[128:143], a[24:27], v[88:91], v[128:143]
 v_mfma_f32_32x32x16_bf16 v[144:159], a[152:155], v[88:91], v[144:159]
 buffer_load_dwordx4 v[88:91], v10, s[36:39], s3 offen offset:2048
 s_waitcnt vmcnt(15)
 v_mfma_f32_32x32x16_bf16 v[128:143], a[28:31], v[92:95], v[128:143]
 v_mfma_f32_32x32x16_bf16 v[144:159], a[156:159], v[92:95], v[144:159]
 buffer_load_dwordx4 v[92:95], v10, s[36:39], s3 offen offset:3072
 s_waitcnt vmcnt(15)
 v_mfma_f32_32x32x16_bf16 v[128:143], a[32:35], v[96:99], v[128:143]
 v_mfma_f32_32x32x16_bf16 v[144:159], a[160:163], v[96:99], v[144:159]
 s_add_u32 s3, s44, 24576
 buffer_load_dwordx4 v[96:99], v10, s[36:39], s3 offen offset:0
 s_waitcnt vmcnt(15)
 v_mfma_f32_32x32x16_bf16 v[128:143], a[36:39], v[100:103], v[128:143]
 v_mfma_f32_32x32x16_bf16 v[144:159], a[164:167], v[100:103], v[144:159]
 buffer_load_dwordx4 v[100:103], v10, s[36:39], s3 offen offset:1024
 s_waitcnt vmcnt(15)
 v_mfma_f32_32x32x16_bf16 v[128:143], a[40:43], v[104:107], v[128:143]
 v_mfma_f32_32x32x16_bf16 v[144:159], a[168:171], v[104:107], v[144:159]
 buffer_load_dwordx4 v[104:107], v10, s[36:39], s3 offen offset:2048
 s_waitcnt vmcnt(15)
 v_mfma_f32_32x32x16_bf16 v[128:143], a[44:47], v[108:111], v[128:143]
 v_mfma_f32_32x32x16_bf16 v[144:159], a[172:175], v[108:111], v[144:159]
 buffer_load_dwordx4 v[108:111], v10, s[36:39], s3 offen offset:3072
 s_waitcnt vmcnt(15)
 v_mfma_f32_32x32x16_bf16 v[128:143], a[48:51], v[112:115], v[128:143]
 v_mfma_f32_32x32x16_bf16 v[144:159], a[176:179], v[112:115], v[144:159]
 s_add_u32 s3, s44, 28672
 buffer_load_dwordx4 v[112:115], v10, s[36:39], s3 offen offset:0
 s_waitcnt vmcnt(15)
 v_mfma_f32_32x32x16_bf16 v[128:143], a[52:55], v[116:119], v[128:143]
 v_mfma_f32_32x32x16_bf16 v[144:159], a[180:183], v[116:119], v[144:159]
 buffer_load_dwordx4 v[116:119], v10, s[36:39], s3 offen offset:1024
 s_waitcnt vmcnt(15)
 v_mfma_f32_32x32x16_bf16 v[128:143], a[56:59], v[120:123], v[128:143]
 v_mfma_f32_32x32x16_bf16 v[144:159], a[184:187], v[120:123], v[144:159]
 buffer_load_dwordx4 v[120:123], v10, s[36:39], s3 offen offset:2048
 s_waitcnt vmcnt(15)
 v_mfma_f32_32x32x16_bf16 v[128:143], a[60:63], v[124:127], v[128:143]
 v_mfma_f32_32x32x16_bf16 v[144:159], a[188:191], v[124:127], v[144:159]
 buffer_load_dwordx4 v[124:127], v10, s[36:39], s3 offen offset:3072
 s_waitcnt vmcnt(15)
 v_mfma_f32_32x32x16_bf16 v[128:143], a[64:67], v[64:67], v[128:143]
 v_mfma_f32_32x32x16_bf16 v[144:159], a[192:195], v[64:67], v[144:159]
 s_add_u32 s3, s45, 0
 buffer_load_dwordx4 v[64:67], v10, s[36:39], s3 offen offset:0
 s_waitcnt vmcnt(15)
 v_mfma_f32_32x32x16_bf16 v[128:143], a[68:71], v[68:71], v[128:143]
 v_mfma_f32_32x32x16_bf16 v[144:159], a[196:199], v[68:71], v[144:159]
 buffer_load_dwordx4 v[68:71], v10, s[36:39], s3 offen offset:1024
 v_mov_b32 v13, s49
 s_mov_b64 exec, 1
 buffer_store_dword v13, v12, s[36:39], s48 offen sc1
 s_mov_b64 exec, -1
 s_waitcnt vmcnt(16)
 v_mfma_f32_32x32x16_bf16 v[128:143], a[72:75], v[72:75], v[128:143]
 v_mfma_f32_32x32x16_bf16 v[144:159], a[200:203], v[72:75], v[144:159]
 buffer_load_dwordx4 v[72:75], v10, s[36:39], s3 offen offset:2048
 s_waitcnt vmcnt(16)
 v_mfma_f32_32x32x16_bf16 v[128:143], a[76:79], v[76:79], v[128:143]
 v_mfma_f32_32x32x16_bf16 v[144:159], a[204:207], v[76:79], v[144:159]
 buffer_load_dwordx4 v[76:79], v10, s[36:39], s3 offen offset:3072
 s_waitcnt vmcnt(16)
 v_mfma_f32_32x32x16_bf16 v[128:143], a[80:83], v[80:83], v[128:143]
 v_mfma_f32_32x32x16_bf16 v[144:159], a[208:211], v[80:83], v[144:159]
 s_add_u32 s3, s45, 4096
 buffer_load_dwordx4 v[80:83], v10, s[36:39], s3 offen offset:0
 s_waitcnt vmcnt(16)
 v_mfma_f32_32x32x16_bf16 v[128:143], a[84:87], v[84:87], v[128:143]
 v_mfma_f32_32x32x16_bf16 v[144:159], a[212:215], v[84:87], v[144:159]
 buffer_load_dwordx4 v[84:87], v10, s[36:39], s3 offen offset:1024
 s_waitcnt vmcnt(16)
 v_mfma_f32_32x32x16_bf16 v[128:143], a[88:91], v[88:91], v[128:143]
 v_mfma_f32_32x32x16_bf16 v[144:159], a[216:219], v[88:91], v[144:159]
 buffer_load_dwordx4 v[88:91], v10, s[36:39], s3 offen offset:2048
 s_waitcnt vmcnt(16)
 v_mfma_f32_32x32x16_bf16 v[128:143], a[92:95], v[92:95], v[128:143]
 v_mfma_f32_32x32x16_bf16 v[144:159], a[220:223], v[92:95], v[144:159]
 buffer_load_dwordx4 v[92:95], v10, s[36:39], s3 offen offset:3072
 s_waitcnt vmcnt(16)
 v_mfma_f32_32x32x16_bf16 v[128:143], a[96:99], v[96:99], v[128:143]
 v_mfma_f32_32x32x16_bf16 v[144:159], a[224:227], v[96:99], v[144:159]
 s_add_u32 s3, s45, 8192
 buffer_load_dwordx4 v[96:99], v10, s[36:39], s3 offen offset:0
 s_waitcnt vmcnt(16)
 v_mfma_f32_32x32x16_bf16 v[128:143], a[100:103], v[100:103], v[128:143]
 v_mfma_f32_32x32x16_bf16 v[144:159], a[228:231], v[100:103], v[144:159]
 buffer_load_dwordx4 v[100:103], v10, s[36:39], s3 offen offset:1024
 s_waitcnt vmcnt(16)
 v_mfma_f32_32x32x16_bf16 v[128:143], a[104:107], v[104:107], v[128:143]
 v_mfma_f32_32x32x16_bf16 v[144:159], a[232:235], v[104:107], v[144:159]
 buffer_load_dwordx4 v[104:107], v10, s[36:39], s3 offen offset:2048
 s_waitcnt vmcnt(16)
 v_mfma_f32_32x32x16_bf16 v[128:143], a[108:111], v[108:111], v[128:143]
 v_mfma_f32_32x32x16_bf16 v[144:159], a[236:239], v[108:111], v[144:159]
 buffer_load_dwordx4 v[108:111], v10, s[36:39], s3 offen offset:3072
 s_waitcnt vmcnt(16)
 v_mfma_f32_32x32x16_bf16 v[128:143], a[112:115], v[112:115], v[128:143]
 v_mfma_f32_32x32x16_bf16 v[144:159], a[240:243], v[112:115], v[144:159]
 s_add_u32 s3, s45, 12288
 buffer_load_dwordx4 v[112:115], v10, s[36:39], s3 offen offset:0
 s_waitcnt vmcnt(16)
 v_mfma_f32_32x32x16_bf16 v[128:143], a[116:119], v[116:119], v[128:143]
 v_mfma_f32_32x32x16_bf16 v[144:159], a[244:247], v[116:119], v[144:159]
 buffer_load_dwordx4 v[116:119], v10, s[36:39], s3 offen offset:1024
 s_waitcnt vmcnt(16)
 v_mfma_f32_32x32x16_bf16 v[128:143], a[120:123], v[120:123], v[128:143]
 v_mfma_f32_32x32x16_bf16 v[144:159], a[248:251], v[120:123], v[144:159]
 buffer_load_dwordx4 v[120:123], v10, s[36:39], s3 offen offset:2048
 s_waitcnt vmcnt(16)
 v_mfma_f32_32x32x16_bf16 v[128:143], a[124:127], v[124:127], v[128:143]
 v_mfma_f32_32x32x16_bf16 v[144:159], a[252:255], v[124:127], v[144:159]
 buffer_load_dwordx4 v[124:127], v10, s[36:39], s3 offen offset:3072
 s_nop 2
 v_cvt_pk_bf16_f32 v160, v128, v129
 v_cvt_pk_bf16_f32 v161, v130, v131
 v_cvt_pk_bf16_f32 v162, v132, v133
 v_cvt_pk_bf16_f32 v163, v134, v135
 buffer_store_dwordx4 v[160:163], v11, s[36:39], s46 offen offset:0 sc1
 v_cvt_pk_bf16_f32 v164, v136, v137
 v_cvt_pk_bf16_f32 v165, v138, v139
 v_cvt_pk_bf16_f32 v166, v140, v141
 v_cvt_pk_bf16_f32 v167, v142, v143
 buffer_store_dwordx4 v[164:167], v11, s[36:39], s46 offen offset:512 sc1
 v_cvt_pk_bf16_f32 v168, v144, v145
 v_cvt_pk_bf16_f32 v169, v146, v147
 v_cvt_pk_bf16_f32 v170, v148, v149
 v_cvt_pk_bf16_f32 v171, v150, v151
 buffer_store_dwordx4 v[168:171], v11, s[36:39], s46 offen offset:1024 sc1
 v_cvt_pk_bf16_f32 v172, v152, v153
 v_cvt_pk_bf16_f32 v173, v154, v155
 v_cvt_pk_bf16_f32 v174, v156, v157
 v_cvt_pk_bf16_f32 v175, v158, v159
 buffer_store_dwordx4 v[172:175], v11, s[36:39], s46 offen offset:1536 sc1
 s_mov_b32 s44, s45
 s_add_u32 s46, s46, 2097152
 s_add_u32 s49, s49, 1
 s_cmp_lt_u32 s49, 16
 s_cbranch_scc1 S1_LK
 s_branch S1_END
 .p2align 6
S1_LQ:
 s_add_u32 s45, s44, 131072
 s_cmp_eq_u32 s49, 15
 s_cselect_b32 s45, s44, s45
 s_waitcnt vmcnt(15)
 v_mfma_f32_32x32x16_bf16 v[128:143], a[0:3], v[64:67], 0
 v_mfma_f32_32x32x16_bf16 v[144:159], a[128:131], v[64:67], 0
 s_add_u32 s3, s44, 16384
 buffer_load_dwordx4 v[64:67], v10, s[36:39], s3 offen offset:0
 s_waitcnt vmcnt(15)
 v_mfma_f32_32x32x16_bf16 v[128:143], a[4:7], v[68:71], v[128:143]
 v_mfma_f32_32x32x16_bf16 v[144:159], a[132:135], v[68:71], v[144:159]
 buffer_load_dwordx4 v[68:71], v10, s[36:39], s3 offen offset:1024
 s_waitcnt vmcnt(15)
 v_mfma_f32_32x32x16_bf16 v[128:143], a[8:11], v[72:75], v[128:143]
 v_mfma_f32_32x32x16_bf16 v[144:159], a[136:139], v[72:75], v[144:159]
 buffer_load_dwordx4 v[72:75], v10, s[36:39], s3 offen offset:2048
 s_waitcnt vmcnt(15)
 v_mfma_f32_32x32x16_bf16 v[128:143], a[12:15], v[76:79], v[128:143]
 v_mfma_f32_32x32x16_bf16 v[144:159], a[140:143], v[76:79], v[144:159]
 buffer_load_dwordx4 v[76:79], v10, s[36:39], s3 offen offset:3072
 s_waitcnt vmcnt(15)
 v_mfma_f32_32x32x16_bf16 v[128:143], a[16:19], v[80:83], v[128:143]
 v_mfma_f32_32x32x16_bf16 v[144:159], a[144:147], v[80:83], v[144:159]
 s_add_u32 s3, s44, 20480
 buffer_load_dwordx4 v[80:83], v10, s[36:39], s3 offen offset:0
 s_waitcnt vmcnt(15)
 v_mfma_f32_32x32x16_bf16 v[128:143], a[20:23], v[84:87], v[128:143]
 v_mfma_f32_32x32x16_bf16 v[144:159], a[148:151], v[84:87], v[144:159]
 buffer_load_dwordx4 v[84:87], v10, s[36:39], s3 offen offset:1024
 s_waitcnt vmcnt(15)
 v_mfma_f32_32x32x16_bf16 v[128:143], a[24:27], v[88:91], v[128:143]
 v_mfma_f32_32x32x16_bf16 v[144:159], a[152:155], v[88:91], v[144:159]
 buffer_load_dwordx4 v[88:91], v10, s[36:39], s3 offen offset:2048
 s_waitcnt vmcnt(15)
 v_mfma_f32_32x32x16_bf16 v[128:143], a[28:31], v[92:95], v[128:143]
 v_mfma_f32_32x32x16_bf16 v[144:159], a[156:159], v[92:95], v[144:159]
 buffer_load_dwordx4 v[92:95], v10, s[36:39], s3 offen offset:3072
 s_waitcnt vmcnt(15)
 v_mfma_f32_32x32x16_bf16 v[128:143], a[32:35], v[96:99], v[128:143]
 v_mfma_f32_32x32x16_bf16 v[144:159], a[160:163], v[96:99], v[144:159]
 s_add_u32 s3, s44, 24576
 buffer_load_dwordx4 v[96:99], v10, s[36:39], s3 offen offset:0
 s_waitcnt vmcnt(15)
 v_mfma_f32_32x32x16_bf16 v[128:143], a[36:39], v[100:103], v[128:143]
 v_mfma_f32_32x32x16_bf16 v[144:159], a[164:167], v[100:103], v[144:159]
 buffer_load_dwordx4 v[100:103], v10, s[36:39], s3 offen offset:1024
 s_waitcnt vmcnt(15)
 v_mfma_f32_32x32x16_bf16 v[128:143], a[40:43], v[104:107], v[128:143]
 v_mfma_f32_32x32x16_bf16 v[144:159], a[168:171], v[104:107], v[144:159]
 buffer_load_dwordx4 v[104:107], v10, s[36:39], s3 offen offset:2048
 s_waitcnt vmcnt(15)
 v_mfma_f32_32x32x16_bf16 v[128:143], a[44:47], v[108:111], v[128:143]
 v_mfma_f32_32x32x16_bf16 v[144:159], a[172:175], v[108:111], v[144:159]
 buffer_load_dwordx4 v[108:111], v10, s[36:39], s3 offen offset:3072
 s_waitcnt vmcnt(15)
 v_mfma_f32_32x32x16_bf16 v[128:143], a[48:51], v[112:115], v[128:143]
 v_mfma_f32_32x32x16_bf16 v[144:159], a[176:179], v[112:115], v[144:159]
 s_add_u32 s3, s44, 28672
 buffer_load_dwordx4 v[112:115], v10, s[36:39], s3 offen offset:0
 s_waitcnt vmcnt(15)
 v_mfma_f32_32x32x16_bf16 v[128:143], a[52:55], v[116:119], v[128:143]
 v_mfma_f32_32x32x16_bf16 v[144:159], a[180:183], v[116:119], v[144:159]
 buffer_load_dwordx4 v[116:119], v10, s[36:39], s3 offen offset:1024
 s_waitcnt vmcnt(15)
 v_mfma_f32_32x32x16_bf16 v[128:143], a[56:59], v[120:123], v[128:143]
 v_mfma_f32_32x32x16_bf16 v[144:159], a[184:187], v[120:123], v[144:159]
 buffer_load_dwordx4 v[120:123], v10, s[36:39], s3 offen offset:2048
 s_waitcnt vmcnt(15)
 v_mfma_f32_32x32x16_bf16 v[128:143], a[60:63], v[124:127], v[128:143]
 v_mfma_f32_32x32x16_bf16 v[144:159], a[188:191], v[124:127], v[144:159]
 buffer_load_dwordx4 v[124:127], v10, s[36:39], s3 offen offset:3072
 s_waitcnt vmcnt(15)
 v_mfma_f32_32x32x16_bf16 v[128:143], a[64:67], v[64:67], v[128:143]
 v_mfma_f32_32x32x16_bf16 v[144:159], a[192:195], v[64:67], v[144:159]
 s_add_u32 s3, s45, 0
 buffer_load_dwordx4 v[64:67], v10, s[36:39], s3 offen offset:0
 s_waitcnt vmcnt(15)
 v_mfma_f32_32x32x16_bf16 v[128:143], a[68:71], v[68:71], v[128:143]
 v_mfma_f32_32x32x16_bf16 v[144:159], a[196:199], v[68:71], v[144:159]
 buffer_load_dwordx4 v[68:71], v10, s[36:39], s3 offen offset:1024
 v_mov_b32 v13, s49
 s_mov_b64 exec, 1
 buffer_store_dword v13, v12, s[36:39], s48 offen sc1
 s_mov_b64 exec, -1
 s_waitcnt vmcnt(16)
 v_mfma_f32_32x32x16_bf16 v[128:143], a[72:75], v[72:75], v[128:143]
 v_mfma_f32_32x32x16_bf16 v[144:159], a[200:203], v[72:75], v[144:159]
 buffer_load_dwordx4 v[72:75], v10, s[36:39], s3 offen offset:2048
 s_waitcnt vmcnt(16)
 v_mfma_f32_32x32x16_bf16 v[128:143], a[76:79], v[76:79], v[128:143]
 v_mfma_f32_32x32x16_bf16 v[144:159], a[204:207], v[76:79], v[144:159]
 buffer_load_dwordx4 v[76:79], v10, s[36:39], s3 offen offset:3072
 s_waitcnt vmcnt(16)
 v_mfma_f32_32x32x16_bf16 v[128:143], a[80:83], v[80:83], v[128:143]
 v_mfma_f32_32x32x16_bf16 v[144:159], a[208:211], v[80:83], v[144:159]
 s_add_u32 s3, s45, 4096
 buffer_load_dwordx4 v[80:83], v10, s[36:39], s3 offen offset:0
 s_waitcnt vmcnt(16)
 v_mfma_f32_32x32x16_bf16 v[128:143], a[84:87], v[84:87], v[128:143]
 v_mfma_f32_32x32x16_bf16 v[144:159], a[212:215], v[84:87], v[144:159]
 buffer_load_dwordx4 v[84:87], v10, s[36:39], s3 offen offset:1024
 s_waitcnt vmcnt(16)
 v_mfma_f32_32x32x16_bf16 v[128:143], a[88:91], v[88:91], v[128:143]
 v_mfma_f32_32x32x16_bf16 v[144:159], a[216:219], v[88:91], v[144:159]
 buffer_load_dwordx4 v[88:91], v10, s[36:39], s3 offen offset:2048
 s_waitcnt vmcnt(16)
 v_mfma_f32_32x32x16_bf16 v[128:143], a[92:95], v[92:95], v[128:143]
 v_mfma_f32_32x32x16_bf16 v[144:159], a[220:223], v[92:95], v[144:159]
 buffer_load_dwordx4 v[92:95], v10, s[36:39], s3 offen offset:3072
 s_waitcnt vmcnt(16)
 v_mfma_f32_32x32x16_bf16 v[128:143], a[96:99], v[96:99], v[128:143]
 v_mfma_f32_32x32x16_bf16 v[144:159], a[224:227], v[96:99], v[144:159]
 s_add_u32 s3, s45, 8192
 buffer_load_dwordx4 v[96:99], v10, s[36:39], s3 offen offset:0
 s_waitcnt vmcnt(16)
 v_mfma_f32_32x32x16_bf16 v[128:143], a[100:103], v[100:103], v[128:143]
 v_mfma_f32_32x32x16_bf16 v[144:159], a[228:231], v[100:103], v[144:159]
 buffer_load_dwordx4 v[100:103], v10, s[36:39], s3 offen offset:1024
 s_waitcnt vmcnt(16)
 v_mfma_f32_32x32x16_bf16 v[128:143], a[104:107], v[104:107], v[128:143]
 v_mfma_f32_32x32x16_bf16 v[144:159], a[232:235], v[104:107], v[144:159]
 buffer_load_dwordx4 v[104:107], v10, s[36:39], s3 offen offset:2048
 s_waitcnt vmcnt(16)
 v_mfma_f32_32x32x16_bf16 v[128:143], a[108:111], v[108:111], v[128:143]
 v_mfma_f32_32x32x16_bf16 v[144:159], a[236:239], v[108:111], v[144:159]
 buffer_load_dwordx4 v[108:111], v10, s[36:39], s3 offen offset:3072
 s_waitcnt vmcnt(16)
 v_mfma_f32_32x32x16_bf16 v[128:143], a[112:115], v[112:115], v[128:143]
 v_mfma_f32_32x32x16_bf16 v[144:159], a[240:243], v[112:115], v[144:159]
 s_add_u32 s3, s45, 12288
 buffer_load_dwordx4 v[112:115], v10, s[36:39], s3 offen offset:0
 s_waitcnt vmcnt(16)
 v_mfma_f32_32x32x16_bf16 v[128:143], a[116:119], v[116:119], v[128:143]
 v_mfma_f32_32x32x16_bf16 v[144:159], a[244:247], v[116:119], v[144:159]
 buffer_load_dwordx4 v[116:119], v10, s[36:39], s3 offen offset:1024
 s_waitcnt vmcnt(16)
 v_mfma_f32_32x32x16_bf16 v[128:143], a[120:123], v[120:123], v[128:143]
 v_mfma_f32_32x32x16_bf16 v[144:159], a[248:251], v[120:123], v[144:159]
 buffer_load_dwordx4 v[120:123], v10, s[36:39], s3 offen offset:2048
 s_waitcnt vmcnt(16)
 v_mfma_f32_32x32x16_bf16 v[128:143], a[124:127], v[124:127], v[128:143]
 v_mfma_f32_32x32x16_bf16 v[144:159], a[252:255], v[124:127], v[144:159]
 buffer_load_dwordx4 v[124:127], v10, s[36:39], s3 offen offset:3072
 s_nop 2
 v_cvt_pk_bf16_f32 v160, v128, v129
 v_cvt_pk_bf16_f32 v161, v130, v131
 v_cvt_pk_bf16_f32 v162, v132, v133
 v_cvt_pk_bf16_f32 v163, v134, v135
 buffer_store_dwordx4 v[160:163], v11, s[36:39], s46 offen offset:0 sc1
 v_cvt_pk_bf16_f32 v164, v136, v137
 v_cvt_pk_bf16_f32 v165, v138, v139
 v_cvt_pk_bf16_f32 v166, v140, v141
 v_cvt_pk_bf16_f32 v167, v142, v143
 buffer_store_dwordx4 v[164:167], v11, s[36:39], s46 offen offset:512 sc1
 v_cvt_pk_bf16_f32 v168, v144, v145
 v_cvt_pk_bf16_f32 v169, v146, v147
 v_cvt_pk_bf16_f32 v170, v148, v149
 v_cvt_pk_bf16_f32 v171, v150, v151
 buffer_store_dwordx4 v[168:171], v11, s[36:39], s46 offen offset:1024 sc1
 v_cvt_pk_bf16_f32 v172, v152, v153
 v_cvt_pk_bf16_f32 v173, v154, v155
 v_cvt_pk_bf16_f32 v174, v156, v157
 v_cvt_pk_bf16_f32 v175, v158, v159
 buffer_store_dwordx4 v[172:175], v11, s[36:39], s46 offen offset:1536 sc1
 s_mov_b32 s44, s45
 s_add_u32 s46, s46, 1048576
 s_add_u32 s49, s49, 1
 s_cmp_lt_u32 s49, 16
 s_cbranch_scc1 S1_LQ
 s_branch S1_END
 .p2align 6
S1_LV:
 s_add_u32 s45, s44, 131072
 s_cmp_eq_u32 s49, 15
 s_cselect_b32 s45, s44, s45
 s_waitcnt vmcnt(15)
 v_mfma_f32_32x32x16_bf16 v[128:143], v[64:67], a[0:3], 0
 v_mfma_f32_32x32x16_bf16 v[144:159], v[64:67], a[128:131], 0
 s_add_u32 s3, s44, 16384
 buffer_load_dwordx4 v[64:67], v10, s[36:39], s3 offen offset:0
 s_waitcnt vmcnt(15)
 v_mfma_f32_32x32x16_bf16 v[128:143], v[68:71], a[4:7], v[128:143]
 v_mfma_f32_32x32x16_bf16 v[144:159], v[68:71], a[132:135], v[144:159]
 buffer_load_dwordx4 v[68:71], v10, s[36:39], s3 offen offset:1024
 s_waitcnt vmcnt(15)
 v_mfma_f32_32x32x16_bf16 v[128:143], v[72:75], a[8:11], v[128:143]
 v_mfma_f32_32x32x16_bf16 v[144:159], v[72:75], a[136:139], v[144:159]
 buffer_load_dwordx4 v[72:75], v10, s[36:39], s3 offen offset:2048
 s_waitcnt vmcnt(15)
 v_mfma_f32_32x32x16_bf16 v[128:143], v[76:79], a[12:15], v[128:143]
 v_mfma_f32_32x32x16_bf16 v[144:159], v[76:79], a[140:143], v[144:159]
 buffer_load_dwordx4 v[76:79], v10, s[36:39], s3 offen offset:3072
 s_waitcnt vmcnt(15)
 v_mfma_f32_32x32x16_bf16 v[128:143], v[80:83], a[16:19], v[128:143]
 v_mfma_f32_32x32x16_bf16 v[144:159], v[80:83], a[144:147], v[144:159]
 s_add_u32 s3, s44, 20480
 buffer_load_dwordx4 v[80:83], v10, s[36:39], s3 offen offset:0
 s_waitcnt vmcnt(15)
 v_mfma_f32_32x32x16_bf16 v[128:143], v[84:87], a[20:23], v[128:143]
 v_mfma_f32_32x32x16_bf16 v[144:159], v[84:87], a[148:151], v[144:159]
 buffer_load_dwordx4 v[84:87], v10, s[36:39], s3 offen offset:1024
 s_waitcnt vmcnt(15)
 v_mfma_f32_32x32x16_bf16 v[128:143], v[88:91], a[24:27], v[128:143]
 v_mfma_f32_32x32x16_bf16 v[144:159], v[88:91], a[152:155], v[144:159]
 buffer_load_dwordx4 v[88:91], v10, s[36:39], s3 offen offset:2048
 s_waitcnt vmcnt(15)
 v_mfma_f32_32x32x16_bf16 v[128:143], v[92:95], a[28:31], v[128:143]
 v_mfma_f32_32x32x16_bf16 v[144:159], v[92:95], a[156:159], v[144:159]
 buffer_load_dwordx4 v[92:95], v10, s[36:39], s3 offen offset:3072
 s_waitcnt vmcnt(15)
 v_mfma_f32_32x32x16_bf16 v[128:143], v[96:99], a[32:35], v[128:143]
 v_mfma_f32_32x32x16_bf16 v[144:159], v[96:99], a[160:163], v[144:159]
 s_add_u32 s3, s44, 24576
 buffer_load_dwordx4 v[96:99], v10, s[36:39], s3 offen offset:0
 s_waitcnt vmcnt(15)
 v_mfma_f32_32x32x16_bf16 v[128:143], v[100:103], a[36:39], v[128:143]
 v_mfma_f32_32x32x16_bf16 v[144:159], v[100:103], a[164:167], v[144:159]
 buffer_load_dwordx4 v[100:103], v10, s[36:39], s3 offen offset:1024
 s_waitcnt vmcnt(15)
 v_mfma_f32_32x32x16_bf16 v[128:143], v[104:107], a[40:43], v[128:143]
 v_mfma_f32_32x32x16_bf16 v[144:159], v[104:107], a[168:171], v[144:159]
 buffer_load_dwordx4 v[104:107], v10, s[36:39], s3 offen offset:2048
 s_waitcnt vmcnt(15)
 v_mfma_f32_32x32x16_bf16 v[128:143], v[108:111], a[44:47], v[128:143]
 v_mfma_f32_32x32x16_bf16 v[144:159], v[108:111], a[172:175], v[144:159]
 buffer_load_dwordx4 v[108:111], v10, s[36:39], s3 offen offset:3072
 s_waitcnt vmcnt(15)
 v_mfma_f32_32x32x16_bf16 v[128:143], v[112:115], a[48:51], v[128:143]
 v_mfma_f32_32x32x16_bf16 v[144:159], v[112:115], a[176:179], v[144:159]
 s_add_u32 s3, s44, 28672
 buffer_load_dwordx4 v[112:115], v10, s[36:39], s3 offen offset:0
 s_waitcnt vmcnt(15)
 v_mfma_f32_32x32x16_bf16 v[128:143], v[116:119], a[52:55], v[128:143]
 v_mfma_f32_32x32x16_bf16 v[144:159], v[116:119], a[180:183], v[144:159]
 buffer_load_dwordx4 v[116:119], v10, s[36:39], s3 offen offset:1024
 s_waitcnt vmcnt(15)
 v_mfma_f32_32x32x16_bf16 v[128:143], v[120:123], a[56:59], v[128:143]
 v_mfma_f32_32x32x16_bf16 v[144:159], v[120:123], a[184:187], v[144:159]
 buffer_load_dwordx4 v[120:123], v10, s[36:39], s3 offen offset:2048
 s_waitcnt vmcnt(15)
 v_mfma_f32_32x32x16_bf16 v[128:143], v[124:127], a[60:63], v[128:143]
 v_mfma_f32_32x32x16_bf16 v[144:159], v[124:127], a[188:191], v[144:159]
 buffer_load_dwordx4 v[124:127], v10, s[36:39], s3 offen offset:3072
 s_waitcnt vmcnt(15)
 v_mfma_f32_32x32x16_bf16 v[128:143], v[64:67], a[64:67], v[128:143]
 v_mfma_f32_32x32x16_bf16 v[144:159], v[64:67], a[192:195], v[144:159]
 s_add_u32 s3, s45, 0
 buffer_load_dwordx4 v[64:67], v10, s[36:39], s3 offen offset:0
 s_waitcnt vmcnt(15)
 v_mfma_f32_32x32x16_bf16 v[128:143], v[68:71], a[68:71], v[128:143]
 v_mfma_f32_32x32x16_bf16 v[144:159], v[68:71], a[196:199], v[144:159]
 buffer_load_dwordx4 v[68:71], v10, s[36:39], s3 offen offset:1024
 v_mov_b32 v13, s49
 s_mov_b64 exec, 1
 buffer_store_dword v13, v12, s[36:39], s48 offen sc1
 s_mov_b64 exec, -1
 s_waitcnt vmcnt(16)
 v_mfma_f32_32x32x16_bf16 v[128:143], v[72:75], a[72:75], v[128:143]
 v_mfma_f32_32x32x16_bf16 v[144:159], v[72:75], a[200:203], v[144:159]
 buffer_load_dwordx4 v[72:75], v10, s[36:39], s3 offen offset:2048
 s_waitcnt vmcnt(16)
 v_mfma_f32_32x32x16_bf16 v[128:143], v[76:79], a[76:79], v[128:143]
 v_mfma_f32_32x32x16_bf16 v[144:159], v[76:79], a[204:207], v[144:159]
 buffer_load_dwordx4 v[76:79], v10, s[36:39], s3 offen offset:3072
 s_waitcnt vmcnt(16)
 v_mfma_f32_32x32x16_bf16 v[128:143], v[80:83], a[80:83], v[128:143]
 v_mfma_f32_32x32x16_bf16 v[144:159], v[80:83], a[208:211], v[144:159]
 s_add_u32 s3, s45, 4096
 buffer_load_dwordx4 v[80:83], v10, s[36:39], s3 offen offset:0
 s_waitcnt vmcnt(16)
 v_mfma_f32_32x32x16_bf16 v[128:143], v[84:87], a[84:87], v[128:143]
 v_mfma_f32_32x32x16_bf16 v[144:159], v[84:87], a[212:215], v[144:159]
 buffer_load_dwordx4 v[84:87], v10, s[36:39], s3 offen offset:1024
 s_waitcnt vmcnt(16)
 v_mfma_f32_32x32x16_bf16 v[128:143], v[88:91], a[88:91], v[128:143]
 v_mfma_f32_32x32x16_bf16 v[144:159], v[88:91], a[216:219], v[144:159]
 buffer_load_dwordx4 v[88:91], v10, s[36:39], s3 offen offset:2048
 s_waitcnt vmcnt(16)
 v_mfma_f32_32x32x16_bf16 v[128:143], v[92:95], a[92:95], v[128:143]
 v_mfma_f32_32x32x16_bf16 v[144:159], v[92:95], a[220:223], v[144:159]
 buffer_load_dwordx4 v[92:95], v10, s[36:39], s3 offen offset:3072
 s_waitcnt vmcnt(16)
 v_mfma_f32_32x32x16_bf16 v[128:143], v[96:99], a[96:99], v[128:143]
 v_mfma_f32_32x32x16_bf16 v[144:159], v[96:99], a[224:227], v[144:159]
 s_add_u32 s3, s45, 8192
 buffer_load_dwordx4 v[96:99], v10, s[36:39], s3 offen offset:0
 s_waitcnt vmcnt(16)
 v_mfma_f32_32x32x16_bf16 v[128:143], v[100:103], a[100:103], v[128:143]
 v_mfma_f32_32x32x16_bf16 v[144:159], v[100:103], a[228:231], v[144:159]
 buffer_load_dwordx4 v[100:103], v10, s[36:39], s3 offen offset:1024
 s_waitcnt vmcnt(16)
 v_mfma_f32_32x32x16_bf16 v[128:143], v[104:107], a[104:107], v[128:143]
 v_mfma_f32_32x32x16_bf16 v[144:159], v[104:107], a[232:235], v[144:159]
 buffer_load_dwordx4 v[104:107], v10, s[36:39], s3 offen offset:2048
 s_waitcnt vmcnt(16)
 v_mfma_f32_32x32x16_bf16 v[128:143], v[108:111], a[108:111], v[128:143]
 v_mfma_f32_32x32x16_bf16 v[144:159], v[108:111], a[236:239], v[144:159]
 buffer_load_dwordx4 v[108:111], v10, s[36:39], s3 offen offset:3072
 s_waitcnt vmcnt(16)
 v_mfma_f32_32x32x16_bf16 v[128:143], v[112:115], a[112:115], v[128:143]
 v_mfma_f32_32x32x16_bf16 v[144:159], v[112:115], a[240:243], v[144:159]
 s_add_u32 s3, s45, 12288
 buffer_load_dwordx4 v[112:115], v10, s[36:39], s3 offen offset:0
 s_waitcnt vmcnt(16)
 v_mfma_f32_32x32x16_bf16 v[128:143], v[116:119], a[116:119], v[128:143]
 v_mfma_f32_32x32x16_bf16 v[144:159], v[116:119], a[244:247], v[144:159]
 buffer_load_dwordx4 v[116:119], v10, s[36:39], s3 offen offset:1024
 s_waitcnt vmcnt(16)
 v_mfma_f32_32x32x16_bf16 v[128:143], v[120:123], a[120:123], v[128:143]
 v_mfma_f32_32x32x16_bf16 v[144:159], v[120:123], a[248:251], v[144:159]
 buffer_load_dwordx4 v[120:123], v10, s[36:39], s3 offen offset:2048
 s_waitcnt vmcnt(16)
 v_mfma_f32_32x32x16_bf16 v[128:143], v[124:127], a[124:127], v[128:143]
 v_mfma_f32_32x32x16_bf16 v[144:159], v[124:127], a[252:255], v[144:159]
 buffer_load_dwordx4 v[124:127], v10, s[36:39], s3 offen offset:3072
 s_nop 2
 v_cvt_pk_bf16_f32 v160, v128, v129
 v_cvt_pk_bf16_f32 v161, v130, v131
 v_cvt_pk_bf16_f32 v162, v136, v137
 v_cvt_pk_bf16_f32 v163, v138, v139
 buffer_store_dwordx4 v[160:163], v11, s[36:39], s46 offen offset:0 sc1
 v_cvt_pk_bf16_f32 v164, v132, v133
 v_cvt_pk_bf16_f32 v165, v134, v135
 v_cvt_pk_bf16_f32 v166, v140, v141
 v_cvt_pk_bf16_f32 v167, v142, v143
 buffer_store_dwordx4 v[164:167], v11, s[36:39], s46 offen offset:512 sc1
 v_cvt_pk_bf16_f32 v168, v144, v145
 v_cvt_pk_bf16_f32 v169, v146, v147
 v_cvt_pk_bf16_f32 v170, v152, v153
 v_cvt_pk_bf16_f32 v171, v154, v155
 buffer_store_dwordx4 v[168:171], v11, s[36:39], s46 offen offset:2048 sc1
 v_cvt_pk_bf16_f32 v172, v148, v149
 v_cvt_pk_bf16_f32 v173, v150, v151
 v_cvt_pk_bf16_f32 v174, v156, v157
 v_cvt_pk_bf16_f32 v175, v158, v159
 buffer_store_dwordx4 v[172:175], v11, s[36:39], s46 offen offset:2560 sc1
 s_mov_b32 s44, s45
 s_add_u32 s46, s46, 2097152
 s_add_u32 s49, s49, 1
 s_cmp_lt_u32 s49, 16
 s_cbranch_scc1 S1_LV
 s_branch S1_END
S1_END:
 s_waitcnt vmcnt(0)
 v_mov_b32 v13, 16
 s_mov_b64 exec, 1
 buffer_store_dword v13, v12, s[36:39], s48 offen sc1
 s_mov_b64 exec, -1
 s_cmp_ge_u32 s72, 4
 s_cbranch_scc1 R_S4
 s_cmp_ge_u32 s72, 4
 s_cbranch_scc1 L_DONE
R_S3:
 s_barrier
 s_mov_b32 s41, s40
 s_sub_u32 s42, s72, 2
 s_mov_b32 s50, 0x3db504f3
 s_mov_b32 s51, 0x3fb8aa3b
 v_and_b32 v8, 63, v0
 v_lshlrev_b32 v1, 4, v8
 v_and_b32 v9, 15, v8
 v_lshrrev_b32 v10, 4, v8
 v_lshlrev_b32 v11, 1, v10
 v_xor_b32 v11, v11, v9
 v_lshlrev_b32 v11, 4, v11
 v_lshl_add_u32 v20, v10, 13, v11
 v_xor_b32 v21, 0x80, v20
 v_lshrrev_b32 v11, 2, v9
 v_and_b32 v12, 3, v9
 v_and_b32 v13, 1, v10
 v_lshl_add_u32 v13, v13, 2, v11
 v_lshlrev_b32 v13, 5, v13
 v_lshl_add_u32 v13, v12, 3, v13
 v_lshl_add_u32 v11, v10, 3, v11
 v_lshl_add_u32 v22, v11, 8, v13
 s_lshl_b32 s3, s47, 6
 v_xor_b32 v22, s3, v22
 v_xor_b32 v23, 0x20, v22
 v_add_u32 v24, 0x10000, v22
 v_add_u32 v25, 0x10000, v23
 s_lshl_b32 s74, s47, 12
 s_lshl_b32 s75, s41, 8
 s_lshl_b32 s3, s47, 17
 s_add_u32 s75, s75, s3
 s_mov_b32 s70, 0x400000
 s_mov_b32 s71, 0x20000
 s_mov_b32 s68, s10
 s_mov_b32 s69, s11
 s_add_u32 m0, s74, 0
 s_add_u32 s3, s75, 0
 buffer_load_dwordx4 v20, s[68:71], s3 offen lds
 s_add_u32 m0, s74, 1024
 s_add_u32 s3, s75, 32768
 buffer_load_dwordx4 v20, s[68:71], s3 offen lds
 s_add_u32 m0, s74, 2048
 s_add_u32 s3, s75, 65536
 buffer_load_dwordx4 v21, s[68:71], s3 offen lds
 s_add_u32 m0, s74, 3072
 s_add_u32 s3, s75, 98304
 buffer_load_dwordx4 v21, s[68:71], s3 offen lds
 s_add_u32 m0, s74, 16384
 s_add_u32 s3, s75, 524288
 buffer_load_dwordx4 v20, s[68:71], s3 offen lds
 s_add_u32 m0, s74, 17408
 s_add_u32 s3, s75, 557056
 buffer_load_dwordx4 v20, s[68:71], s3 offen lds
 s_add_u32 m0, s74, 18432
 s_add_u32 s3, s75, 589824
 buffer_load_dwordx4 v21, s[68:71], s3 offen lds
 s_add_u32 m0, s74, 19456
 s_add_u32 s3, s75, 622592
 buffer_load_dwordx4 v21, s[68:71], s3 offen lds
 s_add_u32 m0, s74, 32768
 s_add_u32 s3, s75, 1048576
 buffer_load_dwordx4 v20, s[68:71], s3 offen lds
 s_add_u32 m0, s74, 33792
 s_add_u32 s3, s75, 1081344
 buffer_load_dwordx4 v20, s[68:71], s3 offen lds
 s_add_u32 m0, s74, 34816
 s_add_u32 s3, s75, 1114112
 buffer_load_dwordx4 v21, s[68:71], s3 offen lds
 s_add_u32 m0, s74, 35840
 s_add_u32 s3, s75, 1146880
 buffer_load_dwordx4 v21, s[68:71], s3 offen lds
 s_add_u32 m0, s74, 49152
 s_add_u32 s3, s75, 1572864
 buffer_load_dwordx4 v20, s[68:71], s3 offen lds
 s_add_u32 m0, s74, 50176
 s_add_u32 s3, s75, 1605632
 buffer_load_dwordx4 v20, s[68:71], s3 offen lds
 s_add_u32 m0, s74, 51200
 s_add_u32 s3, s75, 1638400
 buffer_load_dwordx4 v21, s[68:71], s3 offen lds
 s_add_u32 m0, s74, 52224
 s_add_u32 s3, s75, 1671168
 buffer_load_dwordx4 v21, s[68:71], s3 offen lds
 s_add_u32 m0, s74, 65536
 s_add_u32 s3, s75, 2097152
 buffer_load_dwordx4 v20, s[68:71], s3 offen lds
 s_add_u32 m0, s74, 66560
 s_add_u32 s3, s75, 2129920
 buffer_load_dwordx4 v20, s[68:71], s3 offen lds
 s_add_u32 m0, s74, 67584
 s_add_u32 s3, s75, 2162688
 buffer_load_dwordx4 v21, s[68:71], s3 offen lds
 s_add_u32 m0, s74, 68608
 s_add_u32 s3, s75, 2195456
 buffer_load_dwordx4 v21, s[68:71], s3 offen lds
 s_add_u32 m0, s74, 81920
 s_add_u32 s3, s75, 2621440
 buffer_load_dwordx4 v20, s[68:71], s3 offen lds
 s_add_u32 m0, s74, 82944
 s_add_u32 s3, s75, 2654208
 buffer_load_dwordx4 v20, s[68:71], s3 offen lds
 s_add_u32 m0, s74, 83968
 s_add_u32 s3, s75, 2686976
 buffer_load_dwordx4 v21, s[68:71], s3 offen lds
 s_add_u32 m0, s74, 84992
 s_add_u32 s3, s75, 2719744
 buffer_load_dwordx4 v21, s[68:71], s3 offen lds
 s_add_u32 m0, s74, 98304
 s_add_u32 s3, s75, 3145728
 buffer_load_dwordx4 v20, s[68:71], s3 offen lds
 s_add_u32 m0, s74, 99328
 s_add_u32 s3, s75, 3178496
 buffer_load_dwordx4 v20, s[68:71], s3 offen lds
 s_add_u32 m0, s74, 100352
 s_add_u32 s3, s75, 3211264
 buffer_load_dwordx4 v21, s[68:71], s3 offen lds
 s_add_u32 m0, s74, 101376
 s_add_u32 s3, s75, 3244032
 buffer_load_dwordx4 v21, s[68:71], s3 offen lds
 s_add_u32 m0, s74, 114688
 s_add_u32 s3, s75, 3670016
 buffer_load_dwordx4 v20, s[68:71], s3 offen lds
 s_add_u32 m0, s74, 115712
 s_add_u32 s3, s75, 3702784
 buffer_load_dwordx4 v20, s[68:71], s3 offen lds
 s_add_u32 m0, s74, 116736
 s_add_u32 s3, s75, 3735552
 buffer_load_dwordx4 v21, s[68:71], s3 offen lds
 s_add_u32 m0, s74, 117760
 s_add_u32 s3, s75, 3768320
 buffer_load_dwordx4 v21, s[68:71], s3 offen lds
 v_and_b32 v11, 1, v9
 v_mov_b32 v12, 0x4444
 v_mov_b32 v13, 0xeeee
 v_cmp_eq_u32 vcc, 1, v11
 s_nop 1
 v_cndmask_b32 v16, v12, v13, vcc
 v_lshrrev_b32 v11, 1, v10
 v_lshlrev_b32 v11, 4, v11
 v_and_b32 v12, 1, v10
 v_lshl_add_u32 v11, v12, 2, v11
 v_lshrrev_b32 v12, 2, v9
 v_add_u32 v11, v11, v12
 v_and_b32 v12, 3, v9
 v_lshlrev_b32 v12, 3, v12
 v_lshl_add_u32 v2, v11, 5, v12
 v_lshlrev_b32 v11, 5, v9
 v_lshl_add_u32 v11, v10, 3, v11
 s_lshl_b32 s3, s47, 10
 v_add_u32 v4, s3, v11
 s_lshr_b32 s3, s47, 1
 s_lshl_b32 s3, s3, 11
 v_add_u32 v3, s3, v11
 s_and_b32 s3, s47, 1
 s_lshl_b32 s3, s3, 4
 v_add_u32 v12, s3, v9
 v_lshlrev_b32 v11, 2, v10
 v_cmp_le_u32 s[52:53], v11, v12
 v_add_u32 v11, 1, v11
 v_cmp_le_u32 s[54:55], v11, v12
 v_add_u32 v11, 1, v11
 v_cmp_le_u32 s[56:57], v11, v12
 v_add_u32 v11, 1, v11
 v_cmp_le_u32 s[58:59], v11, v12
 v_add_u32 v11, 13, v11
 v_cmp_le_u32 s[60:61], v11, v12
 v_add_u32 v11, 1, v11
 v_cmp_le_u32 s[62:63], v11, v12
 v_add_u32 v11, 1, v11
 v_cmp_le_u32 s[64:65], v11, v12
 v_add_u32 v11, 1, v11
 v_cmp_le_u32 s[66:67], v11, v12
 v_add_u32 v11, 1, v11
 v_mov_b32 v5, 0
 v_mov_b32 v6, 0xff800000
 v_mov_b32 v7, 1
 v_mov_b32 v181, 0
 v_lshlrev_b32 v14, 2, v9
 v_and_b32 v15, 7, v8
 v_lshlrev_b32 v15, 2, v15
 v_mov_b32 v141, 0
 v_mov_b32 v143, 0
 v_mov_b32 v145, 0
 v_mov_b32 v147, 0
 s_waitcnt vmcnt(28)
 s_barrier
 ds_read_b64_tr_b16 a[0:1], v22 offset:0
 ds_read_b64_tr_b16 a[2:3], v22 offset:1024
 ds_read_b64_tr_b16 a[4:5], v22 offset:8192
 ds_read_b64_tr_b16 a[6:7], v22 offset:9216
 ds_read_b64_tr_b16 a[64:65], v23 offset:0
 ds_read_b64_tr_b16 a[66:67], v23 offset:1024
 ds_read_b64_tr_b16 a[68:69], v23 offset:8192
 ds_read_b64_tr_b16 a[70:71], v23 offset:9216
 s_waitcnt lgkmcnt(0)
 s_barrier
 s_mov_b32 s68, s12
 s_mov_b32 s69, s13
 s_add_u32 m0, s74, 0
 s_add_u32 s3, s75, 0
 buffer_load_dwordx4 v20, s[68:71], s3 offen lds
 s_add_u32 m0, s74, 1024
 s_add_u32 s3, s75, 32768
 buffer_load_dwordx4 v20, s[68:71], s3 offen lds
 s_add_u32 m0, s74, 2048
 s_add_u32 s3, s75, 65536
 buffer_load_dwordx4 v21, s[68:71], s3 offen lds
 s_add_u32 m0, s74, 3072
 s_add_u32 s3, s75, 98304
 buffer_load_dwordx4 v21, s[68:71], s3 offen lds
 s_waitcnt vmcnt(28)
 s_barrier
 ds_read_b64_tr_b16 a[8:9], v22 offset:16384
 ds_read_b64_tr_b16 a[10:11], v22 offset:17408
 ds_read_b64_tr_b16 a[12:13], v22 offset:24576
 ds_read_b64_tr_b16 a[14:15], v22 offset:25600
 ds_read_b64_tr_b16 a[72:73], v23 offset:16384
 ds_read_b64_tr_b16 a[74:75], v23 offset:17408
 ds_read_b64_tr_b16 a[76:77], v23 offset:24576
 ds_read_b64_tr_b16 a[78:79], v23 offset:25600
 s_waitcnt lgkmcnt(0)
 s_barrier
 s_add_u32 m0, s74, 16384
 s_add_u32 s3, s75, 524288
 buffer_load_dwordx4 v20, s[68:71], s3 offen lds
 s_add_u32 m0, s74, 17408
 s_add_u32 s3, s75, 557056
 buffer_load_dwordx4 v20, s[68:71], s3 offen lds
 s_add_u32 m0, s74, 18432
 s_add_u32 s3, s75, 589824
 buffer_load_dwordx4 v21, s[68:71], s3 offen lds
 s_add_u32 m0, s74, 19456
 s_add_u32 s3, s75, 622592
 buffer_load_dwordx4 v21, s[68:71], s3 offen lds
 s_waitcnt vmcnt(28)
 s_barrier
 ds_read_b64_tr_b16 a[16:17], v22 offset:32768
 ds_read_b64_tr_b16 a[18:19], v22 offset:33792
 ds_read_b64_tr_b16 a[20:21], v22 offset:40960
 ds_read_b64_tr_b16 a[22:23], v22 offset:41984
 ds_read_b64_tr_b16 a[80:81], v23 offset:32768
 ds_read_b64_tr_b16 a[82:83], v23 offset:33792
 ds_read_b64_tr_b16 a[84:85], v23 offset:40960
 ds_read_b64_tr_b16 a[86:87], v23 offset:41984
 s_waitcnt lgkmcnt(0)
 s_barrier
 s_add_u32 m0, s74, 32768
 s_add_u32 s3, s75, 1048576
 buffer_load_dwordx4 v20, s[68:71], s3 offen lds
 s_add_u32 m0, s74, 33792
 s_add_u32 s3, s75, 1081344
 buffer_load_dwordx4 v20, s[68:71], s3 offen lds
 s_add_u32 m0, s74, 34816
 s_add_u32 s3, s75, 1114112
 buffer_load_dwordx4 v21, s[68:71], s3 offen lds
 s_add_u32 m0, s74, 35840
 s_add_u32 s3, s75, 1146880
 buffer_load_dwordx4 v21, s[68:71], s3 offen lds
 s_waitcnt vmcnt(28)
 s_barrier
 ds_read_b64_tr_b16 a[24:25], v22 offset:49152
 ds_read_b64_tr_b16 a[26:27], v22 offset:50176
 ds_read_b64_tr_b16 a[28:29], v22 offset:57344
 ds_read_b64_tr_b16 a[30:31], v22 offset:58368
 ds_read_b64_tr_b16 a[88:89], v23 offset:49152
 ds_read_b64_tr_b16 a[90:91], v23 offset:50176
 ds_read_b64_tr_b16 a[92:93], v23 offset:57344
 ds_read_b64_tr_b16 a[94:95], v23 offset:58368
 s_waitcnt lgkmcnt(0)
 s_barrier
 s_add_u32 m0, s74, 49152
 s_add_u32 s3, s75, 1572864
 buffer_load_dwordx4 v20, s[68:71], s3 offen lds
 s_add_u32 m0, s74, 50176
 s_add_u32 s3, s75, 1605632
 buffer_load_dwordx4 v20, s[68:71], s3 offen lds
 s_add_u32 m0, s74, 51200
 s_add_u32 s3, s75, 1638400
 buffer_load_dwordx4 v21, s[68:71], s3 offen lds
 s_add_u32 m0, s74, 52224
 s_add_u32 s3, s75, 1671168
 buffer_load_dwordx4 v21, s[68:71], s3 offen lds
 s_waitcnt vmcnt(28)
 s_barrier
 ds_read_b64_tr_b16 a[32:33], v24 offset:0
 ds_read_b64_tr_b16 a[34:35], v24 offset:1024
 ds_read_b64_tr_b16 a[36:37], v24 offset:8192
 ds_read_b64_tr_b16 a[38:39], v24 offset:9216
 ds_read_b64_tr_b16 a[96:97], v25 offset:0
 ds_read_b64_tr_b16 a[98:99], v25 offset:1024
 ds_read_b64_tr_b16 a[100:101], v25 offset:8192
 ds_read_b64_tr_b16 a[102:103], v25 offset:9216
 s_waitcnt lgkmcnt(0)
 s_barrier
 s_add_u32 m0, s74, 65536
 s_add_u32 s3, s75, 2097152
 buffer_load_dwordx4 v20, s[68:71], s3 offen lds
 s_add_u32 m0, s74, 66560
 s_add_u32 s3, s75, 2129920
 buffer_load_dwordx4 v20, s[68:71], s3 offen lds
 s_add_u32 m0, s74, 67584
 s_add_u32 s3, s75, 2162688
 buffer_load_dwordx4 v21, s[68:71], s3 offen lds
 s_add_u32 m0, s74, 68608
 s_add_u32 s3, s75, 2195456
 buffer_load_dwordx4 v21, s[68:71], s3 offen lds
 s_waitcnt vmcnt(28)
 s_barrier
 ds_read_b64_tr_b16 a[40:41], v24 offset:16384
 ds_read_b64_tr_b16 a[42:43], v24 offset:17408
 ds_read_b64_tr_b16 a[44:45], v24 offset:24576
 ds_read_b64_tr_b16 a[46:47], v24 offset:25600
 ds_read_b64_tr_b16 a[104:105], v25 offset:16384
 ds_read_b64_tr_b16 a[106:107], v25 offset:17408
 ds_read_b64_tr_b16 a[108:109], v25 offset:24576
 ds_read_b64_tr_b16 a[110:111], v25 offset:25600
 s_waitcnt lgkmcnt(0)
 s_barrier
 s_add_u32 m0, s74, 81920
 s_add_u32 s3, s75, 2621440
 buffer_load_dwordx4 v20, s[68:71], s3 offen lds
 s_add_u32 m0, s74, 82944
 s_add_u32 s3, s75, 2654208
 buffer_load_dwordx4 v20, s[68:71], s3 offen lds
 s_add_u32 m0, s74, 83968
 s_add_u32 s3, s75, 2686976
 buffer_load_dwordx4 v21, s[68:71], s3 offen lds
 s_add_u32 m0, s74, 84992
 s_add_u32 s3, s75, 2719744
 buffer_load_dwordx4 v21, s[68:71], s3 offen lds
 s_waitcnt vmcnt(28)
 s_barrier
 ds_read_b64_tr_b16 a[48:49], v24 offset:32768
 ds_read_b64_tr_b16 a[50:51], v24 offset:33792
 ds_read_b64_tr_b16 a[52:53], v24 offset:40960
 ds_read_b64_tr_b16 a[54:55], v24 offset:41984
 ds_read_b64_tr_b16 a[112:113], v25 offset:32768
 ds_read_b64_tr_b16 a[114:115], v25 offset:33792
 ds_read_b64_tr_b16 a[116:117], v25 offset:40960
 ds_read_b64_tr_b16 a[118:119], v25 offset:41984
 s_waitcnt lgkmcnt(0)
 s_barrier
 s_add_u32 m0, s74, 98304
 s_add_u32 s3, s75, 3145728
 buffer_load_dwordx4 v20, s[68:71], s3 offen lds
 s_add_u32 m0, s74, 99328
 s_add_u32 s3, s75, 3178496
 buffer_load_dwordx4 v20, s[68:71], s3 offen lds
 s_add_u32 m0, s74, 100352
 s_add_u32 s3, s75, 3211264
 buffer_load_dwordx4 v21, s[68:71], s3 offen lds
 s_add_u32 m0, s74, 101376
 s_add_u32 s3, s75, 3244032
 buffer_load_dwordx4 v21, s[68:71], s3 offen lds
 s_waitcnt vmcnt(28)
 s_barrier
 ds_read_b64_tr_b16 a[56:57], v24 offset:49152
 ds_read_b64_tr_b16 a[58:59], v24 offset:50176
 ds_read_b64_tr_b16 a[60:61], v24 offset:57344
 ds_read_b64_tr_b16 a[62:63], v24 offset:58368
 ds_read_b64_tr_b16 a[120:121], v25 offset:49152
 ds_read_b64_tr_b16 a[122:123], v25 offset:50176
 ds_read_b64_tr_b16 a[124:125], v25 offset:57344
 ds_read_b64_tr_b16 a[126:127], v25 offset:58368
 s_waitcnt lgkmcnt(0)
 s_barrier
 s_add_u32 m0, s74, 114688
 s_add_u32 s3, s75, 3670016
 buffer_load_dwordx4 v20, s[68:71], s3 offen lds
 s_add_u32 m0, s74, 115712
 s_add_u32 s3, s75, 3702784
 buffer_load_dwordx4 v20, s[68:71], s3 offen lds
 s_add_u32 m0, s74, 116736
 s_add_u32 s3, s75, 3735552
 buffer_load_dwordx4 v21, s[68:71], s3 offen lds
 s_add_u32 m0, s74, 117760
 s_add_u32 s3, s75, 3768320
 buffer_load_dwordx4 v21, s[68:71], s3 offen lds
 s_waitcnt vmcnt(28)
 s_barrier
 ds_read_b64_tr_b16 a[128:129], v22 offset:0
 ds_read_b64_tr_b16 a[130:131], v22 offset:1024
 ds_read_b64_tr_b16 a[132:133], v22 offset:8192
 ds_read_b64_tr_b16 a[134:135], v22 offset:9216
 ds_read_b64_tr_b16 a[192:193], v23 offset:0
 ds_read_b64_tr_b16 a[194:195], v23 offset:1024
 ds_read_b64_tr_b16 a[196:197], v23 offset:8192
 ds_read_b64_tr_b16 a[198:199], v23 offset:9216
 s_waitcnt lgkmcnt(0)
 s_barrier
 s_waitcnt vmcnt(24)
 s_barrier
 ds_read_b64_tr_b16 a[136:137], v22 offset:16384
 ds_read_b64_tr_b16 a[138:139], v22 offset:17408
 ds_read_b64_tr_b16 a[140:141], v22 offset:24576
 ds_read_b64_tr_b16 a[142:143], v22 offset:25600
 ds_read_b64_tr_b16 a[200:201], v23 offset:16384
 ds_read_b64_tr_b16 a[202:203], v23 offset:17408
 ds_read_b64_tr_b16 a[204:205], v23 offset:24576
 ds_read_b64_tr_b16 a[206:207], v23 offset:25600
 s_waitcnt lgkmcnt(0)
 s_barrier
 s_waitcnt vmcnt(20)
 s_barrier
 ds_read_b64_tr_b16 a[144:145], v22 offset:32768
 ds_read_b64_tr_b16 a[146:147], v22 offset:33792
 ds_read_b64_tr_b16 a[148:149], v22 offset:40960
 ds_read_b64_tr_b16 a[150:151], v22 offset:41984
 ds_read_b64_tr_b16 a[208:209], v23 offset:32768
 ds_read_b64_tr_b16 a[210:211], v23 offset:33792
 ds_read_b64_tr_b16 a[212:213], v23 offset:40960
 ds_read_b64_tr_b16 a[214:215], v23 offset:41984
 s_waitcnt lgkmcnt(0)
 s_barrier
 s_waitcnt vmcnt(16)
 s_barrier
 ds_read_b64_tr_b16 a[152:153], v22 offset:49152
 ds_read_b64_tr_b16 a[154:155], v22 offset:50176
 ds_read_b64_tr_b16 a[156:157], v22 offset:57344
 ds_read_b64_tr_b16 a[158:159], v22 offset:58368
 ds_read_b64_tr_b16 a[216:217], v23 offset:49152
 ds_read_b64_tr_b16 a[218:219], v23 offset:50176
 ds_read_b64_tr_b16 a[220:221], v23 offset:57344
 ds_read_b64_tr_b16 a[222:223], v23 offset:58368
 s_waitcnt lgkmcnt(0)
 s_barrier
 s_waitcnt vmcnt(12)
 s_barrier
 ds_read_b64_tr_b16 a[160:161], v24 offset:0
 ds_read_b64_tr_b16 a[162:163], v24 offset:1024
 ds_read_b64_tr_b16 a[164:165], v24 offset:8192
 ds_read_b64_tr_b16 a[166:167], v24 offset:9216
 ds_read_b64_tr_b16 a[224:225], v25 offset:0
 ds_read_b64_tr_b16 a[226:227], v25 offset:1024
 ds_read_b64_tr_b16 a[228:229], v25 offset:8192
 ds_read_b64_tr_b16 a[230:231], v25 offset:9216
 s_waitcnt lgkmcnt(0)
 s_barrier
 s_waitcnt vmcnt(8)
 s_barrier
 ds_read_b64_tr_b16 a[168:169], v24 offset:16384
 ds_read_b64_tr_b16 a[170:171], v24 offset:17408
 ds_read_b64_tr_b16 a[172:173], v24 offset:24576
 ds_read_b64_tr_b16 a[174:175], v24 offset:25600
 ds_read_b64_tr_b16 a[232:233], v25 offset:16384
 ds_read_b64_tr_b16 a[234:235], v25 offset:17408
 ds_read_b64_tr_b16 a[236:237], v25 offset:24576
 ds_read_b64_tr_b16 a[238:239], v25 offset:25600
 s_waitcnt lgkmcnt(0)
 s_barrier
 s_waitcnt vmcnt(4)
 s_barrier
 ds_read_b64_tr_b16 a[176:177], v24 offset:32768
 ds_read_b64_tr_b16 a[178:179], v24 offset:33792
 ds_read_b64_tr_b16 a[180:181], v24 offset:40960
 ds_read_b64_tr_b16 a[182:183], v24 offset:41984
 ds_read_b64_tr_b16 a[240:241], v25 offset:32768
 ds_read_b64_tr_b16 a[242:243], v25 offset:33792
 ds_read_b64_tr_b16 a[244:245], v25 offset:40960
 ds_read_b64_tr_b16 a[246:247], v25 offset:41984
 s_waitcnt lgkmcnt(0)
 s_barrier
 s_waitcnt vmcnt(0)
 s_barrier
 ds_read_b64_tr_b16 a[184:185], v24 offset:49152
 ds_read_b64_tr_b16 a[186:187], v24 offset:50176
 ds_read_b64_tr_b16 a[188:189], v24 offset:57344
 ds_read_b64_tr_b16 a[190:191], v24 offset:58368
 ds_read_b64_tr_b16 a[248:249], v25 offset:49152
 ds_read_b64_tr_b16 a[250:251], v25 offset:50176
 ds_read_b64_tr_b16 a[252:253], v25 offset:57344
 ds_read_b64_tr_b16 a[254:255], v25 offset:58368
 s_waitcnt lgkmcnt(0)
 s_barrier
 s_lshl_b32 s74, s41, 6
 s_add_u32 s74, s74, 1024
 s_lshl_b32 s75, s41, 5
 s_add_u32 s75, s75, 3072
 s_mov_b32 s3, 0
 s_branch S3_kv_go
S3_kv:
 s_sleep 4
S3_kv_go:
 buffer_load_dword v13, v14, s[36:39], s74 offen sc1
 s_add_u32 s3, s3, 1
 s_cmp_gt_u32 s3, 131072
 s_cbranch_scc1 L_ABORT
 s_waitcnt vmcnt(0)
 v_cmp_gt_u32 vcc, 16, v13
 s_cbranch_vccnz S3_kv
 s_mov_b32 s3, 0
 s_branch S3_q_go
S3_q:
 s_sleep 4
S3_q_go:
 buffer_load_dword v13, v15, s[36:39], s75 offen sc1
 s_add_u32 s3, s3, 1
 s_cmp_gt_u32 s3, 131072
 s_cbranch_scc1 L_ABORT
 s_waitcnt vmcnt(0)
 v_cmp_gt_u32 vcc, 16, v13
 s_cbranch_vccnz S3_q
 v_mov_b32 v12, 4
 s_mov_b32 s3, 0
S3_ci:
 global_load_dword v13, v12, s[30:31] sc1
 s_add_u32 s3, s3, 1
 s_cmp_gt_u32 s3, 131072
 s_cbranch_scc1 L_ABORT
 s_waitcnt vmcnt(0)
 v_readfirstlane_b32 s34, v13
 s_nop 0
 s_cmp_lt_u32 s34, 32
 s_cbranch_scc1 S3_ci
 .p2align 6
S3_L:
 s_lshl_b32 s3, s42, 5
 s_add_u32 s3, s3, s41
 s_lshl_b32 s43, s3, 14
 s_add_u32 s43, s43, 16777216
 s_lshr_b32 s34, s47, 1
 s_lshl_b32 s35, s34, 12
 s_add_u32 s45, s43, s35
 s_add_u32 s45, s45, 8192
 s_lshl_b32 s44, s3, 13
 s_and_b32 s35, s47, 1
 s_lshl_b32 s74, s35, 12
 s_add_u32 s44, s44, s74
 s_add_u32 s44, s44, 50331648
 s_lshl_b32 s48, s3, 2
 s_add_u32 s48, s48, 8192
 s_lshl_b32 s3, s42, 1
 s_add_u32 s3, s3, s35
 s_lshl_b32 s3, s3, 5
 s_add_u32 s3, s3, s41
 s_lshl_b32 s46, s3, 12
 s_lshl_b32 s34, s34, 11
 s_add_u32 s46, s46, s34
 s_add_u32 s46, s46, 67108864
 s_lshl_b32 s49, s42, 13
 s_lshl_b32 s3, s47, 11
 s_add_u32 s49, s49, s3
 s_add_u32 s49, s49, 2097152
 v_add_u32 v15, s3, v1
 buffer_load_dwordx4 v[52:55], v1, s[36:39], s44 offen offset:0 sc1
 buffer_load_dwordx4 v[56:59], v1, s[36:39], s44 offen offset:1024 sc1
 buffer_load_dwordx4 v[60:63], v1, s[36:39], s44 offen offset:2048 sc1
 buffer_load_dwordx4 v[64:67], v1, s[36:39], s44 offen offset:3072 sc1
 buffer_load_dwordx4 v[20:23], v1, s[36:39], s43 offen offset:0 sc1
 buffer_load_dwordx4 v[24:27], v1, s[36:39], s43 offen offset:1024 sc1
 buffer_load_dwordx4 v[28:31], v1, s[36:39], s43 offen offset:2048 sc1
 buffer_load_dwordx4 v[32:35], v1, s[36:39], s43 offen offset:3072 sc1
 s_add_u32 s43, s43, 4096
 buffer_load_dwordx4 v[36:39], v1, s[36:39], s43 offen offset:0 sc1
 buffer_load_dwordx4 v[40:43], v1, s[36:39], s43 offen offset:1024 sc1
 buffer_load_dwordx4 v[44:47], v1, s[36:39], s43 offen offset:2048 sc1
 buffer_load_dwordx4 v[48:51], v1, s[36:39], s43 offen offset:3072 sc1
 buffer_load_dwordx4 v[68:71], v1, s[36:39], s45 offen offset:0 sc1
 buffer_load_dwordx4 v[72:75], v1, s[36:39], s45 offen offset:1024 sc1
 buffer_load_dwordx4 v[76:79], v1, s[36:39], s45 offen offset:2048 sc1
 buffer_load_dwordx4 v[80:83], v1, s[36:39], s45 offen offset:3072 sc1
 v_mov_b64 v[148:149], 0
 v_mov_b64 v[150:151], 0
 v_mov_b64 v[152:153], 0
 v_mov_b64 v[154:155], 0
 v_mov_b64 v[156:157], 0
 v_mov_b64 v[158:159], 0
 v_mov_b64 v[160:161], 0
 v_mov_b64 v[162:163], 0
 s_waitcnt vmcnt(11)
 v_mfma_f32_16x16x32_bf16 v[164:167], v[20:23], v[52:55], 0
 s_waitcnt vmcnt(10)
 v_mfma_f32_16x16x32_bf16 v[164:167], v[24:27], v[56:59], v[164:167]
 s_waitcnt vmcnt(9)
 v_mfma_f32_16x16x32_bf16 v[164:167], v[28:31], v[60:63], v[164:167]
 s_waitcnt vmcnt(8)
 v_mfma_f32_16x16x32_bf16 v[164:167], v[32:35], v[64:67], v[164:167]
 s_waitcnt vmcnt(7)
 v_mfma_f32_16x16x32_bf16 v[168:171], v[36:39], v[52:55], 0
 s_waitcnt vmcnt(6)
 v_mfma_f32_16x16x32_bf16 v[168:171], v[40:43], v[56:59], v[168:171]
 s_waitcnt vmcnt(5)
 v_mfma_f32_16x16x32_bf16 v[168:171], v[44:47], v[60:63], v[168:171]
 s_waitcnt vmcnt(4)
 v_mfma_f32_16x16x32_bf16 v[168:171], v[48:51], v[64:67], v[168:171]
 v_cvt_pk_bf16_f32 v165, v164, v165
 v_lshlrev_b32 v164, 16, v165
 v_and_b32 v165, 0xffff0000, v165
 v_mul_f32 v164, s50, v164
 v_mul_f32 v165, s50, v165
 v_cvt_pk_bf16_f32 v165, v164, v165
 v_lshlrev_b32 v164, 16, v165
 v_and_b32 v165, 0xffff0000, v165
 v_cvt_pk_bf16_f32 v167, v166, v167
 v_lshlrev_b32 v166, 16, v167
 v_and_b32 v167, 0xffff0000, v167
 v_mul_f32 v166, s50, v166
 v_mul_f32 v167, s50, v167
 v_cvt_pk_bf16_f32 v167, v166, v167
 v_lshlrev_b32 v166, 16, v167
 v_and_b32 v167, 0xffff0000, v167
 v_cvt_pk_bf16_f32 v169, v168, v169
 v_lshlrev_b32 v168, 16, v169
 v_and_b32 v169, 0xffff0000, v169
 v_mul_f32 v168, s50, v168
 v_mul_f32 v169, s50, v169
 v_cvt_pk_bf16_f32 v169, v168, v169
 v_lshlrev_b32 v168, 16, v169
 v_and_b32 v169, 0xffff0000, v169
 v_cvt_pk_bf16_f32 v171, v170, v171
 v_lshlrev_b32 v170, 16, v171
 v_and_b32 v171, 0xffff0000, v171
 v_mul_f32 v170, s50, v170
 v_mul_f32 v171, s50, v171
 v_cvt_pk_bf16_f32 v171, v170, v171
 v_lshlrev_b32 v170, 16, v171
 v_and_b32 v171, 0xffff0000, v171
 v_cndmask_b32 v164, v6, v164, s[52:53]
 v_cndmask_b32 v165, v6, v165, s[54:55]
 v_cndmask_b32 v166, v6, v166, s[56:57]
 v_cndmask_b32 v167, v6, v167, s[58:59]
 v_cndmask_b32 v168, v6, v168, s[60:61]
 v_cndmask_b32 v169, v6, v169, s[62:63]
 v_cndmask_b32 v170, v6, v170, s[64:65]
 v_cndmask_b32 v171, v6, v171, s[66:67]
 v_max3_f32 v8, v164, v165, v166
 v_max3_f32 v8, v8, v167, v168
 v_max3_f32 v8, v8, v169, v170
 v_max_f32 v8, v8, v171
 s_mov_b32 s3, 0
 s_branch S3_m_go
S3_m:
 s_sleep 1
S3_m_go:
 buffer_load_dwordx4 v[116:119], v1, s[36:39], s49 offen sc1
 buffer_load_dwordx4 v[120:123], v1, s[36:39], s49 offen offset:1024 sc1
 s_add_u32 s3, s3, 1
 s_cmp_gt_u32 s3, 131072
 s_cbranch_scc1 L_ABORT
 s_waitcnt vmcnt(1)
 v_max3_u32 v9, v116, v117, v118
 s_waitcnt vmcnt(0)
 v_max3_u32 v9, v9, v119, v120
 v_max3_u32 v9, v9, v121, v122
 v_max_u32 v9, v9, v123
 v_cmp_eq_u32 vcc, -1, v9
 s_cbranch_vccnz S3_m
 ds_write_b128 v15, v[116:119] offset:0
 ds_write_b128 v15, v[120:123] offset:1024
 s_waitcnt lgkmcnt(0)
 s_barrier
 ds_read_b128 v[84:87], v1 offset:0
 ds_read_b128 v[88:91], v1 offset:1024
 ds_read_b128 v[92:95], v1 offset:2048
 ds_read_b128 v[96:99], v1 offset:3072
 ds_read_b128 v[100:103], v1 offset:4096
 ds_read_b128 v[104:107], v1 offset:5120
 ds_read_b128 v[108:111], v1 offset:6144
 ds_read_b128 v[112:115], v1 offset:7168
 s_waitcnt lgkmcnt(7)
 v_smfmac_f32_16x16x64_bf16 v[148:151], v[84:87], a[0:7], v16
 s_waitcnt lgkmcnt(6)
 v_smfmac_f32_16x16x64_bf16 v[148:151], v[88:91], a[8:15], v16
 s_waitcnt lgkmcnt(5)
 v_smfmac_f32_16x16x64_bf16 v[148:151], v[92:95], a[16:23], v16
 s_waitcnt lgkmcnt(4)
 v_smfmac_f32_16x16x64_bf16 v[148:151], v[96:99], a[24:31], v16
 s_waitcnt lgkmcnt(3)
 v_smfmac_f32_16x16x64_bf16 v[148:151], v[100:103], a[32:39], v16
 s_waitcnt lgkmcnt(2)
 v_smfmac_f32_16x16x64_bf16 v[148:151], v[104:107], a[40:47], v16
 s_waitcnt lgkmcnt(1)
 v_smfmac_f32_16x16x64_bf16 v[148:151], v[108:111], a[48:55], v16
 s_waitcnt lgkmcnt(0)
 v_smfmac_f32_16x16x64_bf16 v[148:151], v[112:115], a[56:63], v16
 v_smfmac_f32_16x16x64_bf16 v[152:155], v[84:87], a[64:71], v16
 v_smfmac_f32_16x16x64_bf16 v[152:155], v[88:91], a[72:79], v16
 v_add_f32 v148, v148, v149
 v_smfmac_f32_16x16x64_bf16 v[152:155], v[92:95], a[80:87], v16
 v_add_f32 v150, v150, v151
 v_smfmac_f32_16x16x64_bf16 v[152:155], v[96:99], a[88:95], v16
 v_cvt_pk_bf16_f32 v148, v148, v150
 v_smfmac_f32_16x16x64_bf16 v[152:155], v[100:103], a[96:103], v16
 ds_write_b32 v4, v148 offset:8192
 v_smfmac_f32_16x16x64_bf16 v[152:155], v[104:107], a[104:111], v16
 v_smfmac_f32_16x16x64_bf16 v[152:155], v[108:111], a[112:119], v16
 v_smfmac_f32_16x16x64_bf16 v[152:155], v[112:115], a[120:127], v16
 v_smfmac_f32_16x16x64_bf16 v[156:159], v[84:87], a[128:135], v16
 v_smfmac_f32_16x16x64_bf16 v[156:159], v[88:91], a[136:143], v16
 v_add_f32 v152, v152, v153
 v_smfmac_f32_16x16x64_bf16 v[156:159], v[92:95], a[144:151], v16
 v_add_f32 v154, v154, v155
 v_smfmac_f32_16x16x64_bf16 v[156:159], v[96:99], a[152:159], v16
 v_cvt_pk_bf16_f32 v152, v152, v154
 v_smfmac_f32_16x16x64_bf16 v[156:159], v[100:103], a[160:167], v16
 ds_write_b32 v4, v152 offset:8704
 v_smfmac_f32_16x16x64_bf16 v[156:159], v[104:107], a[168:175], v16
 v_smfmac_f32_16x16x64_bf16 v[156:159], v[108:111], a[176:183], v16
 v_smfmac_f32_16x16x64_bf16 v[156:159], v[112:115], a[184:191], v16
 v_smfmac_f32_16x16x64_bf16 v[160:163], v[84:87], a[192:199], v16
 v_smfmac_f32_16x16x64_bf16 v[160:163], v[88:91], a[200:207], v16
 v_add_f32 v156, v156, v157
 v_smfmac_f32_16x16x64_bf16 v[160:163], v[92:95], a[208:215], v16
 v_add_f32 v158, v158, v159
 v_smfmac_f32_16x16x64_bf16 v[160:163], v[96:99], a[216:223], v16
 v_cvt_pk_bf16_f32 v156, v156, v158
 v_smfmac_f32_16x16x64_bf16 v[160:163], v[100:103], a[224:231], v16
 ds_write_b32 v4, v156 offset:8196
 v_smfmac_f32_16x16x64_bf16 v[160:163], v[104:107], a[232:239], v16
 v_smfmac_f32_16x16x64_bf16 v[160:163], v[108:111], a[240:247], v16
 v_smfmac_f32_16x16x64_bf16 v[160:163], v[112:115], a[248:255], v16
 s_nop 7
 v_add_f32 v160, v160, v161
 v_add_f32 v162, v162, v163
 v_cvt_pk_bf16_f32 v160, v160, v162
 ds_write_b32 v4, v160 offset:8708
 s_waitcnt lgkmcnt(0)
 s_barrier
 ds_read_b64_tr_b16 v[124:125], v2 offset:8192
 ds_read_b64_tr_b16 v[126:127], v2 offset:8448
 ds_read_b64_tr_b16 v[128:129], v2 offset:9216
 ds_read_b64_tr_b16 v[130:131], v2 offset:9472
 ds_read_b64_tr_b16 v[132:133], v2 offset:10240
 ds_read_b64_tr_b16 v[134:135], v2 offset:10496
 ds_read_b64_tr_b16 v[136:137], v2 offset:11264
 ds_read_b64_tr_b16 v[138:139], v2 offset:11520
 ds_read_b32 v140, v3 offset:8196
 ds_read_b32 v142, v3 offset:8708
 ds_read_b32 v144, v3 offset:9220
 ds_read_b32 v146, v3 offset:9732
 s_waitcnt lgkmcnt(10)
 v_mfma_f32_16x16x32_bf16 v[172:175], v[124:127], v[52:55], 0
 s_waitcnt lgkmcnt(8)
 v_mfma_f32_16x16x32_bf16 v[172:175], v[128:131], v[56:59], v[172:175]
 s_waitcnt lgkmcnt(6)
 v_mfma_f32_16x16x32_bf16 v[172:175], v[132:135], v[60:63], v[172:175]
 s_waitcnt lgkmcnt(4)
 v_mfma_f32_16x16x32_bf16 v[172:175], v[136:139], v[64:67], v[172:175]
 s_nop 7
 v_cvt_pk_bf16_f32 v173, v172, v173
 v_lshlrev_b32 v172, 16, v173
 v_and_b32 v173, 0xffff0000, v173
 v_mul_f32 v172, s50, v172
 v_mul_f32 v173, s50, v173
 v_cvt_pk_bf16_f32 v173, v172, v173
 v_lshlrev_b32 v172, 16, v173
 v_and_b32 v173, 0xffff0000, v173
 v_max3_f32 v8, v8, v172, v173
 v_mov_b32 v10, v8
 s_nop 1
 v_permlane16_swap_b32 v8, v10
 v_max_f32 v8, v8, v10
 v_mov_b32 v10, v8
 s_nop 1
 v_permlane32_swap_b32 v8, v10
 v_max_f32 v8, v8, v10
 v_mul_f32 v8, s51, v8
 v_fma_f32 v172, v172, s51, -v8
 v_fma_f32 v173, v173, s51, -v8
 v_fma_f32 v164, v164, s51, -v8
 v_fma_f32 v165, v165, s51, -v8
 v_fma_f32 v166, v166, s51, -v8
 v_fma_f32 v167, v167, s51, -v8
 v_fma_f32 v168, v168, s51, -v8
 v_fma_f32 v169, v169, s51, -v8
 v_fma_f32 v170, v170, s51, -v8
 v_fma_f32 v171, v171, s51, -v8
 v_exp_f32 v172, v172
 v_exp_f32 v173, v173
 v_exp_f32 v164, v164
 v_exp_f32 v165, v165
 v_exp_f32 v166, v166
 v_exp_f32 v167, v167
 v_exp_f32 v168, v168
 v_exp_f32 v169, v169
 v_exp_f32 v170, v170
 v_exp_f32 v171, v171
 v_add_f32 v8, v172, v173
 v_add_f32 v8, v8, v164
 v_add_f32 v8, v8, v165
 v_add_f32 v8, v8, v166
 v_add_f32 v8, v8, v167
 v_add_f32 v8, v8, v168
 v_add_f32 v8, v8, v169
 v_add_f32 v8, v8, v170
 v_add_f32 v8, v8, v171
 v_mov_b32 v10, v8
 s_nop 1
 v_permlane16_swap_b32 v8, v10
 v_add_f32 v8, v8, v10
 v_mov_b32 v10, v8
 s_nop 1
 v_permlane32_swap_b32 v8, v10
 v_add_f32 v8, v8, v10
 v_rcp_f32 v8, v8
 s_nop 0
 v_mul_f32 v172, v172, v8
 v_mul_f32 v173, v173, v8
 v_mul_f32 v164, v164, v8
 v_mul_f32 v165, v165, v8
 v_mul_f32 v166, v166, v8
 v_mul_f32 v167, v167, v8
 v_mul_f32 v168, v168, v8
 v_mul_f32 v169, v169, v8
 v_mul_f32 v170, v170, v8
 v_mul_f32 v171, v171, v8
 v_cvt_pk_bf16_f32 v176, v164, v165
 v_cvt_pk_bf16_f32 v177, v166, v167
 v_cvt_pk_bf16_f32 v178, v168, v169
 v_cvt_pk_bf16_f32 v179, v170, v171
 v_cvt_pk_bf16_f32 v180, v172, v173
 s_nop 0
 v_mfma_f32_16x16x32_bf16 v[184:187], v[68:71], v[176:179], 0
 v_mfma_f32_16x16x32_bf16 v[188:191], v[72:75], v[176:179], 0
 v_mfma_f32_16x16x32_bf16 v[192:195], v[76:79], v[176:179], 0
 v_mfma_f32_16x16x32_bf16 v[196:199], v[80:83], v[176:179], 0
 s_waitcnt lgkmcnt(3)
 v_mfma_f32_16x16x16_bf16 v[184:187], v[140:141], v[180:181], v[184:187]
 s_waitcnt lgkmcnt(2)
 v_mfma_f32_16x16x16_bf16 v[188:191], v[142:143], v[180:181], v[188:191]
 s_waitcnt lgkmcnt(1)
 v_mfma_f32_16x16x16_bf16 v[192:195], v[144:145], v[180:181], v[192:195]
 s_waitcnt lgkmcnt(0)
 v_mfma_f32_16x16x16_bf16 v[196:199], v[146:147], v[180:181], v[196:199]
 v_cvt_pk_bf16_f32 v184, v184, v185
 v_cvt_pk_bf16_f32 v185, v186, v187
 v_cvt_pk_bf16_f32 v186, v188, v189
 v_cvt_pk_bf16_f32 v187, v190, v191
 buffer_store_dwordx4 v[184:187], v1, s[36:39], s46 offen offset:0 sc1
 v_cvt_pk_bf16_f32 v192, v192, v193
 v_cvt_pk_bf16_f32 v193, v194, v195
 v_cvt_pk_bf16_f32 v194, v196, v197
 v_cvt_pk_bf16_f32 v195, v198, v199
 buffer_store_dwordx4 v[192:195], v1, s[36:39], s46 offen offset:1024 sc1
 s_waitcnt vmcnt(0)
 s_barrier
 s_cmp_lg_u32 s47, 0
 s_cbranch_scc1 S3_nf
 s_mov_b64 exec, 1
 buffer_store_dword v7, v5, s[36:39], s48 offen sc1
 s_mov_b64 exec, -1
S3_nf:
 s_add_u32 s42, s42, 2
 s_cmp_lt_u32 s42, 64
 s_cbranch_scc1 S3_L
 s_branch L_DONE
R_S4:
 s_barrier
 s_and_b32 s41, s40, 15
 s_lshr_b32 s42, s40, 4
 s_sub_u32 s43, s72, 4
 s_mov_b32 s68, s14
 s_mov_b32 s69, s15
 s_mov_b32 s70, 0x400000
 s_mov_b32 s71, 0x20000
 s_mov_b32 s52, s4
 s_mov_b32 s53, s5
 s_mov_b32 s54, 0x200000
 s_mov_b32 s55, 0x20000
 s_mov_b32 s56, s28
 s_mov_b32 s57, s29
 s_mov_b32 s58, 0x200000
 s_mov_b32 s59, 0x20000
 s_lshl_b32 s66, s47, 15
 s_lshl_b32 s67, s47, 20
 s_lshl_b32 s3, s41, 6
 s_add_u32 s67, s67, s3
 v_and_b32 v8, 63, v0
 v_lshlrev_b32 v1, 4, v8
 v_lshrrev_b32 v9, 2, v8
 v_and_b32 v10, 3, v8
 v_lshlrev_b32 v10, 4, v10
 v_lshl_add_u32 v20, v9, 10, v10
 v_and_b32 v9, 15, v8
 v_lshrrev_b32 v10, 4, v8
 v_lshrrev_b32 v11, 2, v9
 v_lshl_add_u32 v11, v10, 2, v11
 v_and_b32 v12, 3, v9
 v_lshlrev_b32 v12, 3, v12
 v_lshl_add_u32 v11, v11, 6, v12
 v_add_u32 v21, s66, v11
 s_add_u32 m0, s66, 0
 s_add_u32 s3, s67, 0
 buffer_load_dwordx4 v20, s[68:71], s3 offen lds
 s_add_u32 m0, s66, 1024
 s_add_u32 s3, s67, 16384
 buffer_load_dwordx4 v20, s[68:71], s3 offen lds
 s_add_u32 m0, s66, 2048
 s_add_u32 s3, s67, 32768
 buffer_load_dwordx4 v20, s[68:71], s3 offen lds
 s_add_u32 m0, s66, 3072
 s_add_u32 s3, s67, 49152
 buffer_load_dwordx4 v20, s[68:71], s3 offen lds
 s_add_u32 m0, s66, 4096
 s_add_u32 s3, s67, 65536
 buffer_load_dwordx4 v20, s[68:71], s3 offen lds
 s_add_u32 m0, s66, 5120
 s_add_u32 s3, s67, 81920
 buffer_load_dwordx4 v20, s[68:71], s3 offen lds
 s_add_u32 m0, s66, 6144
 s_add_u32 s3, s67, 98304
 buffer_load_dwordx4 v20, s[68:71], s3 offen lds
 s_add_u32 m0, s66, 7168
 s_add_u32 s3, s67, 114688
 buffer_load_dwordx4 v20, s[68:71], s3 offen lds
 s_add_u32 m0, s66, 8192
 s_add_u32 s3, s67, 131072
 buffer_load_dwordx4 v20, s[68:71], s3 offen lds
 s_add_u32 m0, s66, 9216
 s_add_u32 s3, s67, 147456
 buffer_load_dwordx4 v20, s[68:71], s3 offen lds
 s_add_u32 m0, s66, 10240
 s_add_u32 s3, s67, 163840
 buffer_load_dwordx4 v20, s[68:71], s3 offen lds
 s_add_u32 m0, s66, 11264
 s_add_u32 s3, s67, 180224
 buffer_load_dwordx4 v20, s[68:71], s3 offen lds
 s_add_u32 m0, s66, 12288
 s_add_u32 s3, s67, 196608
 buffer_load_dwordx4 v20, s[68:71], s3 offen lds
 s_add_u32 m0, s66, 13312
 s_add_u32 s3, s67, 212992
 buffer_load_dwordx4 v20, s[68:71], s3 offen lds
 s_add_u32 m0, s66, 14336
 s_add_u32 s3, s67, 229376
 buffer_load_dwordx4 v20, s[68:71], s3 offen lds
 s_add_u32 m0, s66, 15360
 s_add_u32 s3, s67, 245760
 buffer_load_dwordx4 v20, s[68:71], s3 offen lds
 s_add_u32 m0, s66, 16384
 s_add_u32 s3, s67, 262144
 buffer_load_dwordx4 v20, s[68:71], s3 offen lds
 s_add_u32 m0, s66, 17408
 s_add_u32 s3, s67, 278528
 buffer_load_dwordx4 v20, s[68:71], s3 offen lds
 s_add_u32 m0, s66, 18432
 s_add_u32 s3, s67, 294912
 buffer_load_dwordx4 v20, s[68:71], s3 offen lds
 s_add_u32 m0, s66, 19456
 s_add_u32 s3, s67, 311296
 buffer_load_dwordx4 v20, s[68:71], s3 offen lds
 s_add_u32 m0, s66, 20480
 s_add_u32 s3, s67, 327680
 buffer_load_dwordx4 v20, s[68:71], s3 offen lds
 s_add_u32 m0, s66, 21504
 s_add_u32 s3, s67, 344064
 buffer_load_dwordx4 v20, s[68:71], s3 offen lds
 s_add_u32 m0, s66, 22528
 s_add_u32 s3, s67, 360448
 buffer_load_dwordx4 v20, s[68:71], s3 offen lds
 s_add_u32 m0, s66, 23552
 s_add_u32 s3, s67, 376832
 buffer_load_dwordx4 v20, s[68:71], s3 offen lds
 s_add_u32 m0, s66, 24576
 s_add_u32 s3, s67, 393216
 buffer_load_dwordx4 v20, s[68:71], s3 offen lds
 s_add_u32 m0, s66, 25600
 s_add_u32 s3, s67, 409600
 buffer_load_dwordx4 v20, s[68:71], s3 offen lds
 s_add_u32 m0, s66, 26624
 s_add_u32 s3, s67, 425984
 buffer_load_dwordx4 v20, s[68:71], s3 offen lds
 s_add_u32 m0, s66, 27648
 s_add_u32 s3, s67, 442368
 buffer_load_dwordx4 v20, s[68:71], s3 offen lds
 s_add_u32 m0, s66, 28672
 s_add_u32 s3, s67, 458752
 buffer_load_dwordx4 v20, s[68:71], s3 offen lds
 s_add_u32 m0, s66, 29696
 s_add_u32 s3, s67, 475136
 buffer_load_dwordx4 v20, s[68:71], s3 offen lds
 s_add_u32 m0, s66, 30720
 s_add_u32 s3, s67, 491520
 buffer_load_dwordx4 v20, s[68:71], s3 offen lds
 s_add_u32 m0, s66, 31744
 s_add_u32 s3, s67, 507904
 buffer_load_dwordx4 v20, s[68:71], s3 offen lds
 v_and_b32 v11, 7, v8
 v_lshlrev_b32 v2, 2, v11
 v_mov_b32 v5, 0
 s_and_b32 s3, s47, 1
 s_lshl_b32 s34, s41, 1
 s_add_u32 s34, s34, s3
 s_lshl_b32 s35, s42, 4
 v_add_u32 v11, s35, v9
 v_lshlrev_b32 v12, 10, v11
 v_lshl_add_u32 v12, v10, 3, v12
 s_lshl_b32 s60, s34, 5
 v_add_u32 v3, s60, v12
 v_and_b32 v12, 1, v10
 v_lshl_add_u32 v12, v12, 5, v11
 v_lshlrev_b32 v12, 4, v12
 v_lshrrev_b32 v13, 1, v10
 v_lshl_add_u32 v12, v13, 3, v12
 s_lshl_b32 s60, s34, 10
 v_add_u32 v4, s60, v12
 s_lshl_b32 s3, s3, 10
 s_add_u32 s3, s3, 131072
 v_add_u32 v6, s3, v1
 s_lshl_b32 s3, s47, 11
 s_add_u32 s3, s3, 131072
 v_add_u32 v7, s3, v1
 s_waitcnt vmcnt(16)
 ds_read_b64_tr_b16 a[0:1], v21 offset:0
 ds_read_b64_tr_b16 a[2:3], v21 offset:1024
 ds_read_b64_tr_b16 a[4:5], v21 offset:2048
 ds_read_b64_tr_b16 a[6:7], v21 offset:3072
 ds_read_b64_tr_b16 a[8:9], v21 offset:4096
 ds_read_b64_tr_b16 a[10:11], v21 offset:5120
 ds_read_b64_tr_b16 a[12:13], v21 offset:6144
 ds_read_b64_tr_b16 a[14:15], v21 offset:7168
 s_waitcnt lgkmcnt(0)
 ds_read_b64_tr_b16 a[16:17], v21 offset:8192
 ds_read_b64_tr_b16 a[18:19], v21 offset:9216
 ds_read_b64_tr_b16 a[20:21], v21 offset:10240
 ds_read_b64_tr_b16 a[22:23], v21 offset:11264
 ds_read_b64_tr_b16 a[24:25], v21 offset:12288
 ds_read_b64_tr_b16 a[26:27], v21 offset:13312
 ds_read_b64_tr_b16 a[28:29], v21 offset:14336
 ds_read_b64_tr_b16 a[30:31], v21 offset:15360
 s_waitcnt lgkmcnt(0)
 ds_read_b64_tr_b16 a[128:129], v21 offset:32
 ds_read_b64_tr_b16 a[130:131], v21 offset:1056
 ds_read_b64_tr_b16 a[132:133], v21 offset:2080
 ds_read_b64_tr_b16 a[134:135], v21 offset:3104
 ds_read_b64_tr_b16 a[136:137], v21 offset:4128
 ds_read_b64_tr_b16 a[138:139], v21 offset:5152
 ds_read_b64_tr_b16 a[140:141], v21 offset:6176
 ds_read_b64_tr_b16 a[142:143], v21 offset:7200
 s_waitcnt lgkmcnt(0)
 ds_read_b64_tr_b16 a[144:145], v21 offset:8224
 ds_read_b64_tr_b16 a[146:147], v21 offset:9248
 ds_read_b64_tr_b16 a[148:149], v21 offset:10272
 ds_read_b64_tr_b16 a[150:151], v21 offset:11296
 ds_read_b64_tr_b16 a[152:153], v21 offset:12320
 ds_read_b64_tr_b16 a[154:155], v21 offset:13344
 ds_read_b64_tr_b16 a[156:157], v21 offset:14368
 ds_read_b64_tr_b16 a[158:159], v21 offset:15392
 s_waitcnt lgkmcnt(0)
 s_add_u32 m0, s66, 0
 s_add_u32 s3, s67, 524288
 buffer_load_dwordx4 v20, s[68:71], s3 offen lds
 s_add_u32 m0, s66, 1024
 s_add_u32 s3, s67, 540672
 buffer_load_dwordx4 v20, s[68:71], s3 offen lds
 s_add_u32 m0, s66, 2048
 s_add_u32 s3, s67, 557056
 buffer_load_dwordx4 v20, s[68:71], s3 offen lds
 s_add_u32 m0, s66, 3072
 s_add_u32 s3, s67, 573440
 buffer_load_dwordx4 v20, s[68:71], s3 offen lds
 s_add_u32 m0, s66, 4096
 s_add_u32 s3, s67, 589824
 buffer_load_dwordx4 v20, s[68:71], s3 offen lds
 s_add_u32 m0, s66, 5120
 s_add_u32 s3, s67, 606208
 buffer_load_dwordx4 v20, s[68:71], s3 offen lds
 s_add_u32 m0, s66, 6144
 s_add_u32 s3, s67, 622592
 buffer_load_dwordx4 v20, s[68:71], s3 offen lds
 s_add_u32 m0, s66, 7168
 s_add_u32 s3, s67, 638976
 buffer_load_dwordx4 v20, s[68:71], s3 offen lds
 s_add_u32 m0, s66, 8192
 s_add_u32 s3, s67, 655360
 buffer_load_dwordx4 v20, s[68:71], s3 offen lds
 s_add_u32 m0, s66, 9216
 s_add_u32 s3, s67, 671744
 buffer_load_dwordx4 v20, s[68:71], s3 offen lds
 s_add_u32 m0, s66, 10240
 s_add_u32 s3, s67, 688128
 buffer_load_dwordx4 v20, s[68:71], s3 offen lds
 s_add_u32 m0, s66, 11264
 s_add_u32 s3, s67, 704512
 buffer_load_dwordx4 v20, s[68:71], s3 offen lds
 s_add_u32 m0, s66, 12288
 s_add_u32 s3, s67, 720896
 buffer_load_dwordx4 v20, s[68:71], s3 offen lds
 s_add_u32 m0, s66, 13312
 s_add_u32 s3, s67, 737280
 buffer_load_dwordx4 v20, s[68:71], s3 offen lds
 s_add_u32 m0, s66, 14336
 s_add_u32 s3, s67, 753664
 buffer_load_dwordx4 v20, s[68:71], s3 offen lds
 s_add_u32 m0, s66, 15360
 s_add_u32 s3, s67, 770048
 buffer_load_dwordx4 v20, s[68:71], s3 offen lds
 s_waitcnt vmcnt(16)
 ds_read_b64_tr_b16 a[32:33], v21 offset:16384
 ds_read_b64_tr_b16 a[34:35], v21 offset:17408
 ds_read_b64_tr_b16 a[36:37], v21 offset:18432
 ds_read_b64_tr_b16 a[38:39], v21 offset:19456
 ds_read_b64_tr_b16 a[40:41], v21 offset:20480
 ds_read_b64_tr_b16 a[42:43], v21 offset:21504
 ds_read_b64_tr_b16 a[44:45], v21 offset:22528
 ds_read_b64_tr_b16 a[46:47], v21 offset:23552
 s_waitcnt lgkmcnt(0)
 ds_read_b64_tr_b16 a[48:49], v21 offset:24576
 ds_read_b64_tr_b16 a[50:51], v21 offset:25600
 ds_read_b64_tr_b16 a[52:53], v21 offset:26624
 ds_read_b64_tr_b16 a[54:55], v21 offset:27648
 ds_read_b64_tr_b16 a[56:57], v21 offset:28672
 ds_read_b64_tr_b16 a[58:59], v21 offset:29696
 ds_read_b64_tr_b16 a[60:61], v21 offset:30720
 ds_read_b64_tr_b16 a[62:63], v21 offset:31744
 s_waitcnt lgkmcnt(0)
 ds_read_b64_tr_b16 a[160:161], v21 offset:16416
 ds_read_b64_tr_b16 a[162:163], v21 offset:17440
 ds_read_b64_tr_b16 a[164:165], v21 offset:18464
 ds_read_b64_tr_b16 a[166:167], v21 offset:19488
 ds_read_b64_tr_b16 a[168:169], v21 offset:20512
 ds_read_b64_tr_b16 a[170:171], v21 offset:21536
 ds_read_b64_tr_b16 a[172:173], v21 offset:22560
 ds_read_b64_tr_b16 a[174:175], v21 offset:23584
 s_waitcnt lgkmcnt(0)
 ds_read_b64_tr_b16 a[176:177], v21 offset:24608
 ds_read_b64_tr_b16 a[178:179], v21 offset:25632
 ds_read_b64_tr_b16 a[180:181], v21 offset:26656
 ds_read_b64_tr_b16 a[182:183], v21 offset:27680
 ds_read_b64_tr_b16 a[184:185], v21 offset:28704
 ds_read_b64_tr_b16 a[186:187], v21 offset:29728
 ds_read_b64_tr_b16 a[188:189], v21 offset:30752
 ds_read_b64_tr_b16 a[190:191], v21 offset:31776
 s_waitcnt lgkmcnt(0)
 s_add_u32 m0, s66, 16384
 s_add_u32 s3, s67, 786432
 buffer_load_dwordx4 v20, s[68:71], s3 offen lds
 s_add_u32 m0, s66, 17408
 s_add_u32 s3, s67, 802816
 buffer_load_dwordx4 v20, s[68:71], s3 offen lds
 s_add_u32 m0, s66, 18432
 s_add_u32 s3, s67, 819200
 buffer_load_dwordx4 v20, s[68:71], s3 offen lds
 s_add_u32 m0, s66, 19456
 s_add_u32 s3, s67, 835584
 buffer_load_dwordx4 v20, s[68:71], s3 offen lds
 s_add_u32 m0, s66, 20480
 s_add_u32 s3, s67, 851968
 buffer_load_dwordx4 v20, s[68:71], s3 offen lds
 s_add_u32 m0, s66, 21504
 s_add_u32 s3, s67, 868352
 buffer_load_dwordx4 v20, s[68:71], s3 offen lds
 s_add_u32 m0, s66, 22528
 s_add_u32 s3, s67, 884736
 buffer_load_dwordx4 v20, s[68:71], s3 offen lds
 s_add_u32 m0, s66, 23552
 s_add_u32 s3, s67, 901120
 buffer_load_dwordx4 v20, s[68:71], s3 offen lds
 s_add_u32 m0, s66, 24576
 s_add_u32 s3, s67, 917504
 buffer_load_dwordx4 v20, s[68:71], s3 offen lds
 s_add_u32 m0, s66, 25600
 s_add_u32 s3, s67, 933888
 buffer_load_dwordx4 v20, s[68:71], s3 offen lds
 s_add_u32 m0, s66, 26624
 s_add_u32 s3, s67, 950272
 buffer_load_dwordx4 v20, s[68:71], s3 offen lds
 s_add_u32 m0, s66, 27648
 s_add_u32 s3, s67, 966656
 buffer_load_dwordx4 v20, s[68:71], s3 offen lds
 s_add_u32 m0, s66, 28672
 s_add_u32 s3, s67, 983040
 buffer_load_dwordx4 v20, s[68:71], s3 offen lds
 s_add_u32 m0, s66, 29696
 s_add_u32 s3, s67, 999424
 buffer_load_dwordx4 v20, s[68:71], s3 offen lds
 s_add_u32 m0, s66, 30720
 s_add_u32 s3, s67, 1015808
 buffer_load_dwordx4 v20, s[68:71], s3 offen lds
 s_add_u32 m0, s66, 31744
 s_add_u32 s3, s67, 1032192
 buffer_load_dwordx4 v20, s[68:71], s3 offen lds
 s_waitcnt vmcnt(16)
 ds_read_b64_tr_b16 a[64:65], v21 offset:0
 ds_read_b64_tr_b16 a[66:67], v21 offset:1024
 ds_read_b64_tr_b16 a[68:69], v21 offset:2048
 ds_read_b64_tr_b16 a[70:71], v21 offset:3072
 ds_read_b64_tr_b16 a[72:73], v21 offset:4096
 ds_read_b64_tr_b16 a[74:75], v21 offset:5120
 ds_read_b64_tr_b16 a[76:77], v21 offset:6144
 ds_read_b64_tr_b16 a[78:79], v21 offset:7168
 s_waitcnt lgkmcnt(0)
 ds_read_b64_tr_b16 a[80:81], v21 offset:8192
 ds_read_b64_tr_b16 a[82:83], v21 offset:9216
 ds_read_b64_tr_b16 a[84:85], v21 offset:10240
 ds_read_b64_tr_b16 a[86:87], v21 offset:11264
 ds_read_b64_tr_b16 a[88:89], v21 offset:12288
 ds_read_b64_tr_b16 a[90:91], v21 offset:13312
 ds_read_b64_tr_b16 a[92:93], v21 offset:14336
 ds_read_b64_tr_b16 a[94:95], v21 offset:15360
 s_waitcnt lgkmcnt(0)
 ds_read_b64_tr_b16 a[192:193], v21 offset:32
 ds_read_b64_tr_b16 a[194:195], v21 offset:1056
 ds_read_b64_tr_b16 a[196:197], v21 offset:2080
 ds_read_b64_tr_b16 a[198:199], v21 offset:3104
 ds_read_b64_tr_b16 a[200:201], v21 offset:4128
 ds_read_b64_tr_b16 a[202:203], v21 offset:5152
 ds_read_b64_tr_b16 a[204:205], v21 offset:6176
 ds_read_b64_tr_b16 a[206:207], v21 offset:7200
 s_waitcnt lgkmcnt(0)
 ds_read_b64_tr_b16 a[208:209], v21 offset:8224
 ds_read_b64_tr_b16 a[210:211], v21 offset:9248
 ds_read_b64_tr_b16 a[212:213], v21 offset:10272
 ds_read_b64_tr_b16 a[214:215], v21 offset:11296
 ds_read_b64_tr_b16 a[216:217], v21 offset:12320
 ds_read_b64_tr_b16 a[218:219], v21 offset:13344
 ds_read_b64_tr_b16 a[220:221], v21 offset:14368
 ds_read_b64_tr_b16 a[222:223], v21 offset:15392
 s_waitcnt lgkmcnt(0)
 s_waitcnt vmcnt(0)
 ds_read_b64_tr_b16 a[96:97], v21 offset:16384
 ds_read_b64_tr_b16 a[98:99], v21 offset:17408
 ds_read_b64_tr_b16 a[100:101], v21 offset:18432
 ds_read_b64_tr_b16 a[102:103], v21 offset:19456
 ds_read_b64_tr_b16 a[104:105], v21 offset:20480
 ds_read_b64_tr_b16 a[106:107], v21 offset:21504
 ds_read_b64_tr_b16 a[108:109], v21 offset:22528
 ds_read_b64_tr_b16 a[110:111], v21 offset:23552
 s_waitcnt lgkmcnt(0)
 ds_read_b64_tr_b16 a[112:113], v21 offset:24576
 ds_read_b64_tr_b16 a[114:115], v21 offset:25600
 ds_read_b64_tr_b16 a[116:117], v21 offset:26624
 ds_read_b64_tr_b16 a[118:119], v21 offset:27648
 ds_read_b64_tr_b16 a[120:121], v21 offset:28672
 ds_read_b64_tr_b16 a[122:123], v21 offset:29696
 ds_read_b64_tr_b16 a[124:125], v21 offset:30720
 ds_read_b64_tr_b16 a[126:127], v21 offset:31744
 s_waitcnt lgkmcnt(0)
 ds_read_b64_tr_b16 a[224:225], v21 offset:16416
 ds_read_b64_tr_b16 a[226:227], v21 offset:17440
 ds_read_b64_tr_b16 a[228:229], v21 offset:18464
 ds_read_b64_tr_b16 a[230:231], v21 offset:19488
 ds_read_b64_tr_b16 a[232:233], v21 offset:20512
 ds_read_b64_tr_b16 a[234:235], v21 offset:21536
 ds_read_b64_tr_b16 a[236:237], v21 offset:22560
 ds_read_b64_tr_b16 a[238:239], v21 offset:23584
 s_waitcnt lgkmcnt(0)
 ds_read_b64_tr_b16 a[240:241], v21 offset:24608
 ds_read_b64_tr_b16 a[242:243], v21 offset:25632
 ds_read_b64_tr_b16 a[244:245], v21 offset:26656
 ds_read_b64_tr_b16 a[246:247], v21 offset:27680
 ds_read_b64_tr_b16 a[248:249], v21 offset:28704
 ds_read_b64_tr_b16 a[250:251], v21 offset:29728
 ds_read_b64_tr_b16 a[252:253], v21 offset:30752
 ds_read_b64_tr_b16 a[254:255], v21 offset:31776
 s_waitcnt lgkmcnt(0)
 s_mov_b32 s60, 0
 s_mov_b32 s61, 0
 s_mov_b32 s63, s43
 s_mov_b32 s49, 6144
 v_and_b32 v14, 63, v0
 v_and_b32 v15, 31, v14
 v_lshlrev_b32 v21, 2, v15
 s_and_b32 s3, s47, 1
 s_lshl_b32 s3, s3, 9
 s_add_u32 s3, s3, 0
 v_lshl_add_u32 v20, v14, 3, s3
 .p2align 6
S4_L:
 s_lshl_b32 s3, s43, 1
 s_add_u32 s3, s3, s42
 s_lshl_b32 s3, s3, 2
 s_add_u32 s3, s3, s47
 s_lshl_b32 s44, s3, 15
 s_add_u32 s44, s44, 67108864
 s_lshl_b32 s45, s43, 7
 s_lshl_b32 s3, s47, 5
 s_add_u32 s45, s45, s3
 s_add_u32 s45, s45, 8192
 s_lshl_b32 s46, s43, 15
 s_add_u32 s48, s46, 83886080
 s_cmp_ge_u32 s47, 2
 s_cbranch_scc1 S4_nog
 s_cmp_eq_u32 s60, 1
 s_cbranch_scc1 S4_gok
 buffer_load_dword v14, v21, s[36:39], s49 offen sc1
 s_waitcnt vmcnt(0)
 v_cmp_gt_u32 vcc, 1, v14
 s_cbranch_vccnz S4_nog
 s_mov_b32 s60, 1
 s_mov_b32 s62, 0
 s_cmp_eq_u32 s61, 0
 s_cbranch_scc1 S4_f1_e
S4_f1:
 s_add_u32 s3, s62, 0
 s_sub_u32 s34, s61, 1
 s_min_u32 s3, s3, s34
 s_lshl_b32 s34, s3, 10
 v_add_u32 v40, s34, v20
 ds_read_b64 v[68:69], v40
 s_mul_i32 s3, s3, 4
 s_add_u32 s3, s3, s63
 s_lshl_b32 s74, s3, 15
 s_add_u32 s34, s74, 83886080
 buffer_load_dwordx2 v[64:65], v3, s[52:55], s74 offen
 buffer_load_dwordx2 v[66:67], v4, s[36:39], s34 offen sc1
 s_add_u32 s3, s62, 1
 s_sub_u32 s34, s61, 1
 s_min_u32 s3, s3, s34
 s_lshl_b32 s34, s3, 10
 v_add_u32 v41, s34, v20
 ds_read_b64 v[76:77], v41
 s_mul_i32 s3, s3, 4
 s_add_u32 s3, s3, s63
 s_lshl_b32 s75, s3, 15
 s_add_u32 s34, s75, 83886080
 buffer_load_dwordx2 v[72:73], v3, s[52:55], s75 offen
 buffer_load_dwordx2 v[74:75], v4, s[36:39], s34 offen sc1
 s_add_u32 s3, s62, 2
 s_sub_u32 s34, s61, 1
 s_min_u32 s3, s3, s34
 s_lshl_b32 s34, s3, 10
 v_add_u32 v42, s34, v20
 ds_read_b64 v[84:85], v42
 s_mul_i32 s3, s3, 4
 s_add_u32 s3, s3, s63
 s_lshl_b32 s76, s3, 15
 s_add_u32 s34, s76, 83886080
 buffer_load_dwordx2 v[80:81], v3, s[52:55], s76 offen
 buffer_load_dwordx2 v[82:83], v4, s[36:39], s34 offen sc1
 s_add_u32 s3, s62, 3
 s_sub_u32 s34, s61, 1
 s_min_u32 s3, s3, s34
 s_lshl_b32 s34, s3, 10
 v_add_u32 v43, s34, v20
 ds_read_b64 v[92:93], v43
 s_mul_i32 s3, s3, 4
 s_add_u32 s3, s3, s63
 s_lshl_b32 s77, s3, 15
 s_add_u32 s34, s77, 83886080
 buffer_load_dwordx2 v[88:89], v3, s[52:55], s77 offen
 buffer_load_dwordx2 v[90:91], v4, s[36:39], s34 offen sc1
 s_waitcnt lgkmcnt(3)
 v_lshlrev_b32 v28, 16, v68
 v_and_b32 v29, 0xffff0000, v68
 s_waitcnt vmcnt(6)
 v_lshlrev_b32 v30, 16, v66
 v_and_b32 v31, 0xffff0000, v66
 v_mul_f32 v28, v28, v30
 v_mul_f32 v29, v29, v31
 v_cvt_pk_bf16_f32 v29, v28, v29
 v_lshlrev_b32 v28, 16, v29
 v_and_b32 v29, 0xffff0000, v29
 v_lshlrev_b32 v30, 16, v64
 v_and_b32 v31, 0xffff0000, v64
 v_add_f32 v28, v28, v30
 v_add_f32 v29, v29, v31
 v_cvt_pk_bf16_f32 v68, v28, v29
 v_lshlrev_b32 v28, 16, v69
 v_and_b32 v29, 0xffff0000, v69
 v_lshlrev_b32 v30, 16, v67
 v_and_b32 v31, 0xffff0000, v67
 v_mul_f32 v28, v28, v30
 v_mul_f32 v29, v29, v31
 v_cvt_pk_bf16_f32 v29, v28, v29
 v_lshlrev_b32 v28, 16, v29
 v_and_b32 v29, 0xffff0000, v29
 v_lshlrev_b32 v30, 16, v65
 v_and_b32 v31, 0xffff0000, v65
 v_add_f32 v28, v28, v30
 v_add_f32 v29, v29, v31
 v_cvt_pk_bf16_f32 v69, v28, v29
 buffer_store_dwordx2 v[68:69], v3, s[56:59], s74 offen nt
 s_waitcnt lgkmcnt(2)
 v_lshlrev_b32 v28, 16, v76
 v_and_b32 v29, 0xffff0000, v76
 s_waitcnt vmcnt(5)
 v_lshlrev_b32 v30, 16, v74
 v_and_b32 v31, 0xffff0000, v74
 v_mul_f32 v28, v28, v30
 v_mul_f32 v29, v29, v31
 v_cvt_pk_bf16_f32 v29, v28, v29
 v_lshlrev_b32 v28, 16, v29
 v_and_b32 v29, 0xffff0000, v29
 v_lshlrev_b32 v30, 16, v72
 v_and_b32 v31, 0xffff0000, v72
 v_add_f32 v28, v28, v30
 v_add_f32 v29, v29, v31
 v_cvt_pk_bf16_f32 v76, v28, v29
 v_lshlrev_b32 v28, 16, v77
 v_and_b32 v29, 0xffff0000, v77
 v_lshlrev_b32 v30, 16, v75
 v_and_b32 v31, 0xffff0000, v75
 v_mul_f32 v28, v28, v30
 v_mul_f32 v29, v29, v31
 v_cvt_pk_bf16_f32 v29, v28, v29
 v_lshlrev_b32 v28, 16, v29
 v_and_b32 v29, 0xffff0000, v29
 v_lshlrev_b32 v30, 16, v73
 v_and_b32 v31, 0xffff0000, v73
 v_add_f32 v28, v28, v30
 v_add_f32 v29, v29, v31
 v_cvt_pk_bf16_f32 v77, v28, v29
 buffer_store_dwordx2 v[76:77], v3, s[56:59], s75 offen nt
 s_waitcnt lgkmcnt(1)
 v_lshlrev_b32 v28, 16, v84
 v_and_b32 v29, 0xffff0000, v84
 s_waitcnt vmcnt(4)
 v_lshlrev_b32 v30, 16, v82
 v_and_b32 v31, 0xffff0000, v82
 v_mul_f32 v28, v28, v30
 v_mul_f32 v29, v29, v31
 v_cvt_pk_bf16_f32 v29, v28, v29
 v_lshlrev_b32 v28, 16, v29
 v_and_b32 v29, 0xffff0000, v29
 v_lshlrev_b32 v30, 16, v80
 v_and_b32 v31, 0xffff0000, v80
 v_add_f32 v28, v28, v30
 v_add_f32 v29, v29, v31
 v_cvt_pk_bf16_f32 v84, v28, v29
 v_lshlrev_b32 v28, 16, v85
 v_and_b32 v29, 0xffff0000, v85
 v_lshlrev_b32 v30, 16, v83
 v_and_b32 v31, 0xffff0000, v83
 v_mul_f32 v28, v28, v30
 v_mul_f32 v29, v29, v31
 v_cvt_pk_bf16_f32 v29, v28, v29
 v_lshlrev_b32 v28, 16, v29
 v_and_b32 v29, 0xffff0000, v29
 v_lshlrev_b32 v30, 16, v81
 v_and_b32 v31, 0xffff0000, v81
 v_add_f32 v28, v28, v30
 v_add_f32 v29, v29, v31
 v_cvt_pk_bf16_f32 v85, v28, v29
 buffer_store_dwordx2 v[84:85], v3, s[56:59], s76 offen nt
 s_waitcnt lgkmcnt(0)
 v_lshlrev_b32 v28, 16, v92
 v_and_b32 v29, 0xffff0000, v92
 s_waitcnt vmcnt(3)
 v_lshlrev_b32 v30, 16, v90
 v_and_b32 v31, 0xffff0000, v90
 v_mul_f32 v28, v28, v30
 v_mul_f32 v29, v29, v31
 v_cvt_pk_bf16_f32 v29, v28, v29
 v_lshlrev_b32 v28, 16, v29
 v_and_b32 v29, 0xffff0000, v29
 v_lshlrev_b32 v30, 16, v88
 v_and_b32 v31, 0xffff0000, v88
 v_add_f32 v28, v28, v30
 v_add_f32 v29, v29, v31
 v_cvt_pk_bf16_f32 v92, v28, v29
 v_lshlrev_b32 v28, 16, v93
 v_and_b32 v29, 0xffff0000, v93
 v_lshlrev_b32 v30, 16, v91
 v_and_b32 v31, 0xffff0000, v91
 v_mul_f32 v28, v28, v30
 v_mul_f32 v29, v29, v31
 v_cvt_pk_bf16_f32 v29, v28, v29
 v_lshlrev_b32 v28, 16, v29
 v_and_b32 v29, 0xffff0000, v29
 v_lshlrev_b32 v30, 16, v89
 v_and_b32 v31, 0xffff0000, v89
 v_add_f32 v28, v28, v30
 v_add_f32 v29, v29, v31
 v_cvt_pk_bf16_f32 v93, v28, v29
 buffer_store_dwordx2 v[92:93], v3, s[56:59], s77 offen nt
 s_add_u32 s62, s62, 4
 s_cmp_lt_u32 s62, s61
 s_cbranch_scc1 S4_f1
 s_waitcnt vmcnt(0)
S4_f1_e:
S4_gok:
 buffer_load_dwordx2 v[8:9], v3, s[52:55], s46 offen
 buffer_load_dwordx2 v[10:11], v4, s[36:39], s48 offen sc1
S4_nog:
 s_mov_b32 s3, 0
 s_branch S4_o_go
S4_o:
 s_sleep 2
S4_o_go:
 buffer_load_dword v14, v2, s[36:39], s45 offen sc1
 s_add_u32 s3, s3, 1
 s_cmp_gt_u32 s3, 131072
 s_cbranch_scc1 L_ABORT
 s_waitcnt vmcnt(0)
 v_cmp_gt_u32 vcc, 1, v14
 s_cbranch_vccnz S4_o
 buffer_load_dwordx4 v[64:67], v1, s[36:39], s44 offen offset:0 sc1
 buffer_load_dwordx4 v[68:71], v1, s[36:39], s44 offen offset:1024 sc1
 buffer_load_dwordx4 v[72:75], v1, s[36:39], s44 offen offset:2048 sc1
 buffer_load_dwordx4 v[76:79], v1, s[36:39], s44 offen offset:3072 sc1
 s_add_u32 s44, s44, 4096
 buffer_load_dwordx4 v[80:83], v1, s[36:39], s44 offen offset:0 sc1
 buffer_load_dwordx4 v[84:87], v1, s[36:39], s44 offen offset:1024 sc1
 buffer_load_dwordx4 v[88:91], v1, s[36:39], s44 offen offset:2048 sc1
 buffer_load_dwordx4 v[92:95], v1, s[36:39], s44 offen offset:3072 sc1
 s_add_u32 s44, s44, 4096
 buffer_load_dwordx4 v[96:99], v1, s[36:39], s44 offen offset:0 sc1
 buffer_load_dwordx4 v[100:103], v1, s[36:39], s44 offen offset:1024 sc1
 buffer_load_dwordx4 v[104:107], v1, s[36:39], s44 offen offset:2048 sc1
 buffer_load_dwordx4 v[108:111], v1, s[36:39], s44 offen offset:3072 sc1
 s_add_u32 s44, s44, 4096
 buffer_load_dwordx4 v[112:115], v1, s[36:39], s44 offen offset:0 sc1
 buffer_load_dwordx4 v[116:119], v1, s[36:39], s44 offen offset:1024 sc1
 buffer_load_dwordx4 v[120:123], v1, s[36:39], s44 offen offset:2048 sc1
 buffer_load_dwordx4 v[124:127], v1, s[36:39], s44 offen offset:3072 sc1
 s_add_u32 s44, s44, 4096
 buffer_load_dwordx4 v[128:131], v1, s[36:39], s44 offen offset:0 sc1
 buffer_load_dwordx4 v[132:135], v1, s[36:39], s44 offen offset:1024 sc1
 buffer_load_dwordx4 v[136:139], v1, s[36:39], s44 offen offset:2048 sc1
 buffer_load_dwordx4 v[140:143], v1, s[36:39], s44 offen offset:3072 sc1
 s_add_u32 s44, s44, 4096
 buffer_load_dwordx4 v[144:147], v1, s[36:39], s44 offen offset:0 sc1
 buffer_load_dwordx4 v[148:151], v1, s[36:39], s44 offen offset:1024 sc1
 buffer_load_dwordx4 v[152:155], v1, s[36:39], s44 offen offset:2048 sc1
 buffer_load_dwordx4 v[156:159], v1, s[36:39], s44 offen offset:3072 sc1
 s_add_u32 s44, s44, 4096
 buffer_load_dwordx4 v[160:163], v1, s[36:39], s44 offen offset:0 sc1
 buffer_load_dwordx4 v[164:167], v1, s[36:39], s44 offen offset:1024 sc1
 buffer_load_dwordx4 v[168:171], v1, s[36:39], s44 offen offset:2048 sc1
 buffer_load_dwordx4 v[172:175], v1, s[36:39], s44 offen offset:3072 sc1
 s_add_u32 s44, s44, 4096
 buffer_load_dwordx4 v[176:179], v1, s[36:39], s44 offen offset:0 sc1
 buffer_load_dwordx4 v[180:183], v1, s[36:39], s44 offen offset:1024 sc1
 buffer_load_dwordx4 v[184:187], v1, s[36:39], s44 offen offset:2048 sc1
 buffer_load_dwordx4 v[188:191], v1, s[36:39], s44 offen offset:3072 sc1
 s_add_u32 s44, s44, 4096
 s_waitcnt vmcnt(31)
 v_mfma_f32_16x16x32_bf16 v[12:15], a[0:3], v[64:67], 0
 v_mfma_f32_16x16x32_bf16 v[16:19], a[128:131], v[64:67], 0
 s_waitcnt vmcnt(30)
 v_mfma_f32_16x16x32_bf16 v[12:15], a[4:7], v[68:71], v[12:15]
 v_mfma_f32_16x16x32_bf16 v[16:19], a[132:135], v[68:71], v[16:19]
 s_waitcnt vmcnt(29)
 v_mfma_f32_16x16x32_bf16 v[12:15], a[8:11], v[72:75], v[12:15]
 v_mfma_f32_16x16x32_bf16 v[16:19], a[136:139], v[72:75], v[16:19]
 s_waitcnt vmcnt(28)
 v_mfma_f32_16x16x32_bf16 v[12:15], a[12:15], v[76:79], v[12:15]
 v_mfma_f32_16x16x32_bf16 v[16:19], a[140:143], v[76:79], v[16:19]
 s_waitcnt vmcnt(27)
 v_mfma_f32_16x16x32_bf16 v[12:15], a[16:19], v[80:83], v[12:15]
 v_mfma_f32_16x16x32_bf16 v[16:19], a[144:147], v[80:83], v[16:19]
 s_waitcnt vmcnt(26)
 v_mfma_f32_16x16x32_bf16 v[12:15], a[20:23], v[84:87], v[12:15]
 v_mfma_f32_16x16x32_bf16 v[16:19], a[148:151], v[84:87], v[16:19]
 s_waitcnt vmcnt(25)
 v_mfma_f32_16x16x32_bf16 v[12:15], a[24:27], v[88:91], v[12:15]
 v_mfma_f32_16x16x32_bf16 v[16:19], a[152:155], v[88:91], v[16:19]
 s_waitcnt vmcnt(24)
 v_mfma_f32_16x16x32_bf16 v[12:15], a[28:31], v[92:95], v[12:15]
 v_mfma_f32_16x16x32_bf16 v[16:19], a[156:159], v[92:95], v[16:19]
 s_waitcnt vmcnt(23)
 v_mfma_f32_16x16x32_bf16 v[12:15], a[32:35], v[96:99], v[12:15]
 v_mfma_f32_16x16x32_bf16 v[16:19], a[160:163], v[96:99], v[16:19]
 s_waitcnt vmcnt(22)
 v_mfma_f32_16x16x32_bf16 v[12:15], a[36:39], v[100:103], v[12:15]
 v_mfma_f32_16x16x32_bf16 v[16:19], a[164:167], v[100:103], v[16:19]
 s_waitcnt vmcnt(21)
 v_mfma_f32_16x16x32_bf16 v[12:15], a[40:43], v[104:107], v[12:15]
 v_mfma_f32_16x16x32_bf16 v[16:19], a[168:171], v[104:107], v[16:19]
 s_waitcnt vmcnt(20)
 v_mfma_f32_16x16x32_bf16 v[12:15], a[44:47], v[108:111], v[12:15]
 v_mfma_f32_16x16x32_bf16 v[16:19], a[172:175], v[108:111], v[16:19]
 s_waitcnt vmcnt(19)
 v_mfma_f32_16x16x32_bf16 v[12:15], a[48:51], v[112:115], v[12:15]
 v_mfma_f32_16x16x32_bf16 v[16:19], a[176:179], v[112:115], v[16:19]
 s_waitcnt vmcnt(18)
 v_mfma_f32_16x16x32_bf16 v[12:15], a[52:55], v[116:119], v[12:15]
 v_mfma_f32_16x16x32_bf16 v[16:19], a[180:183], v[116:119], v[16:19]
 s_waitcnt vmcnt(17)
 v_mfma_f32_16x16x32_bf16 v[12:15], a[56:59], v[120:123], v[12:15]
 v_mfma_f32_16x16x32_bf16 v[16:19], a[184:187], v[120:123], v[16:19]
 s_waitcnt vmcnt(16)
 v_mfma_f32_16x16x32_bf16 v[12:15], a[60:63], v[124:127], v[12:15]
 v_mfma_f32_16x16x32_bf16 v[16:19], a[188:191], v[124:127], v[16:19]
 s_waitcnt vmcnt(15)
 v_mfma_f32_16x16x32_bf16 v[12:15], a[64:67], v[128:131], v[12:15]
 v_mfma_f32_16x16x32_bf16 v[16:19], a[192:195], v[128:131], v[16:19]
 s_waitcnt vmcnt(14)
 v_mfma_f32_16x16x32_bf16 v[12:15], a[68:71], v[132:135], v[12:15]
 v_mfma_f32_16x16x32_bf16 v[16:19], a[196:199], v[132:135], v[16:19]
 s_waitcnt vmcnt(13)
 v_mfma_f32_16x16x32_bf16 v[12:15], a[72:75], v[136:139], v[12:15]
 v_mfma_f32_16x16x32_bf16 v[16:19], a[200:203], v[136:139], v[16:19]
 s_waitcnt vmcnt(12)
 v_mfma_f32_16x16x32_bf16 v[12:15], a[76:79], v[140:143], v[12:15]
 v_mfma_f32_16x16x32_bf16 v[16:19], a[204:207], v[140:143], v[16:19]
 s_waitcnt vmcnt(11)
 v_mfma_f32_16x16x32_bf16 v[12:15], a[80:83], v[144:147], v[12:15]
 v_mfma_f32_16x16x32_bf16 v[16:19], a[208:211], v[144:147], v[16:19]
 s_waitcnt vmcnt(10)
 v_mfma_f32_16x16x32_bf16 v[12:15], a[84:87], v[148:151], v[12:15]
 v_mfma_f32_16x16x32_bf16 v[16:19], a[212:215], v[148:151], v[16:19]
 s_waitcnt vmcnt(9)
 v_mfma_f32_16x16x32_bf16 v[12:15], a[88:91], v[152:155], v[12:15]
 v_mfma_f32_16x16x32_bf16 v[16:19], a[216:219], v[152:155], v[16:19]
 s_waitcnt vmcnt(8)
 v_mfma_f32_16x16x32_bf16 v[12:15], a[92:95], v[156:159], v[12:15]
 v_mfma_f32_16x16x32_bf16 v[16:19], a[220:223], v[156:159], v[16:19]
 s_waitcnt vmcnt(7)
 v_mfma_f32_16x16x32_bf16 v[12:15], a[96:99], v[160:163], v[12:15]
 v_mfma_f32_16x16x32_bf16 v[16:19], a[224:227], v[160:163], v[16:19]
 s_waitcnt vmcnt(6)
 v_mfma_f32_16x16x32_bf16 v[12:15], a[100:103], v[164:167], v[12:15]
 v_mfma_f32_16x16x32_bf16 v[16:19], a[228:231], v[164:167], v[16:19]
 s_waitcnt vmcnt(5)
 v_mfma_f32_16x16x32_bf16 v[12:15], a[104:107], v[168:171], v[12:15]
 v_mfma_f32_16x16x32_bf16 v[16:19], a[232:235], v[168:171], v[16:19]
 s_waitcnt vmcnt(4)
 v_mfma_f32_16x16x32_bf16 v[12:15], a[108:111], v[172:175], v[12:15]
 v_mfma_f32_16x16x32_bf16 v[16:19], a[236:239], v[172:175], v[16:19]
 s_waitcnt vmcnt(3)
 v_mfma_f32_16x16x32_bf16 v[12:15], a[112:115], v[176:179], v[12:15]
 v_mfma_f32_16x16x32_bf16 v[16:19], a[240:243], v[176:179], v[16:19]
 s_waitcnt vmcnt(2)
 v_mfma_f32_16x16x32_bf16 v[12:15], a[116:119], v[180:183], v[12:15]
 v_mfma_f32_16x16x32_bf16 v[16:19], a[244:247], v[180:183], v[16:19]
 s_waitcnt vmcnt(1)
 v_mfma_f32_16x16x32_bf16 v[12:15], a[120:123], v[184:187], v[12:15]
 v_mfma_f32_16x16x32_bf16 v[16:19], a[248:251], v[184:187], v[16:19]
 s_waitcnt vmcnt(0)
 v_mfma_f32_16x16x32_bf16 v[12:15], a[124:127], v[188:191], v[12:15]
 v_mfma_f32_16x16x32_bf16 v[16:19], a[252:255], v[188:191], v[16:19]
 s_nop 3
 ds_write_b128 v7, v[12:15]
 s_nop 2
 ds_write_b128 v7, v[16:19] offset:1024
 s_waitcnt lgkmcnt(0)
 s_barrier
 s_cmp_ge_u32 s47, 2
 s_cbranch_scc1 S4_next
 ds_read_b128 v[24:27], v6 offset:0
 ds_read_b128 v[28:31], v6 offset:2048
 ds_read_b128 v[32:35], v6 offset:4096
 ds_read_b128 v[36:39], v6 offset:6144
 s_waitcnt lgkmcnt(2)
 v_add_f32 v24, v24, v28
 s_waitcnt lgkmcnt(0)
 v_add_f32 v32, v32, v36
 v_add_f32 v24, v24, v32
 v_add_f32 v25, v25, v29
 v_add_f32 v33, v33, v37
 v_add_f32 v25, v25, v33
 v_add_f32 v26, v26, v30
 v_add_f32 v34, v34, v38
 v_add_f32 v26, v26, v34
 v_add_f32 v27, v27, v31
 v_add_f32 v35, v35, v39
 v_add_f32 v27, v27, v35
 v_cvt_pk_bf16_f32 v36, v24, v25
 v_cvt_pk_bf16_f32 v37, v26, v27
 s_cmp_eq_u32 s60, 1
 s_cbranch_scc1 S4_fin
 s_lshl_b32 s3, s61, 10
 v_add_u32 v14, s3, v20
 ds_write_b64 v14, v[36:37]
 s_add_u32 s61, s61, 1
 s_waitcnt lgkmcnt(0)
 s_branch S4_next
S4_fin:
 v_lshlrev_b32 v28, 16, v36
 v_and_b32 v29, 0xffff0000, v36
 v_lshlrev_b32 v30, 16, v10
 v_and_b32 v31, 0xffff0000, v10
 v_mul_f32 v28, v28, v30
 v_mul_f32 v29, v29, v31
 v_cvt_pk_bf16_f32 v29, v28, v29
 v_lshlrev_b32 v28, 16, v29
 v_and_b32 v29, 0xffff0000, v29
 v_lshlrev_b32 v30, 16, v8
 v_and_b32 v31, 0xffff0000, v8
 v_add_f32 v28, v28, v30
 v_add_f32 v29, v29, v31
 v_cvt_pk_bf16_f32 v36, v28, v29
 v_lshlrev_b32 v28, 16, v37
 v_and_b32 v29, 0xffff0000, v37
 v_lshlrev_b32 v30, 16, v11
 v_and_b32 v31, 0xffff0000, v11
 v_mul_f32 v28, v28, v30
 v_mul_f32 v29, v29, v31
 v_cvt_pk_bf16_f32 v29, v28, v29
 v_lshlrev_b32 v28, 16, v29
 v_and_b32 v29, 0xffff0000, v29
 v_lshlrev_b32 v30, 16, v9
 v_and_b32 v31, 0xffff0000, v9
 v_add_f32 v28, v28, v30
 v_add_f32 v29, v29, v31
 v_cvt_pk_bf16_f32 v37, v28, v29
 buffer_store_dwordx2 v[36:37], v3, s[56:59], s46 offen nt
S4_next:
 v_xor_b32 v7, 0x2000, v7
 v_xor_b32 v6, 0x2000, v6
 s_add_u32 s43, s43, 4
 s_cmp_lt_u32 s43, 64
 s_cbranch_scc1 S4_L
 s_cmp_ge_u32 s47, 2
 s_cbranch_scc1 L_DONE
 s_cmp_eq_u32 s60, 1
 s_cbranch_scc1 L_DONE
 s_mov_b32 s3, 0
 s_branch S4_g_go
S4_g:
 s_sleep 4
S4_g_go:
 buffer_load_dword v14, v21, s[36:39], s49 offen sc1
 s_add_u32 s3, s3, 1
 s_cmp_gt_u32 s3, 131072
 s_cbranch_scc1 L_ABORT
 s_waitcnt vmcnt(0)
 v_cmp_gt_u32 vcc, 1, v14
 s_cbranch_vccnz S4_g
 s_mov_b32 s60, 1
 s_mov_b32 s62, 0
 s_cmp_eq_u32 s61, 0
 s_cbranch_scc1 S4_f2_e
S4_f2:
 s_add_u32 s3, s62, 0
 s_sub_u32 s34, s61, 1
 s_min_u32 s3, s3, s34
 s_lshl_b32 s34, s3, 10
 v_add_u32 v40, s34, v20
 ds_read_b64 v[68:69], v40
 s_mul_i32 s3, s3, 4
 s_add_u32 s3, s3, s63
 s_lshl_b32 s74, s3, 15
 s_add_u32 s34, s74, 83886080
 buffer_load_dwordx2 v[64:65], v3, s[52:55], s74 offen
 buffer_load_dwordx2 v[66:67], v4, s[36:39], s34 offen sc1
 s_add_u32 s3, s62, 1
 s_sub_u32 s34, s61, 1
 s_min_u32 s3, s3, s34
 s_lshl_b32 s34, s3, 10
 v_add_u32 v41, s34, v20
 ds_read_b64 v[76:77], v41
 s_mul_i32 s3, s3, 4
 s_add_u32 s3, s3, s63
 s_lshl_b32 s75, s3, 15
 s_add_u32 s34, s75, 83886080
 buffer_load_dwordx2 v[72:73], v3, s[52:55], s75 offen
 buffer_load_dwordx2 v[74:75], v4, s[36:39], s34 offen sc1
 s_add_u32 s3, s62, 2
 s_sub_u32 s34, s61, 1
 s_min_u32 s3, s3, s34
 s_lshl_b32 s34, s3, 10
 v_add_u32 v42, s34, v20
 ds_read_b64 v[84:85], v42
 s_mul_i32 s3, s3, 4
 s_add_u32 s3, s3, s63
 s_lshl_b32 s76, s3, 15
 s_add_u32 s34, s76, 83886080
 buffer_load_dwordx2 v[80:81], v3, s[52:55], s76 offen
 buffer_load_dwordx2 v[82:83], v4, s[36:39], s34 offen sc1
 s_add_u32 s3, s62, 3
 s_sub_u32 s34, s61, 1
 s_min_u32 s3, s3, s34
 s_lshl_b32 s34, s3, 10
 v_add_u32 v43, s34, v20
 ds_read_b64 v[92:93], v43
 s_mul_i32 s3, s3, 4
 s_add_u32 s3, s3, s63
 s_lshl_b32 s77, s3, 15
 s_add_u32 s34, s77, 83886080
 buffer_load_dwordx2 v[88:89], v3, s[52:55], s77 offen
 buffer_load_dwordx2 v[90:91], v4, s[36:39], s34 offen sc1
 s_waitcnt lgkmcnt(3)
 v_lshlrev_b32 v28, 16, v68
 v_and_b32 v29, 0xffff0000, v68
 s_waitcnt vmcnt(6)
 v_lshlrev_b32 v30, 16, v66
 v_and_b32 v31, 0xffff0000, v66
 v_mul_f32 v28, v28, v30
 v_mul_f32 v29, v29, v31
 v_cvt_pk_bf16_f32 v29, v28, v29
 v_lshlrev_b32 v28, 16, v29
 v_and_b32 v29, 0xffff0000, v29
 v_lshlrev_b32 v30, 16, v64
 v_and_b32 v31, 0xffff0000, v64
 v_add_f32 v28, v28, v30
 v_add_f32 v29, v29, v31
 v_cvt_pk_bf16_f32 v68, v28, v29
 v_lshlrev_b32 v28, 16, v69
 v_and_b32 v29, 0xffff0000, v69
 v_lshlrev_b32 v30, 16, v67
 v_and_b32 v31, 0xffff0000, v67
 v_mul_f32 v28, v28, v30
 v_mul_f32 v29, v29, v31
 v_cvt_pk_bf16_f32 v29, v28, v29
 v_lshlrev_b32 v28, 16, v29
 v_and_b32 v29, 0xffff0000, v29
 v_lshlrev_b32 v30, 16, v65
 v_and_b32 v31, 0xffff0000, v65
 v_add_f32 v28, v28, v30
 v_add_f32 v29, v29, v31
 v_cvt_pk_bf16_f32 v69, v28, v29
 buffer_store_dwordx2 v[68:69], v3, s[56:59], s74 offen nt
 s_waitcnt lgkmcnt(2)
 v_lshlrev_b32 v28, 16, v76
 v_and_b32 v29, 0xffff0000, v76
 s_waitcnt vmcnt(5)
 v_lshlrev_b32 v30, 16, v74
 v_and_b32 v31, 0xffff0000, v74
 v_mul_f32 v28, v28, v30
 v_mul_f32 v29, v29, v31
 v_cvt_pk_bf16_f32 v29, v28, v29
 v_lshlrev_b32 v28, 16, v29
 v_and_b32 v29, 0xffff0000, v29
 v_lshlrev_b32 v30, 16, v72
 v_and_b32 v31, 0xffff0000, v72
 v_add_f32 v28, v28, v30
 v_add_f32 v29, v29, v31
 v_cvt_pk_bf16_f32 v76, v28, v29
 v_lshlrev_b32 v28, 16, v77
 v_and_b32 v29, 0xffff0000, v77
 v_lshlrev_b32 v30, 16, v75
 v_and_b32 v31, 0xffff0000, v75
 v_mul_f32 v28, v28, v30
 v_mul_f32 v29, v29, v31
 v_cvt_pk_bf16_f32 v29, v28, v29
 v_lshlrev_b32 v28, 16, v29
 v_and_b32 v29, 0xffff0000, v29
 v_lshlrev_b32 v30, 16, v73
 v_and_b32 v31, 0xffff0000, v73
 v_add_f32 v28, v28, v30
 v_add_f32 v29, v29, v31
 v_cvt_pk_bf16_f32 v77, v28, v29
 buffer_store_dwordx2 v[76:77], v3, s[56:59], s75 offen nt
 s_waitcnt lgkmcnt(1)
 v_lshlrev_b32 v28, 16, v84
 v_and_b32 v29, 0xffff0000, v84
 s_waitcnt vmcnt(4)
 v_lshlrev_b32 v30, 16, v82
 v_and_b32 v31, 0xffff0000, v82
 v_mul_f32 v28, v28, v30
 v_mul_f32 v29, v29, v31
 v_cvt_pk_bf16_f32 v29, v28, v29
 v_lshlrev_b32 v28, 16, v29
 v_and_b32 v29, 0xffff0000, v29
 v_lshlrev_b32 v30, 16, v80
 v_and_b32 v31, 0xffff0000, v80
 v_add_f32 v28, v28, v30
 v_add_f32 v29, v29, v31
 v_cvt_pk_bf16_f32 v84, v28, v29
 v_lshlrev_b32 v28, 16, v85
 v_and_b32 v29, 0xffff0000, v85
 v_lshlrev_b32 v30, 16, v83
 v_and_b32 v31, 0xffff0000, v83
 v_mul_f32 v28, v28, v30
 v_mul_f32 v29, v29, v31
 v_cvt_pk_bf16_f32 v29, v28, v29
 v_lshlrev_b32 v28, 16, v29
 v_and_b32 v29, 0xffff0000, v29
 v_lshlrev_b32 v30, 16, v81
 v_and_b32 v31, 0xffff0000, v81
 v_add_f32 v28, v28, v30
 v_add_f32 v29, v29, v31
 v_cvt_pk_bf16_f32 v85, v28, v29
 buffer_store_dwordx2 v[84:85], v3, s[56:59], s76 offen nt
 s_waitcnt lgkmcnt(0)
 v_lshlrev_b32 v28, 16, v92
 v_and_b32 v29, 0xffff0000, v92
 s_waitcnt vmcnt(3)
 v_lshlrev_b32 v30, 16, v90
 v_and_b32 v31, 0xffff0000, v90
 v_mul_f32 v28, v28, v30
 v_mul_f32 v29, v29, v31
 v_cvt_pk_bf16_f32 v29, v28, v29
 v_lshlrev_b32 v28, 16, v29
 v_and_b32 v29, 0xffff0000, v29
 v_lshlrev_b32 v30, 16, v88
 v_and_b32 v31, 0xffff0000, v88
 v_add_f32 v28, v28, v30
 v_add_f32 v29, v29, v31
 v_cvt_pk_bf16_f32 v92, v28, v29
 v_lshlrev_b32 v28, 16, v93
 v_and_b32 v29, 0xffff0000, v93
 v_lshlrev_b32 v30, 16, v91
 v_and_b32 v31, 0xffff0000, v91
 v_mul_f32 v28, v28, v30
 v_mul_f32 v29, v29, v31
 v_cvt_pk_bf16_f32 v29, v28, v29
 v_lshlrev_b32 v28, 16, v29
 v_and_b32 v29, 0xffff0000, v29
 v_lshlrev_b32 v30, 16, v89
 v_and_b32 v31, 0xffff0000, v89
 v_add_f32 v28, v28, v30
 v_add_f32 v29, v29, v31
 v_cvt_pk_bf16_f32 v93, v28, v29
 buffer_store_dwordx2 v[92:93], v3, s[56:59], s77 offen nt
 s_add_u32 s62, s62, 4
 s_cmp_lt_u32 s62, s61
 s_cbranch_scc1 S4_f2
 s_waitcnt vmcnt(0)
S4_f2_e:
 s_branch L_DONE
R_BPATH:
 s_mov_b32 s41, s40
 s_mov_b32 s52, s20
 s_mov_b32 s53, s21
 s_mov_b32 s54, 524288
 s_mov_b32 s55, 0x20000
 s_mov_b32 s56, s22
 s_mov_b32 s57, s23
 s_mov_b32 s58, 524288
 s_mov_b32 s59, 0x20000
 s_mov_b32 s60, s24
 s_mov_b32 s61, s25
 s_mov_b32 s62, 1409024
 s_mov_b32 s63, 0x20000
 s_mov_b32 s68, s26
 s_mov_b32 s69, s27
 s_mov_b32 s70, 1409024
 s_mov_b32 s71, 0x20000
 s_lshl_b32 s66, s47, 14
 s_lshr_b32 s43, s41, 2
 s_cmp_ge_u32 s43, 6
 s_cselect_b32 s3, 6, 0
 s_sub_u32 s43, s43, s3
 s_mov_b32 s45, 0xbdd2d3e8
 s_mov_b32 s46, 0x3f803f80
 v_and_b32 v1, 63, v0
 v_lshlrev_b32 v2, 4, v1
 v_lshrrev_b32 v20, 4, v1
 v_and_b32 v21, 15, v1
 v_lshlrev_b32 v22, 2, v20
 v_xor_b32 v22, v22, v21
 v_lshlrev_b32 v22, 4, v22
 v_lshl_add_u32 v3, v20, 10, v22
 s_and_b32 s49, s41, 7
 s_mul_i32 s64, s49, 65536
 s_lshl_b32 s3, s47, 8
 s_add_u32 s64, s64, s3
 s_add_u32 m0, s66, 0
 s_nop 0
 buffer_load_dwordx4 v3, s[52:55], s64 offen lds
 s_add_u32 s64, s64, 4096
 s_add_u32 m0, s66, 1024
 s_nop 0
 buffer_load_dwordx4 v3, s[52:55], s64 offen lds
 s_add_u32 s64, s64, 4096
 s_add_u32 m0, s66, 2048
 s_nop 0
 buffer_load_dwordx4 v3, s[52:55], s64 offen lds
 s_add_u32 s64, s64, 4096
 s_add_u32 m0, s66, 3072
 s_nop 0
 buffer_load_dwordx4 v3, s[52:55], s64 offen lds
 s_add_u32 s64, s64, 4096
 s_add_u32 m0, s66, 4096
 s_nop 0
 buffer_load_dwordx4 v3, s[52:55], s64 offen lds
 s_add_u32 s64, s64, 4096
 s_add_u32 m0, s66, 5120
 s_nop 0
 buffer_load_dwordx4 v3, s[52:55], s64 offen lds
 s_add_u32 s64, s64, 4096
 s_add_u32 m0, s66, 6144
 s_nop 0
 buffer_load_dwordx4 v3, s[52:55], s64 offen lds
 s_add_u32 s64, s64, 4096
 s_add_u32 m0, s66, 7168
 s_nop 0
 buffer_load_dwordx4 v3, s[52:55], s64 offen lds
 s_add_u32 s64, s64, 4096
 s_add_u32 m0, s66, 8192
 s_nop 0
 buffer_load_dwordx4 v3, s[52:55], s64 offen lds
 s_add_u32 s64, s64, 4096
 s_add_u32 m0, s66, 9216
 s_nop 0
 buffer_load_dwordx4 v3, s[52:55], s64 offen lds
 s_add_u32 s64, s64, 4096
 s_add_u32 m0, s66, 10240
 s_nop 0
 buffer_load_dwordx4 v3, s[52:55], s64 offen lds
 s_add_u32 s64, s64, 4096
 s_add_u32 m0, s66, 11264
 s_nop 0
 buffer_load_dwordx4 v3, s[52:55], s64 offen lds
 s_add_u32 s64, s64, 4096
 s_add_u32 m0, s66, 12288
 s_nop 0
 buffer_load_dwordx4 v3, s[52:55], s64 offen lds
 s_add_u32 s64, s64, 4096
 s_add_u32 m0, s66, 13312
 s_nop 0
 buffer_load_dwordx4 v3, s[52:55], s64 offen lds
 s_add_u32 s64, s64, 4096
 s_add_u32 m0, s66, 14336
 s_nop 0
 buffer_load_dwordx4 v3, s[52:55], s64 offen lds
 s_add_u32 s64, s64, 4096
 s_add_u32 m0, s66, 15360
 s_nop 0
 buffer_load_dwordx4 v3, s[52:55], s64 offen lds
 s_add_u32 s64, s64, 4096
 v_lshrrev_b32 v22, 3, v1
 v_and_b32 v23, 7, v1
 v_and_b32 v24, 1, v20
 v_lshlrev_b32 v25, 2, v24
 v_xor_b32 v23, v23, v25
 v_lshlrev_b32 v23, 4, v23
 v_mul_u32_u24 v22, 2752, v22
 v_add_u32 v4, v22, v23
 v_lshrrev_b32 v26, 2, v21
 v_and_b32 v25, 3, v21
 v_lshrrev_b32 v27, 1, v20
 v_lshl_add_u32 v28, v27, 2, v26
 v_lshlrev_b32 v29, 5, v24
 v_lshl_add_u32 v29, v25, 3, v29
 v_add_u32 v29, s66, v29
 v_lshl_add_u32 v30, v28, 8, v29
 v_lshl_add_u32 v5, v26, 6, v30
 v_xor_b32 v6, 64, v5
 v_xor_b32 v7, 0x80, v5
 v_xor_b32 v8, 0xc0, v5
 v_lshl_add_u32 v30, v28, 7, v29
 v_lshrrev_b32 v26, 1, v26
 v_lshl_add_u32 v9, v26, 6, v30
 v_xor_b32 v10, 64, v9
 v_and_b32 v22, 31, v1
 v_lshlrev_b32 v23, 4, v22
 v_mul_u32_u24 v24, 1152, v27
 v_add3_u32 v11, v23, v24, 0
 v_add_u32 v11, 65536, v11
 v_lshl_add_u32 v12, v27, 10, v23
 v_add_u32 v13, 131072, v12
 v_add_u32 v12, 65536, v12
 v_lshlrev_b32 v14, 2, v22
 v_add_u32 v14, 147456, v14
 v_mov_b32 v16, 0xc0135761
 s_lshl_b32 s3, s41, 6
 s_lshl_b32 s34, s47, 5
 s_add_u32 s3, s3, s34
 s_sub_u32 s3, s3, 2
 v_add_u32 v24, s3, v22
 v_mov_b32 v25, 2047
 v_med3_i32 v24, v24, 0, v25
 v_lshrrev_b32 v25, 5, v24
 v_and_b32 v24, 31, v24
 v_lshlrev_b32 v25, 15, v25
 v_lshl_add_u32 v25, v24, 4, v25
 v_lshl_add_u32 v31, v27, 9, v25
 v_lshlrev_b32 v18, 2, v1
 s_cmp_lg_u32 s47, 0
 s_cbranch_scc1 B_xok
 v_mov_b32 v22, 36
 s_mov_b32 s3, 0
B_init:
 global_load_dword v23, v22, s[30:31] sc1
 s_add_u32 s3, s3, 1
 s_cmp_gt_u32 s3, 131072
 s_cbranch_scc1 L_ABORT
 s_waitcnt vmcnt(0)
 v_readfirstlane_b32 s34, v23
 s_nop 0
 s_cmp_lt_u32 s34, 1
 s_cbranch_scc1 B_init
 s_mov_b32 s3, 0
 s_branch B_xn_go
B_xn:
 s_sleep 1
B_xn_go:
 buffer_load_dword v22, v18, s[36:39], 0 offen sc1
 s_add_u32 s3, s3, 1
 s_cmp_gt_u32 s3, 131072
 s_cbranch_scc1 L_ABORT
 s_waitcnt vmcnt(0)
 v_cmp_gt_u32 vcc, 1, v22
 s_cbranch_vccnz B_xn
B_xok:
 s_barrier
 s_cmp_eq_u32 s47, 3
 s_cbranch_scc1 B_noln
 s_mov_b32 s3, 14680064
 buffer_load_dwordx4 v[96:99], v31, s[36:39], s3 offen offset:0 sc1
 buffer_load_dwordx4 v[100:103], v31, s[36:39], s3 offen offset:1024 sc1
 buffer_load_dwordx4 v[104:107], v31, s[36:39], s3 offen offset:2048 sc1
 buffer_load_dwordx4 v[108:111], v31, s[36:39], s3 offen offset:3072 sc1
 s_add_u32 s3, s3, 4096
 buffer_load_dwordx4 v[112:115], v31, s[36:39], s3 offen offset:0 sc1
 buffer_load_dwordx4 v[116:119], v31, s[36:39], s3 offen offset:1024 sc1
 buffer_load_dwordx4 v[120:123], v31, s[36:39], s3 offen offset:2048 sc1
 buffer_load_dwordx4 v[124:127], v31, s[36:39], s3 offen offset:3072 sc1
 s_add_u32 s3, s3, 4096
 buffer_load_dwordx4 v[128:131], v31, s[36:39], s3 offen offset:0 sc1
 buffer_load_dwordx4 v[132:135], v31, s[36:39], s3 offen offset:1024 sc1
 buffer_load_dwordx4 v[136:139], v31, s[36:39], s3 offen offset:2048 sc1
 buffer_load_dwordx4 v[140:143], v31, s[36:39], s3 offen offset:3072 sc1
 s_add_u32 s3, s3, 4096
 buffer_load_dwordx4 v[144:147], v31, s[36:39], s3 offen offset:0 sc1
 buffer_load_dwordx4 v[148:151], v31, s[36:39], s3 offen offset:1024 sc1
 buffer_load_dwordx4 v[152:155], v31, s[36:39], s3 offen offset:2048 sc1
 buffer_load_dwordx4 v[156:159], v31, s[36:39], s3 offen offset:3072 sc1
 s_add_u32 s3, s3, 4096
 buffer_load_dwordx4 v[160:163], v31, s[36:39], s3 offen offset:0 sc1
 buffer_load_dwordx4 v[164:167], v31, s[36:39], s3 offen offset:1024 sc1
 buffer_load_dwordx4 v[168:171], v31, s[36:39], s3 offen offset:2048 sc1
 buffer_load_dwordx4 v[172:175], v31, s[36:39], s3 offen offset:3072 sc1
 s_add_u32 s3, s3, 4096
 buffer_load_dwordx4 v[176:179], v31, s[36:39], s3 offen offset:0 sc1
 buffer_load_dwordx4 v[180:183], v31, s[36:39], s3 offen offset:1024 sc1
 buffer_load_dwordx4 v[184:187], v31, s[36:39], s3 offen offset:2048 sc1
 buffer_load_dwordx4 v[188:191], v31, s[36:39], s3 offen offset:3072 sc1
 s_add_u32 s3, s3, 4096
 buffer_load_dwordx4 v[192:195], v31, s[36:39], s3 offen offset:0 sc1
 buffer_load_dwordx4 v[196:199], v31, s[36:39], s3 offen offset:1024 sc1
 buffer_load_dwordx4 v[200:203], v31, s[36:39], s3 offen offset:2048 sc1
 buffer_load_dwordx4 v[204:207], v31, s[36:39], s3 offen offset:3072 sc1
 s_add_u32 s3, s3, 4096
 buffer_load_dwordx4 v[208:211], v31, s[36:39], s3 offen offset:0 sc1
 buffer_load_dwordx4 v[212:215], v31, s[36:39], s3 offen offset:1024 sc1
 buffer_load_dwordx4 v[216:219], v31, s[36:39], s3 offen offset:2048 sc1
 buffer_load_dwordx4 v[220:223], v31, s[36:39], s3 offen offset:3072 sc1
 s_add_u32 s3, s3, 4096
 v_mov_b32 v19, 0
 v_mov_b32 v20, 0
 s_waitcnt vmcnt(31)
 v_dot2c_f32_bf16 v19, s46, v96
 v_dot2c_f32_bf16 v20, v96, v96
 v_dot2c_f32_bf16 v19, s46, v97
 v_dot2c_f32_bf16 v20, v97, v97
 v_dot2c_f32_bf16 v19, s46, v98
 v_dot2c_f32_bf16 v20, v98, v98
 v_dot2c_f32_bf16 v19, s46, v99
 v_dot2c_f32_bf16 v20, v99, v99
 s_waitcnt vmcnt(30)
 v_dot2c_f32_bf16 v19, s46, v100
 v_dot2c_f32_bf16 v20, v100, v100
 v_dot2c_f32_bf16 v19, s46, v101
 v_dot2c_f32_bf16 v20, v101, v101
 v_dot2c_f32_bf16 v19, s46, v102
 v_dot2c_f32_bf16 v20, v102, v102
 v_dot2c_f32_bf16 v19, s46, v103
 v_dot2c_f32_bf16 v20, v103, v103
 s_waitcnt vmcnt(29)
 v_dot2c_f32_bf16 v19, s46, v104
 v_dot2c_f32_bf16 v20, v104, v104
 v_dot2c_f32_bf16 v19, s46, v105
 v_dot2c_f32_bf16 v20, v105, v105
 v_dot2c_f32_bf16 v19, s46, v106
 v_dot2c_f32_bf16 v20, v106, v106
 v_dot2c_f32_bf16 v19, s46, v107
 v_dot2c_f32_bf16 v20, v107, v107
 s_waitcnt vmcnt(28)
 v_dot2c_f32_bf16 v19, s46, v108
 v_dot2c_f32_bf16 v20, v108, v108
 v_dot2c_f32_bf16 v19, s46, v109
 v_dot2c_f32_bf16 v20, v109, v109
 v_dot2c_f32_bf16 v19, s46, v110
 v_dot2c_f32_bf16 v20, v110, v110
 v_dot2c_f32_bf16 v19, s46, v111
 v_dot2c_f32_bf16 v20, v111, v111
 s_waitcnt vmcnt(27)
 v_dot2c_f32_bf16 v19, s46, v112
 v_dot2c_f32_bf16 v20, v112, v112
 v_dot2c_f32_bf16 v19, s46, v113
 v_dot2c_f32_bf16 v20, v113, v113
 v_dot2c_f32_bf16 v19, s46, v114
 v_dot2c_f32_bf16 v20, v114, v114
 v_dot2c_f32_bf16 v19, s46, v115
 v_dot2c_f32_bf16 v20, v115, v115
 s_waitcnt vmcnt(26)
 v_dot2c_f32_bf16 v19, s46, v116
 v_dot2c_f32_bf16 v20, v116, v116
 v_dot2c_f32_bf16 v19, s46, v117
 v_dot2c_f32_bf16 v20, v117, v117
 v_dot2c_f32_bf16 v19, s46, v118
 v_dot2c_f32_bf16 v20, v118, v118
 v_dot2c_f32_bf16 v19, s46, v119
 v_dot2c_f32_bf16 v20, v119, v119
 s_waitcnt vmcnt(25)
 v_dot2c_f32_bf16 v19, s46, v120
 v_dot2c_f32_bf16 v20, v120, v120
 v_dot2c_f32_bf16 v19, s46, v121
 v_dot2c_f32_bf16 v20, v121, v121
 v_dot2c_f32_bf16 v19, s46, v122
 v_dot2c_f32_bf16 v20, v122, v122
 v_dot2c_f32_bf16 v19, s46, v123
 v_dot2c_f32_bf16 v20, v123, v123
 s_waitcnt vmcnt(24)
 v_dot2c_f32_bf16 v19, s46, v124
 v_dot2c_f32_bf16 v20, v124, v124
 v_dot2c_f32_bf16 v19, s46, v125
 v_dot2c_f32_bf16 v20, v125, v125
 v_dot2c_f32_bf16 v19, s46, v126
 v_dot2c_f32_bf16 v20, v126, v126
 v_dot2c_f32_bf16 v19, s46, v127
 v_dot2c_f32_bf16 v20, v127, v127
 s_waitcnt vmcnt(23)
 v_dot2c_f32_bf16 v19, s46, v128
 v_dot2c_f32_bf16 v20, v128, v128
 v_dot2c_f32_bf16 v19, s46, v129
 v_dot2c_f32_bf16 v20, v129, v129
 v_dot2c_f32_bf16 v19, s46, v130
 v_dot2c_f32_bf16 v20, v130, v130
 v_dot2c_f32_bf16 v19, s46, v131
 v_dot2c_f32_bf16 v20, v131, v131
 s_waitcnt vmcnt(22)
 v_dot2c_f32_bf16 v19, s46, v132
 v_dot2c_f32_bf16 v20, v132, v132
 v_dot2c_f32_bf16 v19, s46, v133
 v_dot2c_f32_bf16 v20, v133, v133
 v_dot2c_f32_bf16 v19, s46, v134
 v_dot2c_f32_bf16 v20, v134, v134
 v_dot2c_f32_bf16 v19, s46, v135
 v_dot2c_f32_bf16 v20, v135, v135
 s_waitcnt vmcnt(21)
 v_dot2c_f32_bf16 v19, s46, v136
 v_dot2c_f32_bf16 v20, v136, v136
 v_dot2c_f32_bf16 v19, s46, v137
 v_dot2c_f32_bf16 v20, v137, v137
 v_dot2c_f32_bf16 v19, s46, v138
 v_dot2c_f32_bf16 v20, v138, v138
 v_dot2c_f32_bf16 v19, s46, v139
 v_dot2c_f32_bf16 v20, v139, v139
 s_waitcnt vmcnt(20)
 v_dot2c_f32_bf16 v19, s46, v140
 v_dot2c_f32_bf16 v20, v140, v140
 v_dot2c_f32_bf16 v19, s46, v141
 v_dot2c_f32_bf16 v20, v141, v141
 v_dot2c_f32_bf16 v19, s46, v142
 v_dot2c_f32_bf16 v20, v142, v142
 v_dot2c_f32_bf16 v19, s46, v143
 v_dot2c_f32_bf16 v20, v143, v143
 s_waitcnt vmcnt(19)
 v_dot2c_f32_bf16 v19, s46, v144
 v_dot2c_f32_bf16 v20, v144, v144
 v_dot2c_f32_bf16 v19, s46, v145
 v_dot2c_f32_bf16 v20, v145, v145
 v_dot2c_f32_bf16 v19, s46, v146
 v_dot2c_f32_bf16 v20, v146, v146
 v_dot2c_f32_bf16 v19, s46, v147
 v_dot2c_f32_bf16 v20, v147, v147
 s_waitcnt vmcnt(18)
 v_dot2c_f32_bf16 v19, s46, v148
 v_dot2c_f32_bf16 v20, v148, v148
 v_dot2c_f32_bf16 v19, s46, v149
 v_dot2c_f32_bf16 v20, v149, v149
 v_dot2c_f32_bf16 v19, s46, v150
 v_dot2c_f32_bf16 v20, v150, v150
 v_dot2c_f32_bf16 v19, s46, v151
 v_dot2c_f32_bf16 v20, v151, v151
 s_waitcnt vmcnt(17)
 v_dot2c_f32_bf16 v19, s46, v152
 v_dot2c_f32_bf16 v20, v152, v152
 v_dot2c_f32_bf16 v19, s46, v153
 v_dot2c_f32_bf16 v20, v153, v153
 v_dot2c_f32_bf16 v19, s46, v154
 v_dot2c_f32_bf16 v20, v154, v154
 v_dot2c_f32_bf16 v19, s46, v155
 v_dot2c_f32_bf16 v20, v155, v155
 s_waitcnt vmcnt(16)
 v_dot2c_f32_bf16 v19, s46, v156
 v_dot2c_f32_bf16 v20, v156, v156
 v_dot2c_f32_bf16 v19, s46, v157
 v_dot2c_f32_bf16 v20, v157, v157
 v_dot2c_f32_bf16 v19, s46, v158
 v_dot2c_f32_bf16 v20, v158, v158
 v_dot2c_f32_bf16 v19, s46, v159
 v_dot2c_f32_bf16 v20, v159, v159
 s_waitcnt vmcnt(15)
 v_dot2c_f32_bf16 v19, s46, v160
 v_dot2c_f32_bf16 v20, v160, v160
 v_dot2c_f32_bf16 v19, s46, v161
 v_dot2c_f32_bf16 v20, v161, v161
 v_dot2c_f32_bf16 v19, s46, v162
 v_dot2c_f32_bf16 v20, v162, v162
 v_dot2c_f32_bf16 v19, s46, v163
 v_dot2c_f32_bf16 v20, v163, v163
 s_waitcnt vmcnt(14)
 v_dot2c_f32_bf16 v19, s46, v164
 v_dot2c_f32_bf16 v20, v164, v164
 v_dot2c_f32_bf16 v19, s46, v165
 v_dot2c_f32_bf16 v20, v165, v165
 v_dot2c_f32_bf16 v19, s46, v166
 v_dot2c_f32_bf16 v20, v166, v166
 v_dot2c_f32_bf16 v19, s46, v167
 v_dot2c_f32_bf16 v20, v167, v167
 s_waitcnt vmcnt(13)
 v_dot2c_f32_bf16 v19, s46, v168
 v_dot2c_f32_bf16 v20, v168, v168
 v_dot2c_f32_bf16 v19, s46, v169
 v_dot2c_f32_bf16 v20, v169, v169
 v_dot2c_f32_bf16 v19, s46, v170
 v_dot2c_f32_bf16 v20, v170, v170
 v_dot2c_f32_bf16 v19, s46, v171
 v_dot2c_f32_bf16 v20, v171, v171
 s_waitcnt vmcnt(12)
 v_dot2c_f32_bf16 v19, s46, v172
 v_dot2c_f32_bf16 v20, v172, v172
 v_dot2c_f32_bf16 v19, s46, v173
 v_dot2c_f32_bf16 v20, v173, v173
 v_dot2c_f32_bf16 v19, s46, v174
 v_dot2c_f32_bf16 v20, v174, v174
 v_dot2c_f32_bf16 v19, s46, v175
 v_dot2c_f32_bf16 v20, v175, v175
 s_waitcnt vmcnt(11)
 v_dot2c_f32_bf16 v19, s46, v176
 v_dot2c_f32_bf16 v20, v176, v176
 v_dot2c_f32_bf16 v19, s46, v177
 v_dot2c_f32_bf16 v20, v177, v177
 v_dot2c_f32_bf16 v19, s46, v178
 v_dot2c_f32_bf16 v20, v178, v178
 v_dot2c_f32_bf16 v19, s46, v179
 v_dot2c_f32_bf16 v20, v179, v179
 s_waitcnt vmcnt(10)
 v_dot2c_f32_bf16 v19, s46, v180
 v_dot2c_f32_bf16 v20, v180, v180
 v_dot2c_f32_bf16 v19, s46, v181
 v_dot2c_f32_bf16 v20, v181, v181
 v_dot2c_f32_bf16 v19, s46, v182
 v_dot2c_f32_bf16 v20, v182, v182
 v_dot2c_f32_bf16 v19, s46, v183
 v_dot2c_f32_bf16 v20, v183, v183
 s_waitcnt vmcnt(9)
 v_dot2c_f32_bf16 v19, s46, v184
 v_dot2c_f32_bf16 v20, v184, v184
 v_dot2c_f32_bf16 v19, s46, v185
 v_dot2c_f32_bf16 v20, v185, v185
 v_dot2c_f32_bf16 v19, s46, v186
 v_dot2c_f32_bf16 v20, v186, v186
 v_dot2c_f32_bf16 v19, s46, v187
 v_dot2c_f32_bf16 v20, v187, v187
 s_waitcnt vmcnt(8)
 v_dot2c_f32_bf16 v19, s46, v188
 v_dot2c_f32_bf16 v20, v188, v188
 v_dot2c_f32_bf16 v19, s46, v189
 v_dot2c_f32_bf16 v20, v189, v189
 v_dot2c_f32_bf16 v19, s46, v190
 v_dot2c_f32_bf16 v20, v190, v190
 v_dot2c_f32_bf16 v19, s46, v191
 v_dot2c_f32_bf16 v20, v191, v191
 s_waitcnt vmcnt(7)
 v_dot2c_f32_bf16 v19, s46, v192
 v_dot2c_f32_bf16 v20, v192, v192
 v_dot2c_f32_bf16 v19, s46, v193
 v_dot2c_f32_bf16 v20, v193, v193
 v_dot2c_f32_bf16 v19, s46, v194
 v_dot2c_f32_bf16 v20, v194, v194
 v_dot2c_f32_bf16 v19, s46, v195
 v_dot2c_f32_bf16 v20, v195, v195
 s_waitcnt vmcnt(6)
 v_dot2c_f32_bf16 v19, s46, v196
 v_dot2c_f32_bf16 v20, v196, v196
 v_dot2c_f32_bf16 v19, s46, v197
 v_dot2c_f32_bf16 v20, v197, v197
 v_dot2c_f32_bf16 v19, s46, v198
 v_dot2c_f32_bf16 v20, v198, v198
 v_dot2c_f32_bf16 v19, s46, v199
 v_dot2c_f32_bf16 v20, v199, v199
 s_waitcnt vmcnt(5)
 v_dot2c_f32_bf16 v19, s46, v200
 v_dot2c_f32_bf16 v20, v200, v200
 v_dot2c_f32_bf16 v19, s46, v201
 v_dot2c_f32_bf16 v20, v201, v201
 v_dot2c_f32_bf16 v19, s46, v202
 v_dot2c_f32_bf16 v20, v202, v202
 v_dot2c_f32_bf16 v19, s46, v203
 v_dot2c_f32_bf16 v20, v203, v203
 s_waitcnt vmcnt(4)
 v_dot2c_f32_bf16 v19, s46, v204
 v_dot2c_f32_bf16 v20, v204, v204
 v_dot2c_f32_bf16 v19, s46, v205
 v_dot2c_f32_bf16 v20, v205, v205
 v_dot2c_f32_bf16 v19, s46, v206
 v_dot2c_f32_bf16 v20, v206, v206
 v_dot2c_f32_bf16 v19, s46, v207
 v_dot2c_f32_bf16 v20, v207, v207
 s_waitcnt vmcnt(3)
 v_dot2c_f32_bf16 v19, s46, v208
 v_dot2c_f32_bf16 v20, v208, v208
 v_dot2c_f32_bf16 v19, s46, v209
 v_dot2c_f32_bf16 v20, v209, v209
 v_dot2c_f32_bf16 v19, s46, v210
 v_dot2c_f32_bf16 v20, v210, v210
 v_dot2c_f32_bf16 v19, s46, v211
 v_dot2c_f32_bf16 v20, v211, v211
 s_waitcnt vmcnt(2)
 v_dot2c_f32_bf16 v19, s46, v212
 v_dot2c_f32_bf16 v20, v212, v212
 v_dot2c_f32_bf16 v19, s46, v213
 v_dot2c_f32_bf16 v20, v213, v213
 v_dot2c_f32_bf16 v19, s46, v214
 v_dot2c_f32_bf16 v20, v214, v214
 v_dot2c_f32_bf16 v19, s46, v215
 v_dot2c_f32_bf16 v20, v215, v215
 s_waitcnt vmcnt(1)
 v_dot2c_f32_bf16 v19, s46, v216
 v_dot2c_f32_bf16 v20, v216, v216
 v_dot2c_f32_bf16 v19, s46, v217
 v_dot2c_f32_bf16 v20, v217, v217
 v_dot2c_f32_bf16 v19, s46, v218
 v_dot2c_f32_bf16 v20, v218, v218
 v_dot2c_f32_bf16 v19, s46, v219
 v_dot2c_f32_bf16 v20, v219, v219
 s_waitcnt vmcnt(0)
 v_dot2c_f32_bf16 v19, s46, v220
 v_dot2c_f32_bf16 v20, v220, v220
 v_dot2c_f32_bf16 v19, s46, v221
 v_dot2c_f32_bf16 v20, v221, v221
 v_dot2c_f32_bf16 v19, s46, v222
 v_dot2c_f32_bf16 v20, v222, v222
 v_dot2c_f32_bf16 v19, s46, v223
 v_dot2c_f32_bf16 v20, v223, v223
 s_nop 1
 v_mov_b32 v21, v19
 s_nop 1
 v_permlane32_swap_b32 v19, v21
 v_add_f32 v19, v19, v21
 v_mov_b32 v21, v20
 s_nop 1
 v_permlane32_swap_b32 v20, v21
 v_add_f32 v20, v20, v21
 v_mul_f32 v19, 0x3b000000, v19
 v_mul_f32 v21, v19, v19
 v_fma_f32 v20, v20, 0.5, 0
 v_mul_f32 v20, 0x3b800000, v20
 v_sub_f32 v20, v20, v21
 v_cvt_pk_bf16_f32 v19, v19, v19
 v_and_b32 v19, 0xffff0000, v19
 v_cvt_pk_bf16_f32 v20, v20, v20
 v_and_b32 v20, 0xffff0000, v20
 v_add_f32 v20, 0x3727c5ac, v20
 v_cvt_pk_bf16_f32 v20, v20, v20
 v_and_b32 v20, 0xffff0000, v20
 v_sqrt_f32 v20, v20
 s_nop 0
 v_cvt_pk_bf16_f32 v20, v20, v20
 v_and_b32 v20, 0xffff0000, v20
 v_rcp_f32 v20, v20
 s_lshl_b32 s3, s47, 9
 v_add_u32 v22, s3, v11
 v_add_u32 v23, 36864, v22
 s_cmp_eq_u32 s47, 2
 s_cselect_b32 s34, 0xff, -1
 s_mov_b32 exec_lo, s34
 s_mov_b32 exec_hi, s34
 v_lshlrev_b32 v24, 16, v96
 v_and_b32 v25, 0xffff0000, v96
 v_sub_f32 v24, v24, v19
 v_sub_f32 v25, v25, v19
 v_cvt_pk_bf16_f32 v25, v24, v25
 v_lshlrev_b32 v24, 16, v25
 v_and_b32 v25, 0xffff0000, v25
 v_mul_f32 v24, v24, v20
 v_mul_f32 v25, v25, v20
 v_cvt_pk_bf16_f32 v96, v24, v25
 v_lshlrev_b32 v24, 16, v97
 v_and_b32 v25, 0xffff0000, v97
 v_sub_f32 v24, v24, v19
 v_sub_f32 v25, v25, v19
 v_cvt_pk_bf16_f32 v25, v24, v25
 v_lshlrev_b32 v24, 16, v25
 v_and_b32 v25, 0xffff0000, v25
 v_mul_f32 v24, v24, v20
 v_mul_f32 v25, v25, v20
 v_cvt_pk_bf16_f32 v97, v24, v25
 v_lshlrev_b32 v24, 16, v98
 v_and_b32 v25, 0xffff0000, v98
 v_sub_f32 v24, v24, v19
 v_sub_f32 v25, v25, v19
 v_cvt_pk_bf16_f32 v25, v24, v25
 v_lshlrev_b32 v24, 16, v25
 v_and_b32 v25, 0xffff0000, v25
 v_mul_f32 v24, v24, v20
 v_mul_f32 v25, v25, v20
 v_cvt_pk_bf16_f32 v98, v24, v25
 v_lshlrev_b32 v24, 16, v99
 v_and_b32 v25, 0xffff0000, v99
 v_sub_f32 v24, v24, v19
 v_sub_f32 v25, v25, v19
 v_cvt_pk_bf16_f32 v25, v24, v25
 v_lshlrev_b32 v24, 16, v25
 v_and_b32 v25, 0xffff0000, v25
 v_mul_f32 v24, v24, v20
 v_mul_f32 v25, v25, v20
 v_cvt_pk_bf16_f32 v99, v24, v25
 ds_write_b128 v22, v[96:99] offset:0
 v_lshlrev_b32 v24, 16, v100
 v_and_b32 v25, 0xffff0000, v100
 v_sub_f32 v24, v24, v19
 v_sub_f32 v25, v25, v19
 v_cvt_pk_bf16_f32 v25, v24, v25
 v_lshlrev_b32 v24, 16, v25
 v_and_b32 v25, 0xffff0000, v25
 v_mul_f32 v24, v24, v20
 v_mul_f32 v25, v25, v20
 v_cvt_pk_bf16_f32 v100, v24, v25
 v_lshlrev_b32 v24, 16, v101
 v_and_b32 v25, 0xffff0000, v101
 v_sub_f32 v24, v24, v19
 v_sub_f32 v25, v25, v19
 v_cvt_pk_bf16_f32 v25, v24, v25
 v_lshlrev_b32 v24, 16, v25
 v_and_b32 v25, 0xffff0000, v25
 v_mul_f32 v24, v24, v20
 v_mul_f32 v25, v25, v20
 v_cvt_pk_bf16_f32 v101, v24, v25
 v_lshlrev_b32 v24, 16, v102
 v_and_b32 v25, 0xffff0000, v102
 v_sub_f32 v24, v24, v19
 v_sub_f32 v25, v25, v19
 v_cvt_pk_bf16_f32 v25, v24, v25
 v_lshlrev_b32 v24, 16, v25
 v_and_b32 v25, 0xffff0000, v25
 v_mul_f32 v24, v24, v20
 v_mul_f32 v25, v25, v20
 v_cvt_pk_bf16_f32 v102, v24, v25
 v_lshlrev_b32 v24, 16, v103
 v_and_b32 v25, 0xffff0000, v103
 v_sub_f32 v24, v24, v19
 v_sub_f32 v25, v25, v19
 v_cvt_pk_bf16_f32 v25, v24, v25
 v_lshlrev_b32 v24, 16, v25
 v_and_b32 v25, 0xffff0000, v25
 v_mul_f32 v24, v24, v20
 v_mul_f32 v25, v25, v20
 v_cvt_pk_bf16_f32 v103, v24, v25
 ds_write_b128 v22, v[100:103] offset:2304
 v_lshlrev_b32 v24, 16, v104
 v_and_b32 v25, 0xffff0000, v104
 v_sub_f32 v24, v24, v19
 v_sub_f32 v25, v25, v19
 v_cvt_pk_bf16_f32 v25, v24, v25
 v_lshlrev_b32 v24, 16, v25
 v_and_b32 v25, 0xffff0000, v25
 v_mul_f32 v24, v24, v20
 v_mul_f32 v25, v25, v20
 v_cvt_pk_bf16_f32 v104, v24, v25
 v_lshlrev_b32 v24, 16, v105
 v_and_b32 v25, 0xffff0000, v105
 v_sub_f32 v24, v24, v19
 v_sub_f32 v25, v25, v19
 v_cvt_pk_bf16_f32 v25, v24, v25
 v_lshlrev_b32 v24, 16, v25
 v_and_b32 v25, 0xffff0000, v25
 v_mul_f32 v24, v24, v20
 v_mul_f32 v25, v25, v20
 v_cvt_pk_bf16_f32 v105, v24, v25
 v_lshlrev_b32 v24, 16, v106
 v_and_b32 v25, 0xffff0000, v106
 v_sub_f32 v24, v24, v19
 v_sub_f32 v25, v25, v19
 v_cvt_pk_bf16_f32 v25, v24, v25
 v_lshlrev_b32 v24, 16, v25
 v_and_b32 v25, 0xffff0000, v25
 v_mul_f32 v24, v24, v20
 v_mul_f32 v25, v25, v20
 v_cvt_pk_bf16_f32 v106, v24, v25
 v_lshlrev_b32 v24, 16, v107
 v_and_b32 v25, 0xffff0000, v107
 v_sub_f32 v24, v24, v19
 v_sub_f32 v25, v25, v19
 v_cvt_pk_bf16_f32 v25, v24, v25
 v_lshlrev_b32 v24, 16, v25
 v_and_b32 v25, 0xffff0000, v25
 v_mul_f32 v24, v24, v20
 v_mul_f32 v25, v25, v20
 v_cvt_pk_bf16_f32 v107, v24, v25
 ds_write_b128 v22, v[104:107] offset:4608
 v_lshlrev_b32 v24, 16, v108
 v_and_b32 v25, 0xffff0000, v108
 v_sub_f32 v24, v24, v19
 v_sub_f32 v25, v25, v19
 v_cvt_pk_bf16_f32 v25, v24, v25
 v_lshlrev_b32 v24, 16, v25
 v_and_b32 v25, 0xffff0000, v25
 v_mul_f32 v24, v24, v20
 v_mul_f32 v25, v25, v20
 v_cvt_pk_bf16_f32 v108, v24, v25
 v_lshlrev_b32 v24, 16, v109
 v_and_b32 v25, 0xffff0000, v109
 v_sub_f32 v24, v24, v19
 v_sub_f32 v25, v25, v19
 v_cvt_pk_bf16_f32 v25, v24, v25
 v_lshlrev_b32 v24, 16, v25
 v_and_b32 v25, 0xffff0000, v25
 v_mul_f32 v24, v24, v20
 v_mul_f32 v25, v25, v20
 v_cvt_pk_bf16_f32 v109, v24, v25
 v_lshlrev_b32 v24, 16, v110
 v_and_b32 v25, 0xffff0000, v110
 v_sub_f32 v24, v24, v19
 v_sub_f32 v25, v25, v19
 v_cvt_pk_bf16_f32 v25, v24, v25
 v_lshlrev_b32 v24, 16, v25
 v_and_b32 v25, 0xffff0000, v25
 v_mul_f32 v24, v24, v20
 v_mul_f32 v25, v25, v20
 v_cvt_pk_bf16_f32 v110, v24, v25
 v_lshlrev_b32 v24, 16, v111
 v_and_b32 v25, 0xffff0000, v111
 v_sub_f32 v24, v24, v19
 v_sub_f32 v25, v25, v19
 v_cvt_pk_bf16_f32 v25, v24, v25
 v_lshlrev_b32 v24, 16, v25
 v_and_b32 v25, 0xffff0000, v25
 v_mul_f32 v24, v24, v20
 v_mul_f32 v25, v25, v20
 v_cvt_pk_bf16_f32 v111, v24, v25
 ds_write_b128 v22, v[108:111] offset:6912
 v_lshlrev_b32 v24, 16, v112
 v_and_b32 v25, 0xffff0000, v112
 v_sub_f32 v24, v24, v19
 v_sub_f32 v25, v25, v19
 v_cvt_pk_bf16_f32 v25, v24, v25
 v_lshlrev_b32 v24, 16, v25
 v_and_b32 v25, 0xffff0000, v25
 v_mul_f32 v24, v24, v20
 v_mul_f32 v25, v25, v20
 v_cvt_pk_bf16_f32 v112, v24, v25
 v_lshlrev_b32 v24, 16, v113
 v_and_b32 v25, 0xffff0000, v113
 v_sub_f32 v24, v24, v19
 v_sub_f32 v25, v25, v19
 v_cvt_pk_bf16_f32 v25, v24, v25
 v_lshlrev_b32 v24, 16, v25
 v_and_b32 v25, 0xffff0000, v25
 v_mul_f32 v24, v24, v20
 v_mul_f32 v25, v25, v20
 v_cvt_pk_bf16_f32 v113, v24, v25
 v_lshlrev_b32 v24, 16, v114
 v_and_b32 v25, 0xffff0000, v114
 v_sub_f32 v24, v24, v19
 v_sub_f32 v25, v25, v19
 v_cvt_pk_bf16_f32 v25, v24, v25
 v_lshlrev_b32 v24, 16, v25
 v_and_b32 v25, 0xffff0000, v25
 v_mul_f32 v24, v24, v20
 v_mul_f32 v25, v25, v20
 v_cvt_pk_bf16_f32 v114, v24, v25
 v_lshlrev_b32 v24, 16, v115
 v_and_b32 v25, 0xffff0000, v115
 v_sub_f32 v24, v24, v19
 v_sub_f32 v25, v25, v19
 v_cvt_pk_bf16_f32 v25, v24, v25
 v_lshlrev_b32 v24, 16, v25
 v_and_b32 v25, 0xffff0000, v25
 v_mul_f32 v24, v24, v20
 v_mul_f32 v25, v25, v20
 v_cvt_pk_bf16_f32 v115, v24, v25
 ds_write_b128 v22, v[112:115] offset:9216
 v_lshlrev_b32 v24, 16, v116
 v_and_b32 v25, 0xffff0000, v116
 v_sub_f32 v24, v24, v19
 v_sub_f32 v25, v25, v19
 v_cvt_pk_bf16_f32 v25, v24, v25
 v_lshlrev_b32 v24, 16, v25
 v_and_b32 v25, 0xffff0000, v25
 v_mul_f32 v24, v24, v20
 v_mul_f32 v25, v25, v20
 v_cvt_pk_bf16_f32 v116, v24, v25
 v_lshlrev_b32 v24, 16, v117
 v_and_b32 v25, 0xffff0000, v117
 v_sub_f32 v24, v24, v19
 v_sub_f32 v25, v25, v19
 v_cvt_pk_bf16_f32 v25, v24, v25
 v_lshlrev_b32 v24, 16, v25
 v_and_b32 v25, 0xffff0000, v25
 v_mul_f32 v24, v24, v20
 v_mul_f32 v25, v25, v20
 v_cvt_pk_bf16_f32 v117, v24, v25
 v_lshlrev_b32 v24, 16, v118
 v_and_b32 v25, 0xffff0000, v118
 v_sub_f32 v24, v24, v19
 v_sub_f32 v25, v25, v19
 v_cvt_pk_bf16_f32 v25, v24, v25
 v_lshlrev_b32 v24, 16, v25
 v_and_b32 v25, 0xffff0000, v25
 v_mul_f32 v24, v24, v20
 v_mul_f32 v25, v25, v20
 v_cvt_pk_bf16_f32 v118, v24, v25
 v_lshlrev_b32 v24, 16, v119
 v_and_b32 v25, 0xffff0000, v119
 v_sub_f32 v24, v24, v19
 v_sub_f32 v25, v25, v19
 v_cvt_pk_bf16_f32 v25, v24, v25
 v_lshlrev_b32 v24, 16, v25
 v_and_b32 v25, 0xffff0000, v25
 v_mul_f32 v24, v24, v20
 v_mul_f32 v25, v25, v20
 v_cvt_pk_bf16_f32 v119, v24, v25
 ds_write_b128 v22, v[116:119] offset:11520
 v_lshlrev_b32 v24, 16, v120
 v_and_b32 v25, 0xffff0000, v120
 v_sub_f32 v24, v24, v19
 v_sub_f32 v25, v25, v19
 v_cvt_pk_bf16_f32 v25, v24, v25
 v_lshlrev_b32 v24, 16, v25
 v_and_b32 v25, 0xffff0000, v25
 v_mul_f32 v24, v24, v20
 v_mul_f32 v25, v25, v20
 v_cvt_pk_bf16_f32 v120, v24, v25
 v_lshlrev_b32 v24, 16, v121
 v_and_b32 v25, 0xffff0000, v121
 v_sub_f32 v24, v24, v19
 v_sub_f32 v25, v25, v19
 v_cvt_pk_bf16_f32 v25, v24, v25
 v_lshlrev_b32 v24, 16, v25
 v_and_b32 v25, 0xffff0000, v25
 v_mul_f32 v24, v24, v20
 v_mul_f32 v25, v25, v20
 v_cvt_pk_bf16_f32 v121, v24, v25
 v_lshlrev_b32 v24, 16, v122
 v_and_b32 v25, 0xffff0000, v122
 v_sub_f32 v24, v24, v19
 v_sub_f32 v25, v25, v19
 v_cvt_pk_bf16_f32 v25, v24, v25
 v_lshlrev_b32 v24, 16, v25
 v_and_b32 v25, 0xffff0000, v25
 v_mul_f32 v24, v24, v20
 v_mul_f32 v25, v25, v20
 v_cvt_pk_bf16_f32 v122, v24, v25
 v_lshlrev_b32 v24, 16, v123
 v_and_b32 v25, 0xffff0000, v123
 v_sub_f32 v24, v24, v19
 v_sub_f32 v25, v25, v19
 v_cvt_pk_bf16_f32 v25, v24, v25
 v_lshlrev_b32 v24, 16, v25
 v_and_b32 v25, 0xffff0000, v25
 v_mul_f32 v24, v24, v20
 v_mul_f32 v25, v25, v20
 v_cvt_pk_bf16_f32 v123, v24, v25
 ds_write_b128 v22, v[120:123] offset:13824
 v_lshlrev_b32 v24, 16, v124
 v_and_b32 v25, 0xffff0000, v124
 v_sub_f32 v24, v24, v19
 v_sub_f32 v25, v25, v19
 v_cvt_pk_bf16_f32 v25, v24, v25
 v_lshlrev_b32 v24, 16, v25
 v_and_b32 v25, 0xffff0000, v25
 v_mul_f32 v24, v24, v20
 v_mul_f32 v25, v25, v20
 v_cvt_pk_bf16_f32 v124, v24, v25
 v_lshlrev_b32 v24, 16, v125
 v_and_b32 v25, 0xffff0000, v125
 v_sub_f32 v24, v24, v19
 v_sub_f32 v25, v25, v19
 v_cvt_pk_bf16_f32 v25, v24, v25
 v_lshlrev_b32 v24, 16, v25
 v_and_b32 v25, 0xffff0000, v25
 v_mul_f32 v24, v24, v20
 v_mul_f32 v25, v25, v20
 v_cvt_pk_bf16_f32 v125, v24, v25
 v_lshlrev_b32 v24, 16, v126
 v_and_b32 v25, 0xffff0000, v126
 v_sub_f32 v24, v24, v19
 v_sub_f32 v25, v25, v19
 v_cvt_pk_bf16_f32 v25, v24, v25
 v_lshlrev_b32 v24, 16, v25
 v_and_b32 v25, 0xffff0000, v25
 v_mul_f32 v24, v24, v20
 v_mul_f32 v25, v25, v20
 v_cvt_pk_bf16_f32 v126, v24, v25
 v_lshlrev_b32 v24, 16, v127
 v_and_b32 v25, 0xffff0000, v127
 v_sub_f32 v24, v24, v19
 v_sub_f32 v25, v25, v19
 v_cvt_pk_bf16_f32 v25, v24, v25
 v_lshlrev_b32 v24, 16, v25
 v_and_b32 v25, 0xffff0000, v25
 v_mul_f32 v24, v24, v20
 v_mul_f32 v25, v25, v20
 v_cvt_pk_bf16_f32 v127, v24, v25
 ds_write_b128 v22, v[124:127] offset:16128
 v_lshlrev_b32 v24, 16, v128
 v_and_b32 v25, 0xffff0000, v128
 v_sub_f32 v24, v24, v19
 v_sub_f32 v25, v25, v19
 v_cvt_pk_bf16_f32 v25, v24, v25
 v_lshlrev_b32 v24, 16, v25
 v_and_b32 v25, 0xffff0000, v25
 v_mul_f32 v24, v24, v20
 v_mul_f32 v25, v25, v20
 v_cvt_pk_bf16_f32 v128, v24, v25
 v_lshlrev_b32 v24, 16, v129
 v_and_b32 v25, 0xffff0000, v129
 v_sub_f32 v24, v24, v19
 v_sub_f32 v25, v25, v19
 v_cvt_pk_bf16_f32 v25, v24, v25
 v_lshlrev_b32 v24, 16, v25
 v_and_b32 v25, 0xffff0000, v25
 v_mul_f32 v24, v24, v20
 v_mul_f32 v25, v25, v20
 v_cvt_pk_bf16_f32 v129, v24, v25
 v_lshlrev_b32 v24, 16, v130
 v_and_b32 v25, 0xffff0000, v130
 v_sub_f32 v24, v24, v19
 v_sub_f32 v25, v25, v19
 v_cvt_pk_bf16_f32 v25, v24, v25
 v_lshlrev_b32 v24, 16, v25
 v_and_b32 v25, 0xffff0000, v25
 v_mul_f32 v24, v24, v20
 v_mul_f32 v25, v25, v20
 v_cvt_pk_bf16_f32 v130, v24, v25
 v_lshlrev_b32 v24, 16, v131
 v_and_b32 v25, 0xffff0000, v131
 v_sub_f32 v24, v24, v19
 v_sub_f32 v25, v25, v19
 v_cvt_pk_bf16_f32 v25, v24, v25
 v_lshlrev_b32 v24, 16, v25
 v_and_b32 v25, 0xffff0000, v25
 v_mul_f32 v24, v24, v20
 v_mul_f32 v25, v25, v20
 v_cvt_pk_bf16_f32 v131, v24, v25
 ds_write_b128 v22, v[128:131] offset:18432
 v_lshlrev_b32 v24, 16, v132
 v_and_b32 v25, 0xffff0000, v132
 v_sub_f32 v24, v24, v19
 v_sub_f32 v25, v25, v19
 v_cvt_pk_bf16_f32 v25, v24, v25
 v_lshlrev_b32 v24, 16, v25
 v_and_b32 v25, 0xffff0000, v25
 v_mul_f32 v24, v24, v20
 v_mul_f32 v25, v25, v20
 v_cvt_pk_bf16_f32 v132, v24, v25
 v_lshlrev_b32 v24, 16, v133
 v_and_b32 v25, 0xffff0000, v133
 v_sub_f32 v24, v24, v19
 v_sub_f32 v25, v25, v19
 v_cvt_pk_bf16_f32 v25, v24, v25
 v_lshlrev_b32 v24, 16, v25
 v_and_b32 v25, 0xffff0000, v25
 v_mul_f32 v24, v24, v20
 v_mul_f32 v25, v25, v20
 v_cvt_pk_bf16_f32 v133, v24, v25
 v_lshlrev_b32 v24, 16, v134
 v_and_b32 v25, 0xffff0000, v134
 v_sub_f32 v24, v24, v19
 v_sub_f32 v25, v25, v19
 v_cvt_pk_bf16_f32 v25, v24, v25
 v_lshlrev_b32 v24, 16, v25
 v_and_b32 v25, 0xffff0000, v25
 v_mul_f32 v24, v24, v20
 v_mul_f32 v25, v25, v20
 v_cvt_pk_bf16_f32 v134, v24, v25
 v_lshlrev_b32 v24, 16, v135
 v_and_b32 v25, 0xffff0000, v135
 v_sub_f32 v24, v24, v19
 v_sub_f32 v25, v25, v19
 v_cvt_pk_bf16_f32 v25, v24, v25
 v_lshlrev_b32 v24, 16, v25
 v_and_b32 v25, 0xffff0000, v25
 v_mul_f32 v24, v24, v20
 v_mul_f32 v25, v25, v20
 v_cvt_pk_bf16_f32 v135, v24, v25
 ds_write_b128 v22, v[132:135] offset:20736
 v_lshlrev_b32 v24, 16, v136
 v_and_b32 v25, 0xffff0000, v136
 v_sub_f32 v24, v24, v19
 v_sub_f32 v25, v25, v19
 v_cvt_pk_bf16_f32 v25, v24, v25
 v_lshlrev_b32 v24, 16, v25
 v_and_b32 v25, 0xffff0000, v25
 v_mul_f32 v24, v24, v20
 v_mul_f32 v25, v25, v20
 v_cvt_pk_bf16_f32 v136, v24, v25
 v_lshlrev_b32 v24, 16, v137
 v_and_b32 v25, 0xffff0000, v137
 v_sub_f32 v24, v24, v19
 v_sub_f32 v25, v25, v19
 v_cvt_pk_bf16_f32 v25, v24, v25
 v_lshlrev_b32 v24, 16, v25
 v_and_b32 v25, 0xffff0000, v25
 v_mul_f32 v24, v24, v20
 v_mul_f32 v25, v25, v20
 v_cvt_pk_bf16_f32 v137, v24, v25
 v_lshlrev_b32 v24, 16, v138
 v_and_b32 v25, 0xffff0000, v138
 v_sub_f32 v24, v24, v19
 v_sub_f32 v25, v25, v19
 v_cvt_pk_bf16_f32 v25, v24, v25
 v_lshlrev_b32 v24, 16, v25
 v_and_b32 v25, 0xffff0000, v25
 v_mul_f32 v24, v24, v20
 v_mul_f32 v25, v25, v20
 v_cvt_pk_bf16_f32 v138, v24, v25
 v_lshlrev_b32 v24, 16, v139
 v_and_b32 v25, 0xffff0000, v139
 v_sub_f32 v24, v24, v19
 v_sub_f32 v25, v25, v19
 v_cvt_pk_bf16_f32 v25, v24, v25
 v_lshlrev_b32 v24, 16, v25
 v_and_b32 v25, 0xffff0000, v25
 v_mul_f32 v24, v24, v20
 v_mul_f32 v25, v25, v20
 v_cvt_pk_bf16_f32 v139, v24, v25
 ds_write_b128 v22, v[136:139] offset:23040
 v_lshlrev_b32 v24, 16, v140
 v_and_b32 v25, 0xffff0000, v140
 v_sub_f32 v24, v24, v19
 v_sub_f32 v25, v25, v19
 v_cvt_pk_bf16_f32 v25, v24, v25
 v_lshlrev_b32 v24, 16, v25
 v_and_b32 v25, 0xffff0000, v25
 v_mul_f32 v24, v24, v20
 v_mul_f32 v25, v25, v20
 v_cvt_pk_bf16_f32 v140, v24, v25
 v_lshlrev_b32 v24, 16, v141
 v_and_b32 v25, 0xffff0000, v141
 v_sub_f32 v24, v24, v19
 v_sub_f32 v25, v25, v19
 v_cvt_pk_bf16_f32 v25, v24, v25
 v_lshlrev_b32 v24, 16, v25
 v_and_b32 v25, 0xffff0000, v25
 v_mul_f32 v24, v24, v20
 v_mul_f32 v25, v25, v20
 v_cvt_pk_bf16_f32 v141, v24, v25
 v_lshlrev_b32 v24, 16, v142
 v_and_b32 v25, 0xffff0000, v142
 v_sub_f32 v24, v24, v19
 v_sub_f32 v25, v25, v19
 v_cvt_pk_bf16_f32 v25, v24, v25
 v_lshlrev_b32 v24, 16, v25
 v_and_b32 v25, 0xffff0000, v25
 v_mul_f32 v24, v24, v20
 v_mul_f32 v25, v25, v20
 v_cvt_pk_bf16_f32 v142, v24, v25
 v_lshlrev_b32 v24, 16, v143
 v_and_b32 v25, 0xffff0000, v143
 v_sub_f32 v24, v24, v19
 v_sub_f32 v25, v25, v19
 v_cvt_pk_bf16_f32 v25, v24, v25
 v_lshlrev_b32 v24, 16, v25
 v_and_b32 v25, 0xffff0000, v25
 v_mul_f32 v24, v24, v20
 v_mul_f32 v25, v25, v20
 v_cvt_pk_bf16_f32 v143, v24, v25
 ds_write_b128 v22, v[140:143] offset:25344
 v_lshlrev_b32 v24, 16, v144
 v_and_b32 v25, 0xffff0000, v144
 v_sub_f32 v24, v24, v19
 v_sub_f32 v25, v25, v19
 v_cvt_pk_bf16_f32 v25, v24, v25
 v_lshlrev_b32 v24, 16, v25
 v_and_b32 v25, 0xffff0000, v25
 v_mul_f32 v24, v24, v20
 v_mul_f32 v25, v25, v20
 v_cvt_pk_bf16_f32 v144, v24, v25
 v_lshlrev_b32 v24, 16, v145
 v_and_b32 v25, 0xffff0000, v145
 v_sub_f32 v24, v24, v19
 v_sub_f32 v25, v25, v19
 v_cvt_pk_bf16_f32 v25, v24, v25
 v_lshlrev_b32 v24, 16, v25
 v_and_b32 v25, 0xffff0000, v25
 v_mul_f32 v24, v24, v20
 v_mul_f32 v25, v25, v20
 v_cvt_pk_bf16_f32 v145, v24, v25
 v_lshlrev_b32 v24, 16, v146
 v_and_b32 v25, 0xffff0000, v146
 v_sub_f32 v24, v24, v19
 v_sub_f32 v25, v25, v19
 v_cvt_pk_bf16_f32 v25, v24, v25
 v_lshlrev_b32 v24, 16, v25
 v_and_b32 v25, 0xffff0000, v25
 v_mul_f32 v24, v24, v20
 v_mul_f32 v25, v25, v20
 v_cvt_pk_bf16_f32 v146, v24, v25
 v_lshlrev_b32 v24, 16, v147
 v_and_b32 v25, 0xffff0000, v147
 v_sub_f32 v24, v24, v19
 v_sub_f32 v25, v25, v19
 v_cvt_pk_bf16_f32 v25, v24, v25
 v_lshlrev_b32 v24, 16, v25
 v_and_b32 v25, 0xffff0000, v25
 v_mul_f32 v24, v24, v20
 v_mul_f32 v25, v25, v20
 v_cvt_pk_bf16_f32 v147, v24, v25
 ds_write_b128 v22, v[144:147] offset:27648
 v_lshlrev_b32 v24, 16, v148
 v_and_b32 v25, 0xffff0000, v148
 v_sub_f32 v24, v24, v19
 v_sub_f32 v25, v25, v19
 v_cvt_pk_bf16_f32 v25, v24, v25
 v_lshlrev_b32 v24, 16, v25
 v_and_b32 v25, 0xffff0000, v25
 v_mul_f32 v24, v24, v20
 v_mul_f32 v25, v25, v20
 v_cvt_pk_bf16_f32 v148, v24, v25
 v_lshlrev_b32 v24, 16, v149
 v_and_b32 v25, 0xffff0000, v149
 v_sub_f32 v24, v24, v19
 v_sub_f32 v25, v25, v19
 v_cvt_pk_bf16_f32 v25, v24, v25
 v_lshlrev_b32 v24, 16, v25
 v_and_b32 v25, 0xffff0000, v25
 v_mul_f32 v24, v24, v20
 v_mul_f32 v25, v25, v20
 v_cvt_pk_bf16_f32 v149, v24, v25
 v_lshlrev_b32 v24, 16, v150
 v_and_b32 v25, 0xffff0000, v150
 v_sub_f32 v24, v24, v19
 v_sub_f32 v25, v25, v19
 v_cvt_pk_bf16_f32 v25, v24, v25
 v_lshlrev_b32 v24, 16, v25
 v_and_b32 v25, 0xffff0000, v25
 v_mul_f32 v24, v24, v20
 v_mul_f32 v25, v25, v20
 v_cvt_pk_bf16_f32 v150, v24, v25
 v_lshlrev_b32 v24, 16, v151
 v_and_b32 v25, 0xffff0000, v151
 v_sub_f32 v24, v24, v19
 v_sub_f32 v25, v25, v19
 v_cvt_pk_bf16_f32 v25, v24, v25
 v_lshlrev_b32 v24, 16, v25
 v_and_b32 v25, 0xffff0000, v25
 v_mul_f32 v24, v24, v20
 v_mul_f32 v25, v25, v20
 v_cvt_pk_bf16_f32 v151, v24, v25
 ds_write_b128 v22, v[148:151] offset:29952
 v_lshlrev_b32 v24, 16, v152
 v_and_b32 v25, 0xffff0000, v152
 v_sub_f32 v24, v24, v19
 v_sub_f32 v25, v25, v19
 v_cvt_pk_bf16_f32 v25, v24, v25
 v_lshlrev_b32 v24, 16, v25
 v_and_b32 v25, 0xffff0000, v25
 v_mul_f32 v24, v24, v20
 v_mul_f32 v25, v25, v20
 v_cvt_pk_bf16_f32 v152, v24, v25
 v_lshlrev_b32 v24, 16, v153
 v_and_b32 v25, 0xffff0000, v153
 v_sub_f32 v24, v24, v19
 v_sub_f32 v25, v25, v19
 v_cvt_pk_bf16_f32 v25, v24, v25
 v_lshlrev_b32 v24, 16, v25
 v_and_b32 v25, 0xffff0000, v25
 v_mul_f32 v24, v24, v20
 v_mul_f32 v25, v25, v20
 v_cvt_pk_bf16_f32 v153, v24, v25
 v_lshlrev_b32 v24, 16, v154
 v_and_b32 v25, 0xffff0000, v154
 v_sub_f32 v24, v24, v19
 v_sub_f32 v25, v25, v19
 v_cvt_pk_bf16_f32 v25, v24, v25
 v_lshlrev_b32 v24, 16, v25
 v_and_b32 v25, 0xffff0000, v25
 v_mul_f32 v24, v24, v20
 v_mul_f32 v25, v25, v20
 v_cvt_pk_bf16_f32 v154, v24, v25
 v_lshlrev_b32 v24, 16, v155
 v_and_b32 v25, 0xffff0000, v155
 v_sub_f32 v24, v24, v19
 v_sub_f32 v25, v25, v19
 v_cvt_pk_bf16_f32 v25, v24, v25
 v_lshlrev_b32 v24, 16, v25
 v_and_b32 v25, 0xffff0000, v25
 v_mul_f32 v24, v24, v20
 v_mul_f32 v25, v25, v20
 v_cvt_pk_bf16_f32 v155, v24, v25
 ds_write_b128 v22, v[152:155] offset:32256
 v_lshlrev_b32 v24, 16, v156
 v_and_b32 v25, 0xffff0000, v156
 v_sub_f32 v24, v24, v19
 v_sub_f32 v25, v25, v19
 v_cvt_pk_bf16_f32 v25, v24, v25
 v_lshlrev_b32 v24, 16, v25
 v_and_b32 v25, 0xffff0000, v25
 v_mul_f32 v24, v24, v20
 v_mul_f32 v25, v25, v20
 v_cvt_pk_bf16_f32 v156, v24, v25
 v_lshlrev_b32 v24, 16, v157
 v_and_b32 v25, 0xffff0000, v157
 v_sub_f32 v24, v24, v19
 v_sub_f32 v25, v25, v19
 v_cvt_pk_bf16_f32 v25, v24, v25
 v_lshlrev_b32 v24, 16, v25
 v_and_b32 v25, 0xffff0000, v25
 v_mul_f32 v24, v24, v20
 v_mul_f32 v25, v25, v20
 v_cvt_pk_bf16_f32 v157, v24, v25
 v_lshlrev_b32 v24, 16, v158
 v_and_b32 v25, 0xffff0000, v158
 v_sub_f32 v24, v24, v19
 v_sub_f32 v25, v25, v19
 v_cvt_pk_bf16_f32 v25, v24, v25
 v_lshlrev_b32 v24, 16, v25
 v_and_b32 v25, 0xffff0000, v25
 v_mul_f32 v24, v24, v20
 v_mul_f32 v25, v25, v20
 v_cvt_pk_bf16_f32 v158, v24, v25
 v_lshlrev_b32 v24, 16, v159
 v_and_b32 v25, 0xffff0000, v159
 v_sub_f32 v24, v24, v19
 v_sub_f32 v25, v25, v19
 v_cvt_pk_bf16_f32 v25, v24, v25
 v_lshlrev_b32 v24, 16, v25
 v_and_b32 v25, 0xffff0000, v25
 v_mul_f32 v24, v24, v20
 v_mul_f32 v25, v25, v20
 v_cvt_pk_bf16_f32 v159, v24, v25
 ds_write_b128 v22, v[156:159] offset:34560
 v_lshlrev_b32 v24, 16, v160
 v_and_b32 v25, 0xffff0000, v160
 v_sub_f32 v24, v24, v19
 v_sub_f32 v25, v25, v19
 v_cvt_pk_bf16_f32 v25, v24, v25
 v_lshlrev_b32 v24, 16, v25
 v_and_b32 v25, 0xffff0000, v25
 v_mul_f32 v24, v24, v20
 v_mul_f32 v25, v25, v20
 v_cvt_pk_bf16_f32 v160, v24, v25
 v_lshlrev_b32 v24, 16, v161
 v_and_b32 v25, 0xffff0000, v161
 v_sub_f32 v24, v24, v19
 v_sub_f32 v25, v25, v19
 v_cvt_pk_bf16_f32 v25, v24, v25
 v_lshlrev_b32 v24, 16, v25
 v_and_b32 v25, 0xffff0000, v25
 v_mul_f32 v24, v24, v20
 v_mul_f32 v25, v25, v20
 v_cvt_pk_bf16_f32 v161, v24, v25
 v_lshlrev_b32 v24, 16, v162
 v_and_b32 v25, 0xffff0000, v162
 v_sub_f32 v24, v24, v19
 v_sub_f32 v25, v25, v19
 v_cvt_pk_bf16_f32 v25, v24, v25
 v_lshlrev_b32 v24, 16, v25
 v_and_b32 v25, 0xffff0000, v25
 v_mul_f32 v24, v24, v20
 v_mul_f32 v25, v25, v20
 v_cvt_pk_bf16_f32 v162, v24, v25
 v_lshlrev_b32 v24, 16, v163
 v_and_b32 v25, 0xffff0000, v163
 v_sub_f32 v24, v24, v19
 v_sub_f32 v25, v25, v19
 v_cvt_pk_bf16_f32 v25, v24, v25
 v_lshlrev_b32 v24, 16, v25
 v_and_b32 v25, 0xffff0000, v25
 v_mul_f32 v24, v24, v20
 v_mul_f32 v25, v25, v20
 v_cvt_pk_bf16_f32 v163, v24, v25
 ds_write_b128 v23, v[160:163] offset:0
 v_lshlrev_b32 v24, 16, v164
 v_and_b32 v25, 0xffff0000, v164
 v_sub_f32 v24, v24, v19
 v_sub_f32 v25, v25, v19
 v_cvt_pk_bf16_f32 v25, v24, v25
 v_lshlrev_b32 v24, 16, v25
 v_and_b32 v25, 0xffff0000, v25
 v_mul_f32 v24, v24, v20
 v_mul_f32 v25, v25, v20
 v_cvt_pk_bf16_f32 v164, v24, v25
 v_lshlrev_b32 v24, 16, v165
 v_and_b32 v25, 0xffff0000, v165
 v_sub_f32 v24, v24, v19
 v_sub_f32 v25, v25, v19
 v_cvt_pk_bf16_f32 v25, v24, v25
 v_lshlrev_b32 v24, 16, v25
 v_and_b32 v25, 0xffff0000, v25
 v_mul_f32 v24, v24, v20
 v_mul_f32 v25, v25, v20
 v_cvt_pk_bf16_f32 v165, v24, v25
 v_lshlrev_b32 v24, 16, v166
 v_and_b32 v25, 0xffff0000, v166
 v_sub_f32 v24, v24, v19
 v_sub_f32 v25, v25, v19
 v_cvt_pk_bf16_f32 v25, v24, v25
 v_lshlrev_b32 v24, 16, v25
 v_and_b32 v25, 0xffff0000, v25
 v_mul_f32 v24, v24, v20
 v_mul_f32 v25, v25, v20
 v_cvt_pk_bf16_f32 v166, v24, v25
 v_lshlrev_b32 v24, 16, v167
 v_and_b32 v25, 0xffff0000, v167
 v_sub_f32 v24, v24, v19
 v_sub_f32 v25, v25, v19
 v_cvt_pk_bf16_f32 v25, v24, v25
 v_lshlrev_b32 v24, 16, v25
 v_and_b32 v25, 0xffff0000, v25
 v_mul_f32 v24, v24, v20
 v_mul_f32 v25, v25, v20
 v_cvt_pk_bf16_f32 v167, v24, v25
 ds_write_b128 v23, v[164:167] offset:2304
 v_lshlrev_b32 v24, 16, v168
 v_and_b32 v25, 0xffff0000, v168
 v_sub_f32 v24, v24, v19
 v_sub_f32 v25, v25, v19
 v_cvt_pk_bf16_f32 v25, v24, v25
 v_lshlrev_b32 v24, 16, v25
 v_and_b32 v25, 0xffff0000, v25
 v_mul_f32 v24, v24, v20
 v_mul_f32 v25, v25, v20
 v_cvt_pk_bf16_f32 v168, v24, v25
 v_lshlrev_b32 v24, 16, v169
 v_and_b32 v25, 0xffff0000, v169
 v_sub_f32 v24, v24, v19
 v_sub_f32 v25, v25, v19
 v_cvt_pk_bf16_f32 v25, v24, v25
 v_lshlrev_b32 v24, 16, v25
 v_and_b32 v25, 0xffff0000, v25
 v_mul_f32 v24, v24, v20
 v_mul_f32 v25, v25, v20
 v_cvt_pk_bf16_f32 v169, v24, v25
 v_lshlrev_b32 v24, 16, v170
 v_and_b32 v25, 0xffff0000, v170
 v_sub_f32 v24, v24, v19
 v_sub_f32 v25, v25, v19
 v_cvt_pk_bf16_f32 v25, v24, v25
 v_lshlrev_b32 v24, 16, v25
 v_and_b32 v25, 0xffff0000, v25
 v_mul_f32 v24, v24, v20
 v_mul_f32 v25, v25, v20
 v_cvt_pk_bf16_f32 v170, v24, v25
 v_lshlrev_b32 v24, 16, v171
 v_and_b32 v25, 0xffff0000, v171
 v_sub_f32 v24, v24, v19
 v_sub_f32 v25, v25, v19
 v_cvt_pk_bf16_f32 v25, v24, v25
 v_lshlrev_b32 v24, 16, v25
 v_and_b32 v25, 0xffff0000, v25
 v_mul_f32 v24, v24, v20
 v_mul_f32 v25, v25, v20
 v_cvt_pk_bf16_f32 v171, v24, v25
 ds_write_b128 v23, v[168:171] offset:4608
 v_lshlrev_b32 v24, 16, v172
 v_and_b32 v25, 0xffff0000, v172
 v_sub_f32 v24, v24, v19
 v_sub_f32 v25, v25, v19
 v_cvt_pk_bf16_f32 v25, v24, v25
 v_lshlrev_b32 v24, 16, v25
 v_and_b32 v25, 0xffff0000, v25
 v_mul_f32 v24, v24, v20
 v_mul_f32 v25, v25, v20
 v_cvt_pk_bf16_f32 v172, v24, v25
 v_lshlrev_b32 v24, 16, v173
 v_and_b32 v25, 0xffff0000, v173
 v_sub_f32 v24, v24, v19
 v_sub_f32 v25, v25, v19
 v_cvt_pk_bf16_f32 v25, v24, v25
 v_lshlrev_b32 v24, 16, v25
 v_and_b32 v25, 0xffff0000, v25
 v_mul_f32 v24, v24, v20
 v_mul_f32 v25, v25, v20
 v_cvt_pk_bf16_f32 v173, v24, v25
 v_lshlrev_b32 v24, 16, v174
 v_and_b32 v25, 0xffff0000, v174
 v_sub_f32 v24, v24, v19
 v_sub_f32 v25, v25, v19
 v_cvt_pk_bf16_f32 v25, v24, v25
 v_lshlrev_b32 v24, 16, v25
 v_and_b32 v25, 0xffff0000, v25
 v_mul_f32 v24, v24, v20
 v_mul_f32 v25, v25, v20
 v_cvt_pk_bf16_f32 v174, v24, v25
 v_lshlrev_b32 v24, 16, v175
 v_and_b32 v25, 0xffff0000, v175
 v_sub_f32 v24, v24, v19
 v_sub_f32 v25, v25, v19
 v_cvt_pk_bf16_f32 v25, v24, v25
 v_lshlrev_b32 v24, 16, v25
 v_and_b32 v25, 0xffff0000, v25
 v_mul_f32 v24, v24, v20
 v_mul_f32 v25, v25, v20
 v_cvt_pk_bf16_f32 v175, v24, v25
 ds_write_b128 v23, v[172:175] offset:6912
 v_lshlrev_b32 v24, 16, v176
 v_and_b32 v25, 0xffff0000, v176
 v_sub_f32 v24, v24, v19
 v_sub_f32 v25, v25, v19
 v_cvt_pk_bf16_f32 v25, v24, v25
 v_lshlrev_b32 v24, 16, v25
 v_and_b32 v25, 0xffff0000, v25
 v_mul_f32 v24, v24, v20
 v_mul_f32 v25, v25, v20
 v_cvt_pk_bf16_f32 v176, v24, v25
 v_lshlrev_b32 v24, 16, v177
 v_and_b32 v25, 0xffff0000, v177
 v_sub_f32 v24, v24, v19
 v_sub_f32 v25, v25, v19
 v_cvt_pk_bf16_f32 v25, v24, v25
 v_lshlrev_b32 v24, 16, v25
 v_and_b32 v25, 0xffff0000, v25
 v_mul_f32 v24, v24, v20
 v_mul_f32 v25, v25, v20
 v_cvt_pk_bf16_f32 v177, v24, v25
 v_lshlrev_b32 v24, 16, v178
 v_and_b32 v25, 0xffff0000, v178
 v_sub_f32 v24, v24, v19
 v_sub_f32 v25, v25, v19
 v_cvt_pk_bf16_f32 v25, v24, v25
 v_lshlrev_b32 v24, 16, v25
 v_and_b32 v25, 0xffff0000, v25
 v_mul_f32 v24, v24, v20
 v_mul_f32 v25, v25, v20
 v_cvt_pk_bf16_f32 v178, v24, v25
 v_lshlrev_b32 v24, 16, v179
 v_and_b32 v25, 0xffff0000, v179
 v_sub_f32 v24, v24, v19
 v_sub_f32 v25, v25, v19
 v_cvt_pk_bf16_f32 v25, v24, v25
 v_lshlrev_b32 v24, 16, v25
 v_and_b32 v25, 0xffff0000, v25
 v_mul_f32 v24, v24, v20
 v_mul_f32 v25, v25, v20
 v_cvt_pk_bf16_f32 v179, v24, v25
 ds_write_b128 v23, v[176:179] offset:9216
 v_lshlrev_b32 v24, 16, v180
 v_and_b32 v25, 0xffff0000, v180
 v_sub_f32 v24, v24, v19
 v_sub_f32 v25, v25, v19
 v_cvt_pk_bf16_f32 v25, v24, v25
 v_lshlrev_b32 v24, 16, v25
 v_and_b32 v25, 0xffff0000, v25
 v_mul_f32 v24, v24, v20
 v_mul_f32 v25, v25, v20
 v_cvt_pk_bf16_f32 v180, v24, v25
 v_lshlrev_b32 v24, 16, v181
 v_and_b32 v25, 0xffff0000, v181
 v_sub_f32 v24, v24, v19
 v_sub_f32 v25, v25, v19
 v_cvt_pk_bf16_f32 v25, v24, v25
 v_lshlrev_b32 v24, 16, v25
 v_and_b32 v25, 0xffff0000, v25
 v_mul_f32 v24, v24, v20
 v_mul_f32 v25, v25, v20
 v_cvt_pk_bf16_f32 v181, v24, v25
 v_lshlrev_b32 v24, 16, v182
 v_and_b32 v25, 0xffff0000, v182
 v_sub_f32 v24, v24, v19
 v_sub_f32 v25, v25, v19
 v_cvt_pk_bf16_f32 v25, v24, v25
 v_lshlrev_b32 v24, 16, v25
 v_and_b32 v25, 0xffff0000, v25
 v_mul_f32 v24, v24, v20
 v_mul_f32 v25, v25, v20
 v_cvt_pk_bf16_f32 v182, v24, v25
 v_lshlrev_b32 v24, 16, v183
 v_and_b32 v25, 0xffff0000, v183
 v_sub_f32 v24, v24, v19
 v_sub_f32 v25, v25, v19
 v_cvt_pk_bf16_f32 v25, v24, v25
 v_lshlrev_b32 v24, 16, v25
 v_and_b32 v25, 0xffff0000, v25
 v_mul_f32 v24, v24, v20
 v_mul_f32 v25, v25, v20
 v_cvt_pk_bf16_f32 v183, v24, v25
 ds_write_b128 v23, v[180:183] offset:11520
 v_lshlrev_b32 v24, 16, v184
 v_and_b32 v25, 0xffff0000, v184
 v_sub_f32 v24, v24, v19
 v_sub_f32 v25, v25, v19
 v_cvt_pk_bf16_f32 v25, v24, v25
 v_lshlrev_b32 v24, 16, v25
 v_and_b32 v25, 0xffff0000, v25
 v_mul_f32 v24, v24, v20
 v_mul_f32 v25, v25, v20
 v_cvt_pk_bf16_f32 v184, v24, v25
 v_lshlrev_b32 v24, 16, v185
 v_and_b32 v25, 0xffff0000, v185
 v_sub_f32 v24, v24, v19
 v_sub_f32 v25, v25, v19
 v_cvt_pk_bf16_f32 v25, v24, v25
 v_lshlrev_b32 v24, 16, v25
 v_and_b32 v25, 0xffff0000, v25
 v_mul_f32 v24, v24, v20
 v_mul_f32 v25, v25, v20
 v_cvt_pk_bf16_f32 v185, v24, v25
 v_lshlrev_b32 v24, 16, v186
 v_and_b32 v25, 0xffff0000, v186
 v_sub_f32 v24, v24, v19
 v_sub_f32 v25, v25, v19
 v_cvt_pk_bf16_f32 v25, v24, v25
 v_lshlrev_b32 v24, 16, v25
 v_and_b32 v25, 0xffff0000, v25
 v_mul_f32 v24, v24, v20
 v_mul_f32 v25, v25, v20
 v_cvt_pk_bf16_f32 v186, v24, v25
 v_lshlrev_b32 v24, 16, v187
 v_and_b32 v25, 0xffff0000, v187
 v_sub_f32 v24, v24, v19
 v_sub_f32 v25, v25, v19
 v_cvt_pk_bf16_f32 v25, v24, v25
 v_lshlrev_b32 v24, 16, v25
 v_and_b32 v25, 0xffff0000, v25
 v_mul_f32 v24, v24, v20
 v_mul_f32 v25, v25, v20
 v_cvt_pk_bf16_f32 v187, v24, v25
 ds_write_b128 v23, v[184:187] offset:13824
 v_lshlrev_b32 v24, 16, v188
 v_and_b32 v25, 0xffff0000, v188
 v_sub_f32 v24, v24, v19
 v_sub_f32 v25, v25, v19
 v_cvt_pk_bf16_f32 v25, v24, v25
 v_lshlrev_b32 v24, 16, v25
 v_and_b32 v25, 0xffff0000, v25
 v_mul_f32 v24, v24, v20
 v_mul_f32 v25, v25, v20
 v_cvt_pk_bf16_f32 v188, v24, v25
 v_lshlrev_b32 v24, 16, v189
 v_and_b32 v25, 0xffff0000, v189
 v_sub_f32 v24, v24, v19
 v_sub_f32 v25, v25, v19
 v_cvt_pk_bf16_f32 v25, v24, v25
 v_lshlrev_b32 v24, 16, v25
 v_and_b32 v25, 0xffff0000, v25
 v_mul_f32 v24, v24, v20
 v_mul_f32 v25, v25, v20
 v_cvt_pk_bf16_f32 v189, v24, v25
 v_lshlrev_b32 v24, 16, v190
 v_and_b32 v25, 0xffff0000, v190
 v_sub_f32 v24, v24, v19
 v_sub_f32 v25, v25, v19
 v_cvt_pk_bf16_f32 v25, v24, v25
 v_lshlrev_b32 v24, 16, v25
 v_and_b32 v25, 0xffff0000, v25
 v_mul_f32 v24, v24, v20
 v_mul_f32 v25, v25, v20
 v_cvt_pk_bf16_f32 v190, v24, v25
 v_lshlrev_b32 v24, 16, v191
 v_and_b32 v25, 0xffff0000, v191
 v_sub_f32 v24, v24, v19
 v_sub_f32 v25, v25, v19
 v_cvt_pk_bf16_f32 v25, v24, v25
 v_lshlrev_b32 v24, 16, v25
 v_and_b32 v25, 0xffff0000, v25
 v_mul_f32 v24, v24, v20
 v_mul_f32 v25, v25, v20
 v_cvt_pk_bf16_f32 v191, v24, v25
 ds_write_b128 v23, v[188:191] offset:16128
 v_lshlrev_b32 v24, 16, v192
 v_and_b32 v25, 0xffff0000, v192
 v_sub_f32 v24, v24, v19
 v_sub_f32 v25, v25, v19
 v_cvt_pk_bf16_f32 v25, v24, v25
 v_lshlrev_b32 v24, 16, v25
 v_and_b32 v25, 0xffff0000, v25
 v_mul_f32 v24, v24, v20
 v_mul_f32 v25, v25, v20
 v_cvt_pk_bf16_f32 v192, v24, v25
 v_lshlrev_b32 v24, 16, v193
 v_and_b32 v25, 0xffff0000, v193
 v_sub_f32 v24, v24, v19
 v_sub_f32 v25, v25, v19
 v_cvt_pk_bf16_f32 v25, v24, v25
 v_lshlrev_b32 v24, 16, v25
 v_and_b32 v25, 0xffff0000, v25
 v_mul_f32 v24, v24, v20
 v_mul_f32 v25, v25, v20
 v_cvt_pk_bf16_f32 v193, v24, v25
 v_lshlrev_b32 v24, 16, v194
 v_and_b32 v25, 0xffff0000, v194
 v_sub_f32 v24, v24, v19
 v_sub_f32 v25, v25, v19
 v_cvt_pk_bf16_f32 v25, v24, v25
 v_lshlrev_b32 v24, 16, v25
 v_and_b32 v25, 0xffff0000, v25
 v_mul_f32 v24, v24, v20
 v_mul_f32 v25, v25, v20
 v_cvt_pk_bf16_f32 v194, v24, v25
 v_lshlrev_b32 v24, 16, v195
 v_and_b32 v25, 0xffff0000, v195
 v_sub_f32 v24, v24, v19
 v_sub_f32 v25, v25, v19
 v_cvt_pk_bf16_f32 v25, v24, v25
 v_lshlrev_b32 v24, 16, v25
 v_and_b32 v25, 0xffff0000, v25
 v_mul_f32 v24, v24, v20
 v_mul_f32 v25, v25, v20
 v_cvt_pk_bf16_f32 v195, v24, v25
 ds_write_b128 v23, v[192:195] offset:18432
 v_lshlrev_b32 v24, 16, v196
 v_and_b32 v25, 0xffff0000, v196
 v_sub_f32 v24, v24, v19
 v_sub_f32 v25, v25, v19
 v_cvt_pk_bf16_f32 v25, v24, v25
 v_lshlrev_b32 v24, 16, v25
 v_and_b32 v25, 0xffff0000, v25
 v_mul_f32 v24, v24, v20
 v_mul_f32 v25, v25, v20
 v_cvt_pk_bf16_f32 v196, v24, v25
 v_lshlrev_b32 v24, 16, v197
 v_and_b32 v25, 0xffff0000, v197
 v_sub_f32 v24, v24, v19
 v_sub_f32 v25, v25, v19
 v_cvt_pk_bf16_f32 v25, v24, v25
 v_lshlrev_b32 v24, 16, v25
 v_and_b32 v25, 0xffff0000, v25
 v_mul_f32 v24, v24, v20
 v_mul_f32 v25, v25, v20
 v_cvt_pk_bf16_f32 v197, v24, v25
 v_lshlrev_b32 v24, 16, v198
 v_and_b32 v25, 0xffff0000, v198
 v_sub_f32 v24, v24, v19
 v_sub_f32 v25, v25, v19
 v_cvt_pk_bf16_f32 v25, v24, v25
 v_lshlrev_b32 v24, 16, v25
 v_and_b32 v25, 0xffff0000, v25
 v_mul_f32 v24, v24, v20
 v_mul_f32 v25, v25, v20
 v_cvt_pk_bf16_f32 v198, v24, v25
 v_lshlrev_b32 v24, 16, v199
 v_and_b32 v25, 0xffff0000, v199
 v_sub_f32 v24, v24, v19
 v_sub_f32 v25, v25, v19
 v_cvt_pk_bf16_f32 v25, v24, v25
 v_lshlrev_b32 v24, 16, v25
 v_and_b32 v25, 0xffff0000, v25
 v_mul_f32 v24, v24, v20
 v_mul_f32 v25, v25, v20
 v_cvt_pk_bf16_f32 v199, v24, v25
 ds_write_b128 v23, v[196:199] offset:20736
 v_lshlrev_b32 v24, 16, v200
 v_and_b32 v25, 0xffff0000, v200
 v_sub_f32 v24, v24, v19
 v_sub_f32 v25, v25, v19
 v_cvt_pk_bf16_f32 v25, v24, v25
 v_lshlrev_b32 v24, 16, v25
 v_and_b32 v25, 0xffff0000, v25
 v_mul_f32 v24, v24, v20
 v_mul_f32 v25, v25, v20
 v_cvt_pk_bf16_f32 v200, v24, v25
 v_lshlrev_b32 v24, 16, v201
 v_and_b32 v25, 0xffff0000, v201
 v_sub_f32 v24, v24, v19
 v_sub_f32 v25, v25, v19
 v_cvt_pk_bf16_f32 v25, v24, v25
 v_lshlrev_b32 v24, 16, v25
 v_and_b32 v25, 0xffff0000, v25
 v_mul_f32 v24, v24, v20
 v_mul_f32 v25, v25, v20
 v_cvt_pk_bf16_f32 v201, v24, v25
 v_lshlrev_b32 v24, 16, v202
 v_and_b32 v25, 0xffff0000, v202
 v_sub_f32 v24, v24, v19
 v_sub_f32 v25, v25, v19
 v_cvt_pk_bf16_f32 v25, v24, v25
 v_lshlrev_b32 v24, 16, v25
 v_and_b32 v25, 0xffff0000, v25
 v_mul_f32 v24, v24, v20
 v_mul_f32 v25, v25, v20
 v_cvt_pk_bf16_f32 v202, v24, v25
 v_lshlrev_b32 v24, 16, v203
 v_and_b32 v25, 0xffff0000, v203
 v_sub_f32 v24, v24, v19
 v_sub_f32 v25, v25, v19
 v_cvt_pk_bf16_f32 v25, v24, v25
 v_lshlrev_b32 v24, 16, v25
 v_and_b32 v25, 0xffff0000, v25
 v_mul_f32 v24, v24, v20
 v_mul_f32 v25, v25, v20
 v_cvt_pk_bf16_f32 v203, v24, v25
 ds_write_b128 v23, v[200:203] offset:23040
 v_lshlrev_b32 v24, 16, v204
 v_and_b32 v25, 0xffff0000, v204
 v_sub_f32 v24, v24, v19
 v_sub_f32 v25, v25, v19
 v_cvt_pk_bf16_f32 v25, v24, v25
 v_lshlrev_b32 v24, 16, v25
 v_and_b32 v25, 0xffff0000, v25
 v_mul_f32 v24, v24, v20
 v_mul_f32 v25, v25, v20
 v_cvt_pk_bf16_f32 v204, v24, v25
 v_lshlrev_b32 v24, 16, v205
 v_and_b32 v25, 0xffff0000, v205
 v_sub_f32 v24, v24, v19
 v_sub_f32 v25, v25, v19
 v_cvt_pk_bf16_f32 v25, v24, v25
 v_lshlrev_b32 v24, 16, v25
 v_and_b32 v25, 0xffff0000, v25
 v_mul_f32 v24, v24, v20
 v_mul_f32 v25, v25, v20
 v_cvt_pk_bf16_f32 v205, v24, v25
 v_lshlrev_b32 v24, 16, v206
 v_and_b32 v25, 0xffff0000, v206
 v_sub_f32 v24, v24, v19
 v_sub_f32 v25, v25, v19
 v_cvt_pk_bf16_f32 v25, v24, v25
 v_lshlrev_b32 v24, 16, v25
 v_and_b32 v25, 0xffff0000, v25
 v_mul_f32 v24, v24, v20
 v_mul_f32 v25, v25, v20
 v_cvt_pk_bf16_f32 v206, v24, v25
 v_lshlrev_b32 v24, 16, v207
 v_and_b32 v25, 0xffff0000, v207
 v_sub_f32 v24, v24, v19
 v_sub_f32 v25, v25, v19
 v_cvt_pk_bf16_f32 v25, v24, v25
 v_lshlrev_b32 v24, 16, v25
 v_and_b32 v25, 0xffff0000, v25
 v_mul_f32 v24, v24, v20
 v_mul_f32 v25, v25, v20
 v_cvt_pk_bf16_f32 v207, v24, v25
 ds_write_b128 v23, v[204:207] offset:25344
 v_lshlrev_b32 v24, 16, v208
 v_and_b32 v25, 0xffff0000, v208
 v_sub_f32 v24, v24, v19
 v_sub_f32 v25, v25, v19
 v_cvt_pk_bf16_f32 v25, v24, v25
 v_lshlrev_b32 v24, 16, v25
 v_and_b32 v25, 0xffff0000, v25
 v_mul_f32 v24, v24, v20
 v_mul_f32 v25, v25, v20
 v_cvt_pk_bf16_f32 v208, v24, v25
 v_lshlrev_b32 v24, 16, v209
 v_and_b32 v25, 0xffff0000, v209
 v_sub_f32 v24, v24, v19
 v_sub_f32 v25, v25, v19
 v_cvt_pk_bf16_f32 v25, v24, v25
 v_lshlrev_b32 v24, 16, v25
 v_and_b32 v25, 0xffff0000, v25
 v_mul_f32 v24, v24, v20
 v_mul_f32 v25, v25, v20
 v_cvt_pk_bf16_f32 v209, v24, v25
 v_lshlrev_b32 v24, 16, v210
 v_and_b32 v25, 0xffff0000, v210
 v_sub_f32 v24, v24, v19
 v_sub_f32 v25, v25, v19
 v_cvt_pk_bf16_f32 v25, v24, v25
 v_lshlrev_b32 v24, 16, v25
 v_and_b32 v25, 0xffff0000, v25
 v_mul_f32 v24, v24, v20
 v_mul_f32 v25, v25, v20
 v_cvt_pk_bf16_f32 v210, v24, v25
 v_lshlrev_b32 v24, 16, v211
 v_and_b32 v25, 0xffff0000, v211
 v_sub_f32 v24, v24, v19
 v_sub_f32 v25, v25, v19
 v_cvt_pk_bf16_f32 v25, v24, v25
 v_lshlrev_b32 v24, 16, v25
 v_and_b32 v25, 0xffff0000, v25
 v_mul_f32 v24, v24, v20
 v_mul_f32 v25, v25, v20
 v_cvt_pk_bf16_f32 v211, v24, v25
 ds_write_b128 v23, v[208:211] offset:27648
 v_lshlrev_b32 v24, 16, v212
 v_and_b32 v25, 0xffff0000, v212
 v_sub_f32 v24, v24, v19
 v_sub_f32 v25, v25, v19
 v_cvt_pk_bf16_f32 v25, v24, v25
 v_lshlrev_b32 v24, 16, v25
 v_and_b32 v25, 0xffff0000, v25
 v_mul_f32 v24, v24, v20
 v_mul_f32 v25, v25, v20
 v_cvt_pk_bf16_f32 v212, v24, v25
 v_lshlrev_b32 v24, 16, v213
 v_and_b32 v25, 0xffff0000, v213
 v_sub_f32 v24, v24, v19
 v_sub_f32 v25, v25, v19
 v_cvt_pk_bf16_f32 v25, v24, v25
 v_lshlrev_b32 v24, 16, v25
 v_and_b32 v25, 0xffff0000, v25
 v_mul_f32 v24, v24, v20
 v_mul_f32 v25, v25, v20
 v_cvt_pk_bf16_f32 v213, v24, v25
 v_lshlrev_b32 v24, 16, v214
 v_and_b32 v25, 0xffff0000, v214
 v_sub_f32 v24, v24, v19
 v_sub_f32 v25, v25, v19
 v_cvt_pk_bf16_f32 v25, v24, v25
 v_lshlrev_b32 v24, 16, v25
 v_and_b32 v25, 0xffff0000, v25
 v_mul_f32 v24, v24, v20
 v_mul_f32 v25, v25, v20
 v_cvt_pk_bf16_f32 v214, v24, v25
 v_lshlrev_b32 v24, 16, v215
 v_and_b32 v25, 0xffff0000, v215
 v_sub_f32 v24, v24, v19
 v_sub_f32 v25, v25, v19
 v_cvt_pk_bf16_f32 v25, v24, v25
 v_lshlrev_b32 v24, 16, v25
 v_and_b32 v25, 0xffff0000, v25
 v_mul_f32 v24, v24, v20
 v_mul_f32 v25, v25, v20
 v_cvt_pk_bf16_f32 v215, v24, v25
 ds_write_b128 v23, v[212:215] offset:29952
 v_lshlrev_b32 v24, 16, v216
 v_and_b32 v25, 0xffff0000, v216
 v_sub_f32 v24, v24, v19
 v_sub_f32 v25, v25, v19
 v_cvt_pk_bf16_f32 v25, v24, v25
 v_lshlrev_b32 v24, 16, v25
 v_and_b32 v25, 0xffff0000, v25
 v_mul_f32 v24, v24, v20
 v_mul_f32 v25, v25, v20
 v_cvt_pk_bf16_f32 v216, v24, v25
 v_lshlrev_b32 v24, 16, v217
 v_and_b32 v25, 0xffff0000, v217
 v_sub_f32 v24, v24, v19
 v_sub_f32 v25, v25, v19
 v_cvt_pk_bf16_f32 v25, v24, v25
 v_lshlrev_b32 v24, 16, v25
 v_and_b32 v25, 0xffff0000, v25
 v_mul_f32 v24, v24, v20
 v_mul_f32 v25, v25, v20
 v_cvt_pk_bf16_f32 v217, v24, v25
 v_lshlrev_b32 v24, 16, v218
 v_and_b32 v25, 0xffff0000, v218
 v_sub_f32 v24, v24, v19
 v_sub_f32 v25, v25, v19
 v_cvt_pk_bf16_f32 v25, v24, v25
 v_lshlrev_b32 v24, 16, v25
 v_and_b32 v25, 0xffff0000, v25
 v_mul_f32 v24, v24, v20
 v_mul_f32 v25, v25, v20
 v_cvt_pk_bf16_f32 v218, v24, v25
 v_lshlrev_b32 v24, 16, v219
 v_and_b32 v25, 0xffff0000, v219
 v_sub_f32 v24, v24, v19
 v_sub_f32 v25, v25, v19
 v_cvt_pk_bf16_f32 v25, v24, v25
 v_lshlrev_b32 v24, 16, v25
 v_and_b32 v25, 0xffff0000, v25
 v_mul_f32 v24, v24, v20
 v_mul_f32 v25, v25, v20
 v_cvt_pk_bf16_f32 v219, v24, v25
 ds_write_b128 v23, v[216:219] offset:32256
 v_lshlrev_b32 v24, 16, v220
 v_and_b32 v25, 0xffff0000, v220
 v_sub_f32 v24, v24, v19
 v_sub_f32 v25, v25, v19
 v_cvt_pk_bf16_f32 v25, v24, v25
 v_lshlrev_b32 v24, 16, v25
 v_and_b32 v25, 0xffff0000, v25
 v_mul_f32 v24, v24, v20
 v_mul_f32 v25, v25, v20
 v_cvt_pk_bf16_f32 v220, v24, v25
 v_lshlrev_b32 v24, 16, v221
 v_and_b32 v25, 0xffff0000, v221
 v_sub_f32 v24, v24, v19
 v_sub_f32 v25, v25, v19
 v_cvt_pk_bf16_f32 v25, v24, v25
 v_lshlrev_b32 v24, 16, v25
 v_and_b32 v25, 0xffff0000, v25
 v_mul_f32 v24, v24, v20
 v_mul_f32 v25, v25, v20
 v_cvt_pk_bf16_f32 v221, v24, v25
 v_lshlrev_b32 v24, 16, v222
 v_and_b32 v25, 0xffff0000, v222
 v_sub_f32 v24, v24, v19
 v_sub_f32 v25, v25, v19
 v_cvt_pk_bf16_f32 v25, v24, v25
 v_lshlrev_b32 v24, 16, v25
 v_and_b32 v25, 0xffff0000, v25
 v_mul_f32 v24, v24, v20
 v_mul_f32 v25, v25, v20
 v_cvt_pk_bf16_f32 v222, v24, v25
 v_lshlrev_b32 v24, 16, v223
 v_and_b32 v25, 0xffff0000, v223
 v_sub_f32 v24, v24, v19
 v_sub_f32 v25, v25, v19
 v_cvt_pk_bf16_f32 v25, v24, v25
 v_lshlrev_b32 v24, 16, v25
 v_and_b32 v25, 0xffff0000, v25
 v_mul_f32 v24, v24, v20
 v_mul_f32 v25, v25, v20
 v_cvt_pk_bf16_f32 v223, v24, v25
 ds_write_b128 v23, v[220:223] offset:34560
B_noln:
 s_mov_b64 exec, -1
 s_waitcnt lgkmcnt(0) vmcnt(0)
 s_barrier
 s_and_b32 s48, s41, 7
 s_mul_i32 s3, s48, 9216
 v_add_u32 v15, s3, v11
 s_waitcnt vmcnt(12)
 ds_read_b128 v[64:67], v15 offset:0
 ds_read_b128 v[68:71], v15 offset:512
 ds_read_b128 v[72:75], v15 offset:1024
 ds_read_b64_tr_b16 v[32:33], v5 offset:0
 ds_read_b64_tr_b16 v[34:35], v5 offset:2048
 ds_read_b64_tr_b16 v[36:37], v6 offset:0
 ds_read_b64_tr_b16 v[38:39], v6 offset:2048
 ds_read_b64_tr_b16 v[40:41], v7 offset:0
 ds_read_b64_tr_b16 v[42:43], v7 offset:2048
 ds_read_b64_tr_b16 v[44:45], v8 offset:0
 ds_read_b64_tr_b16 v[46:47], v8 offset:2048
 s_add_u32 s49, s48, 1
 s_and_b32 s49, s49, 7
 s_mul_i32 s64, s49, 65536
 s_lshl_b32 s3, s47, 8
 s_add_u32 s64, s64, s3
 s_mul_i32 s3, s49, 9216
 v_add_u32 v17, s3, v11
 s_waitcnt lgkmcnt(6)
 v_mfma_f32_32x32x16_bf16 a[0:15], v[32:35], v[64:67], 0
 s_waitcnt vmcnt(8)
 ds_read_b128 v[80:83], v15 offset:2304
 v_mfma_f32_32x32x16_bf16 a[16:31], v[32:35], v[68:71], 0
 ds_read_b128 v[84:87], v15 offset:2816
 ds_read_b128 v[88:91], v15 offset:3328
 v_mfma_f32_32x32x16_bf16 a[32:47], v[32:35], v[72:75], 0
 ds_read_b64_tr_b16 v[48:49], v5 offset:4096
 ds_read_b64_tr_b16 v[50:51], v5 offset:6144
 s_waitcnt lgkmcnt(9)
 v_mfma_f32_32x32x16_bf16 a[48:63], v[36:39], v[64:67], 0
 ds_read_b64_tr_b16 v[52:53], v6 offset:4096
 ds_read_b64_tr_b16 v[54:55], v6 offset:6144
 v_mfma_f32_32x32x16_bf16 a[64:79], v[36:39], v[68:71], 0
 ds_read_b64_tr_b16 v[56:57], v7 offset:4096
 ds_read_b64_tr_b16 v[58:59], v7 offset:6144
 v_mfma_f32_32x32x16_bf16 a[80:95], v[36:39], v[72:75], 0
 ds_read_b64_tr_b16 v[60:61], v8 offset:4096
 ds_read_b64_tr_b16 v[62:63], v8 offset:6144
 s_waitcnt lgkmcnt(13)
 v_mfma_f32_32x32x16_bf16 a[96:111], v[40:43], v[64:67], 0
 v_mfma_f32_32x32x16_bf16 a[112:127], v[40:43], v[68:71], 0
 v_mfma_f32_32x32x16_bf16 a[128:143], v[40:43], v[72:75], 0
 s_waitcnt lgkmcnt(11)
 s_add_u32 m0, s66, 0
 s_nop 0
 buffer_load_dwordx4 v3, s[52:55], s64 offen lds
 s_add_u32 s64, s64, 4096
 v_mfma_f32_32x32x16_bf16 a[144:159], v[44:47], v[64:67], 0
 s_add_u32 m0, s66, 1024
 s_nop 0
 buffer_load_dwordx4 v3, s[52:55], s64 offen lds
 s_add_u32 s64, s64, 4096
 v_mfma_f32_32x32x16_bf16 a[160:175], v[44:47], v[68:71], 0
 s_add_u32 m0, s66, 2048
 s_nop 0
 buffer_load_dwordx4 v3, s[52:55], s64 offen lds
 s_add_u32 s64, s64, 4096
 v_mfma_f32_32x32x16_bf16 a[176:191], v[44:47], v[72:75], 0
 s_add_u32 m0, s66, 3072
 s_nop 0
 buffer_load_dwordx4 v3, s[52:55], s64 offen lds
 s_add_u32 s64, s64, 4096
 s_waitcnt lgkmcnt(6)
 v_mfma_f32_32x32x16_bf16 a[0:15], v[48:51], v[80:83], a[0:15]
 s_waitcnt vmcnt(8)
 ds_read_b128 v[64:67], v15 offset:4608
 v_mfma_f32_32x32x16_bf16 a[16:31], v[48:51], v[84:87], a[16:31]
 ds_read_b128 v[68:71], v15 offset:5120
 ds_read_b128 v[72:75], v15 offset:5632
 v_mfma_f32_32x32x16_bf16 a[32:47], v[48:51], v[88:91], a[32:47]
 ds_read_b64_tr_b16 v[32:33], v5 offset:8192
 ds_read_b64_tr_b16 v[34:35], v5 offset:10240
 s_waitcnt lgkmcnt(9)
 v_mfma_f32_32x32x16_bf16 a[48:63], v[52:55], v[80:83], a[48:63]
 ds_read_b64_tr_b16 v[36:37], v6 offset:8192
 ds_read_b64_tr_b16 v[38:39], v6 offset:10240
 v_mfma_f32_32x32x16_bf16 a[64:79], v[52:55], v[84:87], a[64:79]
 ds_read_b64_tr_b16 v[40:41], v7 offset:8192
 ds_read_b64_tr_b16 v[42:43], v7 offset:10240
 v_mfma_f32_32x32x16_bf16 a[80:95], v[52:55], v[88:91], a[80:95]
 ds_read_b64_tr_b16 v[44:45], v8 offset:8192
 ds_read_b64_tr_b16 v[46:47], v8 offset:10240
 s_waitcnt lgkmcnt(13)
 v_mfma_f32_32x32x16_bf16 a[96:111], v[56:59], v[80:83], a[96:111]
 v_mfma_f32_32x32x16_bf16 a[112:127], v[56:59], v[84:87], a[112:127]
 v_mfma_f32_32x32x16_bf16 a[128:143], v[56:59], v[88:91], a[128:143]
 s_waitcnt lgkmcnt(11)
 s_add_u32 m0, s66, 4096
 s_nop 0
 buffer_load_dwordx4 v3, s[52:55], s64 offen lds
 s_add_u32 s64, s64, 4096
 v_mfma_f32_32x32x16_bf16 a[144:159], v[60:63], v[80:83], a[144:159]
 s_add_u32 m0, s66, 5120
 s_nop 0
 buffer_load_dwordx4 v3, s[52:55], s64 offen lds
 s_add_u32 s64, s64, 4096
 v_mfma_f32_32x32x16_bf16 a[160:175], v[60:63], v[84:87], a[160:175]
 s_add_u32 m0, s66, 6144
 s_nop 0
 buffer_load_dwordx4 v3, s[52:55], s64 offen lds
 s_add_u32 s64, s64, 4096
 v_mfma_f32_32x32x16_bf16 a[176:191], v[60:63], v[88:91], a[176:191]
 s_add_u32 m0, s66, 7168
 s_nop 0
 buffer_load_dwordx4 v3, s[52:55], s64 offen lds
 s_add_u32 s64, s64, 4096
 s_waitcnt lgkmcnt(6)
 v_mfma_f32_32x32x16_bf16 a[0:15], v[32:35], v[64:67], a[0:15]
 s_waitcnt vmcnt(8)
 ds_read_b128 v[80:83], v15 offset:6912
 v_mfma_f32_32x32x16_bf16 a[16:31], v[32:35], v[68:71], a[16:31]
 ds_read_b128 v[84:87], v15 offset:7424
 ds_read_b128 v[88:91], v15 offset:7936
 v_mfma_f32_32x32x16_bf16 a[32:47], v[32:35], v[72:75], a[32:47]
 ds_read_b64_tr_b16 v[48:49], v5 offset:12288
 ds_read_b64_tr_b16 v[50:51], v5 offset:14336
 s_waitcnt lgkmcnt(9)
 v_mfma_f32_32x32x16_bf16 a[48:63], v[36:39], v[64:67], a[48:63]
 ds_read_b64_tr_b16 v[52:53], v6 offset:12288
 ds_read_b64_tr_b16 v[54:55], v6 offset:14336
 v_mfma_f32_32x32x16_bf16 a[64:79], v[36:39], v[68:71], a[64:79]
 ds_read_b64_tr_b16 v[56:57], v7 offset:12288
 ds_read_b64_tr_b16 v[58:59], v7 offset:14336
 v_mfma_f32_32x32x16_bf16 a[80:95], v[36:39], v[72:75], a[80:95]
 ds_read_b64_tr_b16 v[60:61], v8 offset:12288
 ds_read_b64_tr_b16 v[62:63], v8 offset:14336
 s_waitcnt lgkmcnt(13)
 v_mfma_f32_32x32x16_bf16 a[96:111], v[40:43], v[64:67], a[96:111]
 v_mfma_f32_32x32x16_bf16 a[112:127], v[40:43], v[68:71], a[112:127]
 v_mfma_f32_32x32x16_bf16 a[128:143], v[40:43], v[72:75], a[128:143]
 s_waitcnt lgkmcnt(11)
 s_add_u32 m0, s66, 8192
 s_nop 0
 buffer_load_dwordx4 v3, s[52:55], s64 offen lds
 s_add_u32 s64, s64, 4096
 v_mfma_f32_32x32x16_bf16 a[144:159], v[44:47], v[64:67], a[144:159]
 s_add_u32 m0, s66, 9216
 s_nop 0
 buffer_load_dwordx4 v3, s[52:55], s64 offen lds
 s_add_u32 s64, s64, 4096
 v_mfma_f32_32x32x16_bf16 a[160:175], v[44:47], v[68:71], a[160:175]
 s_add_u32 m0, s66, 10240
 s_nop 0
 buffer_load_dwordx4 v3, s[52:55], s64 offen lds
 s_add_u32 s64, s64, 4096
 v_mfma_f32_32x32x16_bf16 a[176:191], v[44:47], v[72:75], a[176:191]
 s_add_u32 m0, s66, 11264
 s_nop 0
 buffer_load_dwordx4 v3, s[52:55], s64 offen lds
 s_add_u32 s64, s64, 4096
 s_waitcnt lgkmcnt(6)
 v_mfma_f32_32x32x16_bf16 a[0:15], v[48:51], v[80:83], a[0:15]
 s_waitcnt vmcnt(8)
 ds_read_b128 v[64:67], v17 offset:0
 v_mfma_f32_32x32x16_bf16 a[16:31], v[48:51], v[84:87], a[16:31]
 ds_read_b128 v[68:71], v17 offset:512
 ds_read_b128 v[72:75], v17 offset:1024
 v_mfma_f32_32x32x16_bf16 a[32:47], v[48:51], v[88:91], a[32:47]
 ds_read_b64_tr_b16 v[32:33], v5 offset:0
 ds_read_b64_tr_b16 v[34:35], v5 offset:2048
 s_waitcnt lgkmcnt(9)
 v_mfma_f32_32x32x16_bf16 a[48:63], v[52:55], v[80:83], a[48:63]
 ds_read_b64_tr_b16 v[36:37], v6 offset:0
 ds_read_b64_tr_b16 v[38:39], v6 offset:2048
 v_mfma_f32_32x32x16_bf16 a[64:79], v[52:55], v[84:87], a[64:79]
 ds_read_b64_tr_b16 v[40:41], v7 offset:0
 ds_read_b64_tr_b16 v[42:43], v7 offset:2048
 v_mfma_f32_32x32x16_bf16 a[80:95], v[52:55], v[88:91], a[80:95]
 ds_read_b64_tr_b16 v[44:45], v8 offset:0
 ds_read_b64_tr_b16 v[46:47], v8 offset:2048
 s_waitcnt lgkmcnt(13)
 v_mfma_f32_32x32x16_bf16 a[96:111], v[56:59], v[80:83], a[96:111]
 v_mfma_f32_32x32x16_bf16 a[112:127], v[56:59], v[84:87], a[112:127]
 v_mfma_f32_32x32x16_bf16 a[128:143], v[56:59], v[88:91], a[128:143]
 s_waitcnt lgkmcnt(11)
 s_add_u32 m0, s66, 12288
 s_nop 0
 buffer_load_dwordx4 v3, s[52:55], s64 offen lds
 s_add_u32 s64, s64, 4096
 v_mfma_f32_32x32x16_bf16 a[144:159], v[60:63], v[80:83], a[144:159]
 s_add_u32 m0, s66, 13312
 s_nop 0
 buffer_load_dwordx4 v3, s[52:55], s64 offen lds
 s_add_u32 s64, s64, 4096
 v_mfma_f32_32x32x16_bf16 a[160:175], v[60:63], v[84:87], a[160:175]
 s_add_u32 m0, s66, 14336
 s_nop 0
 buffer_load_dwordx4 v3, s[52:55], s64 offen lds
 s_add_u32 s64, s64, 4096
 v_mfma_f32_32x32x16_bf16 a[176:191], v[60:63], v[88:91], a[176:191]
 s_add_u32 m0, s66, 15360
 s_nop 0
 buffer_load_dwordx4 v3, s[52:55], s64 offen lds
 s_add_u32 s64, s64, 4096
 v_mov_b32 v15, v17
 s_mov_b32 s48, s49
 s_mov_b32 s35, 6
 .p2align 6
B_G1_L:
 s_add_u32 s49, s48, 1
 s_and_b32 s49, s49, 7
 s_mul_i32 s64, s49, 65536
 s_lshl_b32 s3, s47, 8
 s_add_u32 s64, s64, s3
 s_mul_i32 s3, s49, 9216
 v_add_u32 v17, s3, v11
 s_waitcnt lgkmcnt(6)
 v_mfma_f32_32x32x16_bf16 a[0:15], v[32:35], v[64:67], a[0:15]
 s_waitcnt vmcnt(8)
 ds_read_b128 v[80:83], v15 offset:2304
 v_mfma_f32_32x32x16_bf16 a[16:31], v[32:35], v[68:71], a[16:31]
 ds_read_b128 v[84:87], v15 offset:2816
 ds_read_b128 v[88:91], v15 offset:3328
 v_mfma_f32_32x32x16_bf16 a[32:47], v[32:35], v[72:75], a[32:47]
 ds_read_b64_tr_b16 v[48:49], v5 offset:4096
 ds_read_b64_tr_b16 v[50:51], v5 offset:6144
 s_waitcnt lgkmcnt(9)
 v_mfma_f32_32x32x16_bf16 a[48:63], v[36:39], v[64:67], a[48:63]
 ds_read_b64_tr_b16 v[52:53], v6 offset:4096
 ds_read_b64_tr_b16 v[54:55], v6 offset:6144
 v_mfma_f32_32x32x16_bf16 a[64:79], v[36:39], v[68:71], a[64:79]
 ds_read_b64_tr_b16 v[56:57], v7 offset:4096
 ds_read_b64_tr_b16 v[58:59], v7 offset:6144
 v_mfma_f32_32x32x16_bf16 a[80:95], v[36:39], v[72:75], a[80:95]
 ds_read_b64_tr_b16 v[60:61], v8 offset:4096
 ds_read_b64_tr_b16 v[62:63], v8 offset:6144
 s_waitcnt lgkmcnt(13)
 v_mfma_f32_32x32x16_bf16 a[96:111], v[40:43], v[64:67], a[96:111]
 v_mfma_f32_32x32x16_bf16 a[112:127], v[40:43], v[68:71], a[112:127]
 v_mfma_f32_32x32x16_bf16 a[128:143], v[40:43], v[72:75], a[128:143]
 s_waitcnt lgkmcnt(11)
 s_add_u32 m0, s66, 0
 s_nop 0
 buffer_load_dwordx4 v3, s[52:55], s64 offen lds
 s_add_u32 s64, s64, 4096
 v_mfma_f32_32x32x16_bf16 a[144:159], v[44:47], v[64:67], a[144:159]
 s_add_u32 m0, s66, 1024
 s_nop 0
 buffer_load_dwordx4 v3, s[52:55], s64 offen lds
 s_add_u32 s64, s64, 4096
 v_mfma_f32_32x32x16_bf16 a[160:175], v[44:47], v[68:71], a[160:175]
 s_add_u32 m0, s66, 2048
 s_nop 0
 buffer_load_dwordx4 v3, s[52:55], s64 offen lds
 s_add_u32 s64, s64, 4096
 v_mfma_f32_32x32x16_bf16 a[176:191], v[44:47], v[72:75], a[176:191]
 s_add_u32 m0, s66, 3072
 s_nop 0
 buffer_load_dwordx4 v3, s[52:55], s64 offen lds
 s_add_u32 s64, s64, 4096
 s_waitcnt lgkmcnt(6)
 v_mfma_f32_32x32x16_bf16 a[0:15], v[48:51], v[80:83], a[0:15]
 s_waitcnt vmcnt(8)
 ds_read_b128 v[64:67], v15 offset:4608
 v_mfma_f32_32x32x16_bf16 a[16:31], v[48:51], v[84:87], a[16:31]
 ds_read_b128 v[68:71], v15 offset:5120
 ds_read_b128 v[72:75], v15 offset:5632
 v_mfma_f32_32x32x16_bf16 a[32:47], v[48:51], v[88:91], a[32:47]
 ds_read_b64_tr_b16 v[32:33], v5 offset:8192
 ds_read_b64_tr_b16 v[34:35], v5 offset:10240
 s_waitcnt lgkmcnt(9)
 v_mfma_f32_32x32x16_bf16 a[48:63], v[52:55], v[80:83], a[48:63]
 ds_read_b64_tr_b16 v[36:37], v6 offset:8192
 ds_read_b64_tr_b16 v[38:39], v6 offset:10240
 v_mfma_f32_32x32x16_bf16 a[64:79], v[52:55], v[84:87], a[64:79]
 ds_read_b64_tr_b16 v[40:41], v7 offset:8192
 ds_read_b64_tr_b16 v[42:43], v7 offset:10240
 v_mfma_f32_32x32x16_bf16 a[80:95], v[52:55], v[88:91], a[80:95]
 ds_read_b64_tr_b16 v[44:45], v8 offset:8192
 ds_read_b64_tr_b16 v[46:47], v8 offset:10240
 s_waitcnt lgkmcnt(13)
 v_mfma_f32_32x32x16_bf16 a[96:111], v[56:59], v[80:83], a[96:111]
 v_mfma_f32_32x32x16_bf16 a[112:127], v[56:59], v[84:87], a[112:127]
 v_mfma_f32_32x32x16_bf16 a[128:143], v[56:59], v[88:91], a[128:143]
 s_waitcnt lgkmcnt(11)
 s_add_u32 m0, s66, 4096
 s_nop 0
 buffer_load_dwordx4 v3, s[52:55], s64 offen lds
 s_add_u32 s64, s64, 4096
 v_mfma_f32_32x32x16_bf16 a[144:159], v[60:63], v[80:83], a[144:159]
 s_add_u32 m0, s66, 5120
 s_nop 0
 buffer_load_dwordx4 v3, s[52:55], s64 offen lds
 s_add_u32 s64, s64, 4096
 v_mfma_f32_32x32x16_bf16 a[160:175], v[60:63], v[84:87], a[160:175]
 s_add_u32 m0, s66, 6144
 s_nop 0
 buffer_load_dwordx4 v3, s[52:55], s64 offen lds
 s_add_u32 s64, s64, 4096
 v_mfma_f32_32x32x16_bf16 a[176:191], v[60:63], v[88:91], a[176:191]
 s_add_u32 m0, s66, 7168
 s_nop 0
 buffer_load_dwordx4 v3, s[52:55], s64 offen lds
 s_add_u32 s64, s64, 4096
 s_waitcnt lgkmcnt(6)
 v_mfma_f32_32x32x16_bf16 a[0:15], v[32:35], v[64:67], a[0:15]
 s_waitcnt vmcnt(8)
 ds_read_b128 v[80:83], v15 offset:6912
 v_mfma_f32_32x32x16_bf16 a[16:31], v[32:35], v[68:71], a[16:31]
 ds_read_b128 v[84:87], v15 offset:7424
 ds_read_b128 v[88:91], v15 offset:7936
 v_mfma_f32_32x32x16_bf16 a[32:47], v[32:35], v[72:75], a[32:47]
 ds_read_b64_tr_b16 v[48:49], v5 offset:12288
 ds_read_b64_tr_b16 v[50:51], v5 offset:14336
 s_waitcnt lgkmcnt(9)
 v_mfma_f32_32x32x16_bf16 a[48:63], v[36:39], v[64:67], a[48:63]
 ds_read_b64_tr_b16 v[52:53], v6 offset:12288
 ds_read_b64_tr_b16 v[54:55], v6 offset:14336
 v_mfma_f32_32x32x16_bf16 a[64:79], v[36:39], v[68:71], a[64:79]
 ds_read_b64_tr_b16 v[56:57], v7 offset:12288
 ds_read_b64_tr_b16 v[58:59], v7 offset:14336
 v_mfma_f32_32x32x16_bf16 a[80:95], v[36:39], v[72:75], a[80:95]
 ds_read_b64_tr_b16 v[60:61], v8 offset:12288
 ds_read_b64_tr_b16 v[62:63], v8 offset:14336
 s_waitcnt lgkmcnt(13)
 v_mfma_f32_32x32x16_bf16 a[96:111], v[40:43], v[64:67], a[96:111]
 v_mfma_f32_32x32x16_bf16 a[112:127], v[40:43], v[68:71], a[112:127]
 v_mfma_f32_32x32x16_bf16 a[128:143], v[40:43], v[72:75], a[128:143]
 s_waitcnt lgkmcnt(11)
 s_add_u32 m0, s66, 8192
 s_nop 0
 buffer_load_dwordx4 v3, s[52:55], s64 offen lds
 s_add_u32 s64, s64, 4096
 v_mfma_f32_32x32x16_bf16 a[144:159], v[44:47], v[64:67], a[144:159]
 s_add_u32 m0, s66, 9216
 s_nop 0
 buffer_load_dwordx4 v3, s[52:55], s64 offen lds
 s_add_u32 s64, s64, 4096
 v_mfma_f32_32x32x16_bf16 a[160:175], v[44:47], v[68:71], a[160:175]
 s_add_u32 m0, s66, 10240
 s_nop 0
 buffer_load_dwordx4 v3, s[52:55], s64 offen lds
 s_add_u32 s64, s64, 4096
 v_mfma_f32_32x32x16_bf16 a[176:191], v[44:47], v[72:75], a[176:191]
 s_add_u32 m0, s66, 11264
 s_nop 0
 buffer_load_dwordx4 v3, s[52:55], s64 offen lds
 s_add_u32 s64, s64, 4096
 s_waitcnt lgkmcnt(6)
 v_mfma_f32_32x32x16_bf16 a[0:15], v[48:51], v[80:83], a[0:15]
 s_waitcnt vmcnt(8)
 ds_read_b128 v[64:67], v17 offset:0
 v_mfma_f32_32x32x16_bf16 a[16:31], v[48:51], v[84:87], a[16:31]
 ds_read_b128 v[68:71], v17 offset:512
 ds_read_b128 v[72:75], v17 offset:1024
 v_mfma_f32_32x32x16_bf16 a[32:47], v[48:51], v[88:91], a[32:47]
 ds_read_b64_tr_b16 v[32:33], v5 offset:0
 ds_read_b64_tr_b16 v[34:35], v5 offset:2048
 s_waitcnt lgkmcnt(9)
 v_mfma_f32_32x32x16_bf16 a[48:63], v[52:55], v[80:83], a[48:63]
 ds_read_b64_tr_b16 v[36:37], v6 offset:0
 ds_read_b64_tr_b16 v[38:39], v6 offset:2048
 v_mfma_f32_32x32x16_bf16 a[64:79], v[52:55], v[84:87], a[64:79]
 ds_read_b64_tr_b16 v[40:41], v7 offset:0
 ds_read_b64_tr_b16 v[42:43], v7 offset:2048
 v_mfma_f32_32x32x16_bf16 a[80:95], v[52:55], v[88:91], a[80:95]
 ds_read_b64_tr_b16 v[44:45], v8 offset:0
 ds_read_b64_tr_b16 v[46:47], v8 offset:2048
 s_waitcnt lgkmcnt(13)
 v_mfma_f32_32x32x16_bf16 a[96:111], v[56:59], v[80:83], a[96:111]
 v_mfma_f32_32x32x16_bf16 a[112:127], v[56:59], v[84:87], a[112:127]
 v_mfma_f32_32x32x16_bf16 a[128:143], v[56:59], v[88:91], a[128:143]
 s_waitcnt lgkmcnt(11)
 s_add_u32 m0, s66, 12288
 s_nop 0
 buffer_load_dwordx4 v3, s[52:55], s64 offen lds
 s_add_u32 s64, s64, 4096
 v_mfma_f32_32x32x16_bf16 a[144:159], v[60:63], v[80:83], a[144:159]
 s_add_u32 m0, s66, 13312
 s_nop 0
 buffer_load_dwordx4 v3, s[52:55], s64 offen lds
 s_add_u32 s64, s64, 4096
 v_mfma_f32_32x32x16_bf16 a[160:175], v[60:63], v[84:87], a[160:175]
 s_add_u32 m0, s66, 14336
 s_nop 0
 buffer_load_dwordx4 v3, s[52:55], s64 offen lds
 s_add_u32 s64, s64, 4096
 v_mfma_f32_32x32x16_bf16 a[176:191], v[60:63], v[88:91], a[176:191]
 s_add_u32 m0, s66, 15360
 s_nop 0
 buffer_load_dwordx4 v3, s[52:55], s64 offen lds
 s_add_u32 s64, s64, 4096
 v_mov_b32 v15, v17
 s_mov_b32 s48, s49
 s_sub_u32 s35, s35, 1
 s_cmp_lg_u32 s35, 0
 s_cbranch_scc1 B_G1_L
 s_and_b32 s49, s41, 7
 s_mul_i32 s64, s49, 65536
 s_lshl_b32 s3, s47, 8
 s_add_u32 s64, s64, s3
 s_waitcnt lgkmcnt(6)
 v_mfma_f32_32x32x16_bf16 a[0:15], v[32:35], v[64:67], a[0:15]
 s_waitcnt vmcnt(8)
 ds_read_b128 v[80:83], v15 offset:2304
 v_mfma_f32_32x32x16_bf16 a[16:31], v[32:35], v[68:71], a[16:31]
 ds_read_b128 v[84:87], v15 offset:2816
 ds_read_b128 v[88:91], v15 offset:3328
 v_mfma_f32_32x32x16_bf16 a[32:47], v[32:35], v[72:75], a[32:47]
 ds_read_b64_tr_b16 v[48:49], v5 offset:4096
 ds_read_b64_tr_b16 v[50:51], v5 offset:6144
 s_waitcnt lgkmcnt(9)
 v_mfma_f32_32x32x16_bf16 a[48:63], v[36:39], v[64:67], a[48:63]
 ds_read_b64_tr_b16 v[52:53], v6 offset:4096
 ds_read_b64_tr_b16 v[54:55], v6 offset:6144
 v_mfma_f32_32x32x16_bf16 a[64:79], v[36:39], v[68:71], a[64:79]
 ds_read_b64_tr_b16 v[56:57], v7 offset:4096
 ds_read_b64_tr_b16 v[58:59], v7 offset:6144
 v_mfma_f32_32x32x16_bf16 a[80:95], v[36:39], v[72:75], a[80:95]
 ds_read_b64_tr_b16 v[60:61], v8 offset:4096
 ds_read_b64_tr_b16 v[62:63], v8 offset:6144
 s_waitcnt lgkmcnt(13)
 v_mfma_f32_32x32x16_bf16 a[96:111], v[40:43], v[64:67], a[96:111]
 v_mfma_f32_32x32x16_bf16 a[112:127], v[40:43], v[68:71], a[112:127]
 v_mfma_f32_32x32x16_bf16 a[128:143], v[40:43], v[72:75], a[128:143]
 s_waitcnt lgkmcnt(11)
 s_add_u32 m0, s66, 0
 s_nop 0
 buffer_load_dwordx4 v3, s[56:59], s64 offen lds
 s_add_u32 s64, s64, 4096
 v_mfma_f32_32x32x16_bf16 a[144:159], v[44:47], v[64:67], a[144:159]
 s_add_u32 m0, s66, 1024
 s_nop 0
 buffer_load_dwordx4 v3, s[56:59], s64 offen lds
 s_add_u32 s64, s64, 4096
 v_mfma_f32_32x32x16_bf16 a[160:175], v[44:47], v[68:71], a[160:175]
 s_add_u32 m0, s66, 2048
 s_nop 0
 buffer_load_dwordx4 v3, s[56:59], s64 offen lds
 s_add_u32 s64, s64, 4096
 v_mfma_f32_32x32x16_bf16 a[176:191], v[44:47], v[72:75], a[176:191]
 s_add_u32 m0, s66, 3072
 s_nop 0
 buffer_load_dwordx4 v3, s[56:59], s64 offen lds
 s_add_u32 s64, s64, 4096
 s_waitcnt lgkmcnt(6)
 v_mfma_f32_32x32x16_bf16 a[0:15], v[48:51], v[80:83], a[0:15]
 s_waitcnt vmcnt(8)
 ds_read_b128 v[64:67], v15 offset:4608
 v_mfma_f32_32x32x16_bf16 a[16:31], v[48:51], v[84:87], a[16:31]
 ds_read_b128 v[68:71], v15 offset:5120
 ds_read_b128 v[72:75], v15 offset:5632
 v_mfma_f32_32x32x16_bf16 a[32:47], v[48:51], v[88:91], a[32:47]
 ds_read_b64_tr_b16 v[32:33], v5 offset:8192
 ds_read_b64_tr_b16 v[34:35], v5 offset:10240
 s_waitcnt lgkmcnt(9)
 v_mfma_f32_32x32x16_bf16 a[48:63], v[52:55], v[80:83], a[48:63]
 ds_read_b64_tr_b16 v[36:37], v6 offset:8192
 ds_read_b64_tr_b16 v[38:39], v6 offset:10240
 v_mfma_f32_32x32x16_bf16 a[64:79], v[52:55], v[84:87], a[64:79]
 ds_read_b64_tr_b16 v[40:41], v7 offset:8192
 ds_read_b64_tr_b16 v[42:43], v7 offset:10240
 v_mfma_f32_32x32x16_bf16 a[80:95], v[52:55], v[88:91], a[80:95]
 ds_read_b64_tr_b16 v[44:45], v8 offset:8192
 ds_read_b64_tr_b16 v[46:47], v8 offset:10240
 s_waitcnt lgkmcnt(13)
 v_mfma_f32_32x32x16_bf16 a[96:111], v[56:59], v[80:83], a[96:111]
 v_mfma_f32_32x32x16_bf16 a[112:127], v[56:59], v[84:87], a[112:127]
 v_mfma_f32_32x32x16_bf16 a[128:143], v[56:59], v[88:91], a[128:143]
 s_waitcnt lgkmcnt(11)
 s_add_u32 m0, s66, 4096
 s_nop 0
 buffer_load_dwordx4 v3, s[56:59], s64 offen lds
 s_add_u32 s64, s64, 4096
 v_mfma_f32_32x32x16_bf16 a[144:159], v[60:63], v[80:83], a[144:159]
 s_add_u32 m0, s66, 5120
 s_nop 0
 buffer_load_dwordx4 v3, s[56:59], s64 offen lds
 s_add_u32 s64, s64, 4096
 v_mfma_f32_32x32x16_bf16 a[160:175], v[60:63], v[84:87], a[160:175]
 s_add_u32 m0, s66, 6144
 s_nop 0
 buffer_load_dwordx4 v3, s[56:59], s64 offen lds
 s_add_u32 s64, s64, 4096
 v_mfma_f32_32x32x16_bf16 a[176:191], v[60:63], v[88:91], a[176:191]
 s_add_u32 m0, s66, 7168
 s_nop 0
 buffer_load_dwordx4 v3, s[56:59], s64 offen lds
 s_add_u32 s64, s64, 4096
 s_waitcnt lgkmcnt(6)
 v_mfma_f32_32x32x16_bf16 a[0:15], v[32:35], v[64:67], a[0:15]
 s_waitcnt vmcnt(8)
 ds_read_b128 v[80:83], v15 offset:6912
 v_mfma_f32_32x32x16_bf16 a[16:31], v[32:35], v[68:71], a[16:31]
 ds_read_b128 v[84:87], v15 offset:7424
 ds_read_b128 v[88:91], v15 offset:7936
 v_mfma_f32_32x32x16_bf16 a[32:47], v[32:35], v[72:75], a[32:47]
 ds_read_b64_tr_b16 v[48:49], v5 offset:12288
 ds_read_b64_tr_b16 v[50:51], v5 offset:14336
 s_waitcnt lgkmcnt(9)
 v_mfma_f32_32x32x16_bf16 a[48:63], v[36:39], v[64:67], a[48:63]
 ds_read_b64_tr_b16 v[52:53], v6 offset:12288
 ds_read_b64_tr_b16 v[54:55], v6 offset:14336
 v_mfma_f32_32x32x16_bf16 a[64:79], v[36:39], v[68:71], a[64:79]
 ds_read_b64_tr_b16 v[56:57], v7 offset:12288
 ds_read_b64_tr_b16 v[58:59], v7 offset:14336
 v_mfma_f32_32x32x16_bf16 a[80:95], v[36:39], v[72:75], a[80:95]
 ds_read_b64_tr_b16 v[60:61], v8 offset:12288
 ds_read_b64_tr_b16 v[62:63], v8 offset:14336
 s_waitcnt lgkmcnt(13)
 v_mfma_f32_32x32x16_bf16 a[96:111], v[40:43], v[64:67], a[96:111]
 v_mfma_f32_32x32x16_bf16 a[112:127], v[40:43], v[68:71], a[112:127]
 v_mfma_f32_32x32x16_bf16 a[128:143], v[40:43], v[72:75], a[128:143]
 s_waitcnt lgkmcnt(11)
 s_add_u32 m0, s66, 8192
 s_nop 0
 buffer_load_dwordx4 v3, s[56:59], s64 offen lds
 s_add_u32 s64, s64, 4096
 v_mfma_f32_32x32x16_bf16 a[144:159], v[44:47], v[64:67], a[144:159]
 s_add_u32 m0, s66, 9216
 s_nop 0
 buffer_load_dwordx4 v3, s[56:59], s64 offen lds
 s_add_u32 s64, s64, 4096
 v_mfma_f32_32x32x16_bf16 a[160:175], v[44:47], v[68:71], a[160:175]
 s_add_u32 m0, s66, 10240
 s_nop 0
 buffer_load_dwordx4 v3, s[56:59], s64 offen lds
 s_add_u32 s64, s64, 4096
 v_mfma_f32_32x32x16_bf16 a[176:191], v[44:47], v[72:75], a[176:191]
 s_add_u32 m0, s66, 11264
 s_nop 0
 buffer_load_dwordx4 v3, s[56:59], s64 offen lds
 s_add_u32 s64, s64, 4096
 s_waitcnt lgkmcnt(6)
 v_mfma_f32_32x32x16_bf16 a[0:15], v[48:51], v[80:83], a[0:15]
 v_mfma_f32_32x32x16_bf16 a[16:31], v[48:51], v[84:87], a[16:31]
 v_mfma_f32_32x32x16_bf16 a[32:47], v[48:51], v[88:91], a[32:47]
 s_waitcnt lgkmcnt(4)
 v_mfma_f32_32x32x16_bf16 a[48:63], v[52:55], v[80:83], a[48:63]
 v_mfma_f32_32x32x16_bf16 a[64:79], v[52:55], v[84:87], a[64:79]
 v_mfma_f32_32x32x16_bf16 a[80:95], v[52:55], v[88:91], a[80:95]
 s_waitcnt lgkmcnt(2)
 v_mfma_f32_32x32x16_bf16 a[96:111], v[56:59], v[80:83], a[96:111]
 v_mfma_f32_32x32x16_bf16 a[112:127], v[56:59], v[84:87], a[112:127]
 v_mfma_f32_32x32x16_bf16 a[128:143], v[56:59], v[88:91], a[128:143]
 s_waitcnt lgkmcnt(0)
 s_add_u32 m0, s66, 12288
 s_nop 0
 buffer_load_dwordx4 v3, s[56:59], s64 offen lds
 s_add_u32 s64, s64, 4096
 v_mfma_f32_32x32x16_bf16 a[144:159], v[60:63], v[80:83], a[144:159]
 s_add_u32 m0, s66, 13312
 s_nop 0
 buffer_load_dwordx4 v3, s[56:59], s64 offen lds
 s_add_u32 s64, s64, 4096
 v_mfma_f32_32x32x16_bf16 a[160:175], v[60:63], v[84:87], a[160:175]
 s_add_u32 m0, s66, 14336
 s_nop 0
 buffer_load_dwordx4 v3, s[56:59], s64 offen lds
 s_add_u32 s64, s64, 4096
 v_mfma_f32_32x32x16_bf16 a[176:191], v[60:63], v[88:91], a[176:191]
 s_add_u32 m0, s66, 15360
 s_nop 0
 buffer_load_dwordx4 v3, s[56:59], s64 offen lds
 s_add_u32 s64, s64, 4096
 s_barrier
 v_and_b32 v22, 31, v1
 s_lshl_b32 s3, s41, 6
 s_sub_u32 s3, s3, 2
 v_add_u32 v22, s3, v22
 s_movk_i32 s3, 0x800
 v_cmp_gt_u32 s[74:75], s3, v22
 v_add_u32 v22, 64, v22
 v_cmp_gt_u32 s[76:77], s3, v22
 s_mul_i32 s3, s47, 18432
 v_add_u32 v23, s3, v11
 v_accvgpr_read_b32 v160, a0
 v_accvgpr_read_b32 v161, a1
 v_accvgpr_read_b32 v162, a2
 v_accvgpr_read_b32 v163, a3
 v_accvgpr_read_b32 v164, a4
 v_accvgpr_read_b32 v165, a5
 v_accvgpr_read_b32 v166, a6
 v_accvgpr_read_b32 v167, a7
 v_accvgpr_read_b32 v168, a8
 v_accvgpr_read_b32 v169, a9
 v_accvgpr_read_b32 v170, a10
 v_accvgpr_read_b32 v171, a11
 v_accvgpr_read_b32 v172, a12
 v_accvgpr_read_b32 v173, a13
 v_accvgpr_read_b32 v174, a14
 v_accvgpr_read_b32 v175, a15
 v_cvt_pk_bf16_f32 v161, v160, v161
 v_lshlrev_b32 v160, 16, v161
 v_and_b32 v161, 0xffff0000, v161
 v_cvt_pk_bf16_f32 v163, v162, v163
 v_lshlrev_b32 v162, 16, v163
 v_and_b32 v163, 0xffff0000, v163
 v_cvt_pk_bf16_f32 v165, v164, v165
 v_lshlrev_b32 v164, 16, v165
 v_and_b32 v165, 0xffff0000, v165
 v_cvt_pk_bf16_f32 v167, v166, v167
 v_lshlrev_b32 v166, 16, v167
 v_and_b32 v167, 0xffff0000, v167
 v_cvt_pk_bf16_f32 v169, v168, v169
 v_lshlrev_b32 v168, 16, v169
 v_and_b32 v169, 0xffff0000, v169
 v_cvt_pk_bf16_f32 v171, v170, v171
 v_lshlrev_b32 v170, 16, v171
 v_and_b32 v171, 0xffff0000, v171
 v_cvt_pk_bf16_f32 v173, v172, v173
 v_lshlrev_b32 v172, 16, v173
 v_and_b32 v173, 0xffff0000, v173
 v_cvt_pk_bf16_f32 v175, v174, v175
 v_lshlrev_b32 v174, 16, v175
 v_and_b32 v175, 0xffff0000, v175
 v_mul_f32 v224, v160, v160
 v_mul_f32 v225, v161, v161
 v_mul_f32 v226, v162, v162
 v_mul_f32 v227, v163, v163
 v_mul_f32 v228, v164, v164
 v_mul_f32 v229, v165, v165
 v_mul_f32 v230, v166, v166
 v_mul_f32 v231, v167, v167
 v_mul_f32 v232, v168, v168
 v_mul_f32 v233, v169, v169
 v_mul_f32 v234, v170, v170
 v_mul_f32 v235, v171, v171
 v_mul_f32 v236, v172, v172
 v_mul_f32 v237, v173, v173
 v_mul_f32 v238, v174, v174
 v_mul_f32 v239, v175, v175
 v_fma_f32 v224, v224, s45, v16
 v_fma_f32 v225, v225, s45, v16
 v_fma_f32 v226, v226, s45, v16
 v_fma_f32 v227, v227, s45, v16
 v_fma_f32 v228, v228, s45, v16
 v_fma_f32 v229, v229, s45, v16
 v_fma_f32 v230, v230, s45, v16
 v_fma_f32 v231, v231, s45, v16
 v_fma_f32 v232, v232, s45, v16
 v_fma_f32 v233, v233, s45, v16
 v_fma_f32 v234, v234, s45, v16
 v_fma_f32 v235, v235, s45, v16
 v_fma_f32 v236, v236, s45, v16
 v_fma_f32 v237, v237, s45, v16
 v_fma_f32 v238, v238, s45, v16
 v_fma_f32 v239, v239, s45, v16
 v_mul_f32 v224, v224, v160
 v_mul_f32 v225, v225, v161
 v_mul_f32 v226, v226, v162
 v_mul_f32 v227, v227, v163
 v_mul_f32 v228, v228, v164
 v_mul_f32 v229, v229, v165
 v_mul_f32 v230, v230, v166
 v_mul_f32 v231, v231, v167
 v_mul_f32 v232, v232, v168
 v_mul_f32 v233, v233, v169
 v_mul_f32 v234, v234, v170
 v_mul_f32 v235, v235, v171
 v_mul_f32 v236, v236, v172
 v_mul_f32 v237, v237, v173
 v_mul_f32 v238, v238, v174
 v_mul_f32 v239, v239, v175
 v_exp_f32 v224, v224
 v_exp_f32 v225, v225
 v_exp_f32 v226, v226
 v_exp_f32 v227, v227
 v_exp_f32 v228, v228
 v_exp_f32 v229, v229
 v_exp_f32 v230, v230
 v_exp_f32 v231, v231
 v_exp_f32 v232, v232
 v_exp_f32 v233, v233
 v_exp_f32 v234, v234
 v_exp_f32 v235, v235
 v_exp_f32 v236, v236
 v_exp_f32 v237, v237
 v_exp_f32 v238, v238
 v_exp_f32 v239, v239
 v_add_f32 v224, 1.0, v224
 v_add_f32 v225, 1.0, v225
 v_add_f32 v226, 1.0, v226
 v_add_f32 v227, 1.0, v227
 v_add_f32 v228, 1.0, v228
 v_add_f32 v229, 1.0, v229
 v_add_f32 v230, 1.0, v230
 v_add_f32 v231, 1.0, v231
 v_add_f32 v232, 1.0, v232
 v_add_f32 v233, 1.0, v233
 v_add_f32 v234, 1.0, v234
 v_add_f32 v235, 1.0, v235
 v_add_f32 v236, 1.0, v236
 v_add_f32 v237, 1.0, v237
 v_add_f32 v238, 1.0, v238
 v_add_f32 v239, 1.0, v239
 v_rcp_f32 v224, v224
 v_rcp_f32 v225, v225
 v_rcp_f32 v226, v226
 v_rcp_f32 v227, v227
 v_rcp_f32 v228, v228
 v_rcp_f32 v229, v229
 v_rcp_f32 v230, v230
 v_rcp_f32 v231, v231
 v_rcp_f32 v232, v232
 v_rcp_f32 v233, v233
 v_rcp_f32 v234, v234
 v_rcp_f32 v235, v235
 v_rcp_f32 v236, v236
 v_rcp_f32 v237, v237
 v_rcp_f32 v238, v238
 v_rcp_f32 v239, v239
 v_mul_f32 v160, v160, v224
 v_mul_f32 v161, v161, v225
 v_mul_f32 v162, v162, v226
 v_mul_f32 v163, v163, v227
 v_mul_f32 v164, v164, v228
 v_mul_f32 v165, v165, v229
 v_mul_f32 v166, v166, v230
 v_mul_f32 v167, v167, v231
 v_mul_f32 v168, v168, v232
 v_mul_f32 v169, v169, v233
 v_mul_f32 v170, v170, v234
 v_mul_f32 v171, v171, v235
 v_mul_f32 v172, v172, v236
 v_mul_f32 v173, v173, v237
 v_mul_f32 v174, v174, v238
 v_mul_f32 v175, v175, v239
 v_cvt_pk_bf16_f32 v176, v160, v161
 v_cndmask_b32 v176, 0, v176, s[74:75]
 v_cvt_pk_bf16_f32 v177, v162, v163
 v_cndmask_b32 v177, 0, v177, s[74:75]
 v_cvt_pk_bf16_f32 v178, v164, v165
 v_cndmask_b32 v178, 0, v178, s[74:75]
 v_cvt_pk_bf16_f32 v179, v166, v167
 v_cndmask_b32 v179, 0, v179, s[74:75]
 v_cvt_pk_bf16_f32 v180, v168, v169
 v_cndmask_b32 v180, 0, v180, s[74:75]
 v_cvt_pk_bf16_f32 v181, v170, v171
 v_cndmask_b32 v181, 0, v181, s[74:75]
 v_cvt_pk_bf16_f32 v182, v172, v173
 v_cndmask_b32 v182, 0, v182, s[74:75]
 v_cvt_pk_bf16_f32 v183, v174, v175
 v_cndmask_b32 v183, 0, v183, s[74:75]
 ds_write_b128 v23, v[176:179] offset:0
 ds_write_b128 v23, v[180:183] offset:2304
 v_accvgpr_read_b32 v160, a16
 v_accvgpr_read_b32 v161, a17
 v_accvgpr_read_b32 v162, a18
 v_accvgpr_read_b32 v163, a19
 v_accvgpr_read_b32 v164, a20
 v_accvgpr_read_b32 v165, a21
 v_accvgpr_read_b32 v166, a22
 v_accvgpr_read_b32 v167, a23
 v_accvgpr_read_b32 v168, a24
 v_accvgpr_read_b32 v169, a25
 v_accvgpr_read_b32 v170, a26
 v_accvgpr_read_b32 v171, a27
 v_accvgpr_read_b32 v172, a28
 v_accvgpr_read_b32 v173, a29
 v_accvgpr_read_b32 v174, a30
 v_accvgpr_read_b32 v175, a31
 v_cvt_pk_bf16_f32 v161, v160, v161
 v_lshlrev_b32 v160, 16, v161
 v_and_b32 v161, 0xffff0000, v161
 v_cvt_pk_bf16_f32 v163, v162, v163
 v_lshlrev_b32 v162, 16, v163
 v_and_b32 v163, 0xffff0000, v163
 v_cvt_pk_bf16_f32 v165, v164, v165
 v_lshlrev_b32 v164, 16, v165
 v_and_b32 v165, 0xffff0000, v165
 v_cvt_pk_bf16_f32 v167, v166, v167
 v_lshlrev_b32 v166, 16, v167
 v_and_b32 v167, 0xffff0000, v167
 v_cvt_pk_bf16_f32 v169, v168, v169
 v_lshlrev_b32 v168, 16, v169
 v_and_b32 v169, 0xffff0000, v169
 v_cvt_pk_bf16_f32 v171, v170, v171
 v_lshlrev_b32 v170, 16, v171
 v_and_b32 v171, 0xffff0000, v171
 v_cvt_pk_bf16_f32 v173, v172, v173
 v_lshlrev_b32 v172, 16, v173
 v_and_b32 v173, 0xffff0000, v173
 v_cvt_pk_bf16_f32 v175, v174, v175
 v_lshlrev_b32 v174, 16, v175
 v_and_b32 v175, 0xffff0000, v175
 v_mul_f32 v224, v160, v160
 v_mul_f32 v225, v161, v161
 v_mul_f32 v226, v162, v162
 v_mul_f32 v227, v163, v163
 v_mul_f32 v228, v164, v164
 v_mul_f32 v229, v165, v165
 v_mul_f32 v230, v166, v166
 v_mul_f32 v231, v167, v167
 v_mul_f32 v232, v168, v168
 v_mul_f32 v233, v169, v169
 v_mul_f32 v234, v170, v170
 v_mul_f32 v235, v171, v171
 v_mul_f32 v236, v172, v172
 v_mul_f32 v237, v173, v173
 v_mul_f32 v238, v174, v174
 v_mul_f32 v239, v175, v175
 v_fma_f32 v224, v224, s45, v16
 v_fma_f32 v225, v225, s45, v16
 v_fma_f32 v226, v226, s45, v16
 v_fma_f32 v227, v227, s45, v16
 v_fma_f32 v228, v228, s45, v16
 v_fma_f32 v229, v229, s45, v16
 v_fma_f32 v230, v230, s45, v16
 v_fma_f32 v231, v231, s45, v16
 v_fma_f32 v232, v232, s45, v16
 v_fma_f32 v233, v233, s45, v16
 v_fma_f32 v234, v234, s45, v16
 v_fma_f32 v235, v235, s45, v16
 v_fma_f32 v236, v236, s45, v16
 v_fma_f32 v237, v237, s45, v16
 v_fma_f32 v238, v238, s45, v16
 v_fma_f32 v239, v239, s45, v16
 v_mul_f32 v224, v224, v160
 v_mul_f32 v225, v225, v161
 v_mul_f32 v226, v226, v162
 v_mul_f32 v227, v227, v163
 v_mul_f32 v228, v228, v164
 v_mul_f32 v229, v229, v165
 v_mul_f32 v230, v230, v166
 v_mul_f32 v231, v231, v167
 v_mul_f32 v232, v232, v168
 v_mul_f32 v233, v233, v169
 v_mul_f32 v234, v234, v170
 v_mul_f32 v235, v235, v171
 v_mul_f32 v236, v236, v172
 v_mul_f32 v237, v237, v173
 v_mul_f32 v238, v238, v174
 v_mul_f32 v239, v239, v175
 v_exp_f32 v224, v224
 v_exp_f32 v225, v225
 v_exp_f32 v226, v226
 v_exp_f32 v227, v227
 v_exp_f32 v228, v228
 v_exp_f32 v229, v229
 v_exp_f32 v230, v230
 v_exp_f32 v231, v231
 v_exp_f32 v232, v232
 v_exp_f32 v233, v233
 v_exp_f32 v234, v234
 v_exp_f32 v235, v235
 v_exp_f32 v236, v236
 v_exp_f32 v237, v237
 v_exp_f32 v238, v238
 v_exp_f32 v239, v239
 v_add_f32 v224, 1.0, v224
 v_add_f32 v225, 1.0, v225
 v_add_f32 v226, 1.0, v226
 v_add_f32 v227, 1.0, v227
 v_add_f32 v228, 1.0, v228
 v_add_f32 v229, 1.0, v229
 v_add_f32 v230, 1.0, v230
 v_add_f32 v231, 1.0, v231
 v_add_f32 v232, 1.0, v232
 v_add_f32 v233, 1.0, v233
 v_add_f32 v234, 1.0, v234
 v_add_f32 v235, 1.0, v235
 v_add_f32 v236, 1.0, v236
 v_add_f32 v237, 1.0, v237
 v_add_f32 v238, 1.0, v238
 v_add_f32 v239, 1.0, v239
 v_rcp_f32 v224, v224
 v_rcp_f32 v225, v225
 v_rcp_f32 v226, v226
 v_rcp_f32 v227, v227
 v_rcp_f32 v228, v228
 v_rcp_f32 v229, v229
 v_rcp_f32 v230, v230
 v_rcp_f32 v231, v231
 v_rcp_f32 v232, v232
 v_rcp_f32 v233, v233
 v_rcp_f32 v234, v234
 v_rcp_f32 v235, v235
 v_rcp_f32 v236, v236
 v_rcp_f32 v237, v237
 v_rcp_f32 v238, v238
 v_rcp_f32 v239, v239
 v_mul_f32 v160, v160, v224
 v_mul_f32 v161, v161, v225
 v_mul_f32 v162, v162, v226
 v_mul_f32 v163, v163, v227
 v_mul_f32 v164, v164, v228
 v_mul_f32 v165, v165, v229
 v_mul_f32 v166, v166, v230
 v_mul_f32 v167, v167, v231
 v_mul_f32 v168, v168, v232
 v_mul_f32 v169, v169, v233
 v_mul_f32 v170, v170, v234
 v_mul_f32 v171, v171, v235
 v_mul_f32 v172, v172, v236
 v_mul_f32 v173, v173, v237
 v_mul_f32 v174, v174, v238
 v_mul_f32 v175, v175, v239
 v_cvt_pk_bf16_f32 v176, v160, v161
 v_cvt_pk_bf16_f32 v177, v162, v163
 v_cvt_pk_bf16_f32 v178, v164, v165
 v_cvt_pk_bf16_f32 v179, v166, v167
 v_cvt_pk_bf16_f32 v180, v168, v169
 v_cvt_pk_bf16_f32 v181, v170, v171
 v_cvt_pk_bf16_f32 v182, v172, v173
 v_cvt_pk_bf16_f32 v183, v174, v175
 ds_write_b128 v23, v[176:179] offset:512
 ds_write_b128 v23, v[180:183] offset:2816
 v_accvgpr_read_b32 v160, a32
 v_accvgpr_read_b32 v161, a33
 v_accvgpr_read_b32 v162, a34
 v_accvgpr_read_b32 v163, a35
 v_accvgpr_read_b32 v164, a36
 v_accvgpr_read_b32 v165, a37
 v_accvgpr_read_b32 v166, a38
 v_accvgpr_read_b32 v167, a39
 v_accvgpr_read_b32 v168, a40
 v_accvgpr_read_b32 v169, a41
 v_accvgpr_read_b32 v170, a42
 v_accvgpr_read_b32 v171, a43
 v_accvgpr_read_b32 v172, a44
 v_accvgpr_read_b32 v173, a45
 v_accvgpr_read_b32 v174, a46
 v_accvgpr_read_b32 v175, a47
 v_cvt_pk_bf16_f32 v161, v160, v161
 v_lshlrev_b32 v160, 16, v161
 v_and_b32 v161, 0xffff0000, v161
 v_cvt_pk_bf16_f32 v163, v162, v163
 v_lshlrev_b32 v162, 16, v163
 v_and_b32 v163, 0xffff0000, v163
 v_cvt_pk_bf16_f32 v165, v164, v165
 v_lshlrev_b32 v164, 16, v165
 v_and_b32 v165, 0xffff0000, v165
 v_cvt_pk_bf16_f32 v167, v166, v167
 v_lshlrev_b32 v166, 16, v167
 v_and_b32 v167, 0xffff0000, v167
 v_cvt_pk_bf16_f32 v169, v168, v169
 v_lshlrev_b32 v168, 16, v169
 v_and_b32 v169, 0xffff0000, v169
 v_cvt_pk_bf16_f32 v171, v170, v171
 v_lshlrev_b32 v170, 16, v171
 v_and_b32 v171, 0xffff0000, v171
 v_cvt_pk_bf16_f32 v173, v172, v173
 v_lshlrev_b32 v172, 16, v173
 v_and_b32 v173, 0xffff0000, v173
 v_cvt_pk_bf16_f32 v175, v174, v175
 v_lshlrev_b32 v174, 16, v175
 v_and_b32 v175, 0xffff0000, v175
 v_mul_f32 v224, v160, v160
 v_mul_f32 v225, v161, v161
 v_mul_f32 v226, v162, v162
 v_mul_f32 v227, v163, v163
 v_mul_f32 v228, v164, v164
 v_mul_f32 v229, v165, v165
 v_mul_f32 v230, v166, v166
 v_mul_f32 v231, v167, v167
 v_mul_f32 v232, v168, v168
 v_mul_f32 v233, v169, v169
 v_mul_f32 v234, v170, v170
 v_mul_f32 v235, v171, v171
 v_mul_f32 v236, v172, v172
 v_mul_f32 v237, v173, v173
 v_mul_f32 v238, v174, v174
 v_mul_f32 v239, v175, v175
 v_fma_f32 v224, v224, s45, v16
 v_fma_f32 v225, v225, s45, v16
 v_fma_f32 v226, v226, s45, v16
 v_fma_f32 v227, v227, s45, v16
 v_fma_f32 v228, v228, s45, v16
 v_fma_f32 v229, v229, s45, v16
 v_fma_f32 v230, v230, s45, v16
 v_fma_f32 v231, v231, s45, v16
 v_fma_f32 v232, v232, s45, v16
 v_fma_f32 v233, v233, s45, v16
 v_fma_f32 v234, v234, s45, v16
 v_fma_f32 v235, v235, s45, v16
 v_fma_f32 v236, v236, s45, v16
 v_fma_f32 v237, v237, s45, v16
 v_fma_f32 v238, v238, s45, v16
 v_fma_f32 v239, v239, s45, v16
 v_mul_f32 v224, v224, v160
 v_mul_f32 v225, v225, v161
 v_mul_f32 v226, v226, v162
 v_mul_f32 v227, v227, v163
 v_mul_f32 v228, v228, v164
 v_mul_f32 v229, v229, v165
 v_mul_f32 v230, v230, v166
 v_mul_f32 v231, v231, v167
 v_mul_f32 v232, v232, v168
 v_mul_f32 v233, v233, v169
 v_mul_f32 v234, v234, v170
 v_mul_f32 v235, v235, v171
 v_mul_f32 v236, v236, v172
 v_mul_f32 v237, v237, v173
 v_mul_f32 v238, v238, v174
 v_mul_f32 v239, v239, v175
 v_exp_f32 v224, v224
 v_exp_f32 v225, v225
 v_exp_f32 v226, v226
 v_exp_f32 v227, v227
 v_exp_f32 v228, v228
 v_exp_f32 v229, v229
 v_exp_f32 v230, v230
 v_exp_f32 v231, v231
 v_exp_f32 v232, v232
 v_exp_f32 v233, v233
 v_exp_f32 v234, v234
 v_exp_f32 v235, v235
 v_exp_f32 v236, v236
 v_exp_f32 v237, v237
 v_exp_f32 v238, v238
 v_exp_f32 v239, v239
 v_add_f32 v224, 1.0, v224
 v_add_f32 v225, 1.0, v225
 v_add_f32 v226, 1.0, v226
 v_add_f32 v227, 1.0, v227
 v_add_f32 v228, 1.0, v228
 v_add_f32 v229, 1.0, v229
 v_add_f32 v230, 1.0, v230
 v_add_f32 v231, 1.0, v231
 v_add_f32 v232, 1.0, v232
 v_add_f32 v233, 1.0, v233
 v_add_f32 v234, 1.0, v234
 v_add_f32 v235, 1.0, v235
 v_add_f32 v236, 1.0, v236
 v_add_f32 v237, 1.0, v237
 v_add_f32 v238, 1.0, v238
 v_add_f32 v239, 1.0, v239
 v_rcp_f32 v224, v224
 v_rcp_f32 v225, v225
 v_rcp_f32 v226, v226
 v_rcp_f32 v227, v227
 v_rcp_f32 v228, v228
 v_rcp_f32 v229, v229
 v_rcp_f32 v230, v230
 v_rcp_f32 v231, v231
 v_rcp_f32 v232, v232
 v_rcp_f32 v233, v233
 v_rcp_f32 v234, v234
 v_rcp_f32 v235, v235
 v_rcp_f32 v236, v236
 v_rcp_f32 v237, v237
 v_rcp_f32 v238, v238
 v_rcp_f32 v239, v239
 v_mul_f32 v160, v160, v224
 v_mul_f32 v161, v161, v225
 v_mul_f32 v162, v162, v226
 v_mul_f32 v163, v163, v227
 v_mul_f32 v164, v164, v228
 v_mul_f32 v165, v165, v229
 v_mul_f32 v166, v166, v230
 v_mul_f32 v167, v167, v231
 v_mul_f32 v168, v168, v232
 v_mul_f32 v169, v169, v233
 v_mul_f32 v170, v170, v234
 v_mul_f32 v171, v171, v235
 v_mul_f32 v172, v172, v236
 v_mul_f32 v173, v173, v237
 v_mul_f32 v174, v174, v238
 v_mul_f32 v175, v175, v239
 v_cvt_pk_bf16_f32 v176, v160, v161
 v_cndmask_b32 v176, 0, v176, s[76:77]
 v_cvt_pk_bf16_f32 v177, v162, v163
 v_cndmask_b32 v177, 0, v177, s[76:77]
 v_cvt_pk_bf16_f32 v178, v164, v165
 v_cndmask_b32 v178, 0, v178, s[76:77]
 v_cvt_pk_bf16_f32 v179, v166, v167
 v_cndmask_b32 v179, 0, v179, s[76:77]
 v_cvt_pk_bf16_f32 v180, v168, v169
 v_cndmask_b32 v180, 0, v180, s[76:77]
 v_cvt_pk_bf16_f32 v181, v170, v171
 v_cndmask_b32 v181, 0, v181, s[76:77]
 v_cvt_pk_bf16_f32 v182, v172, v173
 v_cndmask_b32 v182, 0, v182, s[76:77]
 v_cvt_pk_bf16_f32 v183, v174, v175
 v_cndmask_b32 v183, 0, v183, s[76:77]
 s_mov_b32 exec_lo, 0xff
 s_mov_b32 exec_hi, 0xff
 ds_write_b128 v23, v[176:179] offset:1024
 ds_write_b128 v23, v[180:183] offset:3328
 s_mov_b64 exec, -1
 v_accvgpr_read_b32 v160, a48
 v_accvgpr_read_b32 v161, a49
 v_accvgpr_read_b32 v162, a50
 v_accvgpr_read_b32 v163, a51
 v_accvgpr_read_b32 v164, a52
 v_accvgpr_read_b32 v165, a53
 v_accvgpr_read_b32 v166, a54
 v_accvgpr_read_b32 v167, a55
 v_accvgpr_read_b32 v168, a56
 v_accvgpr_read_b32 v169, a57
 v_accvgpr_read_b32 v170, a58
 v_accvgpr_read_b32 v171, a59
 v_accvgpr_read_b32 v172, a60
 v_accvgpr_read_b32 v173, a61
 v_accvgpr_read_b32 v174, a62
 v_accvgpr_read_b32 v175, a63
 v_cvt_pk_bf16_f32 v161, v160, v161
 v_lshlrev_b32 v160, 16, v161
 v_and_b32 v161, 0xffff0000, v161
 v_cvt_pk_bf16_f32 v163, v162, v163
 v_lshlrev_b32 v162, 16, v163
 v_and_b32 v163, 0xffff0000, v163
 v_cvt_pk_bf16_f32 v165, v164, v165
 v_lshlrev_b32 v164, 16, v165
 v_and_b32 v165, 0xffff0000, v165
 v_cvt_pk_bf16_f32 v167, v166, v167
 v_lshlrev_b32 v166, 16, v167
 v_and_b32 v167, 0xffff0000, v167
 v_cvt_pk_bf16_f32 v169, v168, v169
 v_lshlrev_b32 v168, 16, v169
 v_and_b32 v169, 0xffff0000, v169
 v_cvt_pk_bf16_f32 v171, v170, v171
 v_lshlrev_b32 v170, 16, v171
 v_and_b32 v171, 0xffff0000, v171
 v_cvt_pk_bf16_f32 v173, v172, v173
 v_lshlrev_b32 v172, 16, v173
 v_and_b32 v173, 0xffff0000, v173
 v_cvt_pk_bf16_f32 v175, v174, v175
 v_lshlrev_b32 v174, 16, v175
 v_and_b32 v175, 0xffff0000, v175
 v_mul_f32 v224, v160, v160
 v_mul_f32 v225, v161, v161
 v_mul_f32 v226, v162, v162
 v_mul_f32 v227, v163, v163
 v_mul_f32 v228, v164, v164
 v_mul_f32 v229, v165, v165
 v_mul_f32 v230, v166, v166
 v_mul_f32 v231, v167, v167
 v_mul_f32 v232, v168, v168
 v_mul_f32 v233, v169, v169
 v_mul_f32 v234, v170, v170
 v_mul_f32 v235, v171, v171
 v_mul_f32 v236, v172, v172
 v_mul_f32 v237, v173, v173
 v_mul_f32 v238, v174, v174
 v_mul_f32 v239, v175, v175
 v_fma_f32 v224, v224, s45, v16
 v_fma_f32 v225, v225, s45, v16
 v_fma_f32 v226, v226, s45, v16
 v_fma_f32 v227, v227, s45, v16
 v_fma_f32 v228, v228, s45, v16
 v_fma_f32 v229, v229, s45, v16
 v_fma_f32 v230, v230, s45, v16
 v_fma_f32 v231, v231, s45, v16
 v_fma_f32 v232, v232, s45, v16
 v_fma_f32 v233, v233, s45, v16
 v_fma_f32 v234, v234, s45, v16
 v_fma_f32 v235, v235, s45, v16
 v_fma_f32 v236, v236, s45, v16
 v_fma_f32 v237, v237, s45, v16
 v_fma_f32 v238, v238, s45, v16
 v_fma_f32 v239, v239, s45, v16
 v_mul_f32 v224, v224, v160
 v_mul_f32 v225, v225, v161
 v_mul_f32 v226, v226, v162
 v_mul_f32 v227, v227, v163
 v_mul_f32 v228, v228, v164
 v_mul_f32 v229, v229, v165
 v_mul_f32 v230, v230, v166
 v_mul_f32 v231, v231, v167
 v_mul_f32 v232, v232, v168
 v_mul_f32 v233, v233, v169
 v_mul_f32 v234, v234, v170
 v_mul_f32 v235, v235, v171
 v_mul_f32 v236, v236, v172
 v_mul_f32 v237, v237, v173
 v_mul_f32 v238, v238, v174
 v_mul_f32 v239, v239, v175
 v_exp_f32 v224, v224
 v_exp_f32 v225, v225
 v_exp_f32 v226, v226
 v_exp_f32 v227, v227
 v_exp_f32 v228, v228
 v_exp_f32 v229, v229
 v_exp_f32 v230, v230
 v_exp_f32 v231, v231
 v_exp_f32 v232, v232
 v_exp_f32 v233, v233
 v_exp_f32 v234, v234
 v_exp_f32 v235, v235
 v_exp_f32 v236, v236
 v_exp_f32 v237, v237
 v_exp_f32 v238, v238
 v_exp_f32 v239, v239
 v_add_f32 v224, 1.0, v224
 v_add_f32 v225, 1.0, v225
 v_add_f32 v226, 1.0, v226
 v_add_f32 v227, 1.0, v227
 v_add_f32 v228, 1.0, v228
 v_add_f32 v229, 1.0, v229
 v_add_f32 v230, 1.0, v230
 v_add_f32 v231, 1.0, v231
 v_add_f32 v232, 1.0, v232
 v_add_f32 v233, 1.0, v233
 v_add_f32 v234, 1.0, v234
 v_add_f32 v235, 1.0, v235
 v_add_f32 v236, 1.0, v236
 v_add_f32 v237, 1.0, v237
 v_add_f32 v238, 1.0, v238
 v_add_f32 v239, 1.0, v239
 v_rcp_f32 v224, v224
 v_rcp_f32 v225, v225
 v_rcp_f32 v226, v226
 v_rcp_f32 v227, v227
 v_rcp_f32 v228, v228
 v_rcp_f32 v229, v229
 v_rcp_f32 v230, v230
 v_rcp_f32 v231, v231
 v_rcp_f32 v232, v232
 v_rcp_f32 v233, v233
 v_rcp_f32 v234, v234
 v_rcp_f32 v235, v235
 v_rcp_f32 v236, v236
 v_rcp_f32 v237, v237
 v_rcp_f32 v238, v238
 v_rcp_f32 v239, v239
 v_mul_f32 v160, v160, v224
 v_mul_f32 v161, v161, v225
 v_mul_f32 v162, v162, v226
 v_mul_f32 v163, v163, v227
 v_mul_f32 v164, v164, v228
 v_mul_f32 v165, v165, v229
 v_mul_f32 v166, v166, v230
 v_mul_f32 v167, v167, v231
 v_mul_f32 v168, v168, v232
 v_mul_f32 v169, v169, v233
 v_mul_f32 v170, v170, v234
 v_mul_f32 v171, v171, v235
 v_mul_f32 v172, v172, v236
 v_mul_f32 v173, v173, v237
 v_mul_f32 v174, v174, v238
 v_mul_f32 v175, v175, v239
 v_cvt_pk_bf16_f32 v176, v160, v161
 v_cndmask_b32 v176, 0, v176, s[74:75]
 v_cvt_pk_bf16_f32 v177, v162, v163
 v_cndmask_b32 v177, 0, v177, s[74:75]
 v_cvt_pk_bf16_f32 v178, v164, v165
 v_cndmask_b32 v178, 0, v178, s[74:75]
 v_cvt_pk_bf16_f32 v179, v166, v167
 v_cndmask_b32 v179, 0, v179, s[74:75]
 v_cvt_pk_bf16_f32 v180, v168, v169
 v_cndmask_b32 v180, 0, v180, s[74:75]
 v_cvt_pk_bf16_f32 v181, v170, v171
 v_cndmask_b32 v181, 0, v181, s[74:75]
 v_cvt_pk_bf16_f32 v182, v172, v173
 v_cndmask_b32 v182, 0, v182, s[74:75]
 v_cvt_pk_bf16_f32 v183, v174, v175
 v_cndmask_b32 v183, 0, v183, s[74:75]
 ds_write_b128 v23, v[176:179] offset:4608
 ds_write_b128 v23, v[180:183] offset:6912
 v_accvgpr_read_b32 v160, a64
 v_accvgpr_read_b32 v161, a65
 v_accvgpr_read_b32 v162, a66
 v_accvgpr_read_b32 v163, a67
 v_accvgpr_read_b32 v164, a68
 v_accvgpr_read_b32 v165, a69
 v_accvgpr_read_b32 v166, a70
 v_accvgpr_read_b32 v167, a71
 v_accvgpr_read_b32 v168, a72
 v_accvgpr_read_b32 v169, a73
 v_accvgpr_read_b32 v170, a74
 v_accvgpr_read_b32 v171, a75
 v_accvgpr_read_b32 v172, a76
 v_accvgpr_read_b32 v173, a77
 v_accvgpr_read_b32 v174, a78
 v_accvgpr_read_b32 v175, a79
 v_cvt_pk_bf16_f32 v161, v160, v161
 v_lshlrev_b32 v160, 16, v161
 v_and_b32 v161, 0xffff0000, v161
 v_cvt_pk_bf16_f32 v163, v162, v163
 v_lshlrev_b32 v162, 16, v163
 v_and_b32 v163, 0xffff0000, v163
 v_cvt_pk_bf16_f32 v165, v164, v165
 v_lshlrev_b32 v164, 16, v165
 v_and_b32 v165, 0xffff0000, v165
 v_cvt_pk_bf16_f32 v167, v166, v167
 v_lshlrev_b32 v166, 16, v167
 v_and_b32 v167, 0xffff0000, v167
 v_cvt_pk_bf16_f32 v169, v168, v169
 v_lshlrev_b32 v168, 16, v169
 v_and_b32 v169, 0xffff0000, v169
 v_cvt_pk_bf16_f32 v171, v170, v171
 v_lshlrev_b32 v170, 16, v171
 v_and_b32 v171, 0xffff0000, v171
 v_cvt_pk_bf16_f32 v173, v172, v173
 v_lshlrev_b32 v172, 16, v173
 v_and_b32 v173, 0xffff0000, v173
 v_cvt_pk_bf16_f32 v175, v174, v175
 v_lshlrev_b32 v174, 16, v175
 v_and_b32 v175, 0xffff0000, v175
 v_mul_f32 v224, v160, v160
 v_mul_f32 v225, v161, v161
 v_mul_f32 v226, v162, v162
 v_mul_f32 v227, v163, v163
 v_mul_f32 v228, v164, v164
 v_mul_f32 v229, v165, v165
 v_mul_f32 v230, v166, v166
 v_mul_f32 v231, v167, v167
 v_mul_f32 v232, v168, v168
 v_mul_f32 v233, v169, v169
 v_mul_f32 v234, v170, v170
 v_mul_f32 v235, v171, v171
 v_mul_f32 v236, v172, v172
 v_mul_f32 v237, v173, v173
 v_mul_f32 v238, v174, v174
 v_mul_f32 v239, v175, v175
 v_fma_f32 v224, v224, s45, v16
 v_fma_f32 v225, v225, s45, v16
 v_fma_f32 v226, v226, s45, v16
 v_fma_f32 v227, v227, s45, v16
 v_fma_f32 v228, v228, s45, v16
 v_fma_f32 v229, v229, s45, v16
 v_fma_f32 v230, v230, s45, v16
 v_fma_f32 v231, v231, s45, v16
 v_fma_f32 v232, v232, s45, v16
 v_fma_f32 v233, v233, s45, v16
 v_fma_f32 v234, v234, s45, v16
 v_fma_f32 v235, v235, s45, v16
 v_fma_f32 v236, v236, s45, v16
 v_fma_f32 v237, v237, s45, v16
 v_fma_f32 v238, v238, s45, v16
 v_fma_f32 v239, v239, s45, v16
 v_mul_f32 v224, v224, v160
 v_mul_f32 v225, v225, v161
 v_mul_f32 v226, v226, v162
 v_mul_f32 v227, v227, v163
 v_mul_f32 v228, v228, v164
 v_mul_f32 v229, v229, v165
 v_mul_f32 v230, v230, v166
 v_mul_f32 v231, v231, v167
 v_mul_f32 v232, v232, v168
 v_mul_f32 v233, v233, v169
 v_mul_f32 v234, v234, v170
 v_mul_f32 v235, v235, v171
 v_mul_f32 v236, v236, v172
 v_mul_f32 v237, v237, v173
 v_mul_f32 v238, v238, v174
 v_mul_f32 v239, v239, v175
 v_exp_f32 v224, v224
 v_exp_f32 v225, v225
 v_exp_f32 v226, v226
 v_exp_f32 v227, v227
 v_exp_f32 v228, v228
 v_exp_f32 v229, v229
 v_exp_f32 v230, v230
 v_exp_f32 v231, v231
 v_exp_f32 v232, v232
 v_exp_f32 v233, v233
 v_exp_f32 v234, v234
 v_exp_f32 v235, v235
 v_exp_f32 v236, v236
 v_exp_f32 v237, v237
 v_exp_f32 v238, v238
 v_exp_f32 v239, v239
 v_add_f32 v224, 1.0, v224
 v_add_f32 v225, 1.0, v225
 v_add_f32 v226, 1.0, v226
 v_add_f32 v227, 1.0, v227
 v_add_f32 v228, 1.0, v228
 v_add_f32 v229, 1.0, v229
 v_add_f32 v230, 1.0, v230
 v_add_f32 v231, 1.0, v231
 v_add_f32 v232, 1.0, v232
 v_add_f32 v233, 1.0, v233
 v_add_f32 v234, 1.0, v234
 v_add_f32 v235, 1.0, v235
 v_add_f32 v236, 1.0, v236
 v_add_f32 v237, 1.0, v237
 v_add_f32 v238, 1.0, v238
 v_add_f32 v239, 1.0, v239
 v_rcp_f32 v224, v224
 v_rcp_f32 v225, v225
 v_rcp_f32 v226, v226
 v_rcp_f32 v227, v227
 v_rcp_f32 v228, v228
 v_rcp_f32 v229, v229
 v_rcp_f32 v230, v230
 v_rcp_f32 v231, v231
 v_rcp_f32 v232, v232
 v_rcp_f32 v233, v233
 v_rcp_f32 v234, v234
 v_rcp_f32 v235, v235
 v_rcp_f32 v236, v236
 v_rcp_f32 v237, v237
 v_rcp_f32 v238, v238
 v_rcp_f32 v239, v239
 v_mul_f32 v160, v160, v224
 v_mul_f32 v161, v161, v225
 v_mul_f32 v162, v162, v226
 v_mul_f32 v163, v163, v227
 v_mul_f32 v164, v164, v228
 v_mul_f32 v165, v165, v229
 v_mul_f32 v166, v166, v230
 v_mul_f32 v167, v167, v231
 v_mul_f32 v168, v168, v232
 v_mul_f32 v169, v169, v233
 v_mul_f32 v170, v170, v234
 v_mul_f32 v171, v171, v235
 v_mul_f32 v172, v172, v236
 v_mul_f32 v173, v173, v237
 v_mul_f32 v174, v174, v238
 v_mul_f32 v175, v175, v239
 v_cvt_pk_bf16_f32 v176, v160, v161
 v_cvt_pk_bf16_f32 v177, v162, v163
 v_cvt_pk_bf16_f32 v178, v164, v165
 v_cvt_pk_bf16_f32 v179, v166, v167
 v_cvt_pk_bf16_f32 v180, v168, v169
 v_cvt_pk_bf16_f32 v181, v170, v171
 v_cvt_pk_bf16_f32 v182, v172, v173
 v_cvt_pk_bf16_f32 v183, v174, v175
 ds_write_b128 v23, v[176:179] offset:5120
 ds_write_b128 v23, v[180:183] offset:7424
 v_accvgpr_read_b32 v160, a80
 v_accvgpr_read_b32 v161, a81
 v_accvgpr_read_b32 v162, a82
 v_accvgpr_read_b32 v163, a83
 v_accvgpr_read_b32 v164, a84
 v_accvgpr_read_b32 v165, a85
 v_accvgpr_read_b32 v166, a86
 v_accvgpr_read_b32 v167, a87
 v_accvgpr_read_b32 v168, a88
 v_accvgpr_read_b32 v169, a89
 v_accvgpr_read_b32 v170, a90
 v_accvgpr_read_b32 v171, a91
 v_accvgpr_read_b32 v172, a92
 v_accvgpr_read_b32 v173, a93
 v_accvgpr_read_b32 v174, a94
 v_accvgpr_read_b32 v175, a95
 v_cvt_pk_bf16_f32 v161, v160, v161
 v_lshlrev_b32 v160, 16, v161
 v_and_b32 v161, 0xffff0000, v161
 v_cvt_pk_bf16_f32 v163, v162, v163
 v_lshlrev_b32 v162, 16, v163
 v_and_b32 v163, 0xffff0000, v163
 v_cvt_pk_bf16_f32 v165, v164, v165
 v_lshlrev_b32 v164, 16, v165
 v_and_b32 v165, 0xffff0000, v165
 v_cvt_pk_bf16_f32 v167, v166, v167
 v_lshlrev_b32 v166, 16, v167
 v_and_b32 v167, 0xffff0000, v167
 v_cvt_pk_bf16_f32 v169, v168, v169
 v_lshlrev_b32 v168, 16, v169
 v_and_b32 v169, 0xffff0000, v169
 v_cvt_pk_bf16_f32 v171, v170, v171
 v_lshlrev_b32 v170, 16, v171
 v_and_b32 v171, 0xffff0000, v171
 v_cvt_pk_bf16_f32 v173, v172, v173
 v_lshlrev_b32 v172, 16, v173
 v_and_b32 v173, 0xffff0000, v173
 v_cvt_pk_bf16_f32 v175, v174, v175
 v_lshlrev_b32 v174, 16, v175
 v_and_b32 v175, 0xffff0000, v175
 v_mul_f32 v224, v160, v160
 v_mul_f32 v225, v161, v161
 v_mul_f32 v226, v162, v162
 v_mul_f32 v227, v163, v163
 v_mul_f32 v228, v164, v164
 v_mul_f32 v229, v165, v165
 v_mul_f32 v230, v166, v166
 v_mul_f32 v231, v167, v167
 v_mul_f32 v232, v168, v168
 v_mul_f32 v233, v169, v169
 v_mul_f32 v234, v170, v170
 v_mul_f32 v235, v171, v171
 v_mul_f32 v236, v172, v172
 v_mul_f32 v237, v173, v173
 v_mul_f32 v238, v174, v174
 v_mul_f32 v239, v175, v175
 v_fma_f32 v224, v224, s45, v16
 v_fma_f32 v225, v225, s45, v16
 v_fma_f32 v226, v226, s45, v16
 v_fma_f32 v227, v227, s45, v16
 v_fma_f32 v228, v228, s45, v16
 v_fma_f32 v229, v229, s45, v16
 v_fma_f32 v230, v230, s45, v16
 v_fma_f32 v231, v231, s45, v16
 v_fma_f32 v232, v232, s45, v16
 v_fma_f32 v233, v233, s45, v16
 v_fma_f32 v234, v234, s45, v16
 v_fma_f32 v235, v235, s45, v16
 v_fma_f32 v236, v236, s45, v16
 v_fma_f32 v237, v237, s45, v16
 v_fma_f32 v238, v238, s45, v16
 v_fma_f32 v239, v239, s45, v16
 v_mul_f32 v224, v224, v160
 v_mul_f32 v225, v225, v161
 v_mul_f32 v226, v226, v162
 v_mul_f32 v227, v227, v163
 v_mul_f32 v228, v228, v164
 v_mul_f32 v229, v229, v165
 v_mul_f32 v230, v230, v166
 v_mul_f32 v231, v231, v167
 v_mul_f32 v232, v232, v168
 v_mul_f32 v233, v233, v169
 v_mul_f32 v234, v234, v170
 v_mul_f32 v235, v235, v171
 v_mul_f32 v236, v236, v172
 v_mul_f32 v237, v237, v173
 v_mul_f32 v238, v238, v174
 v_mul_f32 v239, v239, v175
 v_exp_f32 v224, v224
 v_exp_f32 v225, v225
 v_exp_f32 v226, v226
 v_exp_f32 v227, v227
 v_exp_f32 v228, v228
 v_exp_f32 v229, v229
 v_exp_f32 v230, v230
 v_exp_f32 v231, v231
 v_exp_f32 v232, v232
 v_exp_f32 v233, v233
 v_exp_f32 v234, v234
 v_exp_f32 v235, v235
 v_exp_f32 v236, v236
 v_exp_f32 v237, v237
 v_exp_f32 v238, v238
 v_exp_f32 v239, v239
 v_add_f32 v224, 1.0, v224
 v_add_f32 v225, 1.0, v225
 v_add_f32 v226, 1.0, v226
 v_add_f32 v227, 1.0, v227
 v_add_f32 v228, 1.0, v228
 v_add_f32 v229, 1.0, v229
 v_add_f32 v230, 1.0, v230
 v_add_f32 v231, 1.0, v231
 v_add_f32 v232, 1.0, v232
 v_add_f32 v233, 1.0, v233
 v_add_f32 v234, 1.0, v234
 v_add_f32 v235, 1.0, v235
 v_add_f32 v236, 1.0, v236
 v_add_f32 v237, 1.0, v237
 v_add_f32 v238, 1.0, v238
 v_add_f32 v239, 1.0, v239
 v_rcp_f32 v224, v224
 v_rcp_f32 v225, v225
 v_rcp_f32 v226, v226
 v_rcp_f32 v227, v227
 v_rcp_f32 v228, v228
 v_rcp_f32 v229, v229
 v_rcp_f32 v230, v230
 v_rcp_f32 v231, v231
 v_rcp_f32 v232, v232
 v_rcp_f32 v233, v233
 v_rcp_f32 v234, v234
 v_rcp_f32 v235, v235
 v_rcp_f32 v236, v236
 v_rcp_f32 v237, v237
 v_rcp_f32 v238, v238
 v_rcp_f32 v239, v239
 v_mul_f32 v160, v160, v224
 v_mul_f32 v161, v161, v225
 v_mul_f32 v162, v162, v226
 v_mul_f32 v163, v163, v227
 v_mul_f32 v164, v164, v228
 v_mul_f32 v165, v165, v229
 v_mul_f32 v166, v166, v230
 v_mul_f32 v167, v167, v231
 v_mul_f32 v168, v168, v232
 v_mul_f32 v169, v169, v233
 v_mul_f32 v170, v170, v234
 v_mul_f32 v171, v171, v235
 v_mul_f32 v172, v172, v236
 v_mul_f32 v173, v173, v237
 v_mul_f32 v174, v174, v238
 v_mul_f32 v175, v175, v239
 v_cvt_pk_bf16_f32 v176, v160, v161
 v_cndmask_b32 v176, 0, v176, s[76:77]
 v_cvt_pk_bf16_f32 v177, v162, v163
 v_cndmask_b32 v177, 0, v177, s[76:77]
 v_cvt_pk_bf16_f32 v178, v164, v165
 v_cndmask_b32 v178, 0, v178, s[76:77]
 v_cvt_pk_bf16_f32 v179, v166, v167
 v_cndmask_b32 v179, 0, v179, s[76:77]
 v_cvt_pk_bf16_f32 v180, v168, v169
 v_cndmask_b32 v180, 0, v180, s[76:77]
 v_cvt_pk_bf16_f32 v181, v170, v171
 v_cndmask_b32 v181, 0, v181, s[76:77]
 v_cvt_pk_bf16_f32 v182, v172, v173
 v_cndmask_b32 v182, 0, v182, s[76:77]
 v_cvt_pk_bf16_f32 v183, v174, v175
 v_cndmask_b32 v183, 0, v183, s[76:77]
 s_mov_b32 exec_lo, 0xff
 s_mov_b32 exec_hi, 0xff
 ds_write_b128 v23, v[176:179] offset:5632
 ds_write_b128 v23, v[180:183] offset:7936
 s_mov_b64 exec, -1
 v_accvgpr_read_b32 v160, a96
 v_accvgpr_read_b32 v161, a97
 v_accvgpr_read_b32 v162, a98
 v_accvgpr_read_b32 v163, a99
 v_accvgpr_read_b32 v164, a100
 v_accvgpr_read_b32 v165, a101
 v_accvgpr_read_b32 v166, a102
 v_accvgpr_read_b32 v167, a103
 v_accvgpr_read_b32 v168, a104
 v_accvgpr_read_b32 v169, a105
 v_accvgpr_read_b32 v170, a106
 v_accvgpr_read_b32 v171, a107
 v_accvgpr_read_b32 v172, a108
 v_accvgpr_read_b32 v173, a109
 v_accvgpr_read_b32 v174, a110
 v_accvgpr_read_b32 v175, a111
 v_cvt_pk_bf16_f32 v161, v160, v161
 v_lshlrev_b32 v160, 16, v161
 v_and_b32 v161, 0xffff0000, v161
 v_cvt_pk_bf16_f32 v163, v162, v163
 v_lshlrev_b32 v162, 16, v163
 v_and_b32 v163, 0xffff0000, v163
 v_cvt_pk_bf16_f32 v165, v164, v165
 v_lshlrev_b32 v164, 16, v165
 v_and_b32 v165, 0xffff0000, v165
 v_cvt_pk_bf16_f32 v167, v166, v167
 v_lshlrev_b32 v166, 16, v167
 v_and_b32 v167, 0xffff0000, v167
 v_cvt_pk_bf16_f32 v169, v168, v169
 v_lshlrev_b32 v168, 16, v169
 v_and_b32 v169, 0xffff0000, v169
 v_cvt_pk_bf16_f32 v171, v170, v171
 v_lshlrev_b32 v170, 16, v171
 v_and_b32 v171, 0xffff0000, v171
 v_cvt_pk_bf16_f32 v173, v172, v173
 v_lshlrev_b32 v172, 16, v173
 v_and_b32 v173, 0xffff0000, v173
 v_cvt_pk_bf16_f32 v175, v174, v175
 v_lshlrev_b32 v174, 16, v175
 v_and_b32 v175, 0xffff0000, v175
 v_mul_f32 v224, v160, v160
 v_mul_f32 v225, v161, v161
 v_mul_f32 v226, v162, v162
 v_mul_f32 v227, v163, v163
 v_mul_f32 v228, v164, v164
 v_mul_f32 v229, v165, v165
 v_mul_f32 v230, v166, v166
 v_mul_f32 v231, v167, v167
 v_mul_f32 v232, v168, v168
 v_mul_f32 v233, v169, v169
 v_mul_f32 v234, v170, v170
 v_mul_f32 v235, v171, v171
 v_mul_f32 v236, v172, v172
 v_mul_f32 v237, v173, v173
 v_mul_f32 v238, v174, v174
 v_mul_f32 v239, v175, v175
 v_fma_f32 v224, v224, s45, v16
 v_fma_f32 v225, v225, s45, v16
 v_fma_f32 v226, v226, s45, v16
 v_fma_f32 v227, v227, s45, v16
 v_fma_f32 v228, v228, s45, v16
 v_fma_f32 v229, v229, s45, v16
 v_fma_f32 v230, v230, s45, v16
 v_fma_f32 v231, v231, s45, v16
 v_fma_f32 v232, v232, s45, v16
 v_fma_f32 v233, v233, s45, v16
 v_fma_f32 v234, v234, s45, v16
 v_fma_f32 v235, v235, s45, v16
 v_fma_f32 v236, v236, s45, v16
 v_fma_f32 v237, v237, s45, v16
 v_fma_f32 v238, v238, s45, v16
 v_fma_f32 v239, v239, s45, v16
 v_mul_f32 v224, v224, v160
 v_mul_f32 v225, v225, v161
 v_mul_f32 v226, v226, v162
 v_mul_f32 v227, v227, v163
 v_mul_f32 v228, v228, v164
 v_mul_f32 v229, v229, v165
 v_mul_f32 v230, v230, v166
 v_mul_f32 v231, v231, v167
 v_mul_f32 v232, v232, v168
 v_mul_f32 v233, v233, v169
 v_mul_f32 v234, v234, v170
 v_mul_f32 v235, v235, v171
 v_mul_f32 v236, v236, v172
 v_mul_f32 v237, v237, v173
 v_mul_f32 v238, v238, v174
 v_mul_f32 v239, v239, v175
 v_exp_f32 v224, v224
 v_exp_f32 v225, v225
 v_exp_f32 v226, v226
 v_exp_f32 v227, v227
 v_exp_f32 v228, v228
 v_exp_f32 v229, v229
 v_exp_f32 v230, v230
 v_exp_f32 v231, v231
 v_exp_f32 v232, v232
 v_exp_f32 v233, v233
 v_exp_f32 v234, v234
 v_exp_f32 v235, v235
 v_exp_f32 v236, v236
 v_exp_f32 v237, v237
 v_exp_f32 v238, v238
 v_exp_f32 v239, v239
 v_add_f32 v224, 1.0, v224
 v_add_f32 v225, 1.0, v225
 v_add_f32 v226, 1.0, v226
 v_add_f32 v227, 1.0, v227
 v_add_f32 v228, 1.0, v228
 v_add_f32 v229, 1.0, v229
 v_add_f32 v230, 1.0, v230
 v_add_f32 v231, 1.0, v231
 v_add_f32 v232, 1.0, v232
 v_add_f32 v233, 1.0, v233
 v_add_f32 v234, 1.0, v234
 v_add_f32 v235, 1.0, v235
 v_add_f32 v236, 1.0, v236
 v_add_f32 v237, 1.0, v237
 v_add_f32 v238, 1.0, v238
 v_add_f32 v239, 1.0, v239
 v_rcp_f32 v224, v224
 v_rcp_f32 v225, v225
 v_rcp_f32 v226, v226
 v_rcp_f32 v227, v227
 v_rcp_f32 v228, v228
 v_rcp_f32 v229, v229
 v_rcp_f32 v230, v230
 v_rcp_f32 v231, v231
 v_rcp_f32 v232, v232
 v_rcp_f32 v233, v233
 v_rcp_f32 v234, v234
 v_rcp_f32 v235, v235
 v_rcp_f32 v236, v236
 v_rcp_f32 v237, v237
 v_rcp_f32 v238, v238
 v_rcp_f32 v239, v239
 v_mul_f32 v160, v160, v224
 v_mul_f32 v161, v161, v225
 v_mul_f32 v162, v162, v226
 v_mul_f32 v163, v163, v227
 v_mul_f32 v164, v164, v228
 v_mul_f32 v165, v165, v229
 v_mul_f32 v166, v166, v230
 v_mul_f32 v167, v167, v231
 v_mul_f32 v168, v168, v232
 v_mul_f32 v169, v169, v233
 v_mul_f32 v170, v170, v234
 v_mul_f32 v171, v171, v235
 v_mul_f32 v172, v172, v236
 v_mul_f32 v173, v173, v237
 v_mul_f32 v174, v174, v238
 v_mul_f32 v175, v175, v239
 v_cvt_pk_bf16_f32 v176, v160, v161
 v_cndmask_b32 v176, 0, v176, s[74:75]
 v_cvt_pk_bf16_f32 v177, v162, v163
 v_cndmask_b32 v177, 0, v177, s[74:75]
 v_cvt_pk_bf16_f32 v178, v164, v165
 v_cndmask_b32 v178, 0, v178, s[74:75]
 v_cvt_pk_bf16_f32 v179, v166, v167
 v_cndmask_b32 v179, 0, v179, s[74:75]
 v_cvt_pk_bf16_f32 v180, v168, v169
 v_cndmask_b32 v180, 0, v180, s[74:75]
 v_cvt_pk_bf16_f32 v181, v170, v171
 v_cndmask_b32 v181, 0, v181, s[74:75]
 v_cvt_pk_bf16_f32 v182, v172, v173
 v_cndmask_b32 v182, 0, v182, s[74:75]
 v_cvt_pk_bf16_f32 v183, v174, v175
 v_cndmask_b32 v183, 0, v183, s[74:75]
 ds_write_b128 v23, v[176:179] offset:9216
 ds_write_b128 v23, v[180:183] offset:11520
 v_accvgpr_read_b32 v160, a112
 v_accvgpr_read_b32 v161, a113
 v_accvgpr_read_b32 v162, a114
 v_accvgpr_read_b32 v163, a115
 v_accvgpr_read_b32 v164, a116
 v_accvgpr_read_b32 v165, a117
 v_accvgpr_read_b32 v166, a118
 v_accvgpr_read_b32 v167, a119
 v_accvgpr_read_b32 v168, a120
 v_accvgpr_read_b32 v169, a121
 v_accvgpr_read_b32 v170, a122
 v_accvgpr_read_b32 v171, a123
 v_accvgpr_read_b32 v172, a124
 v_accvgpr_read_b32 v173, a125
 v_accvgpr_read_b32 v174, a126
 v_accvgpr_read_b32 v175, a127
 v_cvt_pk_bf16_f32 v161, v160, v161
 v_lshlrev_b32 v160, 16, v161
 v_and_b32 v161, 0xffff0000, v161
 v_cvt_pk_bf16_f32 v163, v162, v163
 v_lshlrev_b32 v162, 16, v163
 v_and_b32 v163, 0xffff0000, v163
 v_cvt_pk_bf16_f32 v165, v164, v165
 v_lshlrev_b32 v164, 16, v165
 v_and_b32 v165, 0xffff0000, v165
 v_cvt_pk_bf16_f32 v167, v166, v167
 v_lshlrev_b32 v166, 16, v167
 v_and_b32 v167, 0xffff0000, v167
 v_cvt_pk_bf16_f32 v169, v168, v169
 v_lshlrev_b32 v168, 16, v169
 v_and_b32 v169, 0xffff0000, v169
 v_cvt_pk_bf16_f32 v171, v170, v171
 v_lshlrev_b32 v170, 16, v171
 v_and_b32 v171, 0xffff0000, v171
 v_cvt_pk_bf16_f32 v173, v172, v173
 v_lshlrev_b32 v172, 16, v173
 v_and_b32 v173, 0xffff0000, v173
 v_cvt_pk_bf16_f32 v175, v174, v175
 v_lshlrev_b32 v174, 16, v175
 v_and_b32 v175, 0xffff0000, v175
 v_mul_f32 v224, v160, v160
 v_mul_f32 v225, v161, v161
 v_mul_f32 v226, v162, v162
 v_mul_f32 v227, v163, v163
 v_mul_f32 v228, v164, v164
 v_mul_f32 v229, v165, v165
 v_mul_f32 v230, v166, v166
 v_mul_f32 v231, v167, v167
 v_mul_f32 v232, v168, v168
 v_mul_f32 v233, v169, v169
 v_mul_f32 v234, v170, v170
 v_mul_f32 v235, v171, v171
 v_mul_f32 v236, v172, v172
 v_mul_f32 v237, v173, v173
 v_mul_f32 v238, v174, v174
 v_mul_f32 v239, v175, v175
 v_fma_f32 v224, v224, s45, v16
 v_fma_f32 v225, v225, s45, v16
 v_fma_f32 v226, v226, s45, v16
 v_fma_f32 v227, v227, s45, v16
 v_fma_f32 v228, v228, s45, v16
 v_fma_f32 v229, v229, s45, v16
 v_fma_f32 v230, v230, s45, v16
 v_fma_f32 v231, v231, s45, v16
 v_fma_f32 v232, v232, s45, v16
 v_fma_f32 v233, v233, s45, v16
 v_fma_f32 v234, v234, s45, v16
 v_fma_f32 v235, v235, s45, v16
 v_fma_f32 v236, v236, s45, v16
 v_fma_f32 v237, v237, s45, v16
 v_fma_f32 v238, v238, s45, v16
 v_fma_f32 v239, v239, s45, v16
 v_mul_f32 v224, v224, v160
 v_mul_f32 v225, v225, v161
 v_mul_f32 v226, v226, v162
 v_mul_f32 v227, v227, v163
 v_mul_f32 v228, v228, v164
 v_mul_f32 v229, v229, v165
 v_mul_f32 v230, v230, v166
 v_mul_f32 v231, v231, v167
 v_mul_f32 v232, v232, v168
 v_mul_f32 v233, v233, v169
 v_mul_f32 v234, v234, v170
 v_mul_f32 v235, v235, v171
 v_mul_f32 v236, v236, v172
 v_mul_f32 v237, v237, v173
 v_mul_f32 v238, v238, v174
 v_mul_f32 v239, v239, v175
 v_exp_f32 v224, v224
 v_exp_f32 v225, v225
 v_exp_f32 v226, v226
 v_exp_f32 v227, v227
 v_exp_f32 v228, v228
 v_exp_f32 v229, v229
 v_exp_f32 v230, v230
 v_exp_f32 v231, v231
 v_exp_f32 v232, v232
 v_exp_f32 v233, v233
 v_exp_f32 v234, v234
 v_exp_f32 v235, v235
 v_exp_f32 v236, v236
 v_exp_f32 v237, v237
 v_exp_f32 v238, v238
 v_exp_f32 v239, v239
 v_add_f32 v224, 1.0, v224
 v_add_f32 v225, 1.0, v225
 v_add_f32 v226, 1.0, v226
 v_add_f32 v227, 1.0, v227
 v_add_f32 v228, 1.0, v228
 v_add_f32 v229, 1.0, v229
 v_add_f32 v230, 1.0, v230
 v_add_f32 v231, 1.0, v231
 v_add_f32 v232, 1.0, v232
 v_add_f32 v233, 1.0, v233
 v_add_f32 v234, 1.0, v234
 v_add_f32 v235, 1.0, v235
 v_add_f32 v236, 1.0, v236
 v_add_f32 v237, 1.0, v237
 v_add_f32 v238, 1.0, v238
 v_add_f32 v239, 1.0, v239
 v_rcp_f32 v224, v224
 v_rcp_f32 v225, v225
 v_rcp_f32 v226, v226
 v_rcp_f32 v227, v227
 v_rcp_f32 v228, v228
 v_rcp_f32 v229, v229
 v_rcp_f32 v230, v230
 v_rcp_f32 v231, v231
 v_rcp_f32 v232, v232
 v_rcp_f32 v233, v233
 v_rcp_f32 v234, v234
 v_rcp_f32 v235, v235
 v_rcp_f32 v236, v236
 v_rcp_f32 v237, v237
 v_rcp_f32 v238, v238
 v_rcp_f32 v239, v239
 v_mul_f32 v160, v160, v224
 v_mul_f32 v161, v161, v225
 v_mul_f32 v162, v162, v226
 v_mul_f32 v163, v163, v227
 v_mul_f32 v164, v164, v228
 v_mul_f32 v165, v165, v229
 v_mul_f32 v166, v166, v230
 v_mul_f32 v167, v167, v231
 v_mul_f32 v168, v168, v232
 v_mul_f32 v169, v169, v233
 v_mul_f32 v170, v170, v234
 v_mul_f32 v171, v171, v235
 v_mul_f32 v172, v172, v236
 v_mul_f32 v173, v173, v237
 v_mul_f32 v174, v174, v238
 v_mul_f32 v175, v175, v239
 v_cvt_pk_bf16_f32 v176, v160, v161
 v_cvt_pk_bf16_f32 v177, v162, v163
 v_cvt_pk_bf16_f32 v178, v164, v165
 v_cvt_pk_bf16_f32 v179, v166, v167
 v_cvt_pk_bf16_f32 v180, v168, v169
 v_cvt_pk_bf16_f32 v181, v170, v171
 v_cvt_pk_bf16_f32 v182, v172, v173
 v_cvt_pk_bf16_f32 v183, v174, v175
 ds_write_b128 v23, v[176:179] offset:9728
 ds_write_b128 v23, v[180:183] offset:12032
 v_accvgpr_read_b32 v160, a128
 v_accvgpr_read_b32 v161, a129
 v_accvgpr_read_b32 v162, a130
 v_accvgpr_read_b32 v163, a131
 v_accvgpr_read_b32 v164, a132
 v_accvgpr_read_b32 v165, a133
 v_accvgpr_read_b32 v166, a134
 v_accvgpr_read_b32 v167, a135
 v_accvgpr_read_b32 v168, a136
 v_accvgpr_read_b32 v169, a137
 v_accvgpr_read_b32 v170, a138
 v_accvgpr_read_b32 v171, a139
 v_accvgpr_read_b32 v172, a140
 v_accvgpr_read_b32 v173, a141
 v_accvgpr_read_b32 v174, a142
 v_accvgpr_read_b32 v175, a143
 v_cvt_pk_bf16_f32 v161, v160, v161
 v_lshlrev_b32 v160, 16, v161
 v_and_b32 v161, 0xffff0000, v161
 v_cvt_pk_bf16_f32 v163, v162, v163
 v_lshlrev_b32 v162, 16, v163
 v_and_b32 v163, 0xffff0000, v163
 v_cvt_pk_bf16_f32 v165, v164, v165
 v_lshlrev_b32 v164, 16, v165
 v_and_b32 v165, 0xffff0000, v165
 v_cvt_pk_bf16_f32 v167, v166, v167
 v_lshlrev_b32 v166, 16, v167
 v_and_b32 v167, 0xffff0000, v167
 v_cvt_pk_bf16_f32 v169, v168, v169
 v_lshlrev_b32 v168, 16, v169
 v_and_b32 v169, 0xffff0000, v169
 v_cvt_pk_bf16_f32 v171, v170, v171
 v_lshlrev_b32 v170, 16, v171
 v_and_b32 v171, 0xffff0000, v171
 v_cvt_pk_bf16_f32 v173, v172, v173
 v_lshlrev_b32 v172, 16, v173
 v_and_b32 v173, 0xffff0000, v173
 v_cvt_pk_bf16_f32 v175, v174, v175
 v_lshlrev_b32 v174, 16, v175
 v_and_b32 v175, 0xffff0000, v175
 v_mul_f32 v224, v160, v160
 v_mul_f32 v225, v161, v161
 v_mul_f32 v226, v162, v162
 v_mul_f32 v227, v163, v163
 v_mul_f32 v228, v164, v164
 v_mul_f32 v229, v165, v165
 v_mul_f32 v230, v166, v166
 v_mul_f32 v231, v167, v167
 v_mul_f32 v232, v168, v168
 v_mul_f32 v233, v169, v169
 v_mul_f32 v234, v170, v170
 v_mul_f32 v235, v171, v171
 v_mul_f32 v236, v172, v172
 v_mul_f32 v237, v173, v173
 v_mul_f32 v238, v174, v174
 v_mul_f32 v239, v175, v175
 v_fma_f32 v224, v224, s45, v16
 v_fma_f32 v225, v225, s45, v16
 v_fma_f32 v226, v226, s45, v16
 v_fma_f32 v227, v227, s45, v16
 v_fma_f32 v228, v228, s45, v16
 v_fma_f32 v229, v229, s45, v16
 v_fma_f32 v230, v230, s45, v16
 v_fma_f32 v231, v231, s45, v16
 v_fma_f32 v232, v232, s45, v16
 v_fma_f32 v233, v233, s45, v16
 v_fma_f32 v234, v234, s45, v16
 v_fma_f32 v235, v235, s45, v16
 v_fma_f32 v236, v236, s45, v16
 v_fma_f32 v237, v237, s45, v16
 v_fma_f32 v238, v238, s45, v16
 v_fma_f32 v239, v239, s45, v16
 v_mul_f32 v224, v224, v160
 v_mul_f32 v225, v225, v161
 v_mul_f32 v226, v226, v162
 v_mul_f32 v227, v227, v163
 v_mul_f32 v228, v228, v164
 v_mul_f32 v229, v229, v165
 v_mul_f32 v230, v230, v166
 v_mul_f32 v231, v231, v167
 v_mul_f32 v232, v232, v168
 v_mul_f32 v233, v233, v169
 v_mul_f32 v234, v234, v170
 v_mul_f32 v235, v235, v171
 v_mul_f32 v236, v236, v172
 v_mul_f32 v237, v237, v173
 v_mul_f32 v238, v238, v174
 v_mul_f32 v239, v239, v175
 v_exp_f32 v224, v224
 v_exp_f32 v225, v225
 v_exp_f32 v226, v226
 v_exp_f32 v227, v227
 v_exp_f32 v228, v228
 v_exp_f32 v229, v229
 v_exp_f32 v230, v230
 v_exp_f32 v231, v231
 v_exp_f32 v232, v232
 v_exp_f32 v233, v233
 v_exp_f32 v234, v234
 v_exp_f32 v235, v235
 v_exp_f32 v236, v236
 v_exp_f32 v237, v237
 v_exp_f32 v238, v238
 v_exp_f32 v239, v239
 v_add_f32 v224, 1.0, v224
 v_add_f32 v225, 1.0, v225
 v_add_f32 v226, 1.0, v226
 v_add_f32 v227, 1.0, v227
 v_add_f32 v228, 1.0, v228
 v_add_f32 v229, 1.0, v229
 v_add_f32 v230, 1.0, v230
 v_add_f32 v231, 1.0, v231
 v_add_f32 v232, 1.0, v232
 v_add_f32 v233, 1.0, v233
 v_add_f32 v234, 1.0, v234
 v_add_f32 v235, 1.0, v235
 v_add_f32 v236, 1.0, v236
 v_add_f32 v237, 1.0, v237
 v_add_f32 v238, 1.0, v238
 v_add_f32 v239, 1.0, v239
 v_rcp_f32 v224, v224
 v_rcp_f32 v225, v225
 v_rcp_f32 v226, v226
 v_rcp_f32 v227, v227
 v_rcp_f32 v228, v228
 v_rcp_f32 v229, v229
 v_rcp_f32 v230, v230
 v_rcp_f32 v231, v231
 v_rcp_f32 v232, v232
 v_rcp_f32 v233, v233
 v_rcp_f32 v234, v234
 v_rcp_f32 v235, v235
 v_rcp_f32 v236, v236
 v_rcp_f32 v237, v237
 v_rcp_f32 v238, v238
 v_rcp_f32 v239, v239
 v_mul_f32 v160, v160, v224
 v_mul_f32 v161, v161, v225
 v_mul_f32 v162, v162, v226
 v_mul_f32 v163, v163, v227
 v_mul_f32 v164, v164, v228
 v_mul_f32 v165, v165, v229
 v_mul_f32 v166, v166, v230
 v_mul_f32 v167, v167, v231
 v_mul_f32 v168, v168, v232
 v_mul_f32 v169, v169, v233
 v_mul_f32 v170, v170, v234
 v_mul_f32 v171, v171, v235
 v_mul_f32 v172, v172, v236
 v_mul_f32 v173, v173, v237
 v_mul_f32 v174, v174, v238
 v_mul_f32 v175, v175, v239
 v_cvt_pk_bf16_f32 v176, v160, v161
 v_cndmask_b32 v176, 0, v176, s[76:77]
 v_cvt_pk_bf16_f32 v177, v162, v163
 v_cndmask_b32 v177, 0, v177, s[76:77]
 v_cvt_pk_bf16_f32 v178, v164, v165
 v_cndmask_b32 v178, 0, v178, s[76:77]
 v_cvt_pk_bf16_f32 v179, v166, v167
 v_cndmask_b32 v179, 0, v179, s[76:77]
 v_cvt_pk_bf16_f32 v180, v168, v169
 v_cndmask_b32 v180, 0, v180, s[76:77]
 v_cvt_pk_bf16_f32 v181, v170, v171
 v_cndmask_b32 v181, 0, v181, s[76:77]
 v_cvt_pk_bf16_f32 v182, v172, v173
 v_cndmask_b32 v182, 0, v182, s[76:77]
 v_cvt_pk_bf16_f32 v183, v174, v175
 v_cndmask_b32 v183, 0, v183, s[76:77]
 s_mov_b32 exec_lo, 0xff
 s_mov_b32 exec_hi, 0xff
 ds_write_b128 v23, v[176:179] offset:10240
 ds_write_b128 v23, v[180:183] offset:12544
 s_mov_b64 exec, -1
 v_accvgpr_read_b32 v160, a144
 v_accvgpr_read_b32 v161, a145
 v_accvgpr_read_b32 v162, a146
 v_accvgpr_read_b32 v163, a147
 v_accvgpr_read_b32 v164, a148
 v_accvgpr_read_b32 v165, a149
 v_accvgpr_read_b32 v166, a150
 v_accvgpr_read_b32 v167, a151
 v_accvgpr_read_b32 v168, a152
 v_accvgpr_read_b32 v169, a153
 v_accvgpr_read_b32 v170, a154
 v_accvgpr_read_b32 v171, a155
 v_accvgpr_read_b32 v172, a156
 v_accvgpr_read_b32 v173, a157
 v_accvgpr_read_b32 v174, a158
 v_accvgpr_read_b32 v175, a159
 v_cvt_pk_bf16_f32 v161, v160, v161
 v_lshlrev_b32 v160, 16, v161
 v_and_b32 v161, 0xffff0000, v161
 v_cvt_pk_bf16_f32 v163, v162, v163
 v_lshlrev_b32 v162, 16, v163
 v_and_b32 v163, 0xffff0000, v163
 v_cvt_pk_bf16_f32 v165, v164, v165
 v_lshlrev_b32 v164, 16, v165
 v_and_b32 v165, 0xffff0000, v165
 v_cvt_pk_bf16_f32 v167, v166, v167
 v_lshlrev_b32 v166, 16, v167
 v_and_b32 v167, 0xffff0000, v167
 v_cvt_pk_bf16_f32 v169, v168, v169
 v_lshlrev_b32 v168, 16, v169
 v_and_b32 v169, 0xffff0000, v169
 v_cvt_pk_bf16_f32 v171, v170, v171
 v_lshlrev_b32 v170, 16, v171
 v_and_b32 v171, 0xffff0000, v171
 v_cvt_pk_bf16_f32 v173, v172, v173
 v_lshlrev_b32 v172, 16, v173
 v_and_b32 v173, 0xffff0000, v173
 v_cvt_pk_bf16_f32 v175, v174, v175
 v_lshlrev_b32 v174, 16, v175
 v_and_b32 v175, 0xffff0000, v175
 v_mul_f32 v224, v160, v160
 v_mul_f32 v225, v161, v161
 v_mul_f32 v226, v162, v162
 v_mul_f32 v227, v163, v163
 v_mul_f32 v228, v164, v164
 v_mul_f32 v229, v165, v165
 v_mul_f32 v230, v166, v166
 v_mul_f32 v231, v167, v167
 v_mul_f32 v232, v168, v168
 v_mul_f32 v233, v169, v169
 v_mul_f32 v234, v170, v170
 v_mul_f32 v235, v171, v171
 v_mul_f32 v236, v172, v172
 v_mul_f32 v237, v173, v173
 v_mul_f32 v238, v174, v174
 v_mul_f32 v239, v175, v175
 v_fma_f32 v224, v224, s45, v16
 v_fma_f32 v225, v225, s45, v16
 v_fma_f32 v226, v226, s45, v16
 v_fma_f32 v227, v227, s45, v16
 v_fma_f32 v228, v228, s45, v16
 v_fma_f32 v229, v229, s45, v16
 v_fma_f32 v230, v230, s45, v16
 v_fma_f32 v231, v231, s45, v16
 v_fma_f32 v232, v232, s45, v16
 v_fma_f32 v233, v233, s45, v16
 v_fma_f32 v234, v234, s45, v16
 v_fma_f32 v235, v235, s45, v16
 v_fma_f32 v236, v236, s45, v16
 v_fma_f32 v237, v237, s45, v16
 v_fma_f32 v238, v238, s45, v16
 v_fma_f32 v239, v239, s45, v16
 v_mul_f32 v224, v224, v160
 v_mul_f32 v225, v225, v161
 v_mul_f32 v226, v226, v162
 v_mul_f32 v227, v227, v163
 v_mul_f32 v228, v228, v164
 v_mul_f32 v229, v229, v165
 v_mul_f32 v230, v230, v166
 v_mul_f32 v231, v231, v167
 v_mul_f32 v232, v232, v168
 v_mul_f32 v233, v233, v169
 v_mul_f32 v234, v234, v170
 v_mul_f32 v235, v235, v171
 v_mul_f32 v236, v236, v172
 v_mul_f32 v237, v237, v173
 v_mul_f32 v238, v238, v174
 v_mul_f32 v239, v239, v175
 v_exp_f32 v224, v224
 v_exp_f32 v225, v225
 v_exp_f32 v226, v226
 v_exp_f32 v227, v227
 v_exp_f32 v228, v228
 v_exp_f32 v229, v229
 v_exp_f32 v230, v230
 v_exp_f32 v231, v231
 v_exp_f32 v232, v232
 v_exp_f32 v233, v233
 v_exp_f32 v234, v234
 v_exp_f32 v235, v235
 v_exp_f32 v236, v236
 v_exp_f32 v237, v237
 v_exp_f32 v238, v238
 v_exp_f32 v239, v239
 v_add_f32 v224, 1.0, v224
 v_add_f32 v225, 1.0, v225
 v_add_f32 v226, 1.0, v226
 v_add_f32 v227, 1.0, v227
 v_add_f32 v228, 1.0, v228
 v_add_f32 v229, 1.0, v229
 v_add_f32 v230, 1.0, v230
 v_add_f32 v231, 1.0, v231
 v_add_f32 v232, 1.0, v232
 v_add_f32 v233, 1.0, v233
 v_add_f32 v234, 1.0, v234
 v_add_f32 v235, 1.0, v235
 v_add_f32 v236, 1.0, v236
 v_add_f32 v237, 1.0, v237
 v_add_f32 v238, 1.0, v238
 v_add_f32 v239, 1.0, v239
 v_rcp_f32 v224, v224
 v_rcp_f32 v225, v225
 v_rcp_f32 v226, v226
 v_rcp_f32 v227, v227
 v_rcp_f32 v228, v228
 v_rcp_f32 v229, v229
 v_rcp_f32 v230, v230
 v_rcp_f32 v231, v231
 v_rcp_f32 v232, v232
 v_rcp_f32 v233, v233
 v_rcp_f32 v234, v234
 v_rcp_f32 v235, v235
 v_rcp_f32 v236, v236
 v_rcp_f32 v237, v237
 v_rcp_f32 v238, v238
 v_rcp_f32 v239, v239
 v_mul_f32 v160, v160, v224
 v_mul_f32 v161, v161, v225
 v_mul_f32 v162, v162, v226
 v_mul_f32 v163, v163, v227
 v_mul_f32 v164, v164, v228
 v_mul_f32 v165, v165, v229
 v_mul_f32 v166, v166, v230
 v_mul_f32 v167, v167, v231
 v_mul_f32 v168, v168, v232
 v_mul_f32 v169, v169, v233
 v_mul_f32 v170, v170, v234
 v_mul_f32 v171, v171, v235
 v_mul_f32 v172, v172, v236
 v_mul_f32 v173, v173, v237
 v_mul_f32 v174, v174, v238
 v_mul_f32 v175, v175, v239
 v_cvt_pk_bf16_f32 v176, v160, v161
 v_cndmask_b32 v176, 0, v176, s[74:75]
 v_cvt_pk_bf16_f32 v177, v162, v163
 v_cndmask_b32 v177, 0, v177, s[74:75]
 v_cvt_pk_bf16_f32 v178, v164, v165
 v_cndmask_b32 v178, 0, v178, s[74:75]
 v_cvt_pk_bf16_f32 v179, v166, v167
 v_cndmask_b32 v179, 0, v179, s[74:75]
 v_cvt_pk_bf16_f32 v180, v168, v169
 v_cndmask_b32 v180, 0, v180, s[74:75]
 v_cvt_pk_bf16_f32 v181, v170, v171
 v_cndmask_b32 v181, 0, v181, s[74:75]
 v_cvt_pk_bf16_f32 v182, v172, v173
 v_cndmask_b32 v182, 0, v182, s[74:75]
 v_cvt_pk_bf16_f32 v183, v174, v175
 v_cndmask_b32 v183, 0, v183, s[74:75]
 ds_write_b128 v23, v[176:179] offset:13824
 ds_write_b128 v23, v[180:183] offset:16128
 v_accvgpr_read_b32 v160, a160
 v_accvgpr_read_b32 v161, a161
 v_accvgpr_read_b32 v162, a162
 v_accvgpr_read_b32 v163, a163
 v_accvgpr_read_b32 v164, a164
 v_accvgpr_read_b32 v165, a165
 v_accvgpr_read_b32 v166, a166
 v_accvgpr_read_b32 v167, a167
 v_accvgpr_read_b32 v168, a168
 v_accvgpr_read_b32 v169, a169
 v_accvgpr_read_b32 v170, a170
 v_accvgpr_read_b32 v171, a171
 v_accvgpr_read_b32 v172, a172
 v_accvgpr_read_b32 v173, a173
 v_accvgpr_read_b32 v174, a174
 v_accvgpr_read_b32 v175, a175
 v_cvt_pk_bf16_f32 v161, v160, v161
 v_lshlrev_b32 v160, 16, v161
 v_and_b32 v161, 0xffff0000, v161
 v_cvt_pk_bf16_f32 v163, v162, v163
 v_lshlrev_b32 v162, 16, v163
 v_and_b32 v163, 0xffff0000, v163
 v_cvt_pk_bf16_f32 v165, v164, v165
 v_lshlrev_b32 v164, 16, v165
 v_and_b32 v165, 0xffff0000, v165
 v_cvt_pk_bf16_f32 v167, v166, v167
 v_lshlrev_b32 v166, 16, v167
 v_and_b32 v167, 0xffff0000, v167
 v_cvt_pk_bf16_f32 v169, v168, v169
 v_lshlrev_b32 v168, 16, v169
 v_and_b32 v169, 0xffff0000, v169
 v_cvt_pk_bf16_f32 v171, v170, v171
 v_lshlrev_b32 v170, 16, v171
 v_and_b32 v171, 0xffff0000, v171
 v_cvt_pk_bf16_f32 v173, v172, v173
 v_lshlrev_b32 v172, 16, v173
 v_and_b32 v173, 0xffff0000, v173
 v_cvt_pk_bf16_f32 v175, v174, v175
 v_lshlrev_b32 v174, 16, v175
 v_and_b32 v175, 0xffff0000, v175
 v_mul_f32 v224, v160, v160
 v_mul_f32 v225, v161, v161
 v_mul_f32 v226, v162, v162
 v_mul_f32 v227, v163, v163
 v_mul_f32 v228, v164, v164
 v_mul_f32 v229, v165, v165
 v_mul_f32 v230, v166, v166
 v_mul_f32 v231, v167, v167
 v_mul_f32 v232, v168, v168
 v_mul_f32 v233, v169, v169
 v_mul_f32 v234, v170, v170
 v_mul_f32 v235, v171, v171
 v_mul_f32 v236, v172, v172
 v_mul_f32 v237, v173, v173
 v_mul_f32 v238, v174, v174
 v_mul_f32 v239, v175, v175
 v_fma_f32 v224, v224, s45, v16
 v_fma_f32 v225, v225, s45, v16
 v_fma_f32 v226, v226, s45, v16
 v_fma_f32 v227, v227, s45, v16
 v_fma_f32 v228, v228, s45, v16
 v_fma_f32 v229, v229, s45, v16
 v_fma_f32 v230, v230, s45, v16
 v_fma_f32 v231, v231, s45, v16
 v_fma_f32 v232, v232, s45, v16
 v_fma_f32 v233, v233, s45, v16
 v_fma_f32 v234, v234, s45, v16
 v_fma_f32 v235, v235, s45, v16
 v_fma_f32 v236, v236, s45, v16
 v_fma_f32 v237, v237, s45, v16
 v_fma_f32 v238, v238, s45, v16
 v_fma_f32 v239, v239, s45, v16
 v_mul_f32 v224, v224, v160
 v_mul_f32 v225, v225, v161
 v_mul_f32 v226, v226, v162
 v_mul_f32 v227, v227, v163
 v_mul_f32 v228, v228, v164
 v_mul_f32 v229, v229, v165
 v_mul_f32 v230, v230, v166
 v_mul_f32 v231, v231, v167
 v_mul_f32 v232, v232, v168
 v_mul_f32 v233, v233, v169
 v_mul_f32 v234, v234, v170
 v_mul_f32 v235, v235, v171
 v_mul_f32 v236, v236, v172
 v_mul_f32 v237, v237, v173
 v_mul_f32 v238, v238, v174
 v_mul_f32 v239, v239, v175
 v_exp_f32 v224, v224
 v_exp_f32 v225, v225
 v_exp_f32 v226, v226
 v_exp_f32 v227, v227
 v_exp_f32 v228, v228
 v_exp_f32 v229, v229
 v_exp_f32 v230, v230
 v_exp_f32 v231, v231
 v_exp_f32 v232, v232
 v_exp_f32 v233, v233
 v_exp_f32 v234, v234
 v_exp_f32 v235, v235
 v_exp_f32 v236, v236
 v_exp_f32 v237, v237
 v_exp_f32 v238, v238
 v_exp_f32 v239, v239
 v_add_f32 v224, 1.0, v224
 v_add_f32 v225, 1.0, v225
 v_add_f32 v226, 1.0, v226
 v_add_f32 v227, 1.0, v227
 v_add_f32 v228, 1.0, v228
 v_add_f32 v229, 1.0, v229
 v_add_f32 v230, 1.0, v230
 v_add_f32 v231, 1.0, v231
 v_add_f32 v232, 1.0, v232
 v_add_f32 v233, 1.0, v233
 v_add_f32 v234, 1.0, v234
 v_add_f32 v235, 1.0, v235
 v_add_f32 v236, 1.0, v236
 v_add_f32 v237, 1.0, v237
 v_add_f32 v238, 1.0, v238
 v_add_f32 v239, 1.0, v239
 v_rcp_f32 v224, v224
 v_rcp_f32 v225, v225
 v_rcp_f32 v226, v226
 v_rcp_f32 v227, v227
 v_rcp_f32 v228, v228
 v_rcp_f32 v229, v229
 v_rcp_f32 v230, v230
 v_rcp_f32 v231, v231
 v_rcp_f32 v232, v232
 v_rcp_f32 v233, v233
 v_rcp_f32 v234, v234
 v_rcp_f32 v235, v235
 v_rcp_f32 v236, v236
 v_rcp_f32 v237, v237
 v_rcp_f32 v238, v238
 v_rcp_f32 v239, v239
 v_mul_f32 v160, v160, v224
 v_mul_f32 v161, v161, v225
 v_mul_f32 v162, v162, v226
 v_mul_f32 v163, v163, v227
 v_mul_f32 v164, v164, v228
 v_mul_f32 v165, v165, v229
 v_mul_f32 v166, v166, v230
 v_mul_f32 v167, v167, v231
 v_mul_f32 v168, v168, v232
 v_mul_f32 v169, v169, v233
 v_mul_f32 v170, v170, v234
 v_mul_f32 v171, v171, v235
 v_mul_f32 v172, v172, v236
 v_mul_f32 v173, v173, v237
 v_mul_f32 v174, v174, v238
 v_mul_f32 v175, v175, v239
 v_cvt_pk_bf16_f32 v176, v160, v161
 v_cvt_pk_bf16_f32 v177, v162, v163
 v_cvt_pk_bf16_f32 v178, v164, v165
 v_cvt_pk_bf16_f32 v179, v166, v167
 v_cvt_pk_bf16_f32 v180, v168, v169
 v_cvt_pk_bf16_f32 v181, v170, v171
 v_cvt_pk_bf16_f32 v182, v172, v173
 v_cvt_pk_bf16_f32 v183, v174, v175
 ds_write_b128 v23, v[176:179] offset:14336
 ds_write_b128 v23, v[180:183] offset:16640
 v_accvgpr_read_b32 v160, a176
 v_accvgpr_read_b32 v161, a177
 v_accvgpr_read_b32 v162, a178
 v_accvgpr_read_b32 v163, a179
 v_accvgpr_read_b32 v164, a180
 v_accvgpr_read_b32 v165, a181
 v_accvgpr_read_b32 v166, a182
 v_accvgpr_read_b32 v167, a183
 v_accvgpr_read_b32 v168, a184
 v_accvgpr_read_b32 v169, a185
 v_accvgpr_read_b32 v170, a186
 v_accvgpr_read_b32 v171, a187
 v_accvgpr_read_b32 v172, a188
 v_accvgpr_read_b32 v173, a189
 v_accvgpr_read_b32 v174, a190
 v_accvgpr_read_b32 v175, a191
 v_cvt_pk_bf16_f32 v161, v160, v161
 v_lshlrev_b32 v160, 16, v161
 v_and_b32 v161, 0xffff0000, v161
 v_cvt_pk_bf16_f32 v163, v162, v163
 v_lshlrev_b32 v162, 16, v163
 v_and_b32 v163, 0xffff0000, v163
 v_cvt_pk_bf16_f32 v165, v164, v165
 v_lshlrev_b32 v164, 16, v165
 v_and_b32 v165, 0xffff0000, v165
 v_cvt_pk_bf16_f32 v167, v166, v167
 v_lshlrev_b32 v166, 16, v167
 v_and_b32 v167, 0xffff0000, v167
 v_cvt_pk_bf16_f32 v169, v168, v169
 v_lshlrev_b32 v168, 16, v169
 v_and_b32 v169, 0xffff0000, v169
 v_cvt_pk_bf16_f32 v171, v170, v171
 v_lshlrev_b32 v170, 16, v171
 v_and_b32 v171, 0xffff0000, v171
 v_cvt_pk_bf16_f32 v173, v172, v173
 v_lshlrev_b32 v172, 16, v173
 v_and_b32 v173, 0xffff0000, v173
 v_cvt_pk_bf16_f32 v175, v174, v175
 v_lshlrev_b32 v174, 16, v175
 v_and_b32 v175, 0xffff0000, v175
 v_mul_f32 v224, v160, v160
 v_mul_f32 v225, v161, v161
 v_mul_f32 v226, v162, v162
 v_mul_f32 v227, v163, v163
 v_mul_f32 v228, v164, v164
 v_mul_f32 v229, v165, v165
 v_mul_f32 v230, v166, v166
 v_mul_f32 v231, v167, v167
 v_mul_f32 v232, v168, v168
 v_mul_f32 v233, v169, v169
 v_mul_f32 v234, v170, v170
 v_mul_f32 v235, v171, v171
 v_mul_f32 v236, v172, v172
 v_mul_f32 v237, v173, v173
 v_mul_f32 v238, v174, v174
 v_mul_f32 v239, v175, v175
 v_fma_f32 v224, v224, s45, v16
 v_fma_f32 v225, v225, s45, v16
 v_fma_f32 v226, v226, s45, v16
 v_fma_f32 v227, v227, s45, v16
 v_fma_f32 v228, v228, s45, v16
 v_fma_f32 v229, v229, s45, v16
 v_fma_f32 v230, v230, s45, v16
 v_fma_f32 v231, v231, s45, v16
 v_fma_f32 v232, v232, s45, v16
 v_fma_f32 v233, v233, s45, v16
 v_fma_f32 v234, v234, s45, v16
 v_fma_f32 v235, v235, s45, v16
 v_fma_f32 v236, v236, s45, v16
 v_fma_f32 v237, v237, s45, v16
 v_fma_f32 v238, v238, s45, v16
 v_fma_f32 v239, v239, s45, v16
 v_mul_f32 v224, v224, v160
 v_mul_f32 v225, v225, v161
 v_mul_f32 v226, v226, v162
 v_mul_f32 v227, v227, v163
 v_mul_f32 v228, v228, v164
 v_mul_f32 v229, v229, v165
 v_mul_f32 v230, v230, v166
 v_mul_f32 v231, v231, v167
 v_mul_f32 v232, v232, v168
 v_mul_f32 v233, v233, v169
 v_mul_f32 v234, v234, v170
 v_mul_f32 v235, v235, v171
 v_mul_f32 v236, v236, v172
 v_mul_f32 v237, v237, v173
 v_mul_f32 v238, v238, v174
 v_mul_f32 v239, v239, v175
 v_exp_f32 v224, v224
 v_exp_f32 v225, v225
 v_exp_f32 v226, v226
 v_exp_f32 v227, v227
 v_exp_f32 v228, v228
 v_exp_f32 v229, v229
 v_exp_f32 v230, v230
 v_exp_f32 v231, v231
 v_exp_f32 v232, v232
 v_exp_f32 v233, v233
 v_exp_f32 v234, v234
 v_exp_f32 v235, v235
 v_exp_f32 v236, v236
 v_exp_f32 v237, v237
 v_exp_f32 v238, v238
 v_exp_f32 v239, v239
 v_add_f32 v224, 1.0, v224
 v_add_f32 v225, 1.0, v225
 v_add_f32 v226, 1.0, v226
 v_add_f32 v227, 1.0, v227
 v_add_f32 v228, 1.0, v228
 v_add_f32 v229, 1.0, v229
 v_add_f32 v230, 1.0, v230
 v_add_f32 v231, 1.0, v231
 v_add_f32 v232, 1.0, v232
 v_add_f32 v233, 1.0, v233
 v_add_f32 v234, 1.0, v234
 v_add_f32 v235, 1.0, v235
 v_add_f32 v236, 1.0, v236
 v_add_f32 v237, 1.0, v237
 v_add_f32 v238, 1.0, v238
 v_add_f32 v239, 1.0, v239
 v_rcp_f32 v224, v224
 v_rcp_f32 v225, v225
 v_rcp_f32 v226, v226
 v_rcp_f32 v227, v227
 v_rcp_f32 v228, v228
 v_rcp_f32 v229, v229
 v_rcp_f32 v230, v230
 v_rcp_f32 v231, v231
 v_rcp_f32 v232, v232
 v_rcp_f32 v233, v233
 v_rcp_f32 v234, v234
 v_rcp_f32 v235, v235
 v_rcp_f32 v236, v236
 v_rcp_f32 v237, v237
 v_rcp_f32 v238, v238
 v_rcp_f32 v239, v239
 v_mul_f32 v160, v160, v224
 v_mul_f32 v161, v161, v225
 v_mul_f32 v162, v162, v226
 v_mul_f32 v163, v163, v227
 v_mul_f32 v164, v164, v228
 v_mul_f32 v165, v165, v229
 v_mul_f32 v166, v166, v230
 v_mul_f32 v167, v167, v231
 v_mul_f32 v168, v168, v232
 v_mul_f32 v169, v169, v233
 v_mul_f32 v170, v170, v234
 v_mul_f32 v171, v171, v235
 v_mul_f32 v172, v172, v236
 v_mul_f32 v173, v173, v237
 v_mul_f32 v174, v174, v238
 v_mul_f32 v175, v175, v239
 v_cvt_pk_bf16_f32 v176, v160, v161
 v_cndmask_b32 v176, 0, v176, s[76:77]
 v_cvt_pk_bf16_f32 v177, v162, v163
 v_cndmask_b32 v177, 0, v177, s[76:77]
 v_cvt_pk_bf16_f32 v178, v164, v165
 v_cndmask_b32 v178, 0, v178, s[76:77]
 v_cvt_pk_bf16_f32 v179, v166, v167
 v_cndmask_b32 v179, 0, v179, s[76:77]
 v_cvt_pk_bf16_f32 v180, v168, v169
 v_cndmask_b32 v180, 0, v180, s[76:77]
 v_cvt_pk_bf16_f32 v181, v170, v171
 v_cndmask_b32 v181, 0, v181, s[76:77]
 v_cvt_pk_bf16_f32 v182, v172, v173
 v_cndmask_b32 v182, 0, v182, s[76:77]
 v_cvt_pk_bf16_f32 v183, v174, v175
 v_cndmask_b32 v183, 0, v183, s[76:77]
 s_mov_b32 exec_lo, 0xff
 s_mov_b32 exec_hi, 0xff
 ds_write_b128 v23, v[176:179] offset:14848
 ds_write_b128 v23, v[180:183] offset:17152
 s_mov_b64 exec, -1
 s_lshl_b32 s3, s41, 16
 s_lshl_b32 s34, s47, 13
 s_add_u32 s3, s3, s34
 s_add_u32 s44, s3, 83886080
 s_add_u32 s3, s3, 14680064
 s_add_u32 s34, s3, 0
 buffer_load_dwordx4 v[96:99], v2, s[36:39], s34 offen offset:0 sc1
 buffer_load_dwordx4 v[100:103], v2, s[36:39], s34 offen offset:1024 sc1
 s_add_u32 s34, s3, 32768
 buffer_load_dwordx4 v[104:107], v2, s[36:39], s34 offen offset:0 sc1
 buffer_load_dwordx4 v[108:111], v2, s[36:39], s34 offen offset:1024 sc1
 s_add_u32 s34, s3, 2048
 buffer_load_dwordx4 v[112:115], v2, s[36:39], s34 offen offset:0 sc1
 buffer_load_dwordx4 v[116:119], v2, s[36:39], s34 offen offset:1024 sc1
 s_add_u32 s34, s3, 34816
 buffer_load_dwordx4 v[120:123], v2, s[36:39], s34 offen offset:0 sc1
 buffer_load_dwordx4 v[124:127], v2, s[36:39], s34 offen offset:1024 sc1
 s_add_u32 s34, s3, 4096
 buffer_load_dwordx4 v[128:131], v2, s[36:39], s34 offen offset:0 sc1
 buffer_load_dwordx4 v[132:135], v2, s[36:39], s34 offen offset:1024 sc1
 s_add_u32 s34, s3, 36864
 buffer_load_dwordx4 v[136:139], v2, s[36:39], s34 offen offset:0 sc1
 buffer_load_dwordx4 v[140:143], v2, s[36:39], s34 offen offset:1024 sc1
 s_add_u32 s34, s3, 6144
 buffer_load_dwordx4 v[144:147], v2, s[36:39], s34 offen offset:0 sc1
 buffer_load_dwordx4 v[148:151], v2, s[36:39], s34 offen offset:1024 sc1
 s_add_u32 s34, s3, 38912
 buffer_load_dwordx4 v[152:155], v2, s[36:39], s34 offen offset:0 sc1
 buffer_load_dwordx4 v[156:159], v2, s[36:39], s34 offen offset:1024 sc1
 s_waitcnt lgkmcnt(0) vmcnt(0)
 s_barrier
 s_and_b32 s48, s41, 7
 s_mul_i32 s3, s48, 9216
 s_lshr_b32 s34, s48, 1
 s_lshl_b32 s34, s34, 3
 s_lshr_b32 s34, 0x40003010, s34
 s_and_b32 s34, s34, 0xff
 s_add_u32 s3, s3, s34
 v_add_u32 v15, s3, v11
 s_waitcnt vmcnt(12)
 ds_read_b128 v[64:67], v15 offset:0
 ds_read_b128 v[68:71], v15 offset:512
 ds_read_b64_tr_b16 v[32:33], v5 offset:0
 ds_read_b64_tr_b16 v[34:35], v5 offset:2048
 ds_read_b64_tr_b16 v[36:37], v6 offset:0
 ds_read_b64_tr_b16 v[38:39], v6 offset:2048
 ds_read_b64_tr_b16 v[40:41], v7 offset:0
 ds_read_b64_tr_b16 v[42:43], v7 offset:2048
 ds_read_b64_tr_b16 v[44:45], v8 offset:0
 ds_read_b64_tr_b16 v[46:47], v8 offset:2048
 s_add_u32 s49, s48, 1
 s_and_b32 s49, s49, 7
 s_mul_i32 s64, s49, 65536
 s_lshl_b32 s3, s47, 8
 s_add_u32 s64, s64, s3
 s_mul_i32 s3, s49, 9216
 s_lshr_b32 s34, s49, 1
 s_lshl_b32 s34, s34, 3
 s_lshr_b32 s34, 0x40003010, s34
 s_and_b32 s34, s34, 0xff
 s_add_u32 s3, s3, s34
 v_add_u32 v17, s3, v11
 s_waitcnt lgkmcnt(6)
 v_mfma_f32_32x32x16_bf16 a[0:15], v[32:35], v[64:67], 0
 s_waitcnt vmcnt(8)
 ds_read_b128 v[80:83], v15 offset:2304
 v_mfma_f32_32x32x16_bf16 a[16:31], v[32:35], v[68:71], 0
 ds_read_b128 v[84:87], v15 offset:2816
 ds_read_b64_tr_b16 v[48:49], v5 offset:4096
 s_waitcnt lgkmcnt(7)
 v_mfma_f32_32x32x16_bf16 a[32:47], v[36:39], v[64:67], 0
 ds_read_b64_tr_b16 v[50:51], v5 offset:6144
 ds_read_b64_tr_b16 v[52:53], v6 offset:4096
 v_mfma_f32_32x32x16_bf16 a[48:63], v[36:39], v[68:71], 0
 ds_read_b64_tr_b16 v[54:55], v6 offset:6144
 ds_read_b64_tr_b16 v[56:57], v7 offset:4096
 s_waitcnt lgkmcnt(9)
 v_mfma_f32_32x32x16_bf16 a[64:79], v[40:43], v[64:67], 0
 ds_read_b64_tr_b16 v[58:59], v7 offset:6144
 ds_read_b64_tr_b16 v[60:61], v8 offset:4096
 s_waitcnt lgkmcnt(9)
 s_add_u32 m0, s66, 0
 s_nop 0
 buffer_load_dwordx4 v3, s[56:59], s64 offen lds
 s_add_u32 s64, s64, 4096
 v_mfma_f32_32x32x16_bf16 a[80:95], v[40:43], v[68:71], 0
 ds_read_b64_tr_b16 v[62:63], v8 offset:6144
 s_add_u32 m0, s66, 1024
 s_nop 0
 buffer_load_dwordx4 v3, s[56:59], s64 offen lds
 s_add_u32 s64, s64, 4096
 v_mfma_f32_32x32x16_bf16 a[96:111], v[44:47], v[64:67], 0
 s_add_u32 m0, s66, 2048
 s_nop 0
 buffer_load_dwordx4 v3, s[56:59], s64 offen lds
 s_add_u32 s64, s64, 4096
 v_mfma_f32_32x32x16_bf16 a[112:127], v[44:47], v[68:71], 0
 s_add_u32 m0, s66, 3072
 s_nop 0
 buffer_load_dwordx4 v3, s[56:59], s64 offen lds
 s_add_u32 s64, s64, 4096
 s_waitcnt lgkmcnt(6)
 v_mfma_f32_32x32x16_bf16 a[0:15], v[48:51], v[80:83], a[0:15]
 s_waitcnt vmcnt(8)
 ds_read_b128 v[64:67], v15 offset:4608
 v_mfma_f32_32x32x16_bf16 a[16:31], v[48:51], v[84:87], a[16:31]
 ds_read_b128 v[68:71], v15 offset:5120
 ds_read_b64_tr_b16 v[32:33], v5 offset:8192
 s_waitcnt lgkmcnt(7)
 v_mfma_f32_32x32x16_bf16 a[32:47], v[52:55], v[80:83], a[32:47]
 ds_read_b64_tr_b16 v[34:35], v5 offset:10240
 ds_read_b64_tr_b16 v[36:37], v6 offset:8192
 v_mfma_f32_32x32x16_bf16 a[48:63], v[52:55], v[84:87], a[48:63]
 ds_read_b64_tr_b16 v[38:39], v6 offset:10240
 ds_read_b64_tr_b16 v[40:41], v7 offset:8192
 s_waitcnt lgkmcnt(9)
 v_mfma_f32_32x32x16_bf16 a[64:79], v[56:59], v[80:83], a[64:79]
 ds_read_b64_tr_b16 v[42:43], v7 offset:10240
 ds_read_b64_tr_b16 v[44:45], v8 offset:8192
 s_waitcnt lgkmcnt(9)
 s_add_u32 m0, s66, 4096
 s_nop 0
 buffer_load_dwordx4 v3, s[56:59], s64 offen lds
 s_add_u32 s64, s64, 4096
 v_mfma_f32_32x32x16_bf16 a[80:95], v[56:59], v[84:87], a[80:95]
 ds_read_b64_tr_b16 v[46:47], v8 offset:10240
 s_add_u32 m0, s66, 5120
 s_nop 0
 buffer_load_dwordx4 v3, s[56:59], s64 offen lds
 s_add_u32 s64, s64, 4096
 v_mfma_f32_32x32x16_bf16 a[96:111], v[60:63], v[80:83], a[96:111]
 s_add_u32 m0, s66, 6144
 s_nop 0
 buffer_load_dwordx4 v3, s[56:59], s64 offen lds
 s_add_u32 s64, s64, 4096
 v_mfma_f32_32x32x16_bf16 a[112:127], v[60:63], v[84:87], a[112:127]
 s_add_u32 m0, s66, 7168
 s_nop 0
 buffer_load_dwordx4 v3, s[56:59], s64 offen lds
 s_add_u32 s64, s64, 4096
 s_waitcnt lgkmcnt(6)
 v_mfma_f32_32x32x16_bf16 a[0:15], v[32:35], v[64:67], a[0:15]
 s_waitcnt vmcnt(8)
 ds_read_b128 v[80:83], v15 offset:6912
 v_mfma_f32_32x32x16_bf16 a[16:31], v[32:35], v[68:71], a[16:31]
 ds_read_b128 v[84:87], v15 offset:7424
 ds_read_b64_tr_b16 v[48:49], v5 offset:12288
 s_waitcnt lgkmcnt(7)
 v_mfma_f32_32x32x16_bf16 a[32:47], v[36:39], v[64:67], a[32:47]
 ds_read_b64_tr_b16 v[50:51], v5 offset:14336
 ds_read_b64_tr_b16 v[52:53], v6 offset:12288
 v_mfma_f32_32x32x16_bf16 a[48:63], v[36:39], v[68:71], a[48:63]
 ds_read_b64_tr_b16 v[54:55], v6 offset:14336
 ds_read_b64_tr_b16 v[56:57], v7 offset:12288
 s_waitcnt lgkmcnt(9)
 v_mfma_f32_32x32x16_bf16 a[64:79], v[40:43], v[64:67], a[64:79]
 ds_read_b64_tr_b16 v[58:59], v7 offset:14336
 ds_read_b64_tr_b16 v[60:61], v8 offset:12288
 s_waitcnt lgkmcnt(9)
 s_add_u32 m0, s66, 8192
 s_nop 0
 buffer_load_dwordx4 v3, s[56:59], s64 offen lds
 s_add_u32 s64, s64, 4096
 v_mfma_f32_32x32x16_bf16 a[80:95], v[40:43], v[68:71], a[80:95]
 ds_read_b64_tr_b16 v[62:63], v8 offset:14336
 s_add_u32 m0, s66, 9216
 s_nop 0
 buffer_load_dwordx4 v3, s[56:59], s64 offen lds
 s_add_u32 s64, s64, 4096
 v_mfma_f32_32x32x16_bf16 a[96:111], v[44:47], v[64:67], a[96:111]
 s_add_u32 m0, s66, 10240
 s_nop 0
 buffer_load_dwordx4 v3, s[56:59], s64 offen lds
 s_add_u32 s64, s64, 4096
 v_mfma_f32_32x32x16_bf16 a[112:127], v[44:47], v[68:71], a[112:127]
 s_add_u32 m0, s66, 11264
 s_nop 0
 buffer_load_dwordx4 v3, s[56:59], s64 offen lds
 s_add_u32 s64, s64, 4096
 s_waitcnt lgkmcnt(6)
 v_mfma_f32_32x32x16_bf16 a[0:15], v[48:51], v[80:83], a[0:15]
 s_waitcnt vmcnt(8)
 ds_read_b128 v[64:67], v17 offset:0
 v_mfma_f32_32x32x16_bf16 a[16:31], v[48:51], v[84:87], a[16:31]
 ds_read_b128 v[68:71], v17 offset:512
 ds_read_b64_tr_b16 v[32:33], v5 offset:0
 s_waitcnt lgkmcnt(7)
 v_mfma_f32_32x32x16_bf16 a[32:47], v[52:55], v[80:83], a[32:47]
 ds_read_b64_tr_b16 v[34:35], v5 offset:2048
 ds_read_b64_tr_b16 v[36:37], v6 offset:0
 v_mfma_f32_32x32x16_bf16 a[48:63], v[52:55], v[84:87], a[48:63]
 ds_read_b64_tr_b16 v[38:39], v6 offset:2048
 ds_read_b64_tr_b16 v[40:41], v7 offset:0
 s_waitcnt lgkmcnt(9)
 v_mfma_f32_32x32x16_bf16 a[64:79], v[56:59], v[80:83], a[64:79]
 ds_read_b64_tr_b16 v[42:43], v7 offset:2048
 ds_read_b64_tr_b16 v[44:45], v8 offset:0
 s_waitcnt lgkmcnt(9)
 s_add_u32 m0, s66, 12288
 s_nop 0
 buffer_load_dwordx4 v3, s[56:59], s64 offen lds
 s_add_u32 s64, s64, 4096
 v_mfma_f32_32x32x16_bf16 a[80:95], v[56:59], v[84:87], a[80:95]
 ds_read_b64_tr_b16 v[46:47], v8 offset:2048
 s_add_u32 m0, s66, 13312
 s_nop 0
 buffer_load_dwordx4 v3, s[56:59], s64 offen lds
 s_add_u32 s64, s64, 4096
 v_mfma_f32_32x32x16_bf16 a[96:111], v[60:63], v[80:83], a[96:111]
 s_add_u32 m0, s66, 14336
 s_nop 0
 buffer_load_dwordx4 v3, s[56:59], s64 offen lds
 s_add_u32 s64, s64, 4096
 v_mfma_f32_32x32x16_bf16 a[112:127], v[60:63], v[84:87], a[112:127]
 s_add_u32 m0, s66, 15360
 s_nop 0
 buffer_load_dwordx4 v3, s[56:59], s64 offen lds
 s_add_u32 s64, s64, 4096
 v_mov_b32 v15, v17
 s_mov_b32 s48, s49
 s_mov_b32 s35, 6
 .p2align 6
B_G2_L:
 s_add_u32 s49, s48, 1
 s_and_b32 s49, s49, 7
 s_mul_i32 s64, s49, 65536
 s_lshl_b32 s3, s47, 8
 s_add_u32 s64, s64, s3
 s_mul_i32 s3, s49, 9216
 s_lshr_b32 s34, s49, 1
 s_lshl_b32 s34, s34, 3
 s_lshr_b32 s34, 0x40003010, s34
 s_and_b32 s34, s34, 0xff
 s_add_u32 s3, s3, s34
 v_add_u32 v17, s3, v11
 s_waitcnt lgkmcnt(6)
 v_mfma_f32_32x32x16_bf16 a[0:15], v[32:35], v[64:67], a[0:15]
 s_waitcnt vmcnt(8)
 ds_read_b128 v[80:83], v15 offset:2304
 v_mfma_f32_32x32x16_bf16 a[16:31], v[32:35], v[68:71], a[16:31]
 ds_read_b128 v[84:87], v15 offset:2816
 ds_read_b64_tr_b16 v[48:49], v5 offset:4096
 s_waitcnt lgkmcnt(7)
 v_mfma_f32_32x32x16_bf16 a[32:47], v[36:39], v[64:67], a[32:47]
 ds_read_b64_tr_b16 v[50:51], v5 offset:6144
 ds_read_b64_tr_b16 v[52:53], v6 offset:4096
 v_mfma_f32_32x32x16_bf16 a[48:63], v[36:39], v[68:71], a[48:63]
 ds_read_b64_tr_b16 v[54:55], v6 offset:6144
 ds_read_b64_tr_b16 v[56:57], v7 offset:4096
 s_waitcnt lgkmcnt(9)
 v_mfma_f32_32x32x16_bf16 a[64:79], v[40:43], v[64:67], a[64:79]
 ds_read_b64_tr_b16 v[58:59], v7 offset:6144
 ds_read_b64_tr_b16 v[60:61], v8 offset:4096
 s_waitcnt lgkmcnt(9)
 s_add_u32 m0, s66, 0
 s_nop 0
 buffer_load_dwordx4 v3, s[56:59], s64 offen lds
 s_add_u32 s64, s64, 4096
 v_mfma_f32_32x32x16_bf16 a[80:95], v[40:43], v[68:71], a[80:95]
 ds_read_b64_tr_b16 v[62:63], v8 offset:6144
 s_add_u32 m0, s66, 1024
 s_nop 0
 buffer_load_dwordx4 v3, s[56:59], s64 offen lds
 s_add_u32 s64, s64, 4096
 v_mfma_f32_32x32x16_bf16 a[96:111], v[44:47], v[64:67], a[96:111]
 s_add_u32 m0, s66, 2048
 s_nop 0
 buffer_load_dwordx4 v3, s[56:59], s64 offen lds
 s_add_u32 s64, s64, 4096
 v_mfma_f32_32x32x16_bf16 a[112:127], v[44:47], v[68:71], a[112:127]
 s_add_u32 m0, s66, 3072
 s_nop 0
 buffer_load_dwordx4 v3, s[56:59], s64 offen lds
 s_add_u32 s64, s64, 4096
 s_waitcnt lgkmcnt(6)
 v_mfma_f32_32x32x16_bf16 a[0:15], v[48:51], v[80:83], a[0:15]
 s_waitcnt vmcnt(8)
 ds_read_b128 v[64:67], v15 offset:4608
 v_mfma_f32_32x32x16_bf16 a[16:31], v[48:51], v[84:87], a[16:31]
 ds_read_b128 v[68:71], v15 offset:5120
 ds_read_b64_tr_b16 v[32:33], v5 offset:8192
 s_waitcnt lgkmcnt(7)
 v_mfma_f32_32x32x16_bf16 a[32:47], v[52:55], v[80:83], a[32:47]
 ds_read_b64_tr_b16 v[34:35], v5 offset:10240
 ds_read_b64_tr_b16 v[36:37], v6 offset:8192
 v_mfma_f32_32x32x16_bf16 a[48:63], v[52:55], v[84:87], a[48:63]
 ds_read_b64_tr_b16 v[38:39], v6 offset:10240
 ds_read_b64_tr_b16 v[40:41], v7 offset:8192
 s_waitcnt lgkmcnt(9)
 v_mfma_f32_32x32x16_bf16 a[64:79], v[56:59], v[80:83], a[64:79]
 ds_read_b64_tr_b16 v[42:43], v7 offset:10240
 ds_read_b64_tr_b16 v[44:45], v8 offset:8192
 s_waitcnt lgkmcnt(9)
 s_add_u32 m0, s66, 4096
 s_nop 0
 buffer_load_dwordx4 v3, s[56:59], s64 offen lds
 s_add_u32 s64, s64, 4096
 v_mfma_f32_32x32x16_bf16 a[80:95], v[56:59], v[84:87], a[80:95]
 ds_read_b64_tr_b16 v[46:47], v8 offset:10240
 s_add_u32 m0, s66, 5120
 s_nop 0
 buffer_load_dwordx4 v3, s[56:59], s64 offen lds
 s_add_u32 s64, s64, 4096
 v_mfma_f32_32x32x16_bf16 a[96:111], v[60:63], v[80:83], a[96:111]
 s_add_u32 m0, s66, 6144
 s_nop 0
 buffer_load_dwordx4 v3, s[56:59], s64 offen lds
 s_add_u32 s64, s64, 4096
 v_mfma_f32_32x32x16_bf16 a[112:127], v[60:63], v[84:87], a[112:127]
 s_add_u32 m0, s66, 7168
 s_nop 0
 buffer_load_dwordx4 v3, s[56:59], s64 offen lds
 s_add_u32 s64, s64, 4096
 s_waitcnt lgkmcnt(6)
 v_mfma_f32_32x32x16_bf16 a[0:15], v[32:35], v[64:67], a[0:15]
 s_waitcnt vmcnt(8)
 ds_read_b128 v[80:83], v15 offset:6912
 v_mfma_f32_32x32x16_bf16 a[16:31], v[32:35], v[68:71], a[16:31]
 ds_read_b128 v[84:87], v15 offset:7424
 ds_read_b64_tr_b16 v[48:49], v5 offset:12288
 s_waitcnt lgkmcnt(7)
 v_mfma_f32_32x32x16_bf16 a[32:47], v[36:39], v[64:67], a[32:47]
 ds_read_b64_tr_b16 v[50:51], v5 offset:14336
 ds_read_b64_tr_b16 v[52:53], v6 offset:12288
 v_mfma_f32_32x32x16_bf16 a[48:63], v[36:39], v[68:71], a[48:63]
 ds_read_b64_tr_b16 v[54:55], v6 offset:14336
 ds_read_b64_tr_b16 v[56:57], v7 offset:12288
 s_waitcnt lgkmcnt(9)
 v_mfma_f32_32x32x16_bf16 a[64:79], v[40:43], v[64:67], a[64:79]
 ds_read_b64_tr_b16 v[58:59], v7 offset:14336
 ds_read_b64_tr_b16 v[60:61], v8 offset:12288
 s_waitcnt lgkmcnt(9)
 s_add_u32 m0, s66, 8192
 s_nop 0
 buffer_load_dwordx4 v3, s[56:59], s64 offen lds
 s_add_u32 s64, s64, 4096
 v_mfma_f32_32x32x16_bf16 a[80:95], v[40:43], v[68:71], a[80:95]
 ds_read_b64_tr_b16 v[62:63], v8 offset:14336
 s_add_u32 m0, s66, 9216
 s_nop 0
 buffer_load_dwordx4 v3, s[56:59], s64 offen lds
 s_add_u32 s64, s64, 4096
 v_mfma_f32_32x32x16_bf16 a[96:111], v[44:47], v[64:67], a[96:111]
 s_add_u32 m0, s66, 10240
 s_nop 0
 buffer_load_dwordx4 v3, s[56:59], s64 offen lds
 s_add_u32 s64, s64, 4096
 v_mfma_f32_32x32x16_bf16 a[112:127], v[44:47], v[68:71], a[112:127]
 s_add_u32 m0, s66, 11264
 s_nop 0
 buffer_load_dwordx4 v3, s[56:59], s64 offen lds
 s_add_u32 s64, s64, 4096
 s_waitcnt lgkmcnt(6)
 v_mfma_f32_32x32x16_bf16 a[0:15], v[48:51], v[80:83], a[0:15]
 s_waitcnt vmcnt(8)
 ds_read_b128 v[64:67], v17 offset:0
 v_mfma_f32_32x32x16_bf16 a[16:31], v[48:51], v[84:87], a[16:31]
 ds_read_b128 v[68:71], v17 offset:512
 ds_read_b64_tr_b16 v[32:33], v5 offset:0
 s_waitcnt lgkmcnt(7)
 v_mfma_f32_32x32x16_bf16 a[32:47], v[52:55], v[80:83], a[32:47]
 ds_read_b64_tr_b16 v[34:35], v5 offset:2048
 ds_read_b64_tr_b16 v[36:37], v6 offset:0
 v_mfma_f32_32x32x16_bf16 a[48:63], v[52:55], v[84:87], a[48:63]
 ds_read_b64_tr_b16 v[38:39], v6 offset:2048
 ds_read_b64_tr_b16 v[40:41], v7 offset:0
 s_waitcnt lgkmcnt(9)
 v_mfma_f32_32x32x16_bf16 a[64:79], v[56:59], v[80:83], a[64:79]
 ds_read_b64_tr_b16 v[42:43], v7 offset:2048
 ds_read_b64_tr_b16 v[44:45], v8 offset:0
 s_waitcnt lgkmcnt(9)
 s_add_u32 m0, s66, 12288
 s_nop 0
 buffer_load_dwordx4 v3, s[56:59], s64 offen lds
 s_add_u32 s64, s64, 4096
 v_mfma_f32_32x32x16_bf16 a[80:95], v[56:59], v[84:87], a[80:95]
 ds_read_b64_tr_b16 v[46:47], v8 offset:2048
 s_add_u32 m0, s66, 13312
 s_nop 0
 buffer_load_dwordx4 v3, s[56:59], s64 offen lds
 s_add_u32 s64, s64, 4096
 v_mfma_f32_32x32x16_bf16 a[96:111], v[60:63], v[80:83], a[96:111]
 s_add_u32 m0, s66, 14336
 s_nop 0
 buffer_load_dwordx4 v3, s[56:59], s64 offen lds
 s_add_u32 s64, s64, 4096
 v_mfma_f32_32x32x16_bf16 a[112:127], v[60:63], v[84:87], a[112:127]
 s_add_u32 m0, s66, 15360
 s_nop 0
 buffer_load_dwordx4 v3, s[56:59], s64 offen lds
 s_add_u32 s64, s64, 4096
 v_mov_b32 v15, v17
 s_mov_b32 s48, s49
 s_sub_u32 s35, s35, 1
 s_cmp_lg_u32 s35, 0
 s_cbranch_scc1 B_G2_L
 s_and_b32 s49, s41, 3
 s_mul_i32 s65, s49, 352256
 s_lshl_b32 s3, s47, 7
 s_add_u32 s65, s65, s3
 s_lshl_b32 s3, s43, 9
 s_add_u32 s65, s65, s3
 s_waitcnt lgkmcnt(6)
 v_mfma_f32_32x32x16_bf16 a[0:15], v[32:35], v[64:67], a[0:15]
 s_waitcnt vmcnt(8)
 ds_read_b128 v[80:83], v15 offset:2304
 v_mfma_f32_32x32x16_bf16 a[16:31], v[32:35], v[68:71], a[16:31]
 ds_read_b128 v[84:87], v15 offset:2816
 ds_read_b64_tr_b16 v[48:49], v5 offset:4096
 s_waitcnt lgkmcnt(7)
 v_mfma_f32_32x32x16_bf16 a[32:47], v[36:39], v[64:67], a[32:47]
 ds_read_b64_tr_b16 v[50:51], v5 offset:6144
 ds_read_b64_tr_b16 v[52:53], v6 offset:4096
 v_mfma_f32_32x32x16_bf16 a[48:63], v[36:39], v[68:71], a[48:63]
 ds_read_b64_tr_b16 v[54:55], v6 offset:6144
 ds_read_b64_tr_b16 v[56:57], v7 offset:4096
 s_waitcnt lgkmcnt(9)
 v_mfma_f32_32x32x16_bf16 a[64:79], v[40:43], v[64:67], a[64:79]
 ds_read_b64_tr_b16 v[58:59], v7 offset:6144
 ds_read_b64_tr_b16 v[60:61], v8 offset:4096
 s_waitcnt lgkmcnt(9)
 s_add_u32 m0, s66, 0
 s_nop 0
 buffer_load_dwordx4 v4, s[60:63], s65 offen lds
 s_add_u32 s65, s65, 22016
 v_mfma_f32_32x32x16_bf16 a[80:95], v[40:43], v[68:71], a[80:95]
 ds_read_b64_tr_b16 v[62:63], v8 offset:6144
 s_add_u32 m0, s66, 1024
 s_nop 0
 buffer_load_dwordx4 v4, s[60:63], s65 offen lds
 s_add_u32 s65, s65, 22016
 v_mfma_f32_32x32x16_bf16 a[96:111], v[44:47], v[64:67], a[96:111]
 s_add_u32 m0, s66, 2048
 s_nop 0
 buffer_load_dwordx4 v4, s[60:63], s65 offen lds
 s_add_u32 s65, s65, 22016
 v_mfma_f32_32x32x16_bf16 a[112:127], v[44:47], v[68:71], a[112:127]
 s_add_u32 m0, s66, 3072
 s_nop 0
 buffer_load_dwordx4 v4, s[60:63], s65 offen lds
 s_add_u32 s65, s65, 22016
 s_waitcnt lgkmcnt(6)
 v_mfma_f32_32x32x16_bf16 a[0:15], v[48:51], v[80:83], a[0:15]
 s_waitcnt vmcnt(8)
 ds_read_b128 v[64:67], v15 offset:4608
 v_mfma_f32_32x32x16_bf16 a[16:31], v[48:51], v[84:87], a[16:31]
 ds_read_b128 v[68:71], v15 offset:5120
 ds_read_b64_tr_b16 v[32:33], v5 offset:8192
 s_waitcnt lgkmcnt(7)
 v_mfma_f32_32x32x16_bf16 a[32:47], v[52:55], v[80:83], a[32:47]
 ds_read_b64_tr_b16 v[34:35], v5 offset:10240
 ds_read_b64_tr_b16 v[36:37], v6 offset:8192
 v_mfma_f32_32x32x16_bf16 a[48:63], v[52:55], v[84:87], a[48:63]
 ds_read_b64_tr_b16 v[38:39], v6 offset:10240
 ds_read_b64_tr_b16 v[40:41], v7 offset:8192
 s_waitcnt lgkmcnt(9)
 v_mfma_f32_32x32x16_bf16 a[64:79], v[56:59], v[80:83], a[64:79]
 ds_read_b64_tr_b16 v[42:43], v7 offset:10240
 ds_read_b64_tr_b16 v[44:45], v8 offset:8192
 s_waitcnt lgkmcnt(9)
 s_add_u32 m0, s66, 4096
 s_nop 0
 buffer_load_dwordx4 v4, s[60:63], s65 offen lds
 s_add_u32 s65, s65, 22016
 v_mfma_f32_32x32x16_bf16 a[80:95], v[56:59], v[84:87], a[80:95]
 ds_read_b64_tr_b16 v[46:47], v8 offset:10240
 s_add_u32 m0, s66, 5120
 s_nop 0
 buffer_load_dwordx4 v4, s[60:63], s65 offen lds
 s_add_u32 s65, s65, 22016
 v_mfma_f32_32x32x16_bf16 a[96:111], v[60:63], v[80:83], a[96:111]
 s_add_u32 m0, s66, 6144
 s_nop 0
 buffer_load_dwordx4 v4, s[60:63], s65 offen lds
 s_add_u32 s65, s65, 22016
 v_mfma_f32_32x32x16_bf16 a[112:127], v[60:63], v[84:87], a[112:127]
 s_add_u32 m0, s66, 7168
 s_nop 0
 buffer_load_dwordx4 v4, s[60:63], s65 offen lds
 s_add_u32 s65, s65, 22016
 s_waitcnt lgkmcnt(6)
 v_mfma_f32_32x32x16_bf16 a[0:15], v[32:35], v[64:67], a[0:15]
 s_waitcnt vmcnt(8)
 ds_read_b128 v[80:83], v15 offset:6912
 v_mfma_f32_32x32x16_bf16 a[16:31], v[32:35], v[68:71], a[16:31]
 ds_read_b128 v[84:87], v15 offset:7424
 ds_read_b64_tr_b16 v[48:49], v5 offset:12288
 s_waitcnt lgkmcnt(7)
 v_mfma_f32_32x32x16_bf16 a[32:47], v[36:39], v[64:67], a[32:47]
 ds_read_b64_tr_b16 v[50:51], v5 offset:14336
 ds_read_b64_tr_b16 v[52:53], v6 offset:12288
 v_mfma_f32_32x32x16_bf16 a[48:63], v[36:39], v[68:71], a[48:63]
 ds_read_b64_tr_b16 v[54:55], v6 offset:14336
 ds_read_b64_tr_b16 v[56:57], v7 offset:12288
 s_waitcnt lgkmcnt(9)
 v_mfma_f32_32x32x16_bf16 a[64:79], v[40:43], v[64:67], a[64:79]
 ds_read_b64_tr_b16 v[58:59], v7 offset:14336
 ds_read_b64_tr_b16 v[60:61], v8 offset:12288
 s_waitcnt lgkmcnt(9)
 s_add_u32 m0, s66, 8192
 s_nop 0
 buffer_load_dwordx4 v4, s[60:63], s65 offen lds
 s_add_u32 s65, s65, 22016
 v_mfma_f32_32x32x16_bf16 a[80:95], v[40:43], v[68:71], a[80:95]
 ds_read_b64_tr_b16 v[62:63], v8 offset:14336
 s_add_u32 m0, s66, 9216
 s_nop 0
 buffer_load_dwordx4 v4, s[60:63], s65 offen lds
 s_add_u32 s65, s65, 22016
 v_mfma_f32_32x32x16_bf16 a[96:111], v[44:47], v[64:67], a[96:111]
 s_add_u32 m0, s66, 10240
 s_nop 0
 buffer_load_dwordx4 v4, s[60:63], s65 offen lds
 s_add_u32 s65, s65, 22016
 v_mfma_f32_32x32x16_bf16 a[112:127], v[44:47], v[68:71], a[112:127]
 s_add_u32 m0, s66, 11264
 s_nop 0
 buffer_load_dwordx4 v4, s[60:63], s65 offen lds
 s_add_u32 s65, s65, 22016
 s_waitcnt lgkmcnt(6)
 v_mfma_f32_32x32x16_bf16 a[0:15], v[48:51], v[80:83], a[0:15]
 v_mfma_f32_32x32x16_bf16 a[16:31], v[48:51], v[84:87], a[16:31]
 s_waitcnt lgkmcnt(4)
 v_mfma_f32_32x32x16_bf16 a[32:47], v[52:55], v[80:83], a[32:47]
 v_mfma_f32_32x32x16_bf16 a[48:63], v[52:55], v[84:87], a[48:63]
 s_waitcnt lgkmcnt(2)
 v_mfma_f32_32x32x16_bf16 a[64:79], v[56:59], v[80:83], a[64:79]
 s_waitcnt lgkmcnt(0)
 s_add_u32 m0, s66, 12288
 s_nop 0
 buffer_load_dwordx4 v4, s[60:63], s65 offen lds
 s_add_u32 s65, s65, 22016
 v_mfma_f32_32x32x16_bf16 a[80:95], v[56:59], v[84:87], a[80:95]
 s_add_u32 m0, s66, 13312
 s_nop 0
 buffer_load_dwordx4 v4, s[60:63], s65 offen lds
 s_add_u32 s65, s65, 22016
 v_mfma_f32_32x32x16_bf16 a[96:111], v[60:63], v[80:83], a[96:111]
 s_add_u32 m0, s66, 14336
 s_nop 0
 buffer_load_dwordx4 v4, s[60:63], s65 offen lds
 s_add_u32 s65, s65, 22016
 v_mfma_f32_32x32x16_bf16 a[112:127], v[60:63], v[84:87], a[112:127]
 s_add_u32 m0, s66, 15360
 s_nop 0
 buffer_load_dwordx4 v4, s[60:63], s65 offen lds
 s_add_u32 s65, s65, 22016
 v_mov_b32 v18, 0
 v_mov_b32 v19, 0
 v_accvgpr_read_b32 v24, a0
 v_accvgpr_read_b32 v25, a1
 v_cvt_pk_bf16_f32 v26, v24, v25
 v_lshlrev_b32 v24, 16, v26
 v_and_b32 v25, 0xffff0000, v26
 v_lshlrev_b32 v26, 16, v96
 v_and_b32 v27, 0xffff0000, v96
 v_add_f32 v24, v24, v26
 v_add_f32 v25, v25, v27
 v_cvt_pk_bf16_f32 v96, v24, v25
 v_dot2c_f32_bf16 v18, s46, v96
 v_accvgpr_read_b32 v24, a2
 v_accvgpr_read_b32 v25, a3
 v_cvt_pk_bf16_f32 v26, v24, v25
 v_lshlrev_b32 v24, 16, v26
 v_and_b32 v25, 0xffff0000, v26
 v_lshlrev_b32 v26, 16, v97
 v_and_b32 v27, 0xffff0000, v97
 v_add_f32 v24, v24, v26
 v_add_f32 v25, v25, v27
 v_cvt_pk_bf16_f32 v97, v24, v25
 v_dot2c_f32_bf16 v18, s46, v97
 v_accvgpr_read_b32 v24, a4
 v_accvgpr_read_b32 v25, a5
 v_cvt_pk_bf16_f32 v26, v24, v25
 v_lshlrev_b32 v24, 16, v26
 v_and_b32 v25, 0xffff0000, v26
 v_lshlrev_b32 v26, 16, v98
 v_and_b32 v27, 0xffff0000, v98
 v_add_f32 v24, v24, v26
 v_add_f32 v25, v25, v27
 v_cvt_pk_bf16_f32 v98, v24, v25
 v_dot2c_f32_bf16 v18, s46, v98
 v_accvgpr_read_b32 v24, a6
 v_accvgpr_read_b32 v25, a7
 v_cvt_pk_bf16_f32 v26, v24, v25
 v_lshlrev_b32 v24, 16, v26
 v_and_b32 v25, 0xffff0000, v26
 v_lshlrev_b32 v26, 16, v99
 v_and_b32 v27, 0xffff0000, v99
 v_add_f32 v24, v24, v26
 v_add_f32 v25, v25, v27
 v_cvt_pk_bf16_f32 v99, v24, v25
 v_dot2c_f32_bf16 v18, s46, v99
 v_accvgpr_read_b32 v24, a8
 v_accvgpr_read_b32 v25, a9
 v_cvt_pk_bf16_f32 v26, v24, v25
 v_lshlrev_b32 v24, 16, v26
 v_and_b32 v25, 0xffff0000, v26
 v_lshlrev_b32 v26, 16, v100
 v_and_b32 v27, 0xffff0000, v100
 v_add_f32 v24, v24, v26
 v_add_f32 v25, v25, v27
 v_cvt_pk_bf16_f32 v100, v24, v25
 v_dot2c_f32_bf16 v18, s46, v100
 v_accvgpr_read_b32 v24, a10
 v_accvgpr_read_b32 v25, a11
 v_cvt_pk_bf16_f32 v26, v24, v25
 v_lshlrev_b32 v24, 16, v26
 v_and_b32 v25, 0xffff0000, v26
 v_lshlrev_b32 v26, 16, v101
 v_and_b32 v27, 0xffff0000, v101
 v_add_f32 v24, v24, v26
 v_add_f32 v25, v25, v27
 v_cvt_pk_bf16_f32 v101, v24, v25
 v_dot2c_f32_bf16 v18, s46, v101
 v_accvgpr_read_b32 v24, a12
 v_accvgpr_read_b32 v25, a13
 v_cvt_pk_bf16_f32 v26, v24, v25
 v_lshlrev_b32 v24, 16, v26
 v_and_b32 v25, 0xffff0000, v26
 v_lshlrev_b32 v26, 16, v102
 v_and_b32 v27, 0xffff0000, v102
 v_add_f32 v24, v24, v26
 v_add_f32 v25, v25, v27
 v_cvt_pk_bf16_f32 v102, v24, v25
 v_dot2c_f32_bf16 v18, s46, v102
 v_accvgpr_read_b32 v24, a14
 v_accvgpr_read_b32 v25, a15
 v_cvt_pk_bf16_f32 v26, v24, v25
 v_lshlrev_b32 v24, 16, v26
 v_and_b32 v25, 0xffff0000, v26
 v_lshlrev_b32 v26, 16, v103
 v_and_b32 v27, 0xffff0000, v103
 v_add_f32 v24, v24, v26
 v_add_f32 v25, v25, v27
 v_cvt_pk_bf16_f32 v103, v24, v25
 v_dot2c_f32_bf16 v18, s46, v103
 v_accvgpr_read_b32 v24, a16
 v_accvgpr_read_b32 v25, a17
 v_cvt_pk_bf16_f32 v26, v24, v25
 v_lshlrev_b32 v24, 16, v26
 v_and_b32 v25, 0xffff0000, v26
 v_lshlrev_b32 v26, 16, v104
 v_and_b32 v27, 0xffff0000, v104
 v_add_f32 v24, v24, v26
 v_add_f32 v25, v25, v27
 v_cvt_pk_bf16_f32 v104, v24, v25
 v_dot2c_f32_bf16 v19, s46, v104
 v_accvgpr_read_b32 v24, a18
 v_accvgpr_read_b32 v25, a19
 v_cvt_pk_bf16_f32 v26, v24, v25
 v_lshlrev_b32 v24, 16, v26
 v_and_b32 v25, 0xffff0000, v26
 v_lshlrev_b32 v26, 16, v105
 v_and_b32 v27, 0xffff0000, v105
 v_add_f32 v24, v24, v26
 v_add_f32 v25, v25, v27
 v_cvt_pk_bf16_f32 v105, v24, v25
 v_dot2c_f32_bf16 v19, s46, v105
 v_accvgpr_read_b32 v24, a20
 v_accvgpr_read_b32 v25, a21
 v_cvt_pk_bf16_f32 v26, v24, v25
 v_lshlrev_b32 v24, 16, v26
 v_and_b32 v25, 0xffff0000, v26
 v_lshlrev_b32 v26, 16, v106
 v_and_b32 v27, 0xffff0000, v106
 v_add_f32 v24, v24, v26
 v_add_f32 v25, v25, v27
 v_cvt_pk_bf16_f32 v106, v24, v25
 v_dot2c_f32_bf16 v19, s46, v106
 v_accvgpr_read_b32 v24, a22
 v_accvgpr_read_b32 v25, a23
 v_cvt_pk_bf16_f32 v26, v24, v25
 v_lshlrev_b32 v24, 16, v26
 v_and_b32 v25, 0xffff0000, v26
 v_lshlrev_b32 v26, 16, v107
 v_and_b32 v27, 0xffff0000, v107
 v_add_f32 v24, v24, v26
 v_add_f32 v25, v25, v27
 v_cvt_pk_bf16_f32 v107, v24, v25
 v_dot2c_f32_bf16 v19, s46, v107
 v_accvgpr_read_b32 v24, a24
 v_accvgpr_read_b32 v25, a25
 v_cvt_pk_bf16_f32 v26, v24, v25
 v_lshlrev_b32 v24, 16, v26
 v_and_b32 v25, 0xffff0000, v26
 v_lshlrev_b32 v26, 16, v108
 v_and_b32 v27, 0xffff0000, v108
 v_add_f32 v24, v24, v26
 v_add_f32 v25, v25, v27
 v_cvt_pk_bf16_f32 v108, v24, v25
 v_dot2c_f32_bf16 v19, s46, v108
 v_accvgpr_read_b32 v24, a26
 v_accvgpr_read_b32 v25, a27
 v_cvt_pk_bf16_f32 v26, v24, v25
 v_lshlrev_b32 v24, 16, v26
 v_and_b32 v25, 0xffff0000, v26
 v_lshlrev_b32 v26, 16, v109
 v_and_b32 v27, 0xffff0000, v109
 v_add_f32 v24, v24, v26
 v_add_f32 v25, v25, v27
 v_cvt_pk_bf16_f32 v109, v24, v25
 v_dot2c_f32_bf16 v19, s46, v109
 v_accvgpr_read_b32 v24, a28
 v_accvgpr_read_b32 v25, a29
 v_cvt_pk_bf16_f32 v26, v24, v25
 v_lshlrev_b32 v24, 16, v26
 v_and_b32 v25, 0xffff0000, v26
 v_lshlrev_b32 v26, 16, v110
 v_and_b32 v27, 0xffff0000, v110
 v_add_f32 v24, v24, v26
 v_add_f32 v25, v25, v27
 v_cvt_pk_bf16_f32 v110, v24, v25
 v_dot2c_f32_bf16 v19, s46, v110
 v_accvgpr_read_b32 v24, a30
 v_accvgpr_read_b32 v25, a31
 v_cvt_pk_bf16_f32 v26, v24, v25
 v_lshlrev_b32 v24, 16, v26
 v_and_b32 v25, 0xffff0000, v26
 v_lshlrev_b32 v26, 16, v111
 v_and_b32 v27, 0xffff0000, v111
 v_add_f32 v24, v24, v26
 v_add_f32 v25, v25, v27
 v_cvt_pk_bf16_f32 v111, v24, v25
 v_dot2c_f32_bf16 v19, s46, v111
 v_accvgpr_read_b32 v24, a32
 v_accvgpr_read_b32 v25, a33
 v_cvt_pk_bf16_f32 v26, v24, v25
 v_lshlrev_b32 v24, 16, v26
 v_and_b32 v25, 0xffff0000, v26
 v_lshlrev_b32 v26, 16, v112
 v_and_b32 v27, 0xffff0000, v112
 v_add_f32 v24, v24, v26
 v_add_f32 v25, v25, v27
 v_cvt_pk_bf16_f32 v112, v24, v25
 v_dot2c_f32_bf16 v18, s46, v112
 v_accvgpr_read_b32 v24, a34
 v_accvgpr_read_b32 v25, a35
 v_cvt_pk_bf16_f32 v26, v24, v25
 v_lshlrev_b32 v24, 16, v26
 v_and_b32 v25, 0xffff0000, v26
 v_lshlrev_b32 v26, 16, v113
 v_and_b32 v27, 0xffff0000, v113
 v_add_f32 v24, v24, v26
 v_add_f32 v25, v25, v27
 v_cvt_pk_bf16_f32 v113, v24, v25
 v_dot2c_f32_bf16 v18, s46, v113
 v_accvgpr_read_b32 v24, a36
 v_accvgpr_read_b32 v25, a37
 v_cvt_pk_bf16_f32 v26, v24, v25
 v_lshlrev_b32 v24, 16, v26
 v_and_b32 v25, 0xffff0000, v26
 v_lshlrev_b32 v26, 16, v114
 v_and_b32 v27, 0xffff0000, v114
 v_add_f32 v24, v24, v26
 v_add_f32 v25, v25, v27
 v_cvt_pk_bf16_f32 v114, v24, v25
 v_dot2c_f32_bf16 v18, s46, v114
 v_accvgpr_read_b32 v24, a38
 v_accvgpr_read_b32 v25, a39
 v_cvt_pk_bf16_f32 v26, v24, v25
 v_lshlrev_b32 v24, 16, v26
 v_and_b32 v25, 0xffff0000, v26
 v_lshlrev_b32 v26, 16, v115
 v_and_b32 v27, 0xffff0000, v115
 v_add_f32 v24, v24, v26
 v_add_f32 v25, v25, v27
 v_cvt_pk_bf16_f32 v115, v24, v25
 v_dot2c_f32_bf16 v18, s46, v115
 v_accvgpr_read_b32 v24, a40
 v_accvgpr_read_b32 v25, a41
 v_cvt_pk_bf16_f32 v26, v24, v25
 v_lshlrev_b32 v24, 16, v26
 v_and_b32 v25, 0xffff0000, v26
 v_lshlrev_b32 v26, 16, v116
 v_and_b32 v27, 0xffff0000, v116
 v_add_f32 v24, v24, v26
 v_add_f32 v25, v25, v27
 v_cvt_pk_bf16_f32 v116, v24, v25
 v_dot2c_f32_bf16 v18, s46, v116
 v_accvgpr_read_b32 v24, a42
 v_accvgpr_read_b32 v25, a43
 v_cvt_pk_bf16_f32 v26, v24, v25
 v_lshlrev_b32 v24, 16, v26
 v_and_b32 v25, 0xffff0000, v26
 v_lshlrev_b32 v26, 16, v117
 v_and_b32 v27, 0xffff0000, v117
 v_add_f32 v24, v24, v26
 v_add_f32 v25, v25, v27
 v_cvt_pk_bf16_f32 v117, v24, v25
 v_dot2c_f32_bf16 v18, s46, v117
 v_accvgpr_read_b32 v24, a44
 v_accvgpr_read_b32 v25, a45
 v_cvt_pk_bf16_f32 v26, v24, v25
 v_lshlrev_b32 v24, 16, v26
 v_and_b32 v25, 0xffff0000, v26
 v_lshlrev_b32 v26, 16, v118
 v_and_b32 v27, 0xffff0000, v118
 v_add_f32 v24, v24, v26
 v_add_f32 v25, v25, v27
 v_cvt_pk_bf16_f32 v118, v24, v25
 v_dot2c_f32_bf16 v18, s46, v118
 v_accvgpr_read_b32 v24, a46
 v_accvgpr_read_b32 v25, a47
 v_cvt_pk_bf16_f32 v26, v24, v25
 v_lshlrev_b32 v24, 16, v26
 v_and_b32 v25, 0xffff0000, v26
 v_lshlrev_b32 v26, 16, v119
 v_and_b32 v27, 0xffff0000, v119
 v_add_f32 v24, v24, v26
 v_add_f32 v25, v25, v27
 v_cvt_pk_bf16_f32 v119, v24, v25
 v_dot2c_f32_bf16 v18, s46, v119
 v_accvgpr_read_b32 v24, a48
 v_accvgpr_read_b32 v25, a49
 v_cvt_pk_bf16_f32 v26, v24, v25
 v_lshlrev_b32 v24, 16, v26
 v_and_b32 v25, 0xffff0000, v26
 v_lshlrev_b32 v26, 16, v120
 v_and_b32 v27, 0xffff0000, v120
 v_add_f32 v24, v24, v26
 v_add_f32 v25, v25, v27
 v_cvt_pk_bf16_f32 v120, v24, v25
 v_dot2c_f32_bf16 v19, s46, v120
 v_accvgpr_read_b32 v24, a50
 v_accvgpr_read_b32 v25, a51
 v_cvt_pk_bf16_f32 v26, v24, v25
 v_lshlrev_b32 v24, 16, v26
 v_and_b32 v25, 0xffff0000, v26
 v_lshlrev_b32 v26, 16, v121
 v_and_b32 v27, 0xffff0000, v121
 v_add_f32 v24, v24, v26
 v_add_f32 v25, v25, v27
 v_cvt_pk_bf16_f32 v121, v24, v25
 v_dot2c_f32_bf16 v19, s46, v121
 v_accvgpr_read_b32 v24, a52
 v_accvgpr_read_b32 v25, a53
 v_cvt_pk_bf16_f32 v26, v24, v25
 v_lshlrev_b32 v24, 16, v26
 v_and_b32 v25, 0xffff0000, v26
 v_lshlrev_b32 v26, 16, v122
 v_and_b32 v27, 0xffff0000, v122
 v_add_f32 v24, v24, v26
 v_add_f32 v25, v25, v27
 v_cvt_pk_bf16_f32 v122, v24, v25
 v_dot2c_f32_bf16 v19, s46, v122
 v_accvgpr_read_b32 v24, a54
 v_accvgpr_read_b32 v25, a55
 v_cvt_pk_bf16_f32 v26, v24, v25
 v_lshlrev_b32 v24, 16, v26
 v_and_b32 v25, 0xffff0000, v26
 v_lshlrev_b32 v26, 16, v123
 v_and_b32 v27, 0xffff0000, v123
 v_add_f32 v24, v24, v26
 v_add_f32 v25, v25, v27
 v_cvt_pk_bf16_f32 v123, v24, v25
 v_dot2c_f32_bf16 v19, s46, v123
 v_accvgpr_read_b32 v24, a56
 v_accvgpr_read_b32 v25, a57
 v_cvt_pk_bf16_f32 v26, v24, v25
 v_lshlrev_b32 v24, 16, v26
 v_and_b32 v25, 0xffff0000, v26
 v_lshlrev_b32 v26, 16, v124
 v_and_b32 v27, 0xffff0000, v124
 v_add_f32 v24, v24, v26
 v_add_f32 v25, v25, v27
 v_cvt_pk_bf16_f32 v124, v24, v25
 v_dot2c_f32_bf16 v19, s46, v124
 v_accvgpr_read_b32 v24, a58
 v_accvgpr_read_b32 v25, a59
 v_cvt_pk_bf16_f32 v26, v24, v25
 v_lshlrev_b32 v24, 16, v26
 v_and_b32 v25, 0xffff0000, v26
 v_lshlrev_b32 v26, 16, v125
 v_and_b32 v27, 0xffff0000, v125
 v_add_f32 v24, v24, v26
 v_add_f32 v25, v25, v27
 v_cvt_pk_bf16_f32 v125, v24, v25
 v_dot2c_f32_bf16 v19, s46, v125
 v_accvgpr_read_b32 v24, a60
 v_accvgpr_read_b32 v25, a61
 v_cvt_pk_bf16_f32 v26, v24, v25
 v_lshlrev_b32 v24, 16, v26
 v_and_b32 v25, 0xffff0000, v26
 v_lshlrev_b32 v26, 16, v126
 v_and_b32 v27, 0xffff0000, v126
 v_add_f32 v24, v24, v26
 v_add_f32 v25, v25, v27
 v_cvt_pk_bf16_f32 v126, v24, v25
 v_dot2c_f32_bf16 v19, s46, v126
 v_accvgpr_read_b32 v24, a62
 v_accvgpr_read_b32 v25, a63
 v_cvt_pk_bf16_f32 v26, v24, v25
 v_lshlrev_b32 v24, 16, v26
 v_and_b32 v25, 0xffff0000, v26
 v_lshlrev_b32 v26, 16, v127
 v_and_b32 v27, 0xffff0000, v127
 v_add_f32 v24, v24, v26
 v_add_f32 v25, v25, v27
 v_cvt_pk_bf16_f32 v127, v24, v25
 v_dot2c_f32_bf16 v19, s46, v127
 v_accvgpr_read_b32 v24, a64
 v_accvgpr_read_b32 v25, a65
 v_cvt_pk_bf16_f32 v26, v24, v25
 v_lshlrev_b32 v24, 16, v26
 v_and_b32 v25, 0xffff0000, v26
 v_lshlrev_b32 v26, 16, v128
 v_and_b32 v27, 0xffff0000, v128
 v_add_f32 v24, v24, v26
 v_add_f32 v25, v25, v27
 v_cvt_pk_bf16_f32 v128, v24, v25
 v_dot2c_f32_bf16 v18, s46, v128
 v_accvgpr_read_b32 v24, a66
 v_accvgpr_read_b32 v25, a67
 v_cvt_pk_bf16_f32 v26, v24, v25
 v_lshlrev_b32 v24, 16, v26
 v_and_b32 v25, 0xffff0000, v26
 v_lshlrev_b32 v26, 16, v129
 v_and_b32 v27, 0xffff0000, v129
 v_add_f32 v24, v24, v26
 v_add_f32 v25, v25, v27
 v_cvt_pk_bf16_f32 v129, v24, v25
 v_dot2c_f32_bf16 v18, s46, v129
 v_accvgpr_read_b32 v24, a68
 v_accvgpr_read_b32 v25, a69
 v_cvt_pk_bf16_f32 v26, v24, v25
 v_lshlrev_b32 v24, 16, v26
 v_and_b32 v25, 0xffff0000, v26
 v_lshlrev_b32 v26, 16, v130
 v_and_b32 v27, 0xffff0000, v130
 v_add_f32 v24, v24, v26
 v_add_f32 v25, v25, v27
 v_cvt_pk_bf16_f32 v130, v24, v25
 v_dot2c_f32_bf16 v18, s46, v130
 v_accvgpr_read_b32 v24, a70
 v_accvgpr_read_b32 v25, a71
 v_cvt_pk_bf16_f32 v26, v24, v25
 v_lshlrev_b32 v24, 16, v26
 v_and_b32 v25, 0xffff0000, v26
 v_lshlrev_b32 v26, 16, v131
 v_and_b32 v27, 0xffff0000, v131
 v_add_f32 v24, v24, v26
 v_add_f32 v25, v25, v27
 v_cvt_pk_bf16_f32 v131, v24, v25
 v_dot2c_f32_bf16 v18, s46, v131
 v_accvgpr_read_b32 v24, a72
 v_accvgpr_read_b32 v25, a73
 v_cvt_pk_bf16_f32 v26, v24, v25
 v_lshlrev_b32 v24, 16, v26
 v_and_b32 v25, 0xffff0000, v26
 v_lshlrev_b32 v26, 16, v132
 v_and_b32 v27, 0xffff0000, v132
 v_add_f32 v24, v24, v26
 v_add_f32 v25, v25, v27
 v_cvt_pk_bf16_f32 v132, v24, v25
 v_dot2c_f32_bf16 v18, s46, v132
 v_accvgpr_read_b32 v24, a74
 v_accvgpr_read_b32 v25, a75
 v_cvt_pk_bf16_f32 v26, v24, v25
 v_lshlrev_b32 v24, 16, v26
 v_and_b32 v25, 0xffff0000, v26
 v_lshlrev_b32 v26, 16, v133
 v_and_b32 v27, 0xffff0000, v133
 v_add_f32 v24, v24, v26
 v_add_f32 v25, v25, v27
 v_cvt_pk_bf16_f32 v133, v24, v25
 v_dot2c_f32_bf16 v18, s46, v133
 v_accvgpr_read_b32 v24, a76
 v_accvgpr_read_b32 v25, a77
 v_cvt_pk_bf16_f32 v26, v24, v25
 v_lshlrev_b32 v24, 16, v26
 v_and_b32 v25, 0xffff0000, v26
 v_lshlrev_b32 v26, 16, v134
 v_and_b32 v27, 0xffff0000, v134
 v_add_f32 v24, v24, v26
 v_add_f32 v25, v25, v27
 v_cvt_pk_bf16_f32 v134, v24, v25
 v_dot2c_f32_bf16 v18, s46, v134
 v_accvgpr_read_b32 v24, a78
 v_accvgpr_read_b32 v25, a79
 v_cvt_pk_bf16_f32 v26, v24, v25
 v_lshlrev_b32 v24, 16, v26
 v_and_b32 v25, 0xffff0000, v26
 v_lshlrev_b32 v26, 16, v135
 v_and_b32 v27, 0xffff0000, v135
 v_add_f32 v24, v24, v26
 v_add_f32 v25, v25, v27
 v_cvt_pk_bf16_f32 v135, v24, v25
 v_dot2c_f32_bf16 v18, s46, v135
 v_accvgpr_read_b32 v24, a80
 v_accvgpr_read_b32 v25, a81
 v_cvt_pk_bf16_f32 v26, v24, v25
 v_lshlrev_b32 v24, 16, v26
 v_and_b32 v25, 0xffff0000, v26
 v_lshlrev_b32 v26, 16, v136
 v_and_b32 v27, 0xffff0000, v136
 v_add_f32 v24, v24, v26
 v_add_f32 v25, v25, v27
 v_cvt_pk_bf16_f32 v136, v24, v25
 v_dot2c_f32_bf16 v19, s46, v136
 v_accvgpr_read_b32 v24, a82
 v_accvgpr_read_b32 v25, a83
 v_cvt_pk_bf16_f32 v26, v24, v25
 v_lshlrev_b32 v24, 16, v26
 v_and_b32 v25, 0xffff0000, v26
 v_lshlrev_b32 v26, 16, v137
 v_and_b32 v27, 0xffff0000, v137
 v_add_f32 v24, v24, v26
 v_add_f32 v25, v25, v27
 v_cvt_pk_bf16_f32 v137, v24, v25
 v_dot2c_f32_bf16 v19, s46, v137
 v_accvgpr_read_b32 v24, a84
 v_accvgpr_read_b32 v25, a85
 v_cvt_pk_bf16_f32 v26, v24, v25
 v_lshlrev_b32 v24, 16, v26
 v_and_b32 v25, 0xffff0000, v26
 v_lshlrev_b32 v26, 16, v138
 v_and_b32 v27, 0xffff0000, v138
 v_add_f32 v24, v24, v26
 v_add_f32 v25, v25, v27
 v_cvt_pk_bf16_f32 v138, v24, v25
 v_dot2c_f32_bf16 v19, s46, v138
 v_accvgpr_read_b32 v24, a86
 v_accvgpr_read_b32 v25, a87
 v_cvt_pk_bf16_f32 v26, v24, v25
 v_lshlrev_b32 v24, 16, v26
 v_and_b32 v25, 0xffff0000, v26
 v_lshlrev_b32 v26, 16, v139
 v_and_b32 v27, 0xffff0000, v139
 v_add_f32 v24, v24, v26
 v_add_f32 v25, v25, v27
 v_cvt_pk_bf16_f32 v139, v24, v25
 v_dot2c_f32_bf16 v19, s46, v139
 v_accvgpr_read_b32 v24, a88
 v_accvgpr_read_b32 v25, a89
 v_cvt_pk_bf16_f32 v26, v24, v25
 v_lshlrev_b32 v24, 16, v26
 v_and_b32 v25, 0xffff0000, v26
 v_lshlrev_b32 v26, 16, v140
 v_and_b32 v27, 0xffff0000, v140
 v_add_f32 v24, v24, v26
 v_add_f32 v25, v25, v27
 v_cvt_pk_bf16_f32 v140, v24, v25
 v_dot2c_f32_bf16 v19, s46, v140
 v_accvgpr_read_b32 v24, a90
 v_accvgpr_read_b32 v25, a91
 v_cvt_pk_bf16_f32 v26, v24, v25
 v_lshlrev_b32 v24, 16, v26
 v_and_b32 v25, 0xffff0000, v26
 v_lshlrev_b32 v26, 16, v141
 v_and_b32 v27, 0xffff0000, v141
 v_add_f32 v24, v24, v26
 v_add_f32 v25, v25, v27
 v_cvt_pk_bf16_f32 v141, v24, v25
 v_dot2c_f32_bf16 v19, s46, v141
 v_accvgpr_read_b32 v24, a92
 v_accvgpr_read_b32 v25, a93
 v_cvt_pk_bf16_f32 v26, v24, v25
 v_lshlrev_b32 v24, 16, v26
 v_and_b32 v25, 0xffff0000, v26
 v_lshlrev_b32 v26, 16, v142
 v_and_b32 v27, 0xffff0000, v142
 v_add_f32 v24, v24, v26
 v_add_f32 v25, v25, v27
 v_cvt_pk_bf16_f32 v142, v24, v25
 v_dot2c_f32_bf16 v19, s46, v142
 v_accvgpr_read_b32 v24, a94
 v_accvgpr_read_b32 v25, a95
 v_cvt_pk_bf16_f32 v26, v24, v25
 v_lshlrev_b32 v24, 16, v26
 v_and_b32 v25, 0xffff0000, v26
 v_lshlrev_b32 v26, 16, v143
 v_and_b32 v27, 0xffff0000, v143
 v_add_f32 v24, v24, v26
 v_add_f32 v25, v25, v27
 v_cvt_pk_bf16_f32 v143, v24, v25
 v_dot2c_f32_bf16 v19, s46, v143
 v_accvgpr_read_b32 v24, a96
 v_accvgpr_read_b32 v25, a97
 v_cvt_pk_bf16_f32 v26, v24, v25
 v_lshlrev_b32 v24, 16, v26
 v_and_b32 v25, 0xffff0000, v26
 v_lshlrev_b32 v26, 16, v144
 v_and_b32 v27, 0xffff0000, v144
 v_add_f32 v24, v24, v26
 v_add_f32 v25, v25, v27
 v_cvt_pk_bf16_f32 v144, v24, v25
 v_dot2c_f32_bf16 v18, s46, v144
 v_accvgpr_read_b32 v24, a98
 v_accvgpr_read_b32 v25, a99
 v_cvt_pk_bf16_f32 v26, v24, v25
 v_lshlrev_b32 v24, 16, v26
 v_and_b32 v25, 0xffff0000, v26
 v_lshlrev_b32 v26, 16, v145
 v_and_b32 v27, 0xffff0000, v145
 v_add_f32 v24, v24, v26
 v_add_f32 v25, v25, v27
 v_cvt_pk_bf16_f32 v145, v24, v25
 v_dot2c_f32_bf16 v18, s46, v145
 v_accvgpr_read_b32 v24, a100
 v_accvgpr_read_b32 v25, a101
 v_cvt_pk_bf16_f32 v26, v24, v25
 v_lshlrev_b32 v24, 16, v26
 v_and_b32 v25, 0xffff0000, v26
 v_lshlrev_b32 v26, 16, v146
 v_and_b32 v27, 0xffff0000, v146
 v_add_f32 v24, v24, v26
 v_add_f32 v25, v25, v27
 v_cvt_pk_bf16_f32 v146, v24, v25
 v_dot2c_f32_bf16 v18, s46, v146
 v_accvgpr_read_b32 v24, a102
 v_accvgpr_read_b32 v25, a103
 v_cvt_pk_bf16_f32 v26, v24, v25
 v_lshlrev_b32 v24, 16, v26
 v_and_b32 v25, 0xffff0000, v26
 v_lshlrev_b32 v26, 16, v147
 v_and_b32 v27, 0xffff0000, v147
 v_add_f32 v24, v24, v26
 v_add_f32 v25, v25, v27
 v_cvt_pk_bf16_f32 v147, v24, v25
 v_dot2c_f32_bf16 v18, s46, v147
 v_accvgpr_read_b32 v24, a104
 v_accvgpr_read_b32 v25, a105
 v_cvt_pk_bf16_f32 v26, v24, v25
 v_lshlrev_b32 v24, 16, v26
 v_and_b32 v25, 0xffff0000, v26
 v_lshlrev_b32 v26, 16, v148
 v_and_b32 v27, 0xffff0000, v148
 v_add_f32 v24, v24, v26
 v_add_f32 v25, v25, v27
 v_cvt_pk_bf16_f32 v148, v24, v25
 v_dot2c_f32_bf16 v18, s46, v148
 v_accvgpr_read_b32 v24, a106
 v_accvgpr_read_b32 v25, a107
 v_cvt_pk_bf16_f32 v26, v24, v25
 v_lshlrev_b32 v24, 16, v26
 v_and_b32 v25, 0xffff0000, v26
 v_lshlrev_b32 v26, 16, v149
 v_and_b32 v27, 0xffff0000, v149
 v_add_f32 v24, v24, v26
 v_add_f32 v25, v25, v27
 v_cvt_pk_bf16_f32 v149, v24, v25
 v_dot2c_f32_bf16 v18, s46, v149
 v_accvgpr_read_b32 v24, a108
 v_accvgpr_read_b32 v25, a109
 v_cvt_pk_bf16_f32 v26, v24, v25
 v_lshlrev_b32 v24, 16, v26
 v_and_b32 v25, 0xffff0000, v26
 v_lshlrev_b32 v26, 16, v150
 v_and_b32 v27, 0xffff0000, v150
 v_add_f32 v24, v24, v26
 v_add_f32 v25, v25, v27
 v_cvt_pk_bf16_f32 v150, v24, v25
 v_dot2c_f32_bf16 v18, s46, v150
 v_accvgpr_read_b32 v24, a110
 v_accvgpr_read_b32 v25, a111
 v_cvt_pk_bf16_f32 v26, v24, v25
 v_lshlrev_b32 v24, 16, v26
 v_and_b32 v25, 0xffff0000, v26
 v_lshlrev_b32 v26, 16, v151
 v_and_b32 v27, 0xffff0000, v151
 v_add_f32 v24, v24, v26
 v_add_f32 v25, v25, v27
 v_cvt_pk_bf16_f32 v151, v24, v25
 v_dot2c_f32_bf16 v18, s46, v151
 v_accvgpr_read_b32 v24, a112
 v_accvgpr_read_b32 v25, a113
 v_cvt_pk_bf16_f32 v26, v24, v25
 v_lshlrev_b32 v24, 16, v26
 v_and_b32 v25, 0xffff0000, v26
 v_lshlrev_b32 v26, 16, v152
 v_and_b32 v27, 0xffff0000, v152
 v_add_f32 v24, v24, v26
 v_add_f32 v25, v25, v27
 v_cvt_pk_bf16_f32 v152, v24, v25
 v_dot2c_f32_bf16 v19, s46, v152
 v_accvgpr_read_b32 v24, a114
 v_accvgpr_read_b32 v25, a115
 v_cvt_pk_bf16_f32 v26, v24, v25
 v_lshlrev_b32 v24, 16, v26
 v_and_b32 v25, 0xffff0000, v26
 v_lshlrev_b32 v26, 16, v153
 v_and_b32 v27, 0xffff0000, v153
 v_add_f32 v24, v24, v26
 v_add_f32 v25, v25, v27
 v_cvt_pk_bf16_f32 v153, v24, v25
 v_dot2c_f32_bf16 v19, s46, v153
 v_accvgpr_read_b32 v24, a116
 v_accvgpr_read_b32 v25, a117
 v_cvt_pk_bf16_f32 v26, v24, v25
 v_lshlrev_b32 v24, 16, v26
 v_and_b32 v25, 0xffff0000, v26
 v_lshlrev_b32 v26, 16, v154
 v_and_b32 v27, 0xffff0000, v154
 v_add_f32 v24, v24, v26
 v_add_f32 v25, v25, v27
 v_cvt_pk_bf16_f32 v154, v24, v25
 v_dot2c_f32_bf16 v19, s46, v154
 v_accvgpr_read_b32 v24, a118
 v_accvgpr_read_b32 v25, a119
 v_cvt_pk_bf16_f32 v26, v24, v25
 v_lshlrev_b32 v24, 16, v26
 v_and_b32 v25, 0xffff0000, v26
 v_lshlrev_b32 v26, 16, v155
 v_and_b32 v27, 0xffff0000, v155
 v_add_f32 v24, v24, v26
 v_add_f32 v25, v25, v27
 v_cvt_pk_bf16_f32 v155, v24, v25
 v_dot2c_f32_bf16 v19, s46, v155
 v_accvgpr_read_b32 v24, a120
 v_accvgpr_read_b32 v25, a121
 v_cvt_pk_bf16_f32 v26, v24, v25
 v_lshlrev_b32 v24, 16, v26
 v_and_b32 v25, 0xffff0000, v26
 v_lshlrev_b32 v26, 16, v156
 v_and_b32 v27, 0xffff0000, v156
 v_add_f32 v24, v24, v26
 v_add_f32 v25, v25, v27
 v_cvt_pk_bf16_f32 v156, v24, v25
 v_dot2c_f32_bf16 v19, s46, v156
 v_accvgpr_read_b32 v24, a122
 v_accvgpr_read_b32 v25, a123
 v_cvt_pk_bf16_f32 v26, v24, v25
 v_lshlrev_b32 v24, 16, v26
 v_and_b32 v25, 0xffff0000, v26
 v_lshlrev_b32 v26, 16, v157
 v_and_b32 v27, 0xffff0000, v157
 v_add_f32 v24, v24, v26
 v_add_f32 v25, v25, v27
 v_cvt_pk_bf16_f32 v157, v24, v25
 v_dot2c_f32_bf16 v19, s46, v157
 v_accvgpr_read_b32 v24, a124
 v_accvgpr_read_b32 v25, a125
 v_cvt_pk_bf16_f32 v26, v24, v25
 v_lshlrev_b32 v24, 16, v26
 v_and_b32 v25, 0xffff0000, v26
 v_lshlrev_b32 v26, 16, v158
 v_and_b32 v27, 0xffff0000, v158
 v_add_f32 v24, v24, v26
 v_add_f32 v25, v25, v27
 v_cvt_pk_bf16_f32 v158, v24, v25
 v_dot2c_f32_bf16 v19, s46, v158
 v_accvgpr_read_b32 v24, a126
 v_accvgpr_read_b32 v25, a127
 v_cvt_pk_bf16_f32 v26, v24, v25
 v_lshlrev_b32 v24, 16, v26
 v_and_b32 v25, 0xffff0000, v26
 v_lshlrev_b32 v26, 16, v159
 v_and_b32 v27, 0xffff0000, v159
 v_add_f32 v24, v24, v26
 v_add_f32 v25, v25, v27
 v_cvt_pk_bf16_f32 v159, v24, v25
 v_dot2c_f32_bf16 v19, s46, v159
 v_mov_b32 v21, v18
 s_nop 1
 v_permlane32_swap_b32 v18, v21
 v_add_f32 v18, v18, v21
 v_mov_b32 v21, v19
 s_nop 1
 v_permlane32_swap_b32 v19, v21
 v_add_f32 v19, v19, v21
 s_lshl_b32 s3, s47, 8
 v_add_u32 v22, s3, v14
 ds_write2_b32 v22, v18, v19 offset0:0 offset1:32
 s_waitcnt lgkmcnt(0)
 s_barrier
 ds_read2_b32 v[24:25], v14 offset0:0 offset1:32
 ds_read2_b32 v[26:27], v14 offset0:64 offset1:96
 ds_read2_b32 v[28:29], v14 offset0:128 offset1:160
 ds_read2_b32 v[30:31], v14 offset0:192 offset1:224
 s_waitcnt lgkmcnt(2)
 v_add_f32 v24, v24, v26
 v_add_f32 v25, v25, v27
 s_waitcnt lgkmcnt(0)
 v_add_f32 v28, v28, v30
 v_add_f32 v29, v29, v31
 v_add_f32 v18, v24, v28
 v_add_f32 v19, v25, v29
 s_barrier
 v_mul_f32 v18, 0x3b000000, v18
 v_mul_f32 v19, 0x3b000000, v19
 v_mov_b32 v20, 0
 v_mov_b32 v17, 0
 v_lshlrev_b32 v24, 16, v96
 v_and_b32 v25, 0xffff0000, v96
 v_sub_f32 v24, v24, v18
 v_sub_f32 v25, v25, v18
 v_fmac_f32 v20, v24, v24
 v_fmac_f32 v20, v25, v25
 v_lshlrev_b32 v24, 16, v97
 v_and_b32 v25, 0xffff0000, v97
 v_sub_f32 v24, v24, v18
 v_sub_f32 v25, v25, v18
 v_fmac_f32 v20, v24, v24
 v_fmac_f32 v20, v25, v25
 v_lshlrev_b32 v24, 16, v98
 v_and_b32 v25, 0xffff0000, v98
 v_sub_f32 v24, v24, v18
 v_sub_f32 v25, v25, v18
 v_fmac_f32 v20, v24, v24
 v_fmac_f32 v20, v25, v25
 v_lshlrev_b32 v24, 16, v99
 v_and_b32 v25, 0xffff0000, v99
 v_sub_f32 v24, v24, v18
 v_sub_f32 v25, v25, v18
 v_fmac_f32 v20, v24, v24
 v_fmac_f32 v20, v25, v25
 v_lshlrev_b32 v24, 16, v100
 v_and_b32 v25, 0xffff0000, v100
 v_sub_f32 v24, v24, v18
 v_sub_f32 v25, v25, v18
 v_fmac_f32 v20, v24, v24
 v_fmac_f32 v20, v25, v25
 v_lshlrev_b32 v24, 16, v101
 v_and_b32 v25, 0xffff0000, v101
 v_sub_f32 v24, v24, v18
 v_sub_f32 v25, v25, v18
 v_fmac_f32 v20, v24, v24
 v_fmac_f32 v20, v25, v25
 v_lshlrev_b32 v24, 16, v102
 v_and_b32 v25, 0xffff0000, v102
 v_sub_f32 v24, v24, v18
 v_sub_f32 v25, v25, v18
 v_fmac_f32 v20, v24, v24
 v_fmac_f32 v20, v25, v25
 v_lshlrev_b32 v24, 16, v103
 v_and_b32 v25, 0xffff0000, v103
 v_sub_f32 v24, v24, v18
 v_sub_f32 v25, v25, v18
 v_fmac_f32 v20, v24, v24
 v_fmac_f32 v20, v25, v25
 v_lshlrev_b32 v24, 16, v104
 v_and_b32 v25, 0xffff0000, v104
 v_sub_f32 v24, v24, v19
 v_sub_f32 v25, v25, v19
 v_fmac_f32 v17, v24, v24
 v_fmac_f32 v17, v25, v25
 v_lshlrev_b32 v24, 16, v105
 v_and_b32 v25, 0xffff0000, v105
 v_sub_f32 v24, v24, v19
 v_sub_f32 v25, v25, v19
 v_fmac_f32 v17, v24, v24
 v_fmac_f32 v17, v25, v25
 v_lshlrev_b32 v24, 16, v106
 v_and_b32 v25, 0xffff0000, v106
 v_sub_f32 v24, v24, v19
 v_sub_f32 v25, v25, v19
 v_fmac_f32 v17, v24, v24
 v_fmac_f32 v17, v25, v25
 v_lshlrev_b32 v24, 16, v107
 v_and_b32 v25, 0xffff0000, v107
 v_sub_f32 v24, v24, v19
 v_sub_f32 v25, v25, v19
 v_fmac_f32 v17, v24, v24
 v_fmac_f32 v17, v25, v25
 v_lshlrev_b32 v24, 16, v108
 v_and_b32 v25, 0xffff0000, v108
 v_sub_f32 v24, v24, v19
 v_sub_f32 v25, v25, v19
 v_fmac_f32 v17, v24, v24
 v_fmac_f32 v17, v25, v25
 v_lshlrev_b32 v24, 16, v109
 v_and_b32 v25, 0xffff0000, v109
 v_sub_f32 v24, v24, v19
 v_sub_f32 v25, v25, v19
 v_fmac_f32 v17, v24, v24
 v_fmac_f32 v17, v25, v25
 v_lshlrev_b32 v24, 16, v110
 v_and_b32 v25, 0xffff0000, v110
 v_sub_f32 v24, v24, v19
 v_sub_f32 v25, v25, v19
 v_fmac_f32 v17, v24, v24
 v_fmac_f32 v17, v25, v25
 v_lshlrev_b32 v24, 16, v111
 v_and_b32 v25, 0xffff0000, v111
 v_sub_f32 v24, v24, v19
 v_sub_f32 v25, v25, v19
 v_fmac_f32 v17, v24, v24
 v_fmac_f32 v17, v25, v25
 v_lshlrev_b32 v24, 16, v112
 v_and_b32 v25, 0xffff0000, v112
 v_sub_f32 v24, v24, v18
 v_sub_f32 v25, v25, v18
 v_fmac_f32 v20, v24, v24
 v_fmac_f32 v20, v25, v25
 v_lshlrev_b32 v24, 16, v113
 v_and_b32 v25, 0xffff0000, v113
 v_sub_f32 v24, v24, v18
 v_sub_f32 v25, v25, v18
 v_fmac_f32 v20, v24, v24
 v_fmac_f32 v20, v25, v25
 v_lshlrev_b32 v24, 16, v114
 v_and_b32 v25, 0xffff0000, v114
 v_sub_f32 v24, v24, v18
 v_sub_f32 v25, v25, v18
 v_fmac_f32 v20, v24, v24
 v_fmac_f32 v20, v25, v25
 v_lshlrev_b32 v24, 16, v115
 v_and_b32 v25, 0xffff0000, v115
 v_sub_f32 v24, v24, v18
 v_sub_f32 v25, v25, v18
 v_fmac_f32 v20, v24, v24
 v_fmac_f32 v20, v25, v25
 v_lshlrev_b32 v24, 16, v116
 v_and_b32 v25, 0xffff0000, v116
 v_sub_f32 v24, v24, v18
 v_sub_f32 v25, v25, v18
 v_fmac_f32 v20, v24, v24
 v_fmac_f32 v20, v25, v25
 v_lshlrev_b32 v24, 16, v117
 v_and_b32 v25, 0xffff0000, v117
 v_sub_f32 v24, v24, v18
 v_sub_f32 v25, v25, v18
 v_fmac_f32 v20, v24, v24
 v_fmac_f32 v20, v25, v25
 v_lshlrev_b32 v24, 16, v118
 v_and_b32 v25, 0xffff0000, v118
 v_sub_f32 v24, v24, v18
 v_sub_f32 v25, v25, v18
 v_fmac_f32 v20, v24, v24
 v_fmac_f32 v20, v25, v25
 v_lshlrev_b32 v24, 16, v119
 v_and_b32 v25, 0xffff0000, v119
 v_sub_f32 v24, v24, v18
 v_sub_f32 v25, v25, v18
 v_fmac_f32 v20, v24, v24
 v_fmac_f32 v20, v25, v25
 v_lshlrev_b32 v24, 16, v120
 v_and_b32 v25, 0xffff0000, v120
 v_sub_f32 v24, v24, v19
 v_sub_f32 v25, v25, v19
 v_fmac_f32 v17, v24, v24
 v_fmac_f32 v17, v25, v25
 v_lshlrev_b32 v24, 16, v121
 v_and_b32 v25, 0xffff0000, v121
 v_sub_f32 v24, v24, v19
 v_sub_f32 v25, v25, v19
 v_fmac_f32 v17, v24, v24
 v_fmac_f32 v17, v25, v25
 v_lshlrev_b32 v24, 16, v122
 v_and_b32 v25, 0xffff0000, v122
 v_sub_f32 v24, v24, v19
 v_sub_f32 v25, v25, v19
 v_fmac_f32 v17, v24, v24
 v_fmac_f32 v17, v25, v25
 v_lshlrev_b32 v24, 16, v123
 v_and_b32 v25, 0xffff0000, v123
 v_sub_f32 v24, v24, v19
 v_sub_f32 v25, v25, v19
 v_fmac_f32 v17, v24, v24
 v_fmac_f32 v17, v25, v25
 v_lshlrev_b32 v24, 16, v124
 v_and_b32 v25, 0xffff0000, v124
 v_sub_f32 v24, v24, v19
 v_sub_f32 v25, v25, v19
 v_fmac_f32 v17, v24, v24
 v_fmac_f32 v17, v25, v25
 v_lshlrev_b32 v24, 16, v125
 v_and_b32 v25, 0xffff0000, v125
 v_sub_f32 v24, v24, v19
 v_sub_f32 v25, v25, v19
 v_fmac_f32 v17, v24, v24
 v_fmac_f32 v17, v25, v25
 v_lshlrev_b32 v24, 16, v126
 v_and_b32 v25, 0xffff0000, v126
 v_sub_f32 v24, v24, v19
 v_sub_f32 v25, v25, v19
 v_fmac_f32 v17, v24, v24
 v_fmac_f32 v17, v25, v25
 v_lshlrev_b32 v24, 16, v127
 v_and_b32 v25, 0xffff0000, v127
 v_sub_f32 v24, v24, v19
 v_sub_f32 v25, v25, v19
 v_fmac_f32 v17, v24, v24
 v_fmac_f32 v17, v25, v25
 v_lshlrev_b32 v24, 16, v128
 v_and_b32 v25, 0xffff0000, v128
 v_sub_f32 v24, v24, v18
 v_sub_f32 v25, v25, v18
 v_fmac_f32 v20, v24, v24
 v_fmac_f32 v20, v25, v25
 v_lshlrev_b32 v24, 16, v129
 v_and_b32 v25, 0xffff0000, v129
 v_sub_f32 v24, v24, v18
 v_sub_f32 v25, v25, v18
 v_fmac_f32 v20, v24, v24
 v_fmac_f32 v20, v25, v25
 v_lshlrev_b32 v24, 16, v130
 v_and_b32 v25, 0xffff0000, v130
 v_sub_f32 v24, v24, v18
 v_sub_f32 v25, v25, v18
 v_fmac_f32 v20, v24, v24
 v_fmac_f32 v20, v25, v25
 v_lshlrev_b32 v24, 16, v131
 v_and_b32 v25, 0xffff0000, v131
 v_sub_f32 v24, v24, v18
 v_sub_f32 v25, v25, v18
 v_fmac_f32 v20, v24, v24
 v_fmac_f32 v20, v25, v25
 v_lshlrev_b32 v24, 16, v132
 v_and_b32 v25, 0xffff0000, v132
 v_sub_f32 v24, v24, v18
 v_sub_f32 v25, v25, v18
 v_fmac_f32 v20, v24, v24
 v_fmac_f32 v20, v25, v25
 v_lshlrev_b32 v24, 16, v133
 v_and_b32 v25, 0xffff0000, v133
 v_sub_f32 v24, v24, v18
 v_sub_f32 v25, v25, v18
 v_fmac_f32 v20, v24, v24
 v_fmac_f32 v20, v25, v25
 v_lshlrev_b32 v24, 16, v134
 v_and_b32 v25, 0xffff0000, v134
 v_sub_f32 v24, v24, v18
 v_sub_f32 v25, v25, v18
 v_fmac_f32 v20, v24, v24
 v_fmac_f32 v20, v25, v25
 v_lshlrev_b32 v24, 16, v135
 v_and_b32 v25, 0xffff0000, v135
 v_sub_f32 v24, v24, v18
 v_sub_f32 v25, v25, v18
 v_fmac_f32 v20, v24, v24
 v_fmac_f32 v20, v25, v25
 v_lshlrev_b32 v24, 16, v136
 v_and_b32 v25, 0xffff0000, v136
 v_sub_f32 v24, v24, v19
 v_sub_f32 v25, v25, v19
 v_fmac_f32 v17, v24, v24
 v_fmac_f32 v17, v25, v25
 v_lshlrev_b32 v24, 16, v137
 v_and_b32 v25, 0xffff0000, v137
 v_sub_f32 v24, v24, v19
 v_sub_f32 v25, v25, v19
 v_fmac_f32 v17, v24, v24
 v_fmac_f32 v17, v25, v25
 v_lshlrev_b32 v24, 16, v138
 v_and_b32 v25, 0xffff0000, v138
 v_sub_f32 v24, v24, v19
 v_sub_f32 v25, v25, v19
 v_fmac_f32 v17, v24, v24
 v_fmac_f32 v17, v25, v25
 v_lshlrev_b32 v24, 16, v139
 v_and_b32 v25, 0xffff0000, v139
 v_sub_f32 v24, v24, v19
 v_sub_f32 v25, v25, v19
 v_fmac_f32 v17, v24, v24
 v_fmac_f32 v17, v25, v25
 v_lshlrev_b32 v24, 16, v140
 v_and_b32 v25, 0xffff0000, v140
 v_sub_f32 v24, v24, v19
 v_sub_f32 v25, v25, v19
 v_fmac_f32 v17, v24, v24
 v_fmac_f32 v17, v25, v25
 v_lshlrev_b32 v24, 16, v141
 v_and_b32 v25, 0xffff0000, v141
 v_sub_f32 v24, v24, v19
 v_sub_f32 v25, v25, v19
 v_fmac_f32 v17, v24, v24
 v_fmac_f32 v17, v25, v25
 v_lshlrev_b32 v24, 16, v142
 v_and_b32 v25, 0xffff0000, v142
 v_sub_f32 v24, v24, v19
 v_sub_f32 v25, v25, v19
 v_fmac_f32 v17, v24, v24
 v_fmac_f32 v17, v25, v25
 v_lshlrev_b32 v24, 16, v143
 v_and_b32 v25, 0xffff0000, v143
 v_sub_f32 v24, v24, v19
 v_sub_f32 v25, v25, v19
 v_fmac_f32 v17, v24, v24
 v_fmac_f32 v17, v25, v25
 v_lshlrev_b32 v24, 16, v144
 v_and_b32 v25, 0xffff0000, v144
 v_sub_f32 v24, v24, v18
 v_sub_f32 v25, v25, v18
 v_fmac_f32 v20, v24, v24
 v_fmac_f32 v20, v25, v25
 v_lshlrev_b32 v24, 16, v145
 v_and_b32 v25, 0xffff0000, v145
 v_sub_f32 v24, v24, v18
 v_sub_f32 v25, v25, v18
 v_fmac_f32 v20, v24, v24
 v_fmac_f32 v20, v25, v25
 v_lshlrev_b32 v24, 16, v146
 v_and_b32 v25, 0xffff0000, v146
 v_sub_f32 v24, v24, v18
 v_sub_f32 v25, v25, v18
 v_fmac_f32 v20, v24, v24
 v_fmac_f32 v20, v25, v25
 v_lshlrev_b32 v24, 16, v147
 v_and_b32 v25, 0xffff0000, v147
 v_sub_f32 v24, v24, v18
 v_sub_f32 v25, v25, v18
 v_fmac_f32 v20, v24, v24
 v_fmac_f32 v20, v25, v25
 v_lshlrev_b32 v24, 16, v148
 v_and_b32 v25, 0xffff0000, v148
 v_sub_f32 v24, v24, v18
 v_sub_f32 v25, v25, v18
 v_fmac_f32 v20, v24, v24
 v_fmac_f32 v20, v25, v25
 v_lshlrev_b32 v24, 16, v149
 v_and_b32 v25, 0xffff0000, v149
 v_sub_f32 v24, v24, v18
 v_sub_f32 v25, v25, v18
 v_fmac_f32 v20, v24, v24
 v_fmac_f32 v20, v25, v25
 v_lshlrev_b32 v24, 16, v150
 v_and_b32 v25, 0xffff0000, v150
 v_sub_f32 v24, v24, v18
 v_sub_f32 v25, v25, v18
 v_fmac_f32 v20, v24, v24
 v_fmac_f32 v20, v25, v25
 v_lshlrev_b32 v24, 16, v151
 v_and_b32 v25, 0xffff0000, v151
 v_sub_f32 v24, v24, v18
 v_sub_f32 v25, v25, v18
 v_fmac_f32 v20, v24, v24
 v_fmac_f32 v20, v25, v25
 v_lshlrev_b32 v24, 16, v152
 v_and_b32 v25, 0xffff0000, v152
 v_sub_f32 v24, v24, v19
 v_sub_f32 v25, v25, v19
 v_fmac_f32 v17, v24, v24
 v_fmac_f32 v17, v25, v25
 v_lshlrev_b32 v24, 16, v153
 v_and_b32 v25, 0xffff0000, v153
 v_sub_f32 v24, v24, v19
 v_sub_f32 v25, v25, v19
 v_fmac_f32 v17, v24, v24
 v_fmac_f32 v17, v25, v25
 v_lshlrev_b32 v24, 16, v154
 v_and_b32 v25, 0xffff0000, v154
 v_sub_f32 v24, v24, v19
 v_sub_f32 v25, v25, v19
 v_fmac_f32 v17, v24, v24
 v_fmac_f32 v17, v25, v25
 v_lshlrev_b32 v24, 16, v155
 v_and_b32 v25, 0xffff0000, v155
 v_sub_f32 v24, v24, v19
 v_sub_f32 v25, v25, v19
 v_fmac_f32 v17, v24, v24
 v_fmac_f32 v17, v25, v25
 v_lshlrev_b32 v24, 16, v156
 v_and_b32 v25, 0xffff0000, v156
 v_sub_f32 v24, v24, v19
 v_sub_f32 v25, v25, v19
 v_fmac_f32 v17, v24, v24
 v_fmac_f32 v17, v25, v25
 v_lshlrev_b32 v24, 16, v157
 v_and_b32 v25, 0xffff0000, v157
 v_sub_f32 v24, v24, v19
 v_sub_f32 v25, v25, v19
 v_fmac_f32 v17, v24, v24
 v_fmac_f32 v17, v25, v25
 v_lshlrev_b32 v24, 16, v158
 v_and_b32 v25, 0xffff0000, v158
 v_sub_f32 v24, v24, v19
 v_sub_f32 v25, v25, v19
 v_fmac_f32 v17, v24, v24
 v_fmac_f32 v17, v25, v25
 v_lshlrev_b32 v24, 16, v159
 v_and_b32 v25, 0xffff0000, v159
 v_sub_f32 v24, v24, v19
 v_sub_f32 v25, v25, v19
 v_fmac_f32 v17, v24, v24
 v_fmac_f32 v17, v25, v25
 v_mov_b32 v21, v20
 s_nop 1
 v_permlane32_swap_b32 v20, v21
 v_add_f32 v20, v20, v21
 v_mov_b32 v21, v17
 s_nop 1
 v_permlane32_swap_b32 v17, v21
 v_add_f32 v17, v17, v21
 s_lshl_b32 s3, s47, 8
 v_add_u32 v22, s3, v14
 ds_write2_b32 v22, v20, v17 offset0:0 offset1:32
 s_waitcnt lgkmcnt(0)
 s_barrier
 ds_read2_b32 v[24:25], v14 offset0:0 offset1:32
 ds_read2_b32 v[26:27], v14 offset0:64 offset1:96
 ds_read2_b32 v[28:29], v14 offset0:128 offset1:160
 ds_read2_b32 v[30:31], v14 offset0:192 offset1:224
 s_waitcnt lgkmcnt(2)
 v_add_f32 v24, v24, v26
 v_add_f32 v25, v25, v27
 s_waitcnt lgkmcnt(0)
 v_add_f32 v28, v28, v30
 v_add_f32 v29, v29, v31
 v_add_f32 v20, v24, v28
 v_add_f32 v17, v25, v29
 s_barrier
 v_mul_f32 v20, 0x3b000000, v20
 v_mul_f32 v17, 0x3b000000, v17
 v_cvt_pk_bf16_f32 v18, v18, v18
 v_and_b32 v18, 0xffff0000, v18
 v_cvt_pk_bf16_f32 v20, v20, v20
 v_and_b32 v20, 0xffff0000, v20
 v_add_f32 v20, 0x3727c5ac, v20
 v_cvt_pk_bf16_f32 v20, v20, v20
 v_and_b32 v20, 0xffff0000, v20
 v_sqrt_f32 v20, v20
 s_nop 0
 v_cvt_pk_bf16_f32 v20, v20, v20
 v_and_b32 v20, 0xffff0000, v20
 v_rcp_f32 v20, v20
 v_cvt_pk_bf16_f32 v19, v19, v19
 v_and_b32 v19, 0xffff0000, v19
 v_cvt_pk_bf16_f32 v17, v17, v17
 v_and_b32 v17, 0xffff0000, v17
 v_add_f32 v17, 0x3727c5ac, v17
 v_cvt_pk_bf16_f32 v17, v17, v17
 v_and_b32 v17, 0xffff0000, v17
 v_sqrt_f32 v17, v17
 s_nop 0
 v_cvt_pk_bf16_f32 v17, v17, v17
 v_and_b32 v17, 0xffff0000, v17
 v_rcp_f32 v17, v17
 s_lshl_b32 s3, s47, 14
 v_add_u32 v23, s3, v12
 v_lshlrev_b32 v24, 16, v96
 v_and_b32 v25, 0xffff0000, v96
 v_sub_f32 v24, v24, v18
 v_sub_f32 v25, v25, v18
 v_cvt_pk_bf16_f32 v25, v24, v25
 v_lshlrev_b32 v24, 16, v25
 v_and_b32 v25, 0xffff0000, v25
 v_mul_f32 v24, v24, v20
 v_mul_f32 v25, v25, v20
 v_cvt_pk_bf16_f32 v224, v24, v25
 v_lshlrev_b32 v24, 16, v97
 v_and_b32 v25, 0xffff0000, v97
 v_sub_f32 v24, v24, v18
 v_sub_f32 v25, v25, v18
 v_cvt_pk_bf16_f32 v25, v24, v25
 v_lshlrev_b32 v24, 16, v25
 v_and_b32 v25, 0xffff0000, v25
 v_mul_f32 v24, v24, v20
 v_mul_f32 v25, v25, v20
 v_cvt_pk_bf16_f32 v225, v24, v25
 v_lshlrev_b32 v24, 16, v98
 v_and_b32 v25, 0xffff0000, v98
 v_sub_f32 v24, v24, v18
 v_sub_f32 v25, v25, v18
 v_cvt_pk_bf16_f32 v25, v24, v25
 v_lshlrev_b32 v24, 16, v25
 v_and_b32 v25, 0xffff0000, v25
 v_mul_f32 v24, v24, v20
 v_mul_f32 v25, v25, v20
 v_cvt_pk_bf16_f32 v226, v24, v25
 v_lshlrev_b32 v24, 16, v99
 v_and_b32 v25, 0xffff0000, v99
 v_sub_f32 v24, v24, v18
 v_sub_f32 v25, v25, v18
 v_cvt_pk_bf16_f32 v25, v24, v25
 v_lshlrev_b32 v24, 16, v25
 v_and_b32 v25, 0xffff0000, v25
 v_mul_f32 v24, v24, v20
 v_mul_f32 v25, v25, v20
 v_cvt_pk_bf16_f32 v227, v24, v25
 ds_write_b128 v23, v[224:227] offset:0
 v_lshlrev_b32 v24, 16, v100
 v_and_b32 v25, 0xffff0000, v100
 v_sub_f32 v24, v24, v18
 v_sub_f32 v25, v25, v18
 v_cvt_pk_bf16_f32 v25, v24, v25
 v_lshlrev_b32 v24, 16, v25
 v_and_b32 v25, 0xffff0000, v25
 v_mul_f32 v24, v24, v20
 v_mul_f32 v25, v25, v20
 v_cvt_pk_bf16_f32 v228, v24, v25
 v_lshlrev_b32 v24, 16, v101
 v_and_b32 v25, 0xffff0000, v101
 v_sub_f32 v24, v24, v18
 v_sub_f32 v25, v25, v18
 v_cvt_pk_bf16_f32 v25, v24, v25
 v_lshlrev_b32 v24, 16, v25
 v_and_b32 v25, 0xffff0000, v25
 v_mul_f32 v24, v24, v20
 v_mul_f32 v25, v25, v20
 v_cvt_pk_bf16_f32 v229, v24, v25
 v_lshlrev_b32 v24, 16, v102
 v_and_b32 v25, 0xffff0000, v102
 v_sub_f32 v24, v24, v18
 v_sub_f32 v25, v25, v18
 v_cvt_pk_bf16_f32 v25, v24, v25
 v_lshlrev_b32 v24, 16, v25
 v_and_b32 v25, 0xffff0000, v25
 v_mul_f32 v24, v24, v20
 v_mul_f32 v25, v25, v20
 v_cvt_pk_bf16_f32 v230, v24, v25
 v_lshlrev_b32 v24, 16, v103
 v_and_b32 v25, 0xffff0000, v103
 v_sub_f32 v24, v24, v18
 v_sub_f32 v25, v25, v18
 v_cvt_pk_bf16_f32 v25, v24, v25
 v_lshlrev_b32 v24, 16, v25
 v_and_b32 v25, 0xffff0000, v25
 v_mul_f32 v24, v24, v20
 v_mul_f32 v25, v25, v20
 v_cvt_pk_bf16_f32 v231, v24, v25
 ds_write_b128 v23, v[228:231] offset:2048
 v_lshlrev_b32 v24, 16, v104
 v_and_b32 v25, 0xffff0000, v104
 v_sub_f32 v24, v24, v19
 v_sub_f32 v25, v25, v19
 v_cvt_pk_bf16_f32 v25, v24, v25
 v_lshlrev_b32 v24, 16, v25
 v_and_b32 v25, 0xffff0000, v25
 v_mul_f32 v24, v24, v17
 v_mul_f32 v25, v25, v17
 v_cvt_pk_bf16_f32 v224, v24, v25
 v_lshlrev_b32 v24, 16, v105
 v_and_b32 v25, 0xffff0000, v105
 v_sub_f32 v24, v24, v19
 v_sub_f32 v25, v25, v19
 v_cvt_pk_bf16_f32 v25, v24, v25
 v_lshlrev_b32 v24, 16, v25
 v_and_b32 v25, 0xffff0000, v25
 v_mul_f32 v24, v24, v17
 v_mul_f32 v25, v25, v17
 v_cvt_pk_bf16_f32 v225, v24, v25
 v_lshlrev_b32 v24, 16, v106
 v_and_b32 v25, 0xffff0000, v106
 v_sub_f32 v24, v24, v19
 v_sub_f32 v25, v25, v19
 v_cvt_pk_bf16_f32 v25, v24, v25
 v_lshlrev_b32 v24, 16, v25
 v_and_b32 v25, 0xffff0000, v25
 v_mul_f32 v24, v24, v17
 v_mul_f32 v25, v25, v17
 v_cvt_pk_bf16_f32 v226, v24, v25
 v_lshlrev_b32 v24, 16, v107
 v_and_b32 v25, 0xffff0000, v107
 v_sub_f32 v24, v24, v19
 v_sub_f32 v25, v25, v19
 v_cvt_pk_bf16_f32 v25, v24, v25
 v_lshlrev_b32 v24, 16, v25
 v_and_b32 v25, 0xffff0000, v25
 v_mul_f32 v24, v24, v17
 v_mul_f32 v25, v25, v17
 v_cvt_pk_bf16_f32 v227, v24, v25
 ds_write_b128 v23, v[224:227] offset:512
 v_lshlrev_b32 v24, 16, v108
 v_and_b32 v25, 0xffff0000, v108
 v_sub_f32 v24, v24, v19
 v_sub_f32 v25, v25, v19
 v_cvt_pk_bf16_f32 v25, v24, v25
 v_lshlrev_b32 v24, 16, v25
 v_and_b32 v25, 0xffff0000, v25
 v_mul_f32 v24, v24, v17
 v_mul_f32 v25, v25, v17
 v_cvt_pk_bf16_f32 v228, v24, v25
 v_lshlrev_b32 v24, 16, v109
 v_and_b32 v25, 0xffff0000, v109
 v_sub_f32 v24, v24, v19
 v_sub_f32 v25, v25, v19
 v_cvt_pk_bf16_f32 v25, v24, v25
 v_lshlrev_b32 v24, 16, v25
 v_and_b32 v25, 0xffff0000, v25
 v_mul_f32 v24, v24, v17
 v_mul_f32 v25, v25, v17
 v_cvt_pk_bf16_f32 v229, v24, v25
 v_lshlrev_b32 v24, 16, v110
 v_and_b32 v25, 0xffff0000, v110
 v_sub_f32 v24, v24, v19
 v_sub_f32 v25, v25, v19
 v_cvt_pk_bf16_f32 v25, v24, v25
 v_lshlrev_b32 v24, 16, v25
 v_and_b32 v25, 0xffff0000, v25
 v_mul_f32 v24, v24, v17
 v_mul_f32 v25, v25, v17
 v_cvt_pk_bf16_f32 v230, v24, v25
 v_lshlrev_b32 v24, 16, v111
 v_and_b32 v25, 0xffff0000, v111
 v_sub_f32 v24, v24, v19
 v_sub_f32 v25, v25, v19
 v_cvt_pk_bf16_f32 v25, v24, v25
 v_lshlrev_b32 v24, 16, v25
 v_and_b32 v25, 0xffff0000, v25
 v_mul_f32 v24, v24, v17
 v_mul_f32 v25, v25, v17
 v_cvt_pk_bf16_f32 v231, v24, v25
 ds_write_b128 v23, v[228:231] offset:2560
 v_lshlrev_b32 v24, 16, v112
 v_and_b32 v25, 0xffff0000, v112
 v_sub_f32 v24, v24, v18
 v_sub_f32 v25, v25, v18
 v_cvt_pk_bf16_f32 v25, v24, v25
 v_lshlrev_b32 v24, 16, v25
 v_and_b32 v25, 0xffff0000, v25
 v_mul_f32 v24, v24, v20
 v_mul_f32 v25, v25, v20
 v_cvt_pk_bf16_f32 v224, v24, v25
 v_lshlrev_b32 v24, 16, v113
 v_and_b32 v25, 0xffff0000, v113
 v_sub_f32 v24, v24, v18
 v_sub_f32 v25, v25, v18
 v_cvt_pk_bf16_f32 v25, v24, v25
 v_lshlrev_b32 v24, 16, v25
 v_and_b32 v25, 0xffff0000, v25
 v_mul_f32 v24, v24, v20
 v_mul_f32 v25, v25, v20
 v_cvt_pk_bf16_f32 v225, v24, v25
 v_lshlrev_b32 v24, 16, v114
 v_and_b32 v25, 0xffff0000, v114
 v_sub_f32 v24, v24, v18
 v_sub_f32 v25, v25, v18
 v_cvt_pk_bf16_f32 v25, v24, v25
 v_lshlrev_b32 v24, 16, v25
 v_and_b32 v25, 0xffff0000, v25
 v_mul_f32 v24, v24, v20
 v_mul_f32 v25, v25, v20
 v_cvt_pk_bf16_f32 v226, v24, v25
 v_lshlrev_b32 v24, 16, v115
 v_and_b32 v25, 0xffff0000, v115
 v_sub_f32 v24, v24, v18
 v_sub_f32 v25, v25, v18
 v_cvt_pk_bf16_f32 v25, v24, v25
 v_lshlrev_b32 v24, 16, v25
 v_and_b32 v25, 0xffff0000, v25
 v_mul_f32 v24, v24, v20
 v_mul_f32 v25, v25, v20
 v_cvt_pk_bf16_f32 v227, v24, v25
 ds_write_b128 v23, v[224:227] offset:4096
 v_lshlrev_b32 v24, 16, v116
 v_and_b32 v25, 0xffff0000, v116
 v_sub_f32 v24, v24, v18
 v_sub_f32 v25, v25, v18
 v_cvt_pk_bf16_f32 v25, v24, v25
 v_lshlrev_b32 v24, 16, v25
 v_and_b32 v25, 0xffff0000, v25
 v_mul_f32 v24, v24, v20
 v_mul_f32 v25, v25, v20
 v_cvt_pk_bf16_f32 v228, v24, v25
 v_lshlrev_b32 v24, 16, v117
 v_and_b32 v25, 0xffff0000, v117
 v_sub_f32 v24, v24, v18
 v_sub_f32 v25, v25, v18
 v_cvt_pk_bf16_f32 v25, v24, v25
 v_lshlrev_b32 v24, 16, v25
 v_and_b32 v25, 0xffff0000, v25
 v_mul_f32 v24, v24, v20
 v_mul_f32 v25, v25, v20
 v_cvt_pk_bf16_f32 v229, v24, v25
 v_lshlrev_b32 v24, 16, v118
 v_and_b32 v25, 0xffff0000, v118
 v_sub_f32 v24, v24, v18
 v_sub_f32 v25, v25, v18
 v_cvt_pk_bf16_f32 v25, v24, v25
 v_lshlrev_b32 v24, 16, v25
 v_and_b32 v25, 0xffff0000, v25
 v_mul_f32 v24, v24, v20
 v_mul_f32 v25, v25, v20
 v_cvt_pk_bf16_f32 v230, v24, v25
 v_lshlrev_b32 v24, 16, v119
 v_and_b32 v25, 0xffff0000, v119
 v_sub_f32 v24, v24, v18
 v_sub_f32 v25, v25, v18
 v_cvt_pk_bf16_f32 v25, v24, v25
 v_lshlrev_b32 v24, 16, v25
 v_and_b32 v25, 0xffff0000, v25
 v_mul_f32 v24, v24, v20
 v_mul_f32 v25, v25, v20
 v_cvt_pk_bf16_f32 v231, v24, v25
 ds_write_b128 v23, v[228:231] offset:6144
 v_lshlrev_b32 v24, 16, v120
 v_and_b32 v25, 0xffff0000, v120
 v_sub_f32 v24, v24, v19
 v_sub_f32 v25, v25, v19
 v_cvt_pk_bf16_f32 v25, v24, v25
 v_lshlrev_b32 v24, 16, v25
 v_and_b32 v25, 0xffff0000, v25
 v_mul_f32 v24, v24, v17
 v_mul_f32 v25, v25, v17
 v_cvt_pk_bf16_f32 v224, v24, v25
 v_lshlrev_b32 v24, 16, v121
 v_and_b32 v25, 0xffff0000, v121
 v_sub_f32 v24, v24, v19
 v_sub_f32 v25, v25, v19
 v_cvt_pk_bf16_f32 v25, v24, v25
 v_lshlrev_b32 v24, 16, v25
 v_and_b32 v25, 0xffff0000, v25
 v_mul_f32 v24, v24, v17
 v_mul_f32 v25, v25, v17
 v_cvt_pk_bf16_f32 v225, v24, v25
 v_lshlrev_b32 v24, 16, v122
 v_and_b32 v25, 0xffff0000, v122
 v_sub_f32 v24, v24, v19
 v_sub_f32 v25, v25, v19
 v_cvt_pk_bf16_f32 v25, v24, v25
 v_lshlrev_b32 v24, 16, v25
 v_and_b32 v25, 0xffff0000, v25
 v_mul_f32 v24, v24, v17
 v_mul_f32 v25, v25, v17
 v_cvt_pk_bf16_f32 v226, v24, v25
 v_lshlrev_b32 v24, 16, v123
 v_and_b32 v25, 0xffff0000, v123
 v_sub_f32 v24, v24, v19
 v_sub_f32 v25, v25, v19
 v_cvt_pk_bf16_f32 v25, v24, v25
 v_lshlrev_b32 v24, 16, v25
 v_and_b32 v25, 0xffff0000, v25
 v_mul_f32 v24, v24, v17
 v_mul_f32 v25, v25, v17
 v_cvt_pk_bf16_f32 v227, v24, v25
 ds_write_b128 v23, v[224:227] offset:4608
 v_lshlrev_b32 v24, 16, v124
 v_and_b32 v25, 0xffff0000, v124
 v_sub_f32 v24, v24, v19
 v_sub_f32 v25, v25, v19
 v_cvt_pk_bf16_f32 v25, v24, v25
 v_lshlrev_b32 v24, 16, v25
 v_and_b32 v25, 0xffff0000, v25
 v_mul_f32 v24, v24, v17
 v_mul_f32 v25, v25, v17
 v_cvt_pk_bf16_f32 v228, v24, v25
 v_lshlrev_b32 v24, 16, v125
 v_and_b32 v25, 0xffff0000, v125
 v_sub_f32 v24, v24, v19
 v_sub_f32 v25, v25, v19
 v_cvt_pk_bf16_f32 v25, v24, v25
 v_lshlrev_b32 v24, 16, v25
 v_and_b32 v25, 0xffff0000, v25
 v_mul_f32 v24, v24, v17
 v_mul_f32 v25, v25, v17
 v_cvt_pk_bf16_f32 v229, v24, v25
 v_lshlrev_b32 v24, 16, v126
 v_and_b32 v25, 0xffff0000, v126
 v_sub_f32 v24, v24, v19
 v_sub_f32 v25, v25, v19
 v_cvt_pk_bf16_f32 v25, v24, v25
 v_lshlrev_b32 v24, 16, v25
 v_and_b32 v25, 0xffff0000, v25
 v_mul_f32 v24, v24, v17
 v_mul_f32 v25, v25, v17
 v_cvt_pk_bf16_f32 v230, v24, v25
 v_lshlrev_b32 v24, 16, v127
 v_and_b32 v25, 0xffff0000, v127
 v_sub_f32 v24, v24, v19
 v_sub_f32 v25, v25, v19
 v_cvt_pk_bf16_f32 v25, v24, v25
 v_lshlrev_b32 v24, 16, v25
 v_and_b32 v25, 0xffff0000, v25
 v_mul_f32 v24, v24, v17
 v_mul_f32 v25, v25, v17
 v_cvt_pk_bf16_f32 v231, v24, v25
 ds_write_b128 v23, v[228:231] offset:6656
 v_lshlrev_b32 v24, 16, v128
 v_and_b32 v25, 0xffff0000, v128
 v_sub_f32 v24, v24, v18
 v_sub_f32 v25, v25, v18
 v_cvt_pk_bf16_f32 v25, v24, v25
 v_lshlrev_b32 v24, 16, v25
 v_and_b32 v25, 0xffff0000, v25
 v_mul_f32 v24, v24, v20
 v_mul_f32 v25, v25, v20
 v_cvt_pk_bf16_f32 v224, v24, v25
 v_lshlrev_b32 v24, 16, v129
 v_and_b32 v25, 0xffff0000, v129
 v_sub_f32 v24, v24, v18
 v_sub_f32 v25, v25, v18
 v_cvt_pk_bf16_f32 v25, v24, v25
 v_lshlrev_b32 v24, 16, v25
 v_and_b32 v25, 0xffff0000, v25
 v_mul_f32 v24, v24, v20
 v_mul_f32 v25, v25, v20
 v_cvt_pk_bf16_f32 v225, v24, v25
 v_lshlrev_b32 v24, 16, v130
 v_and_b32 v25, 0xffff0000, v130
 v_sub_f32 v24, v24, v18
 v_sub_f32 v25, v25, v18
 v_cvt_pk_bf16_f32 v25, v24, v25
 v_lshlrev_b32 v24, 16, v25
 v_and_b32 v25, 0xffff0000, v25
 v_mul_f32 v24, v24, v20
 v_mul_f32 v25, v25, v20
 v_cvt_pk_bf16_f32 v226, v24, v25
 v_lshlrev_b32 v24, 16, v131
 v_and_b32 v25, 0xffff0000, v131
 v_sub_f32 v24, v24, v18
 v_sub_f32 v25, v25, v18
 v_cvt_pk_bf16_f32 v25, v24, v25
 v_lshlrev_b32 v24, 16, v25
 v_and_b32 v25, 0xffff0000, v25
 v_mul_f32 v24, v24, v20
 v_mul_f32 v25, v25, v20
 v_cvt_pk_bf16_f32 v227, v24, v25
 ds_write_b128 v23, v[224:227] offset:8192
 v_lshlrev_b32 v24, 16, v132
 v_and_b32 v25, 0xffff0000, v132
 v_sub_f32 v24, v24, v18
 v_sub_f32 v25, v25, v18
 v_cvt_pk_bf16_f32 v25, v24, v25
 v_lshlrev_b32 v24, 16, v25
 v_and_b32 v25, 0xffff0000, v25
 v_mul_f32 v24, v24, v20
 v_mul_f32 v25, v25, v20
 v_cvt_pk_bf16_f32 v228, v24, v25
 v_lshlrev_b32 v24, 16, v133
 v_and_b32 v25, 0xffff0000, v133
 v_sub_f32 v24, v24, v18
 v_sub_f32 v25, v25, v18
 v_cvt_pk_bf16_f32 v25, v24, v25
 v_lshlrev_b32 v24, 16, v25
 v_and_b32 v25, 0xffff0000, v25
 v_mul_f32 v24, v24, v20
 v_mul_f32 v25, v25, v20
 v_cvt_pk_bf16_f32 v229, v24, v25
 v_lshlrev_b32 v24, 16, v134
 v_and_b32 v25, 0xffff0000, v134
 v_sub_f32 v24, v24, v18
 v_sub_f32 v25, v25, v18
 v_cvt_pk_bf16_f32 v25, v24, v25
 v_lshlrev_b32 v24, 16, v25
 v_and_b32 v25, 0xffff0000, v25
 v_mul_f32 v24, v24, v20
 v_mul_f32 v25, v25, v20
 v_cvt_pk_bf16_f32 v230, v24, v25
 v_lshlrev_b32 v24, 16, v135
 v_and_b32 v25, 0xffff0000, v135
 v_sub_f32 v24, v24, v18
 v_sub_f32 v25, v25, v18
 v_cvt_pk_bf16_f32 v25, v24, v25
 v_lshlrev_b32 v24, 16, v25
 v_and_b32 v25, 0xffff0000, v25
 v_mul_f32 v24, v24, v20
 v_mul_f32 v25, v25, v20
 v_cvt_pk_bf16_f32 v231, v24, v25
 ds_write_b128 v23, v[228:231] offset:10240
 v_lshlrev_b32 v24, 16, v136
 v_and_b32 v25, 0xffff0000, v136
 v_sub_f32 v24, v24, v19
 v_sub_f32 v25, v25, v19
 v_cvt_pk_bf16_f32 v25, v24, v25
 v_lshlrev_b32 v24, 16, v25
 v_and_b32 v25, 0xffff0000, v25
 v_mul_f32 v24, v24, v17
 v_mul_f32 v25, v25, v17
 v_cvt_pk_bf16_f32 v224, v24, v25
 v_lshlrev_b32 v24, 16, v137
 v_and_b32 v25, 0xffff0000, v137
 v_sub_f32 v24, v24, v19
 v_sub_f32 v25, v25, v19
 v_cvt_pk_bf16_f32 v25, v24, v25
 v_lshlrev_b32 v24, 16, v25
 v_and_b32 v25, 0xffff0000, v25
 v_mul_f32 v24, v24, v17
 v_mul_f32 v25, v25, v17
 v_cvt_pk_bf16_f32 v225, v24, v25
 v_lshlrev_b32 v24, 16, v138
 v_and_b32 v25, 0xffff0000, v138
 v_sub_f32 v24, v24, v19
 v_sub_f32 v25, v25, v19
 v_cvt_pk_bf16_f32 v25, v24, v25
 v_lshlrev_b32 v24, 16, v25
 v_and_b32 v25, 0xffff0000, v25
 v_mul_f32 v24, v24, v17
 v_mul_f32 v25, v25, v17
 v_cvt_pk_bf16_f32 v226, v24, v25
 v_lshlrev_b32 v24, 16, v139
 v_and_b32 v25, 0xffff0000, v139
 v_sub_f32 v24, v24, v19
 v_sub_f32 v25, v25, v19
 v_cvt_pk_bf16_f32 v25, v24, v25
 v_lshlrev_b32 v24, 16, v25
 v_and_b32 v25, 0xffff0000, v25
 v_mul_f32 v24, v24, v17
 v_mul_f32 v25, v25, v17
 v_cvt_pk_bf16_f32 v227, v24, v25
 ds_write_b128 v23, v[224:227] offset:8704
 v_lshlrev_b32 v24, 16, v140
 v_and_b32 v25, 0xffff0000, v140
 v_sub_f32 v24, v24, v19
 v_sub_f32 v25, v25, v19
 v_cvt_pk_bf16_f32 v25, v24, v25
 v_lshlrev_b32 v24, 16, v25
 v_and_b32 v25, 0xffff0000, v25
 v_mul_f32 v24, v24, v17
 v_mul_f32 v25, v25, v17
 v_cvt_pk_bf16_f32 v228, v24, v25
 v_lshlrev_b32 v24, 16, v141
 v_and_b32 v25, 0xffff0000, v141
 v_sub_f32 v24, v24, v19
 v_sub_f32 v25, v25, v19
 v_cvt_pk_bf16_f32 v25, v24, v25
 v_lshlrev_b32 v24, 16, v25
 v_and_b32 v25, 0xffff0000, v25
 v_mul_f32 v24, v24, v17
 v_mul_f32 v25, v25, v17
 v_cvt_pk_bf16_f32 v229, v24, v25
 v_lshlrev_b32 v24, 16, v142
 v_and_b32 v25, 0xffff0000, v142
 v_sub_f32 v24, v24, v19
 v_sub_f32 v25, v25, v19
 v_cvt_pk_bf16_f32 v25, v24, v25
 v_lshlrev_b32 v24, 16, v25
 v_and_b32 v25, 0xffff0000, v25
 v_mul_f32 v24, v24, v17
 v_mul_f32 v25, v25, v17
 v_cvt_pk_bf16_f32 v230, v24, v25
 v_lshlrev_b32 v24, 16, v143
 v_and_b32 v25, 0xffff0000, v143
 v_sub_f32 v24, v24, v19
 v_sub_f32 v25, v25, v19
 v_cvt_pk_bf16_f32 v25, v24, v25
 v_lshlrev_b32 v24, 16, v25
 v_and_b32 v25, 0xffff0000, v25
 v_mul_f32 v24, v24, v17
 v_mul_f32 v25, v25, v17
 v_cvt_pk_bf16_f32 v231, v24, v25
 ds_write_b128 v23, v[228:231] offset:10752
 v_lshlrev_b32 v24, 16, v144
 v_and_b32 v25, 0xffff0000, v144
 v_sub_f32 v24, v24, v18
 v_sub_f32 v25, v25, v18
 v_cvt_pk_bf16_f32 v25, v24, v25
 v_lshlrev_b32 v24, 16, v25
 v_and_b32 v25, 0xffff0000, v25
 v_mul_f32 v24, v24, v20
 v_mul_f32 v25, v25, v20
 v_cvt_pk_bf16_f32 v224, v24, v25
 v_lshlrev_b32 v24, 16, v145
 v_and_b32 v25, 0xffff0000, v145
 v_sub_f32 v24, v24, v18
 v_sub_f32 v25, v25, v18
 v_cvt_pk_bf16_f32 v25, v24, v25
 v_lshlrev_b32 v24, 16, v25
 v_and_b32 v25, 0xffff0000, v25
 v_mul_f32 v24, v24, v20
 v_mul_f32 v25, v25, v20
 v_cvt_pk_bf16_f32 v225, v24, v25
 v_lshlrev_b32 v24, 16, v146
 v_and_b32 v25, 0xffff0000, v146
 v_sub_f32 v24, v24, v18
 v_sub_f32 v25, v25, v18
 v_cvt_pk_bf16_f32 v25, v24, v25
 v_lshlrev_b32 v24, 16, v25
 v_and_b32 v25, 0xffff0000, v25
 v_mul_f32 v24, v24, v20
 v_mul_f32 v25, v25, v20
 v_cvt_pk_bf16_f32 v226, v24, v25
 v_lshlrev_b32 v24, 16, v147
 v_and_b32 v25, 0xffff0000, v147
 v_sub_f32 v24, v24, v18
 v_sub_f32 v25, v25, v18
 v_cvt_pk_bf16_f32 v25, v24, v25
 v_lshlrev_b32 v24, 16, v25
 v_and_b32 v25, 0xffff0000, v25
 v_mul_f32 v24, v24, v20
 v_mul_f32 v25, v25, v20
 v_cvt_pk_bf16_f32 v227, v24, v25
 ds_write_b128 v23, v[224:227] offset:12288
 v_lshlrev_b32 v24, 16, v148
 v_and_b32 v25, 0xffff0000, v148
 v_sub_f32 v24, v24, v18
 v_sub_f32 v25, v25, v18
 v_cvt_pk_bf16_f32 v25, v24, v25
 v_lshlrev_b32 v24, 16, v25
 v_and_b32 v25, 0xffff0000, v25
 v_mul_f32 v24, v24, v20
 v_mul_f32 v25, v25, v20
 v_cvt_pk_bf16_f32 v228, v24, v25
 v_lshlrev_b32 v24, 16, v149
 v_and_b32 v25, 0xffff0000, v149
 v_sub_f32 v24, v24, v18
 v_sub_f32 v25, v25, v18
 v_cvt_pk_bf16_f32 v25, v24, v25
 v_lshlrev_b32 v24, 16, v25
 v_and_b32 v25, 0xffff0000, v25
 v_mul_f32 v24, v24, v20
 v_mul_f32 v25, v25, v20
 v_cvt_pk_bf16_f32 v229, v24, v25
 v_lshlrev_b32 v24, 16, v150
 v_and_b32 v25, 0xffff0000, v150
 v_sub_f32 v24, v24, v18
 v_sub_f32 v25, v25, v18
 v_cvt_pk_bf16_f32 v25, v24, v25
 v_lshlrev_b32 v24, 16, v25
 v_and_b32 v25, 0xffff0000, v25
 v_mul_f32 v24, v24, v20
 v_mul_f32 v25, v25, v20
 v_cvt_pk_bf16_f32 v230, v24, v25
 v_lshlrev_b32 v24, 16, v151
 v_and_b32 v25, 0xffff0000, v151
 v_sub_f32 v24, v24, v18
 v_sub_f32 v25, v25, v18
 v_cvt_pk_bf16_f32 v25, v24, v25
 v_lshlrev_b32 v24, 16, v25
 v_and_b32 v25, 0xffff0000, v25
 v_mul_f32 v24, v24, v20
 v_mul_f32 v25, v25, v20
 v_cvt_pk_bf16_f32 v231, v24, v25
 ds_write_b128 v23, v[228:231] offset:14336
 v_lshlrev_b32 v24, 16, v152
 v_and_b32 v25, 0xffff0000, v152
 v_sub_f32 v24, v24, v19
 v_sub_f32 v25, v25, v19
 v_cvt_pk_bf16_f32 v25, v24, v25
 v_lshlrev_b32 v24, 16, v25
 v_and_b32 v25, 0xffff0000, v25
 v_mul_f32 v24, v24, v17
 v_mul_f32 v25, v25, v17
 v_cvt_pk_bf16_f32 v224, v24, v25
 v_lshlrev_b32 v24, 16, v153
 v_and_b32 v25, 0xffff0000, v153
 v_sub_f32 v24, v24, v19
 v_sub_f32 v25, v25, v19
 v_cvt_pk_bf16_f32 v25, v24, v25
 v_lshlrev_b32 v24, 16, v25
 v_and_b32 v25, 0xffff0000, v25
 v_mul_f32 v24, v24, v17
 v_mul_f32 v25, v25, v17
 v_cvt_pk_bf16_f32 v225, v24, v25
 v_lshlrev_b32 v24, 16, v154
 v_and_b32 v25, 0xffff0000, v154
 v_sub_f32 v24, v24, v19
 v_sub_f32 v25, v25, v19
 v_cvt_pk_bf16_f32 v25, v24, v25
 v_lshlrev_b32 v24, 16, v25
 v_and_b32 v25, 0xffff0000, v25
 v_mul_f32 v24, v24, v17
 v_mul_f32 v25, v25, v17
 v_cvt_pk_bf16_f32 v226, v24, v25
 v_lshlrev_b32 v24, 16, v155
 v_and_b32 v25, 0xffff0000, v155
 v_sub_f32 v24, v24, v19
 v_sub_f32 v25, v25, v19
 v_cvt_pk_bf16_f32 v25, v24, v25
 v_lshlrev_b32 v24, 16, v25
 v_and_b32 v25, 0xffff0000, v25
 v_mul_f32 v24, v24, v17
 v_mul_f32 v25, v25, v17
 v_cvt_pk_bf16_f32 v227, v24, v25
 ds_write_b128 v23, v[224:227] offset:12800
 v_lshlrev_b32 v24, 16, v156
 v_and_b32 v25, 0xffff0000, v156
 v_sub_f32 v24, v24, v19
 v_sub_f32 v25, v25, v19
 v_cvt_pk_bf16_f32 v25, v24, v25
 v_lshlrev_b32 v24, 16, v25
 v_and_b32 v25, 0xffff0000, v25
 v_mul_f32 v24, v24, v17
 v_mul_f32 v25, v25, v17
 v_cvt_pk_bf16_f32 v228, v24, v25
 v_lshlrev_b32 v24, 16, v157
 v_and_b32 v25, 0xffff0000, v157
 v_sub_f32 v24, v24, v19
 v_sub_f32 v25, v25, v19
 v_cvt_pk_bf16_f32 v25, v24, v25
 v_lshlrev_b32 v24, 16, v25
 v_and_b32 v25, 0xffff0000, v25
 v_mul_f32 v24, v24, v17
 v_mul_f32 v25, v25, v17
 v_cvt_pk_bf16_f32 v229, v24, v25
 v_lshlrev_b32 v24, 16, v158
 v_and_b32 v25, 0xffff0000, v158
 v_sub_f32 v24, v24, v19
 v_sub_f32 v25, v25, v19
 v_cvt_pk_bf16_f32 v25, v24, v25
 v_lshlrev_b32 v24, 16, v25
 v_and_b32 v25, 0xffff0000, v25
 v_mul_f32 v24, v24, v17
 v_mul_f32 v25, v25, v17
 v_cvt_pk_bf16_f32 v230, v24, v25
 v_lshlrev_b32 v24, 16, v159
 v_and_b32 v25, 0xffff0000, v159
 v_sub_f32 v24, v24, v19
 v_sub_f32 v25, v25, v19
 v_cvt_pk_bf16_f32 v25, v24, v25
 v_lshlrev_b32 v24, 16, v25
 v_and_b32 v25, 0xffff0000, v25
 v_mul_f32 v24, v24, v17
 v_mul_f32 v25, v25, v17
 v_cvt_pk_bf16_f32 v231, v24, v25
 ds_write_b128 v23, v[228:231] offset:14848
 s_mov_b32 s51, 6
 s_waitcnt lgkmcnt(0)
 s_barrier
 v_accvgpr_write_b32 a0, 0
 v_accvgpr_write_b32 a1, 0
 v_accvgpr_write_b32 a2, 0
 v_accvgpr_write_b32 a3, 0
 v_accvgpr_write_b32 a4, 0
 v_accvgpr_write_b32 a5, 0
 v_accvgpr_write_b32 a6, 0
 v_accvgpr_write_b32 a7, 0
 v_accvgpr_write_b32 a8, 0
 v_accvgpr_write_b32 a9, 0
 v_accvgpr_write_b32 a10, 0
 v_accvgpr_write_b32 a11, 0
 v_accvgpr_write_b32 a12, 0
 v_accvgpr_write_b32 a13, 0
 v_accvgpr_write_b32 a14, 0
 v_accvgpr_write_b32 a15, 0
 v_accvgpr_write_b32 a16, 0
 v_accvgpr_write_b32 a17, 0
 v_accvgpr_write_b32 a18, 0
 v_accvgpr_write_b32 a19, 0
 v_accvgpr_write_b32 a20, 0
 v_accvgpr_write_b32 a21, 0
 v_accvgpr_write_b32 a22, 0
 v_accvgpr_write_b32 a23, 0
 v_accvgpr_write_b32 a24, 0
 v_accvgpr_write_b32 a25, 0
 v_accvgpr_write_b32 a26, 0
 v_accvgpr_write_b32 a27, 0
 v_accvgpr_write_b32 a28, 0
 v_accvgpr_write_b32 a29, 0
 v_accvgpr_write_b32 a30, 0
 v_accvgpr_write_b32 a31, 0
 v_accvgpr_write_b32 a32, 0
 v_accvgpr_write_b32 a33, 0
 v_accvgpr_write_b32 a34, 0
 v_accvgpr_write_b32 a35, 0
 v_accvgpr_write_b32 a36, 0
 v_accvgpr_write_b32 a37, 0
 v_accvgpr_write_b32 a38, 0
 v_accvgpr_write_b32 a39, 0
 v_accvgpr_write_b32 a40, 0
 v_accvgpr_write_b32 a41, 0
 v_accvgpr_write_b32 a42, 0
 v_accvgpr_write_b32 a43, 0
 v_accvgpr_write_b32 a44, 0
 v_accvgpr_write_b32 a45, 0
 v_accvgpr_write_b32 a46, 0
 v_accvgpr_write_b32 a47, 0
 v_accvgpr_write_b32 a48, 0
 v_accvgpr_write_b32 a49, 0
 v_accvgpr_write_b32 a50, 0
 v_accvgpr_write_b32 a51, 0
 v_accvgpr_write_b32 a52, 0
 v_accvgpr_write_b32 a53, 0
 v_accvgpr_write_b32 a54, 0
 v_accvgpr_write_b32 a55, 0
 v_accvgpr_write_b32 a56, 0
 v_accvgpr_write_b32 a57, 0
 v_accvgpr_write_b32 a58, 0
 v_accvgpr_write_b32 a59, 0
 v_accvgpr_write_b32 a60, 0
 v_accvgpr_write_b32 a61, 0
 v_accvgpr_write_b32 a62, 0
 v_accvgpr_write_b32 a63, 0
 v_accvgpr_write_b32 a64, 0
 v_accvgpr_write_b32 a65, 0
 v_accvgpr_write_b32 a66, 0
 v_accvgpr_write_b32 a67, 0
 v_accvgpr_write_b32 a68, 0
 v_accvgpr_write_b32 a69, 0
 v_accvgpr_write_b32 a70, 0
 v_accvgpr_write_b32 a71, 0
 v_accvgpr_write_b32 a72, 0
 v_accvgpr_write_b32 a73, 0
 v_accvgpr_write_b32 a74, 0
 v_accvgpr_write_b32 a75, 0
 v_accvgpr_write_b32 a76, 0
 v_accvgpr_write_b32 a77, 0
 v_accvgpr_write_b32 a78, 0
 v_accvgpr_write_b32 a79, 0
 v_accvgpr_write_b32 a80, 0
 v_accvgpr_write_b32 a81, 0
 v_accvgpr_write_b32 a82, 0
 v_accvgpr_write_b32 a83, 0
 v_accvgpr_write_b32 a84, 0
 v_accvgpr_write_b32 a85, 0
 v_accvgpr_write_b32 a86, 0
 v_accvgpr_write_b32 a87, 0
 v_accvgpr_write_b32 a88, 0
 v_accvgpr_write_b32 a89, 0
 v_accvgpr_write_b32 a90, 0
 v_accvgpr_write_b32 a91, 0
 v_accvgpr_write_b32 a92, 0
 v_accvgpr_write_b32 a93, 0
 v_accvgpr_write_b32 a94, 0
 v_accvgpr_write_b32 a95, 0
 v_accvgpr_write_b32 a96, 0
 v_accvgpr_write_b32 a97, 0
 v_accvgpr_write_b32 a98, 0
 v_accvgpr_write_b32 a99, 0
 v_accvgpr_write_b32 a100, 0
 v_accvgpr_write_b32 a101, 0
 v_accvgpr_write_b32 a102, 0
 v_accvgpr_write_b32 a103, 0
 v_accvgpr_write_b32 a104, 0
 v_accvgpr_write_b32 a105, 0
 v_accvgpr_write_b32 a106, 0
 v_accvgpr_write_b32 a107, 0
 v_accvgpr_write_b32 a108, 0
 v_accvgpr_write_b32 a109, 0
 v_accvgpr_write_b32 a110, 0
 v_accvgpr_write_b32 a111, 0
 v_accvgpr_write_b32 a112, 0
 v_accvgpr_write_b32 a113, 0
 v_accvgpr_write_b32 a114, 0
 v_accvgpr_write_b32 a115, 0
 v_accvgpr_write_b32 a116, 0
 v_accvgpr_write_b32 a117, 0
 v_accvgpr_write_b32 a118, 0
 v_accvgpr_write_b32 a119, 0
 v_accvgpr_write_b32 a120, 0
 v_accvgpr_write_b32 a121, 0
 v_accvgpr_write_b32 a122, 0
 v_accvgpr_write_b32 a123, 0
 v_accvgpr_write_b32 a124, 0
 v_accvgpr_write_b32 a125, 0
 v_accvgpr_write_b32 a126, 0
 v_accvgpr_write_b32 a127, 0
B_F:
 s_add_u32 s50, s43, 1
 s_cmp_eq_u32 s50, 6
 s_cselect_b32 s50, 0, s50
 s_and_b32 s48, s41, 3
 s_mul_i32 s3, s48, 16384
 v_add_u32 v15, s3, v12
 s_waitcnt vmcnt(12)
 ds_read_b128 v[64:67], v15 offset:0
 ds_read_b128 v[68:71], v15 offset:512
 ds_read_b64_tr_b16 v[32:33], v9 offset:0
 ds_read_b64_tr_b16 v[34:35], v9 offset:1024
 ds_read_b64_tr_b16 v[36:37], v10 offset:0
 ds_read_b64_tr_b16 v[38:39], v10 offset:1024
 ds_read_b128 v[72:75], v15 offset:2048
 ds_read_b128 v[76:79], v15 offset:2560
 ds_read_b64_tr_b16 v[40:41], v9 offset:2048
 ds_read_b64_tr_b16 v[42:43], v9 offset:3072
 ds_read_b64_tr_b16 v[44:45], v10 offset:2048
 ds_read_b64_tr_b16 v[46:47], v10 offset:3072
 s_add_u32 s49, s48, 1
 s_and_b32 s49, s49, 3
 s_mul_i32 s65, s49, 352256
 s_lshl_b32 s3, s47, 7
 s_add_u32 s65, s65, s3
 s_lshl_b32 s3, s43, 9
 s_add_u32 s65, s65, s3
 s_mul_i32 s3, s49, 16384
 v_add_u32 v17, s3, v12
 s_waitcnt lgkmcnt(8)
 v_mfma_f32_32x32x16_bf16 v[160:175], v[32:35], v[64:67], 0
 s_waitcnt vmcnt(8)
 ds_read_b128 v[80:83], v15 offset:4096
 v_mfma_f32_32x32x16_bf16 v[176:191], v[32:35], v[68:71], 0
 ds_read_b128 v[84:87], v15 offset:4608
 ds_read_b64_tr_b16 v[48:49], v9 offset:4096
 s_waitcnt lgkmcnt(9)
 v_mfma_f32_32x32x16_bf16 v[192:207], v[36:39], v[64:67], 0
 ds_read_b64_tr_b16 v[50:51], v9 offset:5120
 ds_read_b64_tr_b16 v[52:53], v10 offset:4096
 v_mfma_f32_32x32x16_bf16 v[208:223], v[36:39], v[68:71], 0
 ds_read_b64_tr_b16 v[54:55], v10 offset:5120
 ds_read_b128 v[88:91], v15 offset:6144
 s_waitcnt lgkmcnt(9)
 v_mfma_f32_32x32x16_bf16 v[160:175], v[40:43], v[72:75], v[160:175]
 ds_read_b128 v[92:95], v15 offset:6656
 ds_read_b64_tr_b16 v[56:57], v9 offset:6144
 s_waitcnt lgkmcnt(9)
 s_add_u32 m0, s66, 0
 s_nop 0
 buffer_load_dwordx4 v4, s[60:63], s65 offen lds
 s_add_u32 s65, s65, 22016
 v_mfma_f32_32x32x16_bf16 v[176:191], v[40:43], v[76:79], v[176:191]
 ds_read_b64_tr_b16 v[58:59], v9 offset:7168
 ds_read_b64_tr_b16 v[60:61], v10 offset:6144
 s_add_u32 m0, s66, 1024
 s_nop 0
 buffer_load_dwordx4 v4, s[60:63], s65 offen lds
 s_add_u32 s65, s65, 22016
 v_mfma_f32_32x32x16_bf16 v[192:207], v[44:47], v[72:75], v[192:207]
 ds_read_b64_tr_b16 v[62:63], v10 offset:7168
 s_add_u32 m0, s66, 2048
 s_nop 0
 buffer_load_dwordx4 v4, s[60:63], s65 offen lds
 s_add_u32 s65, s65, 22016
 v_mfma_f32_32x32x16_bf16 v[208:223], v[44:47], v[76:79], v[208:223]
 s_add_u32 m0, s66, 3072
 s_nop 0
 buffer_load_dwordx4 v4, s[60:63], s65 offen lds
 s_add_u32 s65, s65, 22016
 s_waitcnt lgkmcnt(8)
 v_mfma_f32_32x32x16_bf16 v[160:175], v[48:51], v[80:83], v[160:175]
 s_waitcnt vmcnt(8)
 ds_read_b128 v[64:67], v15 offset:8192
 v_mfma_f32_32x32x16_bf16 v[176:191], v[48:51], v[84:87], v[176:191]
 ds_read_b128 v[68:71], v15 offset:8704
 ds_read_b64_tr_b16 v[32:33], v9 offset:8192
 s_waitcnt lgkmcnt(9)
 v_mfma_f32_32x32x16_bf16 v[192:207], v[52:55], v[80:83], v[192:207]
 ds_read_b64_tr_b16 v[34:35], v9 offset:9216
 ds_read_b64_tr_b16 v[36:37], v10 offset:8192
 v_mfma_f32_32x32x16_bf16 v[208:223], v[52:55], v[84:87], v[208:223]
 ds_read_b64_tr_b16 v[38:39], v10 offset:9216
 ds_read_b128 v[72:75], v15 offset:10240
 s_waitcnt lgkmcnt(9)
 v_mfma_f32_32x32x16_bf16 v[160:175], v[56:59], v[88:91], v[160:175]
 ds_read_b128 v[76:79], v15 offset:10752
 ds_read_b64_tr_b16 v[40:41], v9 offset:10240
 s_waitcnt lgkmcnt(9)
 s_add_u32 m0, s66, 4096
 s_nop 0
 buffer_load_dwordx4 v4, s[60:63], s65 offen lds
 s_add_u32 s65, s65, 22016
 v_mfma_f32_32x32x16_bf16 v[176:191], v[56:59], v[92:95], v[176:191]
 ds_read_b64_tr_b16 v[42:43], v9 offset:11264
 ds_read_b64_tr_b16 v[44:45], v10 offset:10240
 s_add_u32 m0, s66, 5120
 s_nop 0
 buffer_load_dwordx4 v4, s[60:63], s65 offen lds
 s_add_u32 s65, s65, 22016
 v_mfma_f32_32x32x16_bf16 v[192:207], v[60:63], v[88:91], v[192:207]
 ds_read_b64_tr_b16 v[46:47], v10 offset:11264
 s_add_u32 m0, s66, 6144
 s_nop 0
 buffer_load_dwordx4 v4, s[60:63], s65 offen lds
 s_add_u32 s65, s65, 22016
 v_mfma_f32_32x32x16_bf16 v[208:223], v[60:63], v[92:95], v[208:223]
 s_add_u32 m0, s66, 7168
 s_nop 0
 buffer_load_dwordx4 v4, s[60:63], s65 offen lds
 s_add_u32 s65, s65, 22016
 s_waitcnt lgkmcnt(8)
 v_mfma_f32_32x32x16_bf16 v[160:175], v[32:35], v[64:67], v[160:175]
 s_waitcnt vmcnt(8)
 ds_read_b128 v[80:83], v15 offset:12288
 v_mfma_f32_32x32x16_bf16 v[176:191], v[32:35], v[68:71], v[176:191]
 ds_read_b128 v[84:87], v15 offset:12800
 ds_read_b64_tr_b16 v[48:49], v9 offset:12288
 s_waitcnt lgkmcnt(9)
 v_mfma_f32_32x32x16_bf16 v[192:207], v[36:39], v[64:67], v[192:207]
 ds_read_b64_tr_b16 v[50:51], v9 offset:13312
 ds_read_b64_tr_b16 v[52:53], v10 offset:12288
 v_mfma_f32_32x32x16_bf16 v[208:223], v[36:39], v[68:71], v[208:223]
 ds_read_b64_tr_b16 v[54:55], v10 offset:13312
 ds_read_b128 v[88:91], v15 offset:14336
 s_waitcnt lgkmcnt(9)
 v_mfma_f32_32x32x16_bf16 v[160:175], v[40:43], v[72:75], v[160:175]
 ds_read_b128 v[92:95], v15 offset:14848
 ds_read_b64_tr_b16 v[56:57], v9 offset:14336
 s_waitcnt lgkmcnt(9)
 s_add_u32 m0, s66, 8192
 s_nop 0
 buffer_load_dwordx4 v4, s[60:63], s65 offen lds
 s_add_u32 s65, s65, 22016
 v_mfma_f32_32x32x16_bf16 v[176:191], v[40:43], v[76:79], v[176:191]
 ds_read_b64_tr_b16 v[58:59], v9 offset:15360
 ds_read_b64_tr_b16 v[60:61], v10 offset:14336
 s_add_u32 m0, s66, 9216
 s_nop 0
 buffer_load_dwordx4 v4, s[60:63], s65 offen lds
 s_add_u32 s65, s65, 22016
 v_mfma_f32_32x32x16_bf16 v[192:207], v[44:47], v[72:75], v[192:207]
 ds_read_b64_tr_b16 v[62:63], v10 offset:15360
 s_add_u32 m0, s66, 10240
 s_nop 0
 buffer_load_dwordx4 v4, s[60:63], s65 offen lds
 s_add_u32 s65, s65, 22016
 v_mfma_f32_32x32x16_bf16 v[208:223], v[44:47], v[76:79], v[208:223]
 s_add_u32 m0, s66, 11264
 s_nop 0
 buffer_load_dwordx4 v4, s[60:63], s65 offen lds
 s_add_u32 s65, s65, 22016
 s_waitcnt lgkmcnt(8)
 v_mfma_f32_32x32x16_bf16 v[160:175], v[48:51], v[80:83], v[160:175]
 s_waitcnt vmcnt(8)
 ds_read_b128 v[64:67], v17 offset:0
 v_mfma_f32_32x32x16_bf16 v[176:191], v[48:51], v[84:87], v[176:191]
 ds_read_b128 v[68:71], v17 offset:512
 ds_read_b64_tr_b16 v[32:33], v9 offset:0
 s_waitcnt lgkmcnt(9)
 v_mfma_f32_32x32x16_bf16 v[192:207], v[52:55], v[80:83], v[192:207]
 ds_read_b64_tr_b16 v[34:35], v9 offset:1024
 ds_read_b64_tr_b16 v[36:37], v10 offset:0
 v_mfma_f32_32x32x16_bf16 v[208:223], v[52:55], v[84:87], v[208:223]
 ds_read_b64_tr_b16 v[38:39], v10 offset:1024
 ds_read_b128 v[72:75], v17 offset:2048
 s_waitcnt lgkmcnt(9)
 v_mfma_f32_32x32x16_bf16 v[160:175], v[56:59], v[88:91], v[160:175]
 ds_read_b128 v[76:79], v17 offset:2560
 ds_read_b64_tr_b16 v[40:41], v9 offset:2048
 s_waitcnt lgkmcnt(9)
 s_add_u32 m0, s66, 12288
 s_nop 0
 buffer_load_dwordx4 v4, s[60:63], s65 offen lds
 s_add_u32 s65, s65, 22016
 v_mfma_f32_32x32x16_bf16 v[176:191], v[56:59], v[92:95], v[176:191]
 ds_read_b64_tr_b16 v[42:43], v9 offset:3072
 ds_read_b64_tr_b16 v[44:45], v10 offset:2048
 s_add_u32 m0, s66, 13312
 s_nop 0
 buffer_load_dwordx4 v4, s[60:63], s65 offen lds
 s_add_u32 s65, s65, 22016
 v_mfma_f32_32x32x16_bf16 v[192:207], v[60:63], v[88:91], v[192:207]
 ds_read_b64_tr_b16 v[46:47], v10 offset:3072
 s_add_u32 m0, s66, 14336
 s_nop 0
 buffer_load_dwordx4 v4, s[60:63], s65 offen lds
 s_add_u32 s65, s65, 22016
 v_mfma_f32_32x32x16_bf16 v[208:223], v[60:63], v[92:95], v[208:223]
 s_add_u32 m0, s66, 15360
 s_nop 0
 buffer_load_dwordx4 v4, s[60:63], s65 offen lds
 s_add_u32 s65, s65, 22016
 v_mov_b32 v15, v17
 s_mov_b32 s48, s49
 s_mov_b32 s35, 2
 .p2align 6
B_G3_L:
 s_add_u32 s49, s48, 1
 s_and_b32 s49, s49, 3
 s_mul_i32 s65, s49, 352256
 s_lshl_b32 s3, s47, 7
 s_add_u32 s65, s65, s3
 s_lshl_b32 s3, s43, 9
 s_add_u32 s65, s65, s3
 s_mul_i32 s3, s49, 16384
 v_add_u32 v17, s3, v12
 s_waitcnt lgkmcnt(8)
 v_mfma_f32_32x32x16_bf16 v[160:175], v[32:35], v[64:67], v[160:175]
 s_waitcnt vmcnt(8)
 ds_read_b128 v[80:83], v15 offset:4096
 v_mfma_f32_32x32x16_bf16 v[176:191], v[32:35], v[68:71], v[176:191]
 ds_read_b128 v[84:87], v15 offset:4608
 ds_read_b64_tr_b16 v[48:49], v9 offset:4096
 s_waitcnt lgkmcnt(9)
 v_mfma_f32_32x32x16_bf16 v[192:207], v[36:39], v[64:67], v[192:207]
 ds_read_b64_tr_b16 v[50:51], v9 offset:5120
 ds_read_b64_tr_b16 v[52:53], v10 offset:4096
 v_mfma_f32_32x32x16_bf16 v[208:223], v[36:39], v[68:71], v[208:223]
 ds_read_b64_tr_b16 v[54:55], v10 offset:5120
 ds_read_b128 v[88:91], v15 offset:6144
 s_waitcnt lgkmcnt(9)
 v_mfma_f32_32x32x16_bf16 v[160:175], v[40:43], v[72:75], v[160:175]
 ds_read_b128 v[92:95], v15 offset:6656
 ds_read_b64_tr_b16 v[56:57], v9 offset:6144
 s_waitcnt lgkmcnt(9)
 s_add_u32 m0, s66, 0
 s_nop 0
 buffer_load_dwordx4 v4, s[60:63], s65 offen lds
 s_add_u32 s65, s65, 22016
 v_mfma_f32_32x32x16_bf16 v[176:191], v[40:43], v[76:79], v[176:191]
 ds_read_b64_tr_b16 v[58:59], v9 offset:7168
 ds_read_b64_tr_b16 v[60:61], v10 offset:6144
 s_add_u32 m0, s66, 1024
 s_nop 0
 buffer_load_dwordx4 v4, s[60:63], s65 offen lds
 s_add_u32 s65, s65, 22016
 v_mfma_f32_32x32x16_bf16 v[192:207], v[44:47], v[72:75], v[192:207]
 ds_read_b64_tr_b16 v[62:63], v10 offset:7168
 s_add_u32 m0, s66, 2048
 s_nop 0
 buffer_load_dwordx4 v4, s[60:63], s65 offen lds
 s_add_u32 s65, s65, 22016
 v_mfma_f32_32x32x16_bf16 v[208:223], v[44:47], v[76:79], v[208:223]
 s_add_u32 m0, s66, 3072
 s_nop 0
 buffer_load_dwordx4 v4, s[60:63], s65 offen lds
 s_add_u32 s65, s65, 22016
 s_waitcnt lgkmcnt(8)
 v_mfma_f32_32x32x16_bf16 v[160:175], v[48:51], v[80:83], v[160:175]
 s_waitcnt vmcnt(8)
 ds_read_b128 v[64:67], v15 offset:8192
 v_mfma_f32_32x32x16_bf16 v[176:191], v[48:51], v[84:87], v[176:191]
 ds_read_b128 v[68:71], v15 offset:8704
 ds_read_b64_tr_b16 v[32:33], v9 offset:8192
 s_waitcnt lgkmcnt(9)
 v_mfma_f32_32x32x16_bf16 v[192:207], v[52:55], v[80:83], v[192:207]
 ds_read_b64_tr_b16 v[34:35], v9 offset:9216
 ds_read_b64_tr_b16 v[36:37], v10 offset:8192
 v_mfma_f32_32x32x16_bf16 v[208:223], v[52:55], v[84:87], v[208:223]
 ds_read_b64_tr_b16 v[38:39], v10 offset:9216
 ds_read_b128 v[72:75], v15 offset:10240
 s_waitcnt lgkmcnt(9)
 v_mfma_f32_32x32x16_bf16 v[160:175], v[56:59], v[88:91], v[160:175]
 ds_read_b128 v[76:79], v15 offset:10752
 ds_read_b64_tr_b16 v[40:41], v9 offset:10240
 s_waitcnt lgkmcnt(9)
 s_add_u32 m0, s66, 4096
 s_nop 0
 buffer_load_dwordx4 v4, s[60:63], s65 offen lds
 s_add_u32 s65, s65, 22016
 v_mfma_f32_32x32x16_bf16 v[176:191], v[56:59], v[92:95], v[176:191]
 ds_read_b64_tr_b16 v[42:43], v9 offset:11264
 ds_read_b64_tr_b16 v[44:45], v10 offset:10240
 s_add_u32 m0, s66, 5120
 s_nop 0
 buffer_load_dwordx4 v4, s[60:63], s65 offen lds
 s_add_u32 s65, s65, 22016
 v_mfma_f32_32x32x16_bf16 v[192:207], v[60:63], v[88:91], v[192:207]
 ds_read_b64_tr_b16 v[46:47], v10 offset:11264
 s_add_u32 m0, s66, 6144
 s_nop 0
 buffer_load_dwordx4 v4, s[60:63], s65 offen lds
 s_add_u32 s65, s65, 22016
 v_mfma_f32_32x32x16_bf16 v[208:223], v[60:63], v[92:95], v[208:223]
 s_add_u32 m0, s66, 7168
 s_nop 0
 buffer_load_dwordx4 v4, s[60:63], s65 offen lds
 s_add_u32 s65, s65, 22016
 s_waitcnt lgkmcnt(8)
 v_mfma_f32_32x32x16_bf16 v[160:175], v[32:35], v[64:67], v[160:175]
 s_waitcnt vmcnt(8)
 ds_read_b128 v[80:83], v15 offset:12288
 v_mfma_f32_32x32x16_bf16 v[176:191], v[32:35], v[68:71], v[176:191]
 ds_read_b128 v[84:87], v15 offset:12800
 ds_read_b64_tr_b16 v[48:49], v9 offset:12288
 s_waitcnt lgkmcnt(9)
 v_mfma_f32_32x32x16_bf16 v[192:207], v[36:39], v[64:67], v[192:207]
 ds_read_b64_tr_b16 v[50:51], v9 offset:13312
 ds_read_b64_tr_b16 v[52:53], v10 offset:12288
 v_mfma_f32_32x32x16_bf16 v[208:223], v[36:39], v[68:71], v[208:223]
 ds_read_b64_tr_b16 v[54:55], v10 offset:13312
 ds_read_b128 v[88:91], v15 offset:14336
 s_waitcnt lgkmcnt(9)
 v_mfma_f32_32x32x16_bf16 v[160:175], v[40:43], v[72:75], v[160:175]
 ds_read_b128 v[92:95], v15 offset:14848
 ds_read_b64_tr_b16 v[56:57], v9 offset:14336
 s_waitcnt lgkmcnt(9)
 s_add_u32 m0, s66, 8192
 s_nop 0
 buffer_load_dwordx4 v4, s[60:63], s65 offen lds
 s_add_u32 s65, s65, 22016
 v_mfma_f32_32x32x16_bf16 v[176:191], v[40:43], v[76:79], v[176:191]
 ds_read_b64_tr_b16 v[58:59], v9 offset:15360
 ds_read_b64_tr_b16 v[60:61], v10 offset:14336
 s_add_u32 m0, s66, 9216
 s_nop 0
 buffer_load_dwordx4 v4, s[60:63], s65 offen lds
 s_add_u32 s65, s65, 22016
 v_mfma_f32_32x32x16_bf16 v[192:207], v[44:47], v[72:75], v[192:207]
 ds_read_b64_tr_b16 v[62:63], v10 offset:15360
 s_add_u32 m0, s66, 10240
 s_nop 0
 buffer_load_dwordx4 v4, s[60:63], s65 offen lds
 s_add_u32 s65, s65, 22016
 v_mfma_f32_32x32x16_bf16 v[208:223], v[44:47], v[76:79], v[208:223]
 s_add_u32 m0, s66, 11264
 s_nop 0
 buffer_load_dwordx4 v4, s[60:63], s65 offen lds
 s_add_u32 s65, s65, 22016
 s_waitcnt lgkmcnt(8)
 v_mfma_f32_32x32x16_bf16 v[160:175], v[48:51], v[80:83], v[160:175]
 s_waitcnt vmcnt(8)
 ds_read_b128 v[64:67], v17 offset:0
 v_mfma_f32_32x32x16_bf16 v[176:191], v[48:51], v[84:87], v[176:191]
 ds_read_b128 v[68:71], v17 offset:512
 ds_read_b64_tr_b16 v[32:33], v9 offset:0
 s_waitcnt lgkmcnt(9)
 v_mfma_f32_32x32x16_bf16 v[192:207], v[52:55], v[80:83], v[192:207]
 ds_read_b64_tr_b16 v[34:35], v9 offset:1024
 ds_read_b64_tr_b16 v[36:37], v10 offset:0
 v_mfma_f32_32x32x16_bf16 v[208:223], v[52:55], v[84:87], v[208:223]
 ds_read_b64_tr_b16 v[38:39], v10 offset:1024
 ds_read_b128 v[72:75], v17 offset:2048
 s_waitcnt lgkmcnt(9)
 v_mfma_f32_32x32x16_bf16 v[160:175], v[56:59], v[88:91], v[160:175]
 ds_read_b128 v[76:79], v17 offset:2560
 ds_read_b64_tr_b16 v[40:41], v9 offset:2048
 s_waitcnt lgkmcnt(9)
 s_add_u32 m0, s66, 12288
 s_nop 0
 buffer_load_dwordx4 v4, s[60:63], s65 offen lds
 s_add_u32 s65, s65, 22016
 v_mfma_f32_32x32x16_bf16 v[176:191], v[56:59], v[92:95], v[176:191]
 ds_read_b64_tr_b16 v[42:43], v9 offset:3072
 ds_read_b64_tr_b16 v[44:45], v10 offset:2048
 s_add_u32 m0, s66, 13312
 s_nop 0
 buffer_load_dwordx4 v4, s[60:63], s65 offen lds
 s_add_u32 s65, s65, 22016
 v_mfma_f32_32x32x16_bf16 v[192:207], v[60:63], v[88:91], v[192:207]
 ds_read_b64_tr_b16 v[46:47], v10 offset:3072
 s_add_u32 m0, s66, 14336
 s_nop 0
 buffer_load_dwordx4 v4, s[60:63], s65 offen lds
 s_add_u32 s65, s65, 22016
 v_mfma_f32_32x32x16_bf16 v[208:223], v[60:63], v[92:95], v[208:223]
 s_add_u32 m0, s66, 15360
 s_nop 0
 buffer_load_dwordx4 v4, s[60:63], s65 offen lds
 s_add_u32 s65, s65, 22016
 v_mov_b32 v15, v17
 s_mov_b32 s48, s49
 s_sub_u32 s35, s35, 1
 s_cmp_lg_u32 s35, 0
 s_cbranch_scc1 B_G3_L
 s_and_b32 s49, s41, 3
 s_mul_i32 s73, s49, 65536
 s_lshl_b32 s3, s47, 8
 s_add_u32 s73, s73, s3
 s_lshl_b32 s3, s43, 18
 s_add_u32 s73, s73, s3
 s_waitcnt lgkmcnt(8)
 v_mfma_f32_32x32x16_bf16 v[160:175], v[32:35], v[64:67], v[160:175]
 s_waitcnt vmcnt(8)
 ds_read_b128 v[80:83], v15 offset:4096
 v_mfma_f32_32x32x16_bf16 v[176:191], v[32:35], v[68:71], v[176:191]
 ds_read_b128 v[84:87], v15 offset:4608
 ds_read_b64_tr_b16 v[48:49], v9 offset:4096
 s_waitcnt lgkmcnt(9)
 v_mfma_f32_32x32x16_bf16 v[192:207], v[36:39], v[64:67], v[192:207]
 ds_read_b64_tr_b16 v[50:51], v9 offset:5120
 ds_read_b64_tr_b16 v[52:53], v10 offset:4096
 v_mfma_f32_32x32x16_bf16 v[208:223], v[36:39], v[68:71], v[208:223]
 ds_read_b64_tr_b16 v[54:55], v10 offset:5120
 ds_read_b128 v[88:91], v15 offset:6144
 s_waitcnt lgkmcnt(9)
 v_mfma_f32_32x32x16_bf16 v[160:175], v[40:43], v[72:75], v[160:175]
 ds_read_b128 v[92:95], v15 offset:6656
 ds_read_b64_tr_b16 v[56:57], v9 offset:6144
 s_waitcnt lgkmcnt(9)
 s_add_u32 m0, s66, 0
 s_nop 0
 buffer_load_dwordx4 v3, s[68:71], s73 offen lds
 s_add_u32 s73, s73, 4096
 v_mfma_f32_32x32x16_bf16 v[176:191], v[40:43], v[76:79], v[176:191]
 ds_read_b64_tr_b16 v[58:59], v9 offset:7168
 ds_read_b64_tr_b16 v[60:61], v10 offset:6144
 s_add_u32 m0, s66, 1024
 s_nop 0
 buffer_load_dwordx4 v3, s[68:71], s73 offen lds
 s_add_u32 s73, s73, 4096
 v_mfma_f32_32x32x16_bf16 v[192:207], v[44:47], v[72:75], v[192:207]
 ds_read_b64_tr_b16 v[62:63], v10 offset:7168
 s_add_u32 m0, s66, 2048
 s_nop 0
 buffer_load_dwordx4 v3, s[68:71], s73 offen lds
 s_add_u32 s73, s73, 4096
 v_mfma_f32_32x32x16_bf16 v[208:223], v[44:47], v[76:79], v[208:223]
 s_add_u32 m0, s66, 3072
 s_nop 0
 buffer_load_dwordx4 v3, s[68:71], s73 offen lds
 s_add_u32 s73, s73, 4096
 s_waitcnt lgkmcnt(8)
 v_mfma_f32_32x32x16_bf16 v[160:175], v[48:51], v[80:83], v[160:175]
 s_waitcnt vmcnt(8)
 ds_read_b128 v[64:67], v15 offset:8192
 v_mfma_f32_32x32x16_bf16 v[176:191], v[48:51], v[84:87], v[176:191]
 ds_read_b128 v[68:71], v15 offset:8704
 ds_read_b64_tr_b16 v[32:33], v9 offset:8192
 s_waitcnt lgkmcnt(9)
 v_mfma_f32_32x32x16_bf16 v[192:207], v[52:55], v[80:83], v[192:207]
 ds_read_b64_tr_b16 v[34:35], v9 offset:9216
 ds_read_b64_tr_b16 v[36:37], v10 offset:8192
 v_mfma_f32_32x32x16_bf16 v[208:223], v[52:55], v[84:87], v[208:223]
 ds_read_b64_tr_b16 v[38:39], v10 offset:9216
 ds_read_b128 v[72:75], v15 offset:10240
 s_waitcnt lgkmcnt(9)
 v_mfma_f32_32x32x16_bf16 v[160:175], v[56:59], v[88:91], v[160:175]
 ds_read_b128 v[76:79], v15 offset:10752
 ds_read_b64_tr_b16 v[40:41], v9 offset:10240
 s_waitcnt lgkmcnt(9)
 s_add_u32 m0, s66, 4096
 s_nop 0
 buffer_load_dwordx4 v3, s[68:71], s73 offen lds
 s_add_u32 s73, s73, 4096
 v_mfma_f32_32x32x16_bf16 v[176:191], v[56:59], v[92:95], v[176:191]
 ds_read_b64_tr_b16 v[42:43], v9 offset:11264
 ds_read_b64_tr_b16 v[44:45], v10 offset:10240
 s_add_u32 m0, s66, 5120
 s_nop 0
 buffer_load_dwordx4 v3, s[68:71], s73 offen lds
 s_add_u32 s73, s73, 4096
 v_mfma_f32_32x32x16_bf16 v[192:207], v[60:63], v[88:91], v[192:207]
 ds_read_b64_tr_b16 v[46:47], v10 offset:11264
 s_add_u32 m0, s66, 6144
 s_nop 0
 buffer_load_dwordx4 v3, s[68:71], s73 offen lds
 s_add_u32 s73, s73, 4096
 v_mfma_f32_32x32x16_bf16 v[208:223], v[60:63], v[92:95], v[208:223]
 s_add_u32 m0, s66, 7168
 s_nop 0
 buffer_load_dwordx4 v3, s[68:71], s73 offen lds
 s_add_u32 s73, s73, 4096
 s_waitcnt lgkmcnt(8)
 v_mfma_f32_32x32x16_bf16 v[160:175], v[32:35], v[64:67], v[160:175]
 s_waitcnt vmcnt(8)
 ds_read_b128 v[80:83], v15 offset:12288
 v_mfma_f32_32x32x16_bf16 v[176:191], v[32:35], v[68:71], v[176:191]
 ds_read_b128 v[84:87], v15 offset:12800
 ds_read_b64_tr_b16 v[48:49], v9 offset:12288
 s_waitcnt lgkmcnt(9)
 v_mfma_f32_32x32x16_bf16 v[192:207], v[36:39], v[64:67], v[192:207]
 ds_read_b64_tr_b16 v[50:51], v9 offset:13312
 ds_read_b64_tr_b16 v[52:53], v10 offset:12288
 v_mfma_f32_32x32x16_bf16 v[208:223], v[36:39], v[68:71], v[208:223]
 ds_read_b64_tr_b16 v[54:55], v10 offset:13312
 ds_read_b128 v[88:91], v15 offset:14336
 s_waitcnt lgkmcnt(9)
 v_mfma_f32_32x32x16_bf16 v[160:175], v[40:43], v[72:75], v[160:175]
 ds_read_b128 v[92:95], v15 offset:14848
 ds_read_b64_tr_b16 v[56:57], v9 offset:14336
 s_waitcnt lgkmcnt(9)
 s_add_u32 m0, s66, 8192
 s_nop 0
 buffer_load_dwordx4 v3, s[68:71], s73 offen lds
 s_add_u32 s73, s73, 4096
 v_mfma_f32_32x32x16_bf16 v[176:191], v[40:43], v[76:79], v[176:191]
 ds_read_b64_tr_b16 v[58:59], v9 offset:15360
 ds_read_b64_tr_b16 v[60:61], v10 offset:14336
 s_add_u32 m0, s66, 9216
 s_nop 0
 buffer_load_dwordx4 v3, s[68:71], s73 offen lds
 s_add_u32 s73, s73, 4096
 v_mfma_f32_32x32x16_bf16 v[192:207], v[44:47], v[72:75], v[192:207]
 ds_read_b64_tr_b16 v[62:63], v10 offset:15360
 s_add_u32 m0, s66, 10240
 s_nop 0
 buffer_load_dwordx4 v3, s[68:71], s73 offen lds
 s_add_u32 s73, s73, 4096
 v_mfma_f32_32x32x16_bf16 v[208:223], v[44:47], v[76:79], v[208:223]
 s_add_u32 m0, s66, 11264
 s_nop 0
 buffer_load_dwordx4 v3, s[68:71], s73 offen lds
 s_add_u32 s73, s73, 4096
 s_waitcnt lgkmcnt(8)
 v_mfma_f32_32x32x16_bf16 v[160:175], v[48:51], v[80:83], v[160:175]
 v_mfma_f32_32x32x16_bf16 v[176:191], v[48:51], v[84:87], v[176:191]
 s_waitcnt lgkmcnt(6)
 v_mfma_f32_32x32x16_bf16 v[192:207], v[52:55], v[80:83], v[192:207]
 v_mfma_f32_32x32x16_bf16 v[208:223], v[52:55], v[84:87], v[208:223]
 s_waitcnt lgkmcnt(2)
 v_mfma_f32_32x32x16_bf16 v[160:175], v[56:59], v[88:91], v[160:175]
 s_waitcnt lgkmcnt(0)
 s_add_u32 m0, s66, 12288
 s_nop 0
 buffer_load_dwordx4 v3, s[68:71], s73 offen lds
 s_add_u32 s73, s73, 4096
 v_mfma_f32_32x32x16_bf16 v[176:191], v[56:59], v[92:95], v[176:191]
 s_add_u32 m0, s66, 13312
 s_nop 0
 buffer_load_dwordx4 v3, s[68:71], s73 offen lds
 s_add_u32 s73, s73, 4096
 v_mfma_f32_32x32x16_bf16 v[192:207], v[60:63], v[88:91], v[192:207]
 s_add_u32 m0, s66, 14336
 s_nop 0
 buffer_load_dwordx4 v3, s[68:71], s73 offen lds
 s_add_u32 s73, s73, 4096
 v_mfma_f32_32x32x16_bf16 v[208:223], v[60:63], v[92:95], v[208:223]
 s_add_u32 m0, s66, 15360
 s_nop 0
 buffer_load_dwordx4 v3, s[68:71], s73 offen lds
 s_add_u32 s73, s73, 4096
 s_lshl_b32 s3, s47, 13
 v_add_u32 v23, s3, v13
 v_cvt_pk_bf16_f32 v161, v160, v161
 v_lshlrev_b32 v160, 16, v161
 v_and_b32 v161, 0xffff0000, v161
 v_cvt_pk_bf16_f32 v163, v162, v163
 v_lshlrev_b32 v162, 16, v163
 v_and_b32 v163, 0xffff0000, v163
 v_cvt_pk_bf16_f32 v165, v164, v165
 v_lshlrev_b32 v164, 16, v165
 v_and_b32 v165, 0xffff0000, v165
 v_cvt_pk_bf16_f32 v167, v166, v167
 v_lshlrev_b32 v166, 16, v167
 v_and_b32 v167, 0xffff0000, v167
 v_cvt_pk_bf16_f32 v169, v168, v169
 v_lshlrev_b32 v168, 16, v169
 v_and_b32 v169, 0xffff0000, v169
 v_cvt_pk_bf16_f32 v171, v170, v171
 v_lshlrev_b32 v170, 16, v171
 v_and_b32 v171, 0xffff0000, v171
 v_cvt_pk_bf16_f32 v173, v172, v173
 v_lshlrev_b32 v172, 16, v173
 v_and_b32 v173, 0xffff0000, v173
 v_cvt_pk_bf16_f32 v175, v174, v175
 v_lshlrev_b32 v174, 16, v175
 v_and_b32 v175, 0xffff0000, v175
 v_mul_f32 v224, v160, v160
 v_mul_f32 v225, v161, v161
 v_mul_f32 v226, v162, v162
 v_mul_f32 v227, v163, v163
 v_mul_f32 v228, v164, v164
 v_mul_f32 v229, v165, v165
 v_mul_f32 v230, v166, v166
 v_mul_f32 v231, v167, v167
 v_mul_f32 v232, v168, v168
 v_mul_f32 v233, v169, v169
 v_mul_f32 v234, v170, v170
 v_mul_f32 v235, v171, v171
 v_mul_f32 v236, v172, v172
 v_mul_f32 v237, v173, v173
 v_mul_f32 v238, v174, v174
 v_mul_f32 v239, v175, v175
 v_fma_f32 v224, v224, s45, v16
 v_fma_f32 v225, v225, s45, v16
 v_fma_f32 v226, v226, s45, v16
 v_fma_f32 v227, v227, s45, v16
 v_fma_f32 v228, v228, s45, v16
 v_fma_f32 v229, v229, s45, v16
 v_fma_f32 v230, v230, s45, v16
 v_fma_f32 v231, v231, s45, v16
 v_fma_f32 v232, v232, s45, v16
 v_fma_f32 v233, v233, s45, v16
 v_fma_f32 v234, v234, s45, v16
 v_fma_f32 v235, v235, s45, v16
 v_fma_f32 v236, v236, s45, v16
 v_fma_f32 v237, v237, s45, v16
 v_fma_f32 v238, v238, s45, v16
 v_fma_f32 v239, v239, s45, v16
 v_mul_f32 v224, v224, v160
 v_mul_f32 v225, v225, v161
 v_mul_f32 v226, v226, v162
 v_mul_f32 v227, v227, v163
 v_mul_f32 v228, v228, v164
 v_mul_f32 v229, v229, v165
 v_mul_f32 v230, v230, v166
 v_mul_f32 v231, v231, v167
 v_mul_f32 v232, v232, v168
 v_mul_f32 v233, v233, v169
 v_mul_f32 v234, v234, v170
 v_mul_f32 v235, v235, v171
 v_mul_f32 v236, v236, v172
 v_mul_f32 v237, v237, v173
 v_mul_f32 v238, v238, v174
 v_mul_f32 v239, v239, v175
 v_exp_f32 v224, v224
 v_exp_f32 v225, v225
 v_exp_f32 v226, v226
 v_exp_f32 v227, v227
 v_exp_f32 v228, v228
 v_exp_f32 v229, v229
 v_exp_f32 v230, v230
 v_exp_f32 v231, v231
 v_exp_f32 v232, v232
 v_exp_f32 v233, v233
 v_exp_f32 v234, v234
 v_exp_f32 v235, v235
 v_exp_f32 v236, v236
 v_exp_f32 v237, v237
 v_exp_f32 v238, v238
 v_exp_f32 v239, v239
 v_add_f32 v224, 1.0, v224
 v_add_f32 v225, 1.0, v225
 v_add_f32 v226, 1.0, v226
 v_add_f32 v227, 1.0, v227
 v_add_f32 v228, 1.0, v228
 v_add_f32 v229, 1.0, v229
 v_add_f32 v230, 1.0, v230
 v_add_f32 v231, 1.0, v231
 v_add_f32 v232, 1.0, v232
 v_add_f32 v233, 1.0, v233
 v_add_f32 v234, 1.0, v234
 v_add_f32 v235, 1.0, v235
 v_add_f32 v236, 1.0, v236
 v_add_f32 v237, 1.0, v237
 v_add_f32 v238, 1.0, v238
 v_add_f32 v239, 1.0, v239
 v_rcp_f32 v224, v224
 v_rcp_f32 v225, v225
 v_rcp_f32 v226, v226
 v_rcp_f32 v227, v227
 v_rcp_f32 v228, v228
 v_rcp_f32 v229, v229
 v_rcp_f32 v230, v230
 v_rcp_f32 v231, v231
 v_rcp_f32 v232, v232
 v_rcp_f32 v233, v233
 v_rcp_f32 v234, v234
 v_rcp_f32 v235, v235
 v_rcp_f32 v236, v236
 v_rcp_f32 v237, v237
 v_rcp_f32 v238, v238
 v_rcp_f32 v239, v239
 v_mul_f32 v160, v160, v224
 v_mul_f32 v161, v161, v225
 v_mul_f32 v162, v162, v226
 v_mul_f32 v163, v163, v227
 v_mul_f32 v164, v164, v228
 v_mul_f32 v165, v165, v229
 v_mul_f32 v166, v166, v230
 v_mul_f32 v167, v167, v231
 v_mul_f32 v168, v168, v232
 v_mul_f32 v169, v169, v233
 v_mul_f32 v170, v170, v234
 v_mul_f32 v171, v171, v235
 v_mul_f32 v172, v172, v236
 v_mul_f32 v173, v173, v237
 v_mul_f32 v174, v174, v238
 v_mul_f32 v175, v175, v239
 v_cvt_pk_bf16_f32 v160, v160, v161
 v_cvt_pk_bf16_f32 v161, v162, v163
 v_cvt_pk_bf16_f32 v162, v164, v165
 v_cvt_pk_bf16_f32 v163, v166, v167
 v_cvt_pk_bf16_f32 v164, v168, v169
 v_cvt_pk_bf16_f32 v165, v170, v171
 v_cvt_pk_bf16_f32 v166, v172, v173
 v_cvt_pk_bf16_f32 v167, v174, v175
 v_cvt_pk_bf16_f32 v177, v176, v177
 v_lshlrev_b32 v176, 16, v177
 v_and_b32 v177, 0xffff0000, v177
 v_cvt_pk_bf16_f32 v179, v178, v179
 v_lshlrev_b32 v178, 16, v179
 v_and_b32 v179, 0xffff0000, v179
 v_cvt_pk_bf16_f32 v181, v180, v181
 v_lshlrev_b32 v180, 16, v181
 v_and_b32 v181, 0xffff0000, v181
 v_cvt_pk_bf16_f32 v183, v182, v183
 v_lshlrev_b32 v182, 16, v183
 v_and_b32 v183, 0xffff0000, v183
 v_cvt_pk_bf16_f32 v185, v184, v185
 v_lshlrev_b32 v184, 16, v185
 v_and_b32 v185, 0xffff0000, v185
 v_cvt_pk_bf16_f32 v187, v186, v187
 v_lshlrev_b32 v186, 16, v187
 v_and_b32 v187, 0xffff0000, v187
 v_cvt_pk_bf16_f32 v189, v188, v189
 v_lshlrev_b32 v188, 16, v189
 v_and_b32 v189, 0xffff0000, v189
 v_cvt_pk_bf16_f32 v191, v190, v191
 v_lshlrev_b32 v190, 16, v191
 v_and_b32 v191, 0xffff0000, v191
 v_mul_f32 v224, v176, v176
 v_mul_f32 v225, v177, v177
 v_mul_f32 v226, v178, v178
 v_mul_f32 v227, v179, v179
 v_mul_f32 v228, v180, v180
 v_mul_f32 v229, v181, v181
 v_mul_f32 v230, v182, v182
 v_mul_f32 v231, v183, v183
 v_mul_f32 v232, v184, v184
 v_mul_f32 v233, v185, v185
 v_mul_f32 v234, v186, v186
 v_mul_f32 v235, v187, v187
 v_mul_f32 v236, v188, v188
 v_mul_f32 v237, v189, v189
 v_mul_f32 v238, v190, v190
 v_mul_f32 v239, v191, v191
 v_fma_f32 v224, v224, s45, v16
 v_fma_f32 v225, v225, s45, v16
 v_fma_f32 v226, v226, s45, v16
 v_fma_f32 v227, v227, s45, v16
 v_fma_f32 v228, v228, s45, v16
 v_fma_f32 v229, v229, s45, v16
 v_fma_f32 v230, v230, s45, v16
 v_fma_f32 v231, v231, s45, v16
 v_fma_f32 v232, v232, s45, v16
 v_fma_f32 v233, v233, s45, v16
 v_fma_f32 v234, v234, s45, v16
 v_fma_f32 v235, v235, s45, v16
 v_fma_f32 v236, v236, s45, v16
 v_fma_f32 v237, v237, s45, v16
 v_fma_f32 v238, v238, s45, v16
 v_fma_f32 v239, v239, s45, v16
 v_mul_f32 v224, v224, v176
 v_mul_f32 v225, v225, v177
 v_mul_f32 v226, v226, v178
 v_mul_f32 v227, v227, v179
 v_mul_f32 v228, v228, v180
 v_mul_f32 v229, v229, v181
 v_mul_f32 v230, v230, v182
 v_mul_f32 v231, v231, v183
 v_mul_f32 v232, v232, v184
 v_mul_f32 v233, v233, v185
 v_mul_f32 v234, v234, v186
 v_mul_f32 v235, v235, v187
 v_mul_f32 v236, v236, v188
 v_mul_f32 v237, v237, v189
 v_mul_f32 v238, v238, v190
 v_mul_f32 v239, v239, v191
 v_exp_f32 v224, v224
 v_exp_f32 v225, v225
 v_exp_f32 v226, v226
 v_exp_f32 v227, v227
 v_exp_f32 v228, v228
 v_exp_f32 v229, v229
 v_exp_f32 v230, v230
 v_exp_f32 v231, v231
 v_exp_f32 v232, v232
 v_exp_f32 v233, v233
 v_exp_f32 v234, v234
 v_exp_f32 v235, v235
 v_exp_f32 v236, v236
 v_exp_f32 v237, v237
 v_exp_f32 v238, v238
 v_exp_f32 v239, v239
 v_add_f32 v224, 1.0, v224
 v_add_f32 v225, 1.0, v225
 v_add_f32 v226, 1.0, v226
 v_add_f32 v227, 1.0, v227
 v_add_f32 v228, 1.0, v228
 v_add_f32 v229, 1.0, v229
 v_add_f32 v230, 1.0, v230
 v_add_f32 v231, 1.0, v231
 v_add_f32 v232, 1.0, v232
 v_add_f32 v233, 1.0, v233
 v_add_f32 v234, 1.0, v234
 v_add_f32 v235, 1.0, v235
 v_add_f32 v236, 1.0, v236
 v_add_f32 v237, 1.0, v237
 v_add_f32 v238, 1.0, v238
 v_add_f32 v239, 1.0, v239
 v_rcp_f32 v224, v224
 v_rcp_f32 v225, v225
 v_rcp_f32 v226, v226
 v_rcp_f32 v227, v227
 v_rcp_f32 v228, v228
 v_rcp_f32 v229, v229
 v_rcp_f32 v230, v230
 v_rcp_f32 v231, v231
 v_rcp_f32 v232, v232
 v_rcp_f32 v233, v233
 v_rcp_f32 v234, v234
 v_rcp_f32 v235, v235
 v_rcp_f32 v236, v236
 v_rcp_f32 v237, v237
 v_rcp_f32 v238, v238
 v_rcp_f32 v239, v239
 v_mul_f32 v176, v176, v224
 v_mul_f32 v177, v177, v225
 v_mul_f32 v178, v178, v226
 v_mul_f32 v179, v179, v227
 v_mul_f32 v180, v180, v228
 v_mul_f32 v181, v181, v229
 v_mul_f32 v182, v182, v230
 v_mul_f32 v183, v183, v231
 v_mul_f32 v184, v184, v232
 v_mul_f32 v185, v185, v233
 v_mul_f32 v186, v186, v234
 v_mul_f32 v187, v187, v235
 v_mul_f32 v188, v188, v236
 v_mul_f32 v189, v189, v237
 v_mul_f32 v190, v190, v238
 v_mul_f32 v191, v191, v239
 v_cvt_pk_bf16_f32 v176, v176, v177
 v_cvt_pk_bf16_f32 v177, v178, v179
 v_cvt_pk_bf16_f32 v178, v180, v181
 v_cvt_pk_bf16_f32 v179, v182, v183
 v_cvt_pk_bf16_f32 v180, v184, v185
 v_cvt_pk_bf16_f32 v181, v186, v187
 v_cvt_pk_bf16_f32 v182, v188, v189
 v_cvt_pk_bf16_f32 v183, v190, v191
 v_cvt_pk_bf16_f32 v193, v192, v193
 v_lshlrev_b32 v192, 16, v193
 v_and_b32 v193, 0xffff0000, v193
 v_cvt_pk_bf16_f32 v195, v194, v195
 v_lshlrev_b32 v194, 16, v195
 v_and_b32 v195, 0xffff0000, v195
 v_cvt_pk_bf16_f32 v197, v196, v197
 v_lshlrev_b32 v196, 16, v197
 v_and_b32 v197, 0xffff0000, v197
 v_cvt_pk_bf16_f32 v199, v198, v199
 v_lshlrev_b32 v198, 16, v199
 v_and_b32 v199, 0xffff0000, v199
 v_cvt_pk_bf16_f32 v201, v200, v201
 v_lshlrev_b32 v200, 16, v201
 v_and_b32 v201, 0xffff0000, v201
 v_cvt_pk_bf16_f32 v203, v202, v203
 v_lshlrev_b32 v202, 16, v203
 v_and_b32 v203, 0xffff0000, v203
 v_cvt_pk_bf16_f32 v205, v204, v205
 v_lshlrev_b32 v204, 16, v205
 v_and_b32 v205, 0xffff0000, v205
 v_cvt_pk_bf16_f32 v207, v206, v207
 v_lshlrev_b32 v206, 16, v207
 v_and_b32 v207, 0xffff0000, v207
 v_mul_f32 v224, v192, v192
 v_mul_f32 v225, v193, v193
 v_mul_f32 v226, v194, v194
 v_mul_f32 v227, v195, v195
 v_mul_f32 v228, v196, v196
 v_mul_f32 v229, v197, v197
 v_mul_f32 v230, v198, v198
 v_mul_f32 v231, v199, v199
 v_mul_f32 v232, v200, v200
 v_mul_f32 v233, v201, v201
 v_mul_f32 v234, v202, v202
 v_mul_f32 v235, v203, v203
 v_mul_f32 v236, v204, v204
 v_mul_f32 v237, v205, v205
 v_mul_f32 v238, v206, v206
 v_mul_f32 v239, v207, v207
 v_fma_f32 v224, v224, s45, v16
 v_fma_f32 v225, v225, s45, v16
 v_fma_f32 v226, v226, s45, v16
 v_fma_f32 v227, v227, s45, v16
 v_fma_f32 v228, v228, s45, v16
 v_fma_f32 v229, v229, s45, v16
 v_fma_f32 v230, v230, s45, v16
 v_fma_f32 v231, v231, s45, v16
 v_fma_f32 v232, v232, s45, v16
 v_fma_f32 v233, v233, s45, v16
 v_fma_f32 v234, v234, s45, v16
 v_fma_f32 v235, v235, s45, v16
 v_fma_f32 v236, v236, s45, v16
 v_fma_f32 v237, v237, s45, v16
 v_fma_f32 v238, v238, s45, v16
 v_fma_f32 v239, v239, s45, v16
 v_mul_f32 v224, v224, v192
 v_mul_f32 v225, v225, v193
 v_mul_f32 v226, v226, v194
 v_mul_f32 v227, v227, v195
 v_mul_f32 v228, v228, v196
 v_mul_f32 v229, v229, v197
 v_mul_f32 v230, v230, v198
 v_mul_f32 v231, v231, v199
 v_mul_f32 v232, v232, v200
 v_mul_f32 v233, v233, v201
 v_mul_f32 v234, v234, v202
 v_mul_f32 v235, v235, v203
 v_mul_f32 v236, v236, v204
 v_mul_f32 v237, v237, v205
 v_mul_f32 v238, v238, v206
 v_mul_f32 v239, v239, v207
 v_exp_f32 v224, v224
 v_exp_f32 v225, v225
 v_exp_f32 v226, v226
 v_exp_f32 v227, v227
 v_exp_f32 v228, v228
 v_exp_f32 v229, v229
 v_exp_f32 v230, v230
 v_exp_f32 v231, v231
 v_exp_f32 v232, v232
 v_exp_f32 v233, v233
 v_exp_f32 v234, v234
 v_exp_f32 v235, v235
 v_exp_f32 v236, v236
 v_exp_f32 v237, v237
 v_exp_f32 v238, v238
 v_exp_f32 v239, v239
 v_add_f32 v224, 1.0, v224
 v_add_f32 v225, 1.0, v225
 v_add_f32 v226, 1.0, v226
 v_add_f32 v227, 1.0, v227
 v_add_f32 v228, 1.0, v228
 v_add_f32 v229, 1.0, v229
 v_add_f32 v230, 1.0, v230
 v_add_f32 v231, 1.0, v231
 v_add_f32 v232, 1.0, v232
 v_add_f32 v233, 1.0, v233
 v_add_f32 v234, 1.0, v234
 v_add_f32 v235, 1.0, v235
 v_add_f32 v236, 1.0, v236
 v_add_f32 v237, 1.0, v237
 v_add_f32 v238, 1.0, v238
 v_add_f32 v239, 1.0, v239
 v_rcp_f32 v224, v224
 v_rcp_f32 v225, v225
 v_rcp_f32 v226, v226
 v_rcp_f32 v227, v227
 v_rcp_f32 v228, v228
 v_rcp_f32 v229, v229
 v_rcp_f32 v230, v230
 v_rcp_f32 v231, v231
 v_rcp_f32 v232, v232
 v_rcp_f32 v233, v233
 v_rcp_f32 v234, v234
 v_rcp_f32 v235, v235
 v_rcp_f32 v236, v236
 v_rcp_f32 v237, v237
 v_rcp_f32 v238, v238
 v_rcp_f32 v239, v239
 v_mul_f32 v192, v192, v224
 v_mul_f32 v193, v193, v225
 v_mul_f32 v194, v194, v226
 v_mul_f32 v195, v195, v227
 v_mul_f32 v196, v196, v228
 v_mul_f32 v197, v197, v229
 v_mul_f32 v198, v198, v230
 v_mul_f32 v199, v199, v231
 v_mul_f32 v200, v200, v232
 v_mul_f32 v201, v201, v233
 v_mul_f32 v202, v202, v234
 v_mul_f32 v203, v203, v235
 v_mul_f32 v204, v204, v236
 v_mul_f32 v205, v205, v237
 v_mul_f32 v206, v206, v238
 v_mul_f32 v207, v207, v239
 v_cvt_pk_bf16_f32 v192, v192, v193
 v_cvt_pk_bf16_f32 v193, v194, v195
 v_cvt_pk_bf16_f32 v194, v196, v197
 v_cvt_pk_bf16_f32 v195, v198, v199
 v_cvt_pk_bf16_f32 v196, v200, v201
 v_cvt_pk_bf16_f32 v197, v202, v203
 v_cvt_pk_bf16_f32 v198, v204, v205
 v_cvt_pk_bf16_f32 v199, v206, v207
 v_cvt_pk_bf16_f32 v209, v208, v209
 v_lshlrev_b32 v208, 16, v209
 v_and_b32 v209, 0xffff0000, v209
 v_cvt_pk_bf16_f32 v211, v210, v211
 v_lshlrev_b32 v210, 16, v211
 v_and_b32 v211, 0xffff0000, v211
 v_cvt_pk_bf16_f32 v213, v212, v213
 v_lshlrev_b32 v212, 16, v213
 v_and_b32 v213, 0xffff0000, v213
 v_cvt_pk_bf16_f32 v215, v214, v215
 v_lshlrev_b32 v214, 16, v215
 v_and_b32 v215, 0xffff0000, v215
 v_cvt_pk_bf16_f32 v217, v216, v217
 v_lshlrev_b32 v216, 16, v217
 v_and_b32 v217, 0xffff0000, v217
 v_cvt_pk_bf16_f32 v219, v218, v219
 v_lshlrev_b32 v218, 16, v219
 v_and_b32 v219, 0xffff0000, v219
 v_cvt_pk_bf16_f32 v221, v220, v221
 v_lshlrev_b32 v220, 16, v221
 v_and_b32 v221, 0xffff0000, v221
 v_cvt_pk_bf16_f32 v223, v222, v223
 v_lshlrev_b32 v222, 16, v223
 v_and_b32 v223, 0xffff0000, v223
 v_mul_f32 v224, v208, v208
 v_mul_f32 v225, v209, v209
 v_mul_f32 v226, v210, v210
 v_mul_f32 v227, v211, v211
 v_mul_f32 v228, v212, v212
 v_mul_f32 v229, v213, v213
 v_mul_f32 v230, v214, v214
 v_mul_f32 v231, v215, v215
 v_mul_f32 v232, v216, v216
 v_mul_f32 v233, v217, v217
 v_mul_f32 v234, v218, v218
 v_mul_f32 v235, v219, v219
 v_mul_f32 v236, v220, v220
 v_mul_f32 v237, v221, v221
 v_mul_f32 v238, v222, v222
 v_mul_f32 v239, v223, v223
 v_fma_f32 v224, v224, s45, v16
 v_fma_f32 v225, v225, s45, v16
 v_fma_f32 v226, v226, s45, v16
 v_fma_f32 v227, v227, s45, v16
 v_fma_f32 v228, v228, s45, v16
 v_fma_f32 v229, v229, s45, v16
 v_fma_f32 v230, v230, s45, v16
 v_fma_f32 v231, v231, s45, v16
 v_fma_f32 v232, v232, s45, v16
 v_fma_f32 v233, v233, s45, v16
 v_fma_f32 v234, v234, s45, v16
 v_fma_f32 v235, v235, s45, v16
 v_fma_f32 v236, v236, s45, v16
 v_fma_f32 v237, v237, s45, v16
 v_fma_f32 v238, v238, s45, v16
 v_fma_f32 v239, v239, s45, v16
 v_mul_f32 v224, v224, v208
 v_mul_f32 v225, v225, v209
 v_mul_f32 v226, v226, v210
 v_mul_f32 v227, v227, v211
 v_mul_f32 v228, v228, v212
 v_mul_f32 v229, v229, v213
 v_mul_f32 v230, v230, v214
 v_mul_f32 v231, v231, v215
 v_mul_f32 v232, v232, v216
 v_mul_f32 v233, v233, v217
 v_mul_f32 v234, v234, v218
 v_mul_f32 v235, v235, v219
 v_mul_f32 v236, v236, v220
 v_mul_f32 v237, v237, v221
 v_mul_f32 v238, v238, v222
 v_mul_f32 v239, v239, v223
 v_exp_f32 v224, v224
 v_exp_f32 v225, v225
 v_exp_f32 v226, v226
 v_exp_f32 v227, v227
 v_exp_f32 v228, v228
 v_exp_f32 v229, v229
 v_exp_f32 v230, v230
 v_exp_f32 v231, v231
 v_exp_f32 v232, v232
 v_exp_f32 v233, v233
 v_exp_f32 v234, v234
 v_exp_f32 v235, v235
 v_exp_f32 v236, v236
 v_exp_f32 v237, v237
 v_exp_f32 v238, v238
 v_exp_f32 v239, v239
 v_add_f32 v224, 1.0, v224
 v_add_f32 v225, 1.0, v225
 v_add_f32 v226, 1.0, v226
 v_add_f32 v227, 1.0, v227
 v_add_f32 v228, 1.0, v228
 v_add_f32 v229, 1.0, v229
 v_add_f32 v230, 1.0, v230
 v_add_f32 v231, 1.0, v231
 v_add_f32 v232, 1.0, v232
 v_add_f32 v233, 1.0, v233
 v_add_f32 v234, 1.0, v234
 v_add_f32 v235, 1.0, v235
 v_add_f32 v236, 1.0, v236
 v_add_f32 v237, 1.0, v237
 v_add_f32 v238, 1.0, v238
 v_add_f32 v239, 1.0, v239
 v_rcp_f32 v224, v224
 v_rcp_f32 v225, v225
 v_rcp_f32 v226, v226
 v_rcp_f32 v227, v227
 v_rcp_f32 v228, v228
 v_rcp_f32 v229, v229
 v_rcp_f32 v230, v230
 v_rcp_f32 v231, v231
 v_rcp_f32 v232, v232
 v_rcp_f32 v233, v233
 v_rcp_f32 v234, v234
 v_rcp_f32 v235, v235
 v_rcp_f32 v236, v236
 v_rcp_f32 v237, v237
 v_rcp_f32 v238, v238
 v_rcp_f32 v239, v239
 v_mul_f32 v208, v208, v224
 v_mul_f32 v209, v209, v225
 v_mul_f32 v210, v210, v226
 v_mul_f32 v211, v211, v227
 v_mul_f32 v212, v212, v228
 v_mul_f32 v213, v213, v229
 v_mul_f32 v214, v214, v230
 v_mul_f32 v215, v215, v231
 v_mul_f32 v216, v216, v232
 v_mul_f32 v217, v217, v233
 v_mul_f32 v218, v218, v234
 v_mul_f32 v219, v219, v235
 v_mul_f32 v220, v220, v236
 v_mul_f32 v221, v221, v237
 v_mul_f32 v222, v222, v238
 v_mul_f32 v223, v223, v239
 v_cvt_pk_bf16_f32 v208, v208, v209
 v_cvt_pk_bf16_f32 v209, v210, v211
 v_cvt_pk_bf16_f32 v210, v212, v213
 v_cvt_pk_bf16_f32 v211, v214, v215
 v_cvt_pk_bf16_f32 v212, v216, v217
 v_cvt_pk_bf16_f32 v213, v218, v219
 v_cvt_pk_bf16_f32 v214, v220, v221
 v_cvt_pk_bf16_f32 v215, v222, v223
 s_barrier
 ds_write_b128 v23, v[160:163] offset:0
 ds_write_b128 v23, v[164:167] offset:2048
 ds_write_b128 v23, v[176:179] offset:512
 ds_write_b128 v23, v[180:183] offset:2560
 ds_write_b128 v23, v[192:195] offset:4096
 ds_write_b128 v23, v[196:199] offset:6144
 ds_write_b128 v23, v[208:211] offset:4608
 ds_write_b128 v23, v[212:215] offset:6656
 s_waitcnt lgkmcnt(0)
 s_barrier
 s_and_b32 s48, s41, 3
 s_mul_i32 s3, s48, 8192
 v_add_u32 v15, s3, v13
 s_waitcnt vmcnt(12)
 ds_read_b128 v[64:67], v15 offset:0
 ds_read_b128 v[68:71], v15 offset:512
 ds_read_b64_tr_b16 v[32:33], v5 offset:0
 ds_read_b64_tr_b16 v[34:35], v5 offset:2048
 ds_read_b64_tr_b16 v[36:37], v6 offset:0
 ds_read_b64_tr_b16 v[38:39], v6 offset:2048
 ds_read_b64_tr_b16 v[40:41], v7 offset:0
 ds_read_b64_tr_b16 v[42:43], v7 offset:2048
 ds_read_b64_tr_b16 v[44:45], v8 offset:0
 ds_read_b64_tr_b16 v[46:47], v8 offset:2048
 s_mov_b32 s35, 3
 .p2align 6
B_G4_L:
 s_add_u32 s49, s48, 1
 s_and_b32 s49, s49, 3
 s_mul_i32 s73, s49, 65536
 s_lshl_b32 s3, s47, 8
 s_add_u32 s73, s73, s3
 s_lshl_b32 s3, s43, 18
 s_add_u32 s73, s73, s3
 s_mul_i32 s3, s49, 8192
 v_add_u32 v17, s3, v13
 s_waitcnt lgkmcnt(6)
 v_mfma_f32_32x32x16_bf16 a[0:15], v[32:35], v[64:67], a[0:15]
 s_waitcnt vmcnt(8)
 ds_read_b128 v[80:83], v15 offset:2048
 v_mfma_f32_32x32x16_bf16 a[16:31], v[32:35], v[68:71], a[16:31]
 ds_read_b128 v[84:87], v15 offset:2560
 ds_read_b64_tr_b16 v[48:49], v5 offset:4096
 s_waitcnt lgkmcnt(7)
 v_mfma_f32_32x32x16_bf16 a[32:47], v[36:39], v[64:67], a[32:47]
 ds_read_b64_tr_b16 v[50:51], v5 offset:6144
 ds_read_b64_tr_b16 v[52:53], v6 offset:4096
 v_mfma_f32_32x32x16_bf16 a[48:63], v[36:39], v[68:71], a[48:63]
 ds_read_b64_tr_b16 v[54:55], v6 offset:6144
 ds_read_b64_tr_b16 v[56:57], v7 offset:4096
 s_waitcnt lgkmcnt(9)
 v_mfma_f32_32x32x16_bf16 a[64:79], v[40:43], v[64:67], a[64:79]
 ds_read_b64_tr_b16 v[58:59], v7 offset:6144
 ds_read_b64_tr_b16 v[60:61], v8 offset:4096
 s_waitcnt lgkmcnt(9)
 s_add_u32 m0, s66, 0
 s_nop 0
 buffer_load_dwordx4 v3, s[68:71], s73 offen lds
 s_add_u32 s73, s73, 4096
 v_mfma_f32_32x32x16_bf16 a[80:95], v[40:43], v[68:71], a[80:95]
 ds_read_b64_tr_b16 v[62:63], v8 offset:6144
 s_add_u32 m0, s66, 1024
 s_nop 0
 buffer_load_dwordx4 v3, s[68:71], s73 offen lds
 s_add_u32 s73, s73, 4096
 v_mfma_f32_32x32x16_bf16 a[96:111], v[44:47], v[64:67], a[96:111]
 s_add_u32 m0, s66, 2048
 s_nop 0
 buffer_load_dwordx4 v3, s[68:71], s73 offen lds
 s_add_u32 s73, s73, 4096
 v_mfma_f32_32x32x16_bf16 a[112:127], v[44:47], v[68:71], a[112:127]
 s_add_u32 m0, s66, 3072
 s_nop 0
 buffer_load_dwordx4 v3, s[68:71], s73 offen lds
 s_add_u32 s73, s73, 4096
 s_waitcnt lgkmcnt(6)
 v_mfma_f32_32x32x16_bf16 a[0:15], v[48:51], v[80:83], a[0:15]
 s_waitcnt vmcnt(8)
 ds_read_b128 v[64:67], v15 offset:4096
 v_mfma_f32_32x32x16_bf16 a[16:31], v[48:51], v[84:87], a[16:31]
 ds_read_b128 v[68:71], v15 offset:4608
 ds_read_b64_tr_b16 v[32:33], v5 offset:8192
 s_waitcnt lgkmcnt(7)
 v_mfma_f32_32x32x16_bf16 a[32:47], v[52:55], v[80:83], a[32:47]
 ds_read_b64_tr_b16 v[34:35], v5 offset:10240
 ds_read_b64_tr_b16 v[36:37], v6 offset:8192
 v_mfma_f32_32x32x16_bf16 a[48:63], v[52:55], v[84:87], a[48:63]
 ds_read_b64_tr_b16 v[38:39], v6 offset:10240
 ds_read_b64_tr_b16 v[40:41], v7 offset:8192
 s_waitcnt lgkmcnt(9)
 v_mfma_f32_32x32x16_bf16 a[64:79], v[56:59], v[80:83], a[64:79]
 ds_read_b64_tr_b16 v[42:43], v7 offset:10240
 ds_read_b64_tr_b16 v[44:45], v8 offset:8192
 s_waitcnt lgkmcnt(9)
 s_add_u32 m0, s66, 4096
 s_nop 0
 buffer_load_dwordx4 v3, s[68:71], s73 offen lds
 s_add_u32 s73, s73, 4096
 v_mfma_f32_32x32x16_bf16 a[80:95], v[56:59], v[84:87], a[80:95]
 ds_read_b64_tr_b16 v[46:47], v8 offset:10240
 s_add_u32 m0, s66, 5120
 s_nop 0
 buffer_load_dwordx4 v3, s[68:71], s73 offen lds
 s_add_u32 s73, s73, 4096
 v_mfma_f32_32x32x16_bf16 a[96:111], v[60:63], v[80:83], a[96:111]
 s_add_u32 m0, s66, 6144
 s_nop 0
 buffer_load_dwordx4 v3, s[68:71], s73 offen lds
 s_add_u32 s73, s73, 4096
 v_mfma_f32_32x32x16_bf16 a[112:127], v[60:63], v[84:87], a[112:127]
 s_add_u32 m0, s66, 7168
 s_nop 0
 buffer_load_dwordx4 v3, s[68:71], s73 offen lds
 s_add_u32 s73, s73, 4096
 s_waitcnt lgkmcnt(6)
 v_mfma_f32_32x32x16_bf16 a[0:15], v[32:35], v[64:67], a[0:15]
 s_waitcnt vmcnt(8)
 ds_read_b128 v[80:83], v15 offset:6144
 v_mfma_f32_32x32x16_bf16 a[16:31], v[32:35], v[68:71], a[16:31]
 ds_read_b128 v[84:87], v15 offset:6656
 ds_read_b64_tr_b16 v[48:49], v5 offset:12288
 s_waitcnt lgkmcnt(7)
 v_mfma_f32_32x32x16_bf16 a[32:47], v[36:39], v[64:67], a[32:47]
 ds_read_b64_tr_b16 v[50:51], v5 offset:14336
 ds_read_b64_tr_b16 v[52:53], v6 offset:12288
 v_mfma_f32_32x32x16_bf16 a[48:63], v[36:39], v[68:71], a[48:63]
 ds_read_b64_tr_b16 v[54:55], v6 offset:14336
 ds_read_b64_tr_b16 v[56:57], v7 offset:12288
 s_waitcnt lgkmcnt(9)
 v_mfma_f32_32x32x16_bf16 a[64:79], v[40:43], v[64:67], a[64:79]
 ds_read_b64_tr_b16 v[58:59], v7 offset:14336
 ds_read_b64_tr_b16 v[60:61], v8 offset:12288
 s_waitcnt lgkmcnt(9)
 s_add_u32 m0, s66, 8192
 s_nop 0
 buffer_load_dwordx4 v3, s[68:71], s73 offen lds
 s_add_u32 s73, s73, 4096
 v_mfma_f32_32x32x16_bf16 a[80:95], v[40:43], v[68:71], a[80:95]
 ds_read_b64_tr_b16 v[62:63], v8 offset:14336
 s_add_u32 m0, s66, 9216
 s_nop 0
 buffer_load_dwordx4 v3, s[68:71], s73 offen lds
 s_add_u32 s73, s73, 4096
 v_mfma_f32_32x32x16_bf16 a[96:111], v[44:47], v[64:67], a[96:111]
 s_add_u32 m0, s66, 10240
 s_nop 0
 buffer_load_dwordx4 v3, s[68:71], s73 offen lds
 s_add_u32 s73, s73, 4096
 v_mfma_f32_32x32x16_bf16 a[112:127], v[44:47], v[68:71], a[112:127]
 s_add_u32 m0, s66, 11264
 s_nop 0
 buffer_load_dwordx4 v3, s[68:71], s73 offen lds
 s_add_u32 s73, s73, 4096
 s_waitcnt lgkmcnt(6)
 v_mfma_f32_32x32x16_bf16 a[0:15], v[48:51], v[80:83], a[0:15]
 s_waitcnt vmcnt(8)
 ds_read_b128 v[64:67], v17 offset:0
 v_mfma_f32_32x32x16_bf16 a[16:31], v[48:51], v[84:87], a[16:31]
 ds_read_b128 v[68:71], v17 offset:512
 ds_read_b64_tr_b16 v[32:33], v5 offset:0
 s_waitcnt lgkmcnt(7)
 v_mfma_f32_32x32x16_bf16 a[32:47], v[52:55], v[80:83], a[32:47]
 ds_read_b64_tr_b16 v[34:35], v5 offset:2048
 ds_read_b64_tr_b16 v[36:37], v6 offset:0
 v_mfma_f32_32x32x16_bf16 a[48:63], v[52:55], v[84:87], a[48:63]
 ds_read_b64_tr_b16 v[38:39], v6 offset:2048
 ds_read_b64_tr_b16 v[40:41], v7 offset:0
 s_waitcnt lgkmcnt(9)
 v_mfma_f32_32x32x16_bf16 a[64:79], v[56:59], v[80:83], a[64:79]
 ds_read_b64_tr_b16 v[42:43], v7 offset:2048
 ds_read_b64_tr_b16 v[44:45], v8 offset:0
 s_waitcnt lgkmcnt(9)
 s_add_u32 m0, s66, 12288
 s_nop 0
 buffer_load_dwordx4 v3, s[68:71], s73 offen lds
 s_add_u32 s73, s73, 4096
 v_mfma_f32_32x32x16_bf16 a[80:95], v[56:59], v[84:87], a[80:95]
 ds_read_b64_tr_b16 v[46:47], v8 offset:2048
 s_add_u32 m0, s66, 13312
 s_nop 0
 buffer_load_dwordx4 v3, s[68:71], s73 offen lds
 s_add_u32 s73, s73, 4096
 v_mfma_f32_32x32x16_bf16 a[96:111], v[60:63], v[80:83], a[96:111]
 s_add_u32 m0, s66, 14336
 s_nop 0
 buffer_load_dwordx4 v3, s[68:71], s73 offen lds
 s_add_u32 s73, s73, 4096
 v_mfma_f32_32x32x16_bf16 a[112:127], v[60:63], v[84:87], a[112:127]
 s_add_u32 m0, s66, 15360
 s_nop 0
 buffer_load_dwordx4 v3, s[68:71], s73 offen lds
 s_add_u32 s73, s73, 4096
 v_mov_b32 v15, v17
 s_mov_b32 s48, s49
 s_sub_u32 s35, s35, 1
 s_cmp_lg_u32 s35, 0
 s_cbranch_scc1 B_G4_L
 s_and_b32 s49, s41, 3
 s_mul_i32 s65, s49, 352256
 s_lshl_b32 s3, s47, 7
 s_add_u32 s65, s65, s3
 s_lshl_b32 s3, s50, 9
 s_add_u32 s65, s65, s3
 s_waitcnt lgkmcnt(6)
 v_mfma_f32_32x32x16_bf16 a[0:15], v[32:35], v[64:67], a[0:15]
 s_waitcnt vmcnt(8)
 ds_read_b128 v[80:83], v15 offset:2048
 v_mfma_f32_32x32x16_bf16 a[16:31], v[32:35], v[68:71], a[16:31]
 ds_read_b128 v[84:87], v15 offset:2560
 ds_read_b64_tr_b16 v[48:49], v5 offset:4096
 s_waitcnt lgkmcnt(7)
 v_mfma_f32_32x32x16_bf16 a[32:47], v[36:39], v[64:67], a[32:47]
 ds_read_b64_tr_b16 v[50:51], v5 offset:6144
 ds_read_b64_tr_b16 v[52:53], v6 offset:4096
 v_mfma_f32_32x32x16_bf16 a[48:63], v[36:39], v[68:71], a[48:63]
 ds_read_b64_tr_b16 v[54:55], v6 offset:6144
 ds_read_b64_tr_b16 v[56:57], v7 offset:4096
 s_waitcnt lgkmcnt(9)
 v_mfma_f32_32x32x16_bf16 a[64:79], v[40:43], v[64:67], a[64:79]
 ds_read_b64_tr_b16 v[58:59], v7 offset:6144
 ds_read_b64_tr_b16 v[60:61], v8 offset:4096
 s_waitcnt lgkmcnt(9)
 s_add_u32 m0, s66, 0
 s_nop 0
 buffer_load_dwordx4 v4, s[60:63], s65 offen lds
 s_add_u32 s65, s65, 22016
 v_mfma_f32_32x32x16_bf16 a[80:95], v[40:43], v[68:71], a[80:95]
 ds_read_b64_tr_b16 v[62:63], v8 offset:6144
 s_add_u32 m0, s66, 1024
 s_nop 0
 buffer_load_dwordx4 v4, s[60:63], s65 offen lds
 s_add_u32 s65, s65, 22016
 v_mfma_f32_32x32x16_bf16 a[96:111], v[44:47], v[64:67], a[96:111]
 s_add_u32 m0, s66, 2048
 s_nop 0
 buffer_load_dwordx4 v4, s[60:63], s65 offen lds
 s_add_u32 s65, s65, 22016
 v_mfma_f32_32x32x16_bf16 a[112:127], v[44:47], v[68:71], a[112:127]
 s_add_u32 m0, s66, 3072
 s_nop 0
 buffer_load_dwordx4 v4, s[60:63], s65 offen lds
 s_add_u32 s65, s65, 22016
 s_waitcnt lgkmcnt(6)
 v_mfma_f32_32x32x16_bf16 a[0:15], v[48:51], v[80:83], a[0:15]
 s_waitcnt vmcnt(8)
 ds_read_b128 v[64:67], v15 offset:4096
 v_mfma_f32_32x32x16_bf16 a[16:31], v[48:51], v[84:87], a[16:31]
 ds_read_b128 v[68:71], v15 offset:4608
 ds_read_b64_tr_b16 v[32:33], v5 offset:8192
 s_waitcnt lgkmcnt(7)
 v_mfma_f32_32x32x16_bf16 a[32:47], v[52:55], v[80:83], a[32:47]
 ds_read_b64_tr_b16 v[34:35], v5 offset:10240
 ds_read_b64_tr_b16 v[36:37], v6 offset:8192
 v_mfma_f32_32x32x16_bf16 a[48:63], v[52:55], v[84:87], a[48:63]
 ds_read_b64_tr_b16 v[38:39], v6 offset:10240
 ds_read_b64_tr_b16 v[40:41], v7 offset:8192
 s_waitcnt lgkmcnt(9)
 v_mfma_f32_32x32x16_bf16 a[64:79], v[56:59], v[80:83], a[64:79]
 ds_read_b64_tr_b16 v[42:43], v7 offset:10240
 ds_read_b64_tr_b16 v[44:45], v8 offset:8192
 s_waitcnt lgkmcnt(9)
 s_add_u32 m0, s66, 4096
 s_nop 0
 buffer_load_dwordx4 v4, s[60:63], s65 offen lds
 s_add_u32 s65, s65, 22016
 v_mfma_f32_32x32x16_bf16 a[80:95], v[56:59], v[84:87], a[80:95]
 ds_read_b64_tr_b16 v[46:47], v8 offset:10240
 s_add_u32 m0, s66, 5120
 s_nop 0
 buffer_load_dwordx4 v4, s[60:63], s65 offen lds
 s_add_u32 s65, s65, 22016
 v_mfma_f32_32x32x16_bf16 a[96:111], v[60:63], v[80:83], a[96:111]
 s_add_u32 m0, s66, 6144
 s_nop 0
 buffer_load_dwordx4 v4, s[60:63], s65 offen lds
 s_add_u32 s65, s65, 22016
 v_mfma_f32_32x32x16_bf16 a[112:127], v[60:63], v[84:87], a[112:127]
 s_add_u32 m0, s66, 7168
 s_nop 0
 buffer_load_dwordx4 v4, s[60:63], s65 offen lds
 s_add_u32 s65, s65, 22016
 s_waitcnt lgkmcnt(6)
 v_mfma_f32_32x32x16_bf16 a[0:15], v[32:35], v[64:67], a[0:15]
 s_waitcnt vmcnt(8)
 ds_read_b128 v[80:83], v15 offset:6144
 v_mfma_f32_32x32x16_bf16 a[16:31], v[32:35], v[68:71], a[16:31]
 ds_read_b128 v[84:87], v15 offset:6656
 ds_read_b64_tr_b16 v[48:49], v5 offset:12288
 s_waitcnt lgkmcnt(7)
 v_mfma_f32_32x32x16_bf16 a[32:47], v[36:39], v[64:67], a[32:47]
 ds_read_b64_tr_b16 v[50:51], v5 offset:14336
 ds_read_b64_tr_b16 v[52:53], v6 offset:12288
 v_mfma_f32_32x32x16_bf16 a[48:63], v[36:39], v[68:71], a[48:63]
 ds_read_b64_tr_b16 v[54:55], v6 offset:14336
 ds_read_b64_tr_b16 v[56:57], v7 offset:12288
 s_waitcnt lgkmcnt(9)
 v_mfma_f32_32x32x16_bf16 a[64:79], v[40:43], v[64:67], a[64:79]
 ds_read_b64_tr_b16 v[58:59], v7 offset:14336
 ds_read_b64_tr_b16 v[60:61], v8 offset:12288
 s_waitcnt lgkmcnt(9)
 s_add_u32 m0, s66, 8192
 s_nop 0
 buffer_load_dwordx4 v4, s[60:63], s65 offen lds
 s_add_u32 s65, s65, 22016
 v_mfma_f32_32x32x16_bf16 a[80:95], v[40:43], v[68:71], a[80:95]
 ds_read_b64_tr_b16 v[62:63], v8 offset:14336
 s_add_u32 m0, s66, 9216
 s_nop 0
 buffer_load_dwordx4 v4, s[60:63], s65 offen lds
 s_add_u32 s65, s65, 22016
 v_mfma_f32_32x32x16_bf16 a[96:111], v[44:47], v[64:67], a[96:111]
 s_add_u32 m0, s66, 10240
 s_nop 0
 buffer_load_dwordx4 v4, s[60:63], s65 offen lds
 s_add_u32 s65, s65, 22016
 v_mfma_f32_32x32x16_bf16 a[112:127], v[44:47], v[68:71], a[112:127]
 s_add_u32 m0, s66, 11264
 s_nop 0
 buffer_load_dwordx4 v4, s[60:63], s65 offen lds
 s_add_u32 s65, s65, 22016
 s_waitcnt lgkmcnt(6)
 v_mfma_f32_32x32x16_bf16 a[0:15], v[48:51], v[80:83], a[0:15]
 v_mfma_f32_32x32x16_bf16 a[16:31], v[48:51], v[84:87], a[16:31]
 s_waitcnt lgkmcnt(4)
 v_mfma_f32_32x32x16_bf16 a[32:47], v[52:55], v[80:83], a[32:47]
 v_mfma_f32_32x32x16_bf16 a[48:63], v[52:55], v[84:87], a[48:63]
 s_waitcnt lgkmcnt(2)
 v_mfma_f32_32x32x16_bf16 a[64:79], v[56:59], v[80:83], a[64:79]
 s_waitcnt lgkmcnt(0)
 s_add_u32 m0, s66, 12288
 s_nop 0
 buffer_load_dwordx4 v4, s[60:63], s65 offen lds
 s_add_u32 s65, s65, 22016
 v_mfma_f32_32x32x16_bf16 a[80:95], v[56:59], v[84:87], a[80:95]
 s_add_u32 m0, s66, 13312
 s_nop 0
 buffer_load_dwordx4 v4, s[60:63], s65 offen lds
 s_add_u32 s65, s65, 22016
 v_mfma_f32_32x32x16_bf16 a[96:111], v[60:63], v[80:83], a[96:111]
 s_add_u32 m0, s66, 14336
 s_nop 0
 buffer_load_dwordx4 v4, s[60:63], s65 offen lds
 s_add_u32 s65, s65, 22016
 v_mfma_f32_32x32x16_bf16 a[112:127], v[60:63], v[84:87], a[112:127]
 s_add_u32 m0, s66, 15360
 s_nop 0
 buffer_load_dwordx4 v4, s[60:63], s65 offen lds
 s_add_u32 s65, s65, 22016
 s_mov_b32 s43, s50
 s_sub_u32 s51, s51, 1
 s_cmp_lg_u32 s51, 0
 s_cbranch_scc1 B_F
 s_mov_b32 s3, 0xbfb8aa3b
 s_add_u32 s34, s44, 0
 v_accvgpr_read_b32 v24, a0
 v_accvgpr_read_b32 v25, a1
 v_cvt_pk_bf16_f32 v26, v24, v25
 v_lshlrev_b32 v24, 16, v26
 v_and_b32 v25, 0xffff0000, v26
 v_lshlrev_b32 v26, 16, v96
 v_and_b32 v27, 0xffff0000, v96
 v_add_f32 v24, v24, v26
 v_add_f32 v25, v25, v27
 v_cvt_pk_bf16_f32 v26, v24, v25
 v_lshlrev_b32 v160, 16, v26
 v_and_b32 v161, 0xffff0000, v26
 v_accvgpr_read_b32 v24, a2
 v_accvgpr_read_b32 v25, a3
 v_cvt_pk_bf16_f32 v26, v24, v25
 v_lshlrev_b32 v24, 16, v26
 v_and_b32 v25, 0xffff0000, v26
 v_lshlrev_b32 v26, 16, v97
 v_and_b32 v27, 0xffff0000, v97
 v_add_f32 v24, v24, v26
 v_add_f32 v25, v25, v27
 v_cvt_pk_bf16_f32 v26, v24, v25
 v_lshlrev_b32 v162, 16, v26
 v_and_b32 v163, 0xffff0000, v26
 v_accvgpr_read_b32 v24, a4
 v_accvgpr_read_b32 v25, a5
 v_cvt_pk_bf16_f32 v26, v24, v25
 v_lshlrev_b32 v24, 16, v26
 v_and_b32 v25, 0xffff0000, v26
 v_lshlrev_b32 v26, 16, v98
 v_and_b32 v27, 0xffff0000, v98
 v_add_f32 v24, v24, v26
 v_add_f32 v25, v25, v27
 v_cvt_pk_bf16_f32 v26, v24, v25
 v_lshlrev_b32 v164, 16, v26
 v_and_b32 v165, 0xffff0000, v26
 v_accvgpr_read_b32 v24, a6
 v_accvgpr_read_b32 v25, a7
 v_cvt_pk_bf16_f32 v26, v24, v25
 v_lshlrev_b32 v24, 16, v26
 v_and_b32 v25, 0xffff0000, v26
 v_lshlrev_b32 v26, 16, v99
 v_and_b32 v27, 0xffff0000, v99
 v_add_f32 v24, v24, v26
 v_add_f32 v25, v25, v27
 v_cvt_pk_bf16_f32 v26, v24, v25
 v_lshlrev_b32 v166, 16, v26
 v_and_b32 v167, 0xffff0000, v26
 v_mul_f32 v168, s3, v160
 v_mul_f32 v169, s3, v161
 v_mul_f32 v170, s3, v162
 v_mul_f32 v171, s3, v163
 v_mul_f32 v172, s3, v164
 v_mul_f32 v173, s3, v165
 v_mul_f32 v174, s3, v166
 v_mul_f32 v175, s3, v167
 v_exp_f32 v168, v168
 v_exp_f32 v169, v169
 v_exp_f32 v170, v170
 v_exp_f32 v171, v171
 v_exp_f32 v172, v172
 v_exp_f32 v173, v173
 v_exp_f32 v174, v174
 v_exp_f32 v175, v175
 v_add_f32 v168, 1.0, v168
 v_add_f32 v169, 1.0, v169
 v_add_f32 v170, 1.0, v170
 v_add_f32 v171, 1.0, v171
 v_add_f32 v172, 1.0, v172
 v_add_f32 v173, 1.0, v173
 v_add_f32 v174, 1.0, v174
 v_add_f32 v175, 1.0, v175
 v_rcp_f32 v168, v168
 v_rcp_f32 v169, v169
 v_rcp_f32 v170, v170
 v_rcp_f32 v171, v171
 v_rcp_f32 v172, v172
 v_rcp_f32 v173, v173
 v_rcp_f32 v174, v174
 v_rcp_f32 v175, v175
 v_mul_f32 v160, v160, v168
 v_mul_f32 v161, v161, v169
 v_mul_f32 v162, v162, v170
 v_mul_f32 v163, v163, v171
 v_mul_f32 v164, v164, v172
 v_mul_f32 v165, v165, v173
 v_mul_f32 v166, v166, v174
 v_mul_f32 v167, v167, v175
 v_cvt_pk_bf16_f32 v176, v160, v161
 v_cvt_pk_bf16_f32 v177, v162, v163
 v_cvt_pk_bf16_f32 v178, v164, v165
 v_cvt_pk_bf16_f32 v179, v166, v167
 buffer_store_dwordx4 v[176:179], v2, s[36:39], s34 offen offset:0 sc1
 v_accvgpr_read_b32 v24, a8
 v_accvgpr_read_b32 v25, a9
 v_cvt_pk_bf16_f32 v26, v24, v25
 v_lshlrev_b32 v24, 16, v26
 v_and_b32 v25, 0xffff0000, v26
 v_lshlrev_b32 v26, 16, v100
 v_and_b32 v27, 0xffff0000, v100
 v_add_f32 v24, v24, v26
 v_add_f32 v25, v25, v27
 v_cvt_pk_bf16_f32 v26, v24, v25
 v_lshlrev_b32 v160, 16, v26
 v_and_b32 v161, 0xffff0000, v26
 v_accvgpr_read_b32 v24, a10
 v_accvgpr_read_b32 v25, a11
 v_cvt_pk_bf16_f32 v26, v24, v25
 v_lshlrev_b32 v24, 16, v26
 v_and_b32 v25, 0xffff0000, v26
 v_lshlrev_b32 v26, 16, v101
 v_and_b32 v27, 0xffff0000, v101
 v_add_f32 v24, v24, v26
 v_add_f32 v25, v25, v27
 v_cvt_pk_bf16_f32 v26, v24, v25
 v_lshlrev_b32 v162, 16, v26
 v_and_b32 v163, 0xffff0000, v26
 v_accvgpr_read_b32 v24, a12
 v_accvgpr_read_b32 v25, a13
 v_cvt_pk_bf16_f32 v26, v24, v25
 v_lshlrev_b32 v24, 16, v26
 v_and_b32 v25, 0xffff0000, v26
 v_lshlrev_b32 v26, 16, v102
 v_and_b32 v27, 0xffff0000, v102
 v_add_f32 v24, v24, v26
 v_add_f32 v25, v25, v27
 v_cvt_pk_bf16_f32 v26, v24, v25
 v_lshlrev_b32 v164, 16, v26
 v_and_b32 v165, 0xffff0000, v26
 v_accvgpr_read_b32 v24, a14
 v_accvgpr_read_b32 v25, a15
 v_cvt_pk_bf16_f32 v26, v24, v25
 v_lshlrev_b32 v24, 16, v26
 v_and_b32 v25, 0xffff0000, v26
 v_lshlrev_b32 v26, 16, v103
 v_and_b32 v27, 0xffff0000, v103
 v_add_f32 v24, v24, v26
 v_add_f32 v25, v25, v27
 v_cvt_pk_bf16_f32 v26, v24, v25
 v_lshlrev_b32 v166, 16, v26
 v_and_b32 v167, 0xffff0000, v26
 v_mul_f32 v168, s3, v160
 v_mul_f32 v169, s3, v161
 v_mul_f32 v170, s3, v162
 v_mul_f32 v171, s3, v163
 v_mul_f32 v172, s3, v164
 v_mul_f32 v173, s3, v165
 v_mul_f32 v174, s3, v166
 v_mul_f32 v175, s3, v167
 v_exp_f32 v168, v168
 v_exp_f32 v169, v169
 v_exp_f32 v170, v170
 v_exp_f32 v171, v171
 v_exp_f32 v172, v172
 v_exp_f32 v173, v173
 v_exp_f32 v174, v174
 v_exp_f32 v175, v175
 v_add_f32 v168, 1.0, v168
 v_add_f32 v169, 1.0, v169
 v_add_f32 v170, 1.0, v170
 v_add_f32 v171, 1.0, v171
 v_add_f32 v172, 1.0, v172
 v_add_f32 v173, 1.0, v173
 v_add_f32 v174, 1.0, v174
 v_add_f32 v175, 1.0, v175
 v_rcp_f32 v168, v168
 v_rcp_f32 v169, v169
 v_rcp_f32 v170, v170
 v_rcp_f32 v171, v171
 v_rcp_f32 v172, v172
 v_rcp_f32 v173, v173
 v_rcp_f32 v174, v174
 v_rcp_f32 v175, v175
 v_mul_f32 v160, v160, v168
 v_mul_f32 v161, v161, v169
 v_mul_f32 v162, v162, v170
 v_mul_f32 v163, v163, v171
 v_mul_f32 v164, v164, v172
 v_mul_f32 v165, v165, v173
 v_mul_f32 v166, v166, v174
 v_mul_f32 v167, v167, v175
 v_cvt_pk_bf16_f32 v180, v160, v161
 v_cvt_pk_bf16_f32 v181, v162, v163
 v_cvt_pk_bf16_f32 v182, v164, v165
 v_cvt_pk_bf16_f32 v183, v166, v167
 buffer_store_dwordx4 v[180:183], v2, s[36:39], s34 offen offset:1024 sc1
 s_add_u32 s34, s44, 32768
 v_accvgpr_read_b32 v24, a16
 v_accvgpr_read_b32 v25, a17
 v_cvt_pk_bf16_f32 v26, v24, v25
 v_lshlrev_b32 v24, 16, v26
 v_and_b32 v25, 0xffff0000, v26
 v_lshlrev_b32 v26, 16, v104
 v_and_b32 v27, 0xffff0000, v104
 v_add_f32 v24, v24, v26
 v_add_f32 v25, v25, v27
 v_cvt_pk_bf16_f32 v26, v24, v25
 v_lshlrev_b32 v160, 16, v26
 v_and_b32 v161, 0xffff0000, v26
 v_accvgpr_read_b32 v24, a18
 v_accvgpr_read_b32 v25, a19
 v_cvt_pk_bf16_f32 v26, v24, v25
 v_lshlrev_b32 v24, 16, v26
 v_and_b32 v25, 0xffff0000, v26
 v_lshlrev_b32 v26, 16, v105
 v_and_b32 v27, 0xffff0000, v105
 v_add_f32 v24, v24, v26
 v_add_f32 v25, v25, v27
 v_cvt_pk_bf16_f32 v26, v24, v25
 v_lshlrev_b32 v162, 16, v26
 v_and_b32 v163, 0xffff0000, v26
 v_accvgpr_read_b32 v24, a20
 v_accvgpr_read_b32 v25, a21
 v_cvt_pk_bf16_f32 v26, v24, v25
 v_lshlrev_b32 v24, 16, v26
 v_and_b32 v25, 0xffff0000, v26
 v_lshlrev_b32 v26, 16, v106
 v_and_b32 v27, 0xffff0000, v106
 v_add_f32 v24, v24, v26
 v_add_f32 v25, v25, v27
 v_cvt_pk_bf16_f32 v26, v24, v25
 v_lshlrev_b32 v164, 16, v26
 v_and_b32 v165, 0xffff0000, v26
 v_accvgpr_read_b32 v24, a22
 v_accvgpr_read_b32 v25, a23
 v_cvt_pk_bf16_f32 v26, v24, v25
 v_lshlrev_b32 v24, 16, v26
 v_and_b32 v25, 0xffff0000, v26
 v_lshlrev_b32 v26, 16, v107
 v_and_b32 v27, 0xffff0000, v107
 v_add_f32 v24, v24, v26
 v_add_f32 v25, v25, v27
 v_cvt_pk_bf16_f32 v26, v24, v25
 v_lshlrev_b32 v166, 16, v26
 v_and_b32 v167, 0xffff0000, v26
 v_mul_f32 v168, s3, v160
 v_mul_f32 v169, s3, v161
 v_mul_f32 v170, s3, v162
 v_mul_f32 v171, s3, v163
 v_mul_f32 v172, s3, v164
 v_mul_f32 v173, s3, v165
 v_mul_f32 v174, s3, v166
 v_mul_f32 v175, s3, v167
 v_exp_f32 v168, v168
 v_exp_f32 v169, v169
 v_exp_f32 v170, v170
 v_exp_f32 v171, v171
 v_exp_f32 v172, v172
 v_exp_f32 v173, v173
 v_exp_f32 v174, v174
 v_exp_f32 v175, v175
 v_add_f32 v168, 1.0, v168
 v_add_f32 v169, 1.0, v169
 v_add_f32 v170, 1.0, v170
 v_add_f32 v171, 1.0, v171
 v_add_f32 v172, 1.0, v172
 v_add_f32 v173, 1.0, v173
 v_add_f32 v174, 1.0, v174
 v_add_f32 v175, 1.0, v175
 v_rcp_f32 v168, v168
 v_rcp_f32 v169, v169
 v_rcp_f32 v170, v170
 v_rcp_f32 v171, v171
 v_rcp_f32 v172, v172
 v_rcp_f32 v173, v173
 v_rcp_f32 v174, v174
 v_rcp_f32 v175, v175
 v_mul_f32 v160, v160, v168
 v_mul_f32 v161, v161, v169
 v_mul_f32 v162, v162, v170
 v_mul_f32 v163, v163, v171
 v_mul_f32 v164, v164, v172
 v_mul_f32 v165, v165, v173
 v_mul_f32 v166, v166, v174
 v_mul_f32 v167, v167, v175
 v_cvt_pk_bf16_f32 v176, v160, v161
 v_cvt_pk_bf16_f32 v177, v162, v163
 v_cvt_pk_bf16_f32 v178, v164, v165
 v_cvt_pk_bf16_f32 v179, v166, v167
 buffer_store_dwordx4 v[176:179], v2, s[36:39], s34 offen offset:0 sc1
 v_accvgpr_read_b32 v24, a24
 v_accvgpr_read_b32 v25, a25
 v_cvt_pk_bf16_f32 v26, v24, v25
 v_lshlrev_b32 v24, 16, v26
 v_and_b32 v25, 0xffff0000, v26
 v_lshlrev_b32 v26, 16, v108
 v_and_b32 v27, 0xffff0000, v108
 v_add_f32 v24, v24, v26
 v_add_f32 v25, v25, v27
 v_cvt_pk_bf16_f32 v26, v24, v25
 v_lshlrev_b32 v160, 16, v26
 v_and_b32 v161, 0xffff0000, v26
 v_accvgpr_read_b32 v24, a26
 v_accvgpr_read_b32 v25, a27
 v_cvt_pk_bf16_f32 v26, v24, v25
 v_lshlrev_b32 v24, 16, v26
 v_and_b32 v25, 0xffff0000, v26
 v_lshlrev_b32 v26, 16, v109
 v_and_b32 v27, 0xffff0000, v109
 v_add_f32 v24, v24, v26
 v_add_f32 v25, v25, v27
 v_cvt_pk_bf16_f32 v26, v24, v25
 v_lshlrev_b32 v162, 16, v26
 v_and_b32 v163, 0xffff0000, v26
 v_accvgpr_read_b32 v24, a28
 v_accvgpr_read_b32 v25, a29
 v_cvt_pk_bf16_f32 v26, v24, v25
 v_lshlrev_b32 v24, 16, v26
 v_and_b32 v25, 0xffff0000, v26
 v_lshlrev_b32 v26, 16, v110
 v_and_b32 v27, 0xffff0000, v110
 v_add_f32 v24, v24, v26
 v_add_f32 v25, v25, v27
 v_cvt_pk_bf16_f32 v26, v24, v25
 v_lshlrev_b32 v164, 16, v26
 v_and_b32 v165, 0xffff0000, v26
 v_accvgpr_read_b32 v24, a30
 v_accvgpr_read_b32 v25, a31
 v_cvt_pk_bf16_f32 v26, v24, v25
 v_lshlrev_b32 v24, 16, v26
 v_and_b32 v25, 0xffff0000, v26
 v_lshlrev_b32 v26, 16, v111
 v_and_b32 v27, 0xffff0000, v111
 v_add_f32 v24, v24, v26
 v_add_f32 v25, v25, v27
 v_cvt_pk_bf16_f32 v26, v24, v25
 v_lshlrev_b32 v166, 16, v26
 v_and_b32 v167, 0xffff0000, v26
 v_mul_f32 v168, s3, v160
 v_mul_f32 v169, s3, v161
 v_mul_f32 v170, s3, v162
 v_mul_f32 v171, s3, v163
 v_mul_f32 v172, s3, v164
 v_mul_f32 v173, s3, v165
 v_mul_f32 v174, s3, v166
 v_mul_f32 v175, s3, v167
 v_exp_f32 v168, v168
 v_exp_f32 v169, v169
 v_exp_f32 v170, v170
 v_exp_f32 v171, v171
 v_exp_f32 v172, v172
 v_exp_f32 v173, v173
 v_exp_f32 v174, v174
 v_exp_f32 v175, v175
 v_add_f32 v168, 1.0, v168
 v_add_f32 v169, 1.0, v169
 v_add_f32 v170, 1.0, v170
 v_add_f32 v171, 1.0, v171
 v_add_f32 v172, 1.0, v172
 v_add_f32 v173, 1.0, v173
 v_add_f32 v174, 1.0, v174
 v_add_f32 v175, 1.0, v175
 v_rcp_f32 v168, v168
 v_rcp_f32 v169, v169
 v_rcp_f32 v170, v170
 v_rcp_f32 v171, v171
 v_rcp_f32 v172, v172
 v_rcp_f32 v173, v173
 v_rcp_f32 v174, v174
 v_rcp_f32 v175, v175
 v_mul_f32 v160, v160, v168
 v_mul_f32 v161, v161, v169
 v_mul_f32 v162, v162, v170
 v_mul_f32 v163, v163, v171
 v_mul_f32 v164, v164, v172
 v_mul_f32 v165, v165, v173
 v_mul_f32 v166, v166, v174
 v_mul_f32 v167, v167, v175
 v_cvt_pk_bf16_f32 v180, v160, v161
 v_cvt_pk_bf16_f32 v181, v162, v163
 v_cvt_pk_bf16_f32 v182, v164, v165
 v_cvt_pk_bf16_f32 v183, v166, v167
 buffer_store_dwordx4 v[180:183], v2, s[36:39], s34 offen offset:1024 sc1
 s_add_u32 s34, s44, 2048
 v_accvgpr_read_b32 v24, a32
 v_accvgpr_read_b32 v25, a33
 v_cvt_pk_bf16_f32 v26, v24, v25
 v_lshlrev_b32 v24, 16, v26
 v_and_b32 v25, 0xffff0000, v26
 v_lshlrev_b32 v26, 16, v112
 v_and_b32 v27, 0xffff0000, v112
 v_add_f32 v24, v24, v26
 v_add_f32 v25, v25, v27
 v_cvt_pk_bf16_f32 v26, v24, v25
 v_lshlrev_b32 v160, 16, v26
 v_and_b32 v161, 0xffff0000, v26
 v_accvgpr_read_b32 v24, a34
 v_accvgpr_read_b32 v25, a35
 v_cvt_pk_bf16_f32 v26, v24, v25
 v_lshlrev_b32 v24, 16, v26
 v_and_b32 v25, 0xffff0000, v26
 v_lshlrev_b32 v26, 16, v113
 v_and_b32 v27, 0xffff0000, v113
 v_add_f32 v24, v24, v26
 v_add_f32 v25, v25, v27
 v_cvt_pk_bf16_f32 v26, v24, v25
 v_lshlrev_b32 v162, 16, v26
 v_and_b32 v163, 0xffff0000, v26
 v_accvgpr_read_b32 v24, a36
 v_accvgpr_read_b32 v25, a37
 v_cvt_pk_bf16_f32 v26, v24, v25
 v_lshlrev_b32 v24, 16, v26
 v_and_b32 v25, 0xffff0000, v26
 v_lshlrev_b32 v26, 16, v114
 v_and_b32 v27, 0xffff0000, v114
 v_add_f32 v24, v24, v26
 v_add_f32 v25, v25, v27
 v_cvt_pk_bf16_f32 v26, v24, v25
 v_lshlrev_b32 v164, 16, v26
 v_and_b32 v165, 0xffff0000, v26
 v_accvgpr_read_b32 v24, a38
 v_accvgpr_read_b32 v25, a39
 v_cvt_pk_bf16_f32 v26, v24, v25
 v_lshlrev_b32 v24, 16, v26
 v_and_b32 v25, 0xffff0000, v26
 v_lshlrev_b32 v26, 16, v115
 v_and_b32 v27, 0xffff0000, v115
 v_add_f32 v24, v24, v26
 v_add_f32 v25, v25, v27
 v_cvt_pk_bf16_f32 v26, v24, v25
 v_lshlrev_b32 v166, 16, v26
 v_and_b32 v167, 0xffff0000, v26
 v_mul_f32 v168, s3, v160
 v_mul_f32 v169, s3, v161
 v_mul_f32 v170, s3, v162
 v_mul_f32 v171, s3, v163
 v_mul_f32 v172, s3, v164
 v_mul_f32 v173, s3, v165
 v_mul_f32 v174, s3, v166
 v_mul_f32 v175, s3, v167
 v_exp_f32 v168, v168
 v_exp_f32 v169, v169
 v_exp_f32 v170, v170
 v_exp_f32 v171, v171
 v_exp_f32 v172, v172
 v_exp_f32 v173, v173
 v_exp_f32 v174, v174
 v_exp_f32 v175, v175
 v_add_f32 v168, 1.0, v168
 v_add_f32 v169, 1.0, v169
 v_add_f32 v170, 1.0, v170
 v_add_f32 v171, 1.0, v171
 v_add_f32 v172, 1.0, v172
 v_add_f32 v173, 1.0, v173
 v_add_f32 v174, 1.0, v174
 v_add_f32 v175, 1.0, v175
 v_rcp_f32 v168, v168
 v_rcp_f32 v169, v169
 v_rcp_f32 v170, v170
 v_rcp_f32 v171, v171
 v_rcp_f32 v172, v172
 v_rcp_f32 v173, v173
 v_rcp_f32 v174, v174
 v_rcp_f32 v175, v175
 v_mul_f32 v160, v160, v168
 v_mul_f32 v161, v161, v169
 v_mul_f32 v162, v162, v170
 v_mul_f32 v163, v163, v171
 v_mul_f32 v164, v164, v172
 v_mul_f32 v165, v165, v173
 v_mul_f32 v166, v166, v174
 v_mul_f32 v167, v167, v175
 v_cvt_pk_bf16_f32 v176, v160, v161
 v_cvt_pk_bf16_f32 v177, v162, v163
 v_cvt_pk_bf16_f32 v178, v164, v165
 v_cvt_pk_bf16_f32 v179, v166, v167
 buffer_store_dwordx4 v[176:179], v2, s[36:39], s34 offen offset:0 sc1
 v_accvgpr_read_b32 v24, a40
 v_accvgpr_read_b32 v25, a41
 v_cvt_pk_bf16_f32 v26, v24, v25
 v_lshlrev_b32 v24, 16, v26
 v_and_b32 v25, 0xffff0000, v26
 v_lshlrev_b32 v26, 16, v116
 v_and_b32 v27, 0xffff0000, v116
 v_add_f32 v24, v24, v26
 v_add_f32 v25, v25, v27
 v_cvt_pk_bf16_f32 v26, v24, v25
 v_lshlrev_b32 v160, 16, v26
 v_and_b32 v161, 0xffff0000, v26
 v_accvgpr_read_b32 v24, a42
 v_accvgpr_read_b32 v25, a43
 v_cvt_pk_bf16_f32 v26, v24, v25
 v_lshlrev_b32 v24, 16, v26
 v_and_b32 v25, 0xffff0000, v26
 v_lshlrev_b32 v26, 16, v117
 v_and_b32 v27, 0xffff0000, v117
 v_add_f32 v24, v24, v26
 v_add_f32 v25, v25, v27
 v_cvt_pk_bf16_f32 v26, v24, v25
 v_lshlrev_b32 v162, 16, v26
 v_and_b32 v163, 0xffff0000, v26
 v_accvgpr_read_b32 v24, a44
 v_accvgpr_read_b32 v25, a45
 v_cvt_pk_bf16_f32 v26, v24, v25
 v_lshlrev_b32 v24, 16, v26
 v_and_b32 v25, 0xffff0000, v26
 v_lshlrev_b32 v26, 16, v118
 v_and_b32 v27, 0xffff0000, v118
 v_add_f32 v24, v24, v26
 v_add_f32 v25, v25, v27
 v_cvt_pk_bf16_f32 v26, v24, v25
 v_lshlrev_b32 v164, 16, v26
 v_and_b32 v165, 0xffff0000, v26
 v_accvgpr_read_b32 v24, a46
 v_accvgpr_read_b32 v25, a47
 v_cvt_pk_bf16_f32 v26, v24, v25
 v_lshlrev_b32 v24, 16, v26
 v_and_b32 v25, 0xffff0000, v26
 v_lshlrev_b32 v26, 16, v119
 v_and_b32 v27, 0xffff0000, v119
 v_add_f32 v24, v24, v26
 v_add_f32 v25, v25, v27
 v_cvt_pk_bf16_f32 v26, v24, v25
 v_lshlrev_b32 v166, 16, v26
 v_and_b32 v167, 0xffff0000, v26
 v_mul_f32 v168, s3, v160
 v_mul_f32 v169, s3, v161
 v_mul_f32 v170, s3, v162
 v_mul_f32 v171, s3, v163
 v_mul_f32 v172, s3, v164
 v_mul_f32 v173, s3, v165
 v_mul_f32 v174, s3, v166
 v_mul_f32 v175, s3, v167
 v_exp_f32 v168, v168
 v_exp_f32 v169, v169
 v_exp_f32 v170, v170
 v_exp_f32 v171, v171
 v_exp_f32 v172, v172
 v_exp_f32 v173, v173
 v_exp_f32 v174, v174
 v_exp_f32 v175, v175
 v_add_f32 v168, 1.0, v168
 v_add_f32 v169, 1.0, v169
 v_add_f32 v170, 1.0, v170
 v_add_f32 v171, 1.0, v171
 v_add_f32 v172, 1.0, v172
 v_add_f32 v173, 1.0, v173
 v_add_f32 v174, 1.0, v174
 v_add_f32 v175, 1.0, v175
 v_rcp_f32 v168, v168
 v_rcp_f32 v169, v169
 v_rcp_f32 v170, v170
 v_rcp_f32 v171, v171
 v_rcp_f32 v172, v172
 v_rcp_f32 v173, v173
 v_rcp_f32 v174, v174
 v_rcp_f32 v175, v175
 v_mul_f32 v160, v160, v168
 v_mul_f32 v161, v161, v169
 v_mul_f32 v162, v162, v170
 v_mul_f32 v163, v163, v171
 v_mul_f32 v164, v164, v172
 v_mul_f32 v165, v165, v173
 v_mul_f32 v166, v166, v174
 v_mul_f32 v167, v167, v175
 v_cvt_pk_bf16_f32 v180, v160, v161
 v_cvt_pk_bf16_f32 v181, v162, v163
 v_cvt_pk_bf16_f32 v182, v164, v165
 v_cvt_pk_bf16_f32 v183, v166, v167
 buffer_store_dwordx4 v[180:183], v2, s[36:39], s34 offen offset:1024 sc1
 s_add_u32 s34, s44, 34816
 v_accvgpr_read_b32 v24, a48
 v_accvgpr_read_b32 v25, a49
 v_cvt_pk_bf16_f32 v26, v24, v25
 v_lshlrev_b32 v24, 16, v26
 v_and_b32 v25, 0xffff0000, v26
 v_lshlrev_b32 v26, 16, v120
 v_and_b32 v27, 0xffff0000, v120
 v_add_f32 v24, v24, v26
 v_add_f32 v25, v25, v27
 v_cvt_pk_bf16_f32 v26, v24, v25
 v_lshlrev_b32 v160, 16, v26
 v_and_b32 v161, 0xffff0000, v26
 v_accvgpr_read_b32 v24, a50
 v_accvgpr_read_b32 v25, a51
 v_cvt_pk_bf16_f32 v26, v24, v25
 v_lshlrev_b32 v24, 16, v26
 v_and_b32 v25, 0xffff0000, v26
 v_lshlrev_b32 v26, 16, v121
 v_and_b32 v27, 0xffff0000, v121
 v_add_f32 v24, v24, v26
 v_add_f32 v25, v25, v27
 v_cvt_pk_bf16_f32 v26, v24, v25
 v_lshlrev_b32 v162, 16, v26
 v_and_b32 v163, 0xffff0000, v26
 v_accvgpr_read_b32 v24, a52
 v_accvgpr_read_b32 v25, a53
 v_cvt_pk_bf16_f32 v26, v24, v25
 v_lshlrev_b32 v24, 16, v26
 v_and_b32 v25, 0xffff0000, v26
 v_lshlrev_b32 v26, 16, v122
 v_and_b32 v27, 0xffff0000, v122
 v_add_f32 v24, v24, v26
 v_add_f32 v25, v25, v27
 v_cvt_pk_bf16_f32 v26, v24, v25
 v_lshlrev_b32 v164, 16, v26
 v_and_b32 v165, 0xffff0000, v26
 v_accvgpr_read_b32 v24, a54
 v_accvgpr_read_b32 v25, a55
 v_cvt_pk_bf16_f32 v26, v24, v25
 v_lshlrev_b32 v24, 16, v26
 v_and_b32 v25, 0xffff0000, v26
 v_lshlrev_b32 v26, 16, v123
 v_and_b32 v27, 0xffff0000, v123
 v_add_f32 v24, v24, v26
 v_add_f32 v25, v25, v27
 v_cvt_pk_bf16_f32 v26, v24, v25
 v_lshlrev_b32 v166, 16, v26
 v_and_b32 v167, 0xffff0000, v26
 v_mul_f32 v168, s3, v160
 v_mul_f32 v169, s3, v161
 v_mul_f32 v170, s3, v162
 v_mul_f32 v171, s3, v163
 v_mul_f32 v172, s3, v164
 v_mul_f32 v173, s3, v165
 v_mul_f32 v174, s3, v166
 v_mul_f32 v175, s3, v167
 v_exp_f32 v168, v168
 v_exp_f32 v169, v169
 v_exp_f32 v170, v170
 v_exp_f32 v171, v171
 v_exp_f32 v172, v172
 v_exp_f32 v173, v173
 v_exp_f32 v174, v174
 v_exp_f32 v175, v175
 v_add_f32 v168, 1.0, v168
 v_add_f32 v169, 1.0, v169
 v_add_f32 v170, 1.0, v170
 v_add_f32 v171, 1.0, v171
 v_add_f32 v172, 1.0, v172
 v_add_f32 v173, 1.0, v173
 v_add_f32 v174, 1.0, v174
 v_add_f32 v175, 1.0, v175
 v_rcp_f32 v168, v168
 v_rcp_f32 v169, v169
 v_rcp_f32 v170, v170
 v_rcp_f32 v171, v171
 v_rcp_f32 v172, v172
 v_rcp_f32 v173, v173
 v_rcp_f32 v174, v174
 v_rcp_f32 v175, v175
 v_mul_f32 v160, v160, v168
 v_mul_f32 v161, v161, v169
 v_mul_f32 v162, v162, v170
 v_mul_f32 v163, v163, v171
 v_mul_f32 v164, v164, v172
 v_mul_f32 v165, v165, v173
 v_mul_f32 v166, v166, v174
 v_mul_f32 v167, v167, v175
 v_cvt_pk_bf16_f32 v176, v160, v161
 v_cvt_pk_bf16_f32 v177, v162, v163
 v_cvt_pk_bf16_f32 v178, v164, v165
 v_cvt_pk_bf16_f32 v179, v166, v167
 buffer_store_dwordx4 v[176:179], v2, s[36:39], s34 offen offset:0 sc1
 v_accvgpr_read_b32 v24, a56
 v_accvgpr_read_b32 v25, a57
 v_cvt_pk_bf16_f32 v26, v24, v25
 v_lshlrev_b32 v24, 16, v26
 v_and_b32 v25, 0xffff0000, v26
 v_lshlrev_b32 v26, 16, v124
 v_and_b32 v27, 0xffff0000, v124
 v_add_f32 v24, v24, v26
 v_add_f32 v25, v25, v27
 v_cvt_pk_bf16_f32 v26, v24, v25
 v_lshlrev_b32 v160, 16, v26
 v_and_b32 v161, 0xffff0000, v26
 v_accvgpr_read_b32 v24, a58
 v_accvgpr_read_b32 v25, a59
 v_cvt_pk_bf16_f32 v26, v24, v25
 v_lshlrev_b32 v24, 16, v26
 v_and_b32 v25, 0xffff0000, v26
 v_lshlrev_b32 v26, 16, v125
 v_and_b32 v27, 0xffff0000, v125
 v_add_f32 v24, v24, v26
 v_add_f32 v25, v25, v27
 v_cvt_pk_bf16_f32 v26, v24, v25
 v_lshlrev_b32 v162, 16, v26
 v_and_b32 v163, 0xffff0000, v26
 v_accvgpr_read_b32 v24, a60
 v_accvgpr_read_b32 v25, a61
 v_cvt_pk_bf16_f32 v26, v24, v25
 v_lshlrev_b32 v24, 16, v26
 v_and_b32 v25, 0xffff0000, v26
 v_lshlrev_b32 v26, 16, v126
 v_and_b32 v27, 0xffff0000, v126
 v_add_f32 v24, v24, v26
 v_add_f32 v25, v25, v27
 v_cvt_pk_bf16_f32 v26, v24, v25
 v_lshlrev_b32 v164, 16, v26
 v_and_b32 v165, 0xffff0000, v26
 v_accvgpr_read_b32 v24, a62
 v_accvgpr_read_b32 v25, a63
 v_cvt_pk_bf16_f32 v26, v24, v25
 v_lshlrev_b32 v24, 16, v26
 v_and_b32 v25, 0xffff0000, v26
 v_lshlrev_b32 v26, 16, v127
 v_and_b32 v27, 0xffff0000, v127
 v_add_f32 v24, v24, v26
 v_add_f32 v25, v25, v27
 v_cvt_pk_bf16_f32 v26, v24, v25
 v_lshlrev_b32 v166, 16, v26
 v_and_b32 v167, 0xffff0000, v26
 v_mul_f32 v168, s3, v160
 v_mul_f32 v169, s3, v161
 v_mul_f32 v170, s3, v162
 v_mul_f32 v171, s3, v163
 v_mul_f32 v172, s3, v164
 v_mul_f32 v173, s3, v165
 v_mul_f32 v174, s3, v166
 v_mul_f32 v175, s3, v167
 v_exp_f32 v168, v168
 v_exp_f32 v169, v169
 v_exp_f32 v170, v170
 v_exp_f32 v171, v171
 v_exp_f32 v172, v172
 v_exp_f32 v173, v173
 v_exp_f32 v174, v174
 v_exp_f32 v175, v175
 v_add_f32 v168, 1.0, v168
 v_add_f32 v169, 1.0, v169
 v_add_f32 v170, 1.0, v170
 v_add_f32 v171, 1.0, v171
 v_add_f32 v172, 1.0, v172
 v_add_f32 v173, 1.0, v173
 v_add_f32 v174, 1.0, v174
 v_add_f32 v175, 1.0, v175
 v_rcp_f32 v168, v168
 v_rcp_f32 v169, v169
 v_rcp_f32 v170, v170
 v_rcp_f32 v171, v171
 v_rcp_f32 v172, v172
 v_rcp_f32 v173, v173
 v_rcp_f32 v174, v174
 v_rcp_f32 v175, v175
 v_mul_f32 v160, v160, v168
 v_mul_f32 v161, v161, v169
 v_mul_f32 v162, v162, v170
 v_mul_f32 v163, v163, v171
 v_mul_f32 v164, v164, v172
 v_mul_f32 v165, v165, v173
 v_mul_f32 v166, v166, v174
 v_mul_f32 v167, v167, v175
 v_cvt_pk_bf16_f32 v180, v160, v161
 v_cvt_pk_bf16_f32 v181, v162, v163
 v_cvt_pk_bf16_f32 v182, v164, v165
 v_cvt_pk_bf16_f32 v183, v166, v167
 buffer_store_dwordx4 v[180:183], v2, s[36:39], s34 offen offset:1024 sc1
 s_add_u32 s34, s44, 4096
 v_accvgpr_read_b32 v24, a64
 v_accvgpr_read_b32 v25, a65
 v_cvt_pk_bf16_f32 v26, v24, v25
 v_lshlrev_b32 v24, 16, v26
 v_and_b32 v25, 0xffff0000, v26
 v_lshlrev_b32 v26, 16, v128
 v_and_b32 v27, 0xffff0000, v128
 v_add_f32 v24, v24, v26
 v_add_f32 v25, v25, v27
 v_cvt_pk_bf16_f32 v26, v24, v25
 v_lshlrev_b32 v160, 16, v26
 v_and_b32 v161, 0xffff0000, v26
 v_accvgpr_read_b32 v24, a66
 v_accvgpr_read_b32 v25, a67
 v_cvt_pk_bf16_f32 v26, v24, v25
 v_lshlrev_b32 v24, 16, v26
 v_and_b32 v25, 0xffff0000, v26
 v_lshlrev_b32 v26, 16, v129
 v_and_b32 v27, 0xffff0000, v129
 v_add_f32 v24, v24, v26
 v_add_f32 v25, v25, v27
 v_cvt_pk_bf16_f32 v26, v24, v25
 v_lshlrev_b32 v162, 16, v26
 v_and_b32 v163, 0xffff0000, v26
 v_accvgpr_read_b32 v24, a68
 v_accvgpr_read_b32 v25, a69
 v_cvt_pk_bf16_f32 v26, v24, v25
 v_lshlrev_b32 v24, 16, v26
 v_and_b32 v25, 0xffff0000, v26
 v_lshlrev_b32 v26, 16, v130
 v_and_b32 v27, 0xffff0000, v130
 v_add_f32 v24, v24, v26
 v_add_f32 v25, v25, v27
 v_cvt_pk_bf16_f32 v26, v24, v25
 v_lshlrev_b32 v164, 16, v26
 v_and_b32 v165, 0xffff0000, v26
 v_accvgpr_read_b32 v24, a70
 v_accvgpr_read_b32 v25, a71
 v_cvt_pk_bf16_f32 v26, v24, v25
 v_lshlrev_b32 v24, 16, v26
 v_and_b32 v25, 0xffff0000, v26
 v_lshlrev_b32 v26, 16, v131
 v_and_b32 v27, 0xffff0000, v131
 v_add_f32 v24, v24, v26
 v_add_f32 v25, v25, v27
 v_cvt_pk_bf16_f32 v26, v24, v25
 v_lshlrev_b32 v166, 16, v26
 v_and_b32 v167, 0xffff0000, v26
 v_mul_f32 v168, s3, v160
 v_mul_f32 v169, s3, v161
 v_mul_f32 v170, s3, v162
 v_mul_f32 v171, s3, v163
 v_mul_f32 v172, s3, v164
 v_mul_f32 v173, s3, v165
 v_mul_f32 v174, s3, v166
 v_mul_f32 v175, s3, v167
 v_exp_f32 v168, v168
 v_exp_f32 v169, v169
 v_exp_f32 v170, v170
 v_exp_f32 v171, v171
 v_exp_f32 v172, v172
 v_exp_f32 v173, v173
 v_exp_f32 v174, v174
 v_exp_f32 v175, v175
 v_add_f32 v168, 1.0, v168
 v_add_f32 v169, 1.0, v169
 v_add_f32 v170, 1.0, v170
 v_add_f32 v171, 1.0, v171
 v_add_f32 v172, 1.0, v172
 v_add_f32 v173, 1.0, v173
 v_add_f32 v174, 1.0, v174
 v_add_f32 v175, 1.0, v175
 v_rcp_f32 v168, v168
 v_rcp_f32 v169, v169
 v_rcp_f32 v170, v170
 v_rcp_f32 v171, v171
 v_rcp_f32 v172, v172
 v_rcp_f32 v173, v173
 v_rcp_f32 v174, v174
 v_rcp_f32 v175, v175
 v_mul_f32 v160, v160, v168
 v_mul_f32 v161, v161, v169
 v_mul_f32 v162, v162, v170
 v_mul_f32 v163, v163, v171
 v_mul_f32 v164, v164, v172
 v_mul_f32 v165, v165, v173
 v_mul_f32 v166, v166, v174
 v_mul_f32 v167, v167, v175
 v_cvt_pk_bf16_f32 v176, v160, v161
 v_cvt_pk_bf16_f32 v177, v162, v163
 v_cvt_pk_bf16_f32 v178, v164, v165
 v_cvt_pk_bf16_f32 v179, v166, v167
 buffer_store_dwordx4 v[176:179], v2, s[36:39], s34 offen offset:0 sc1
 v_accvgpr_read_b32 v24, a72
 v_accvgpr_read_b32 v25, a73
 v_cvt_pk_bf16_f32 v26, v24, v25
 v_lshlrev_b32 v24, 16, v26
 v_and_b32 v25, 0xffff0000, v26
 v_lshlrev_b32 v26, 16, v132
 v_and_b32 v27, 0xffff0000, v132
 v_add_f32 v24, v24, v26
 v_add_f32 v25, v25, v27
 v_cvt_pk_bf16_f32 v26, v24, v25
 v_lshlrev_b32 v160, 16, v26
 v_and_b32 v161, 0xffff0000, v26
 v_accvgpr_read_b32 v24, a74
 v_accvgpr_read_b32 v25, a75
 v_cvt_pk_bf16_f32 v26, v24, v25
 v_lshlrev_b32 v24, 16, v26
 v_and_b32 v25, 0xffff0000, v26
 v_lshlrev_b32 v26, 16, v133
 v_and_b32 v27, 0xffff0000, v133
 v_add_f32 v24, v24, v26
 v_add_f32 v25, v25, v27
 v_cvt_pk_bf16_f32 v26, v24, v25
 v_lshlrev_b32 v162, 16, v26
 v_and_b32 v163, 0xffff0000, v26
 v_accvgpr_read_b32 v24, a76
 v_accvgpr_read_b32 v25, a77
 v_cvt_pk_bf16_f32 v26, v24, v25
 v_lshlrev_b32 v24, 16, v26
 v_and_b32 v25, 0xffff0000, v26
 v_lshlrev_b32 v26, 16, v134
 v_and_b32 v27, 0xffff0000, v134
 v_add_f32 v24, v24, v26
 v_add_f32 v25, v25, v27
 v_cvt_pk_bf16_f32 v26, v24, v25
 v_lshlrev_b32 v164, 16, v26
 v_and_b32 v165, 0xffff0000, v26
 v_accvgpr_read_b32 v24, a78
 v_accvgpr_read_b32 v25, a79
 v_cvt_pk_bf16_f32 v26, v24, v25
 v_lshlrev_b32 v24, 16, v26
 v_and_b32 v25, 0xffff0000, v26
 v_lshlrev_b32 v26, 16, v135
 v_and_b32 v27, 0xffff0000, v135
 v_add_f32 v24, v24, v26
 v_add_f32 v25, v25, v27
 v_cvt_pk_bf16_f32 v26, v24, v25
 v_lshlrev_b32 v166, 16, v26
 v_and_b32 v167, 0xffff0000, v26
 v_mul_f32 v168, s3, v160
 v_mul_f32 v169, s3, v161
 v_mul_f32 v170, s3, v162
 v_mul_f32 v171, s3, v163
 v_mul_f32 v172, s3, v164
 v_mul_f32 v173, s3, v165
 v_mul_f32 v174, s3, v166
 v_mul_f32 v175, s3, v167
 v_exp_f32 v168, v168
 v_exp_f32 v169, v169
 v_exp_f32 v170, v170
 v_exp_f32 v171, v171
 v_exp_f32 v172, v172
 v_exp_f32 v173, v173
 v_exp_f32 v174, v174
 v_exp_f32 v175, v175
 v_add_f32 v168, 1.0, v168
 v_add_f32 v169, 1.0, v169
 v_add_f32 v170, 1.0, v170
 v_add_f32 v171, 1.0, v171
 v_add_f32 v172, 1.0, v172
 v_add_f32 v173, 1.0, v173
 v_add_f32 v174, 1.0, v174
 v_add_f32 v175, 1.0, v175
 v_rcp_f32 v168, v168
 v_rcp_f32 v169, v169
 v_rcp_f32 v170, v170
 v_rcp_f32 v171, v171
 v_rcp_f32 v172, v172
 v_rcp_f32 v173, v173
 v_rcp_f32 v174, v174
 v_rcp_f32 v175, v175
 v_mul_f32 v160, v160, v168
 v_mul_f32 v161, v161, v169
 v_mul_f32 v162, v162, v170
 v_mul_f32 v163, v163, v171
 v_mul_f32 v164, v164, v172
 v_mul_f32 v165, v165, v173
 v_mul_f32 v166, v166, v174
 v_mul_f32 v167, v167, v175
 v_cvt_pk_bf16_f32 v180, v160, v161
 v_cvt_pk_bf16_f32 v181, v162, v163
 v_cvt_pk_bf16_f32 v182, v164, v165
 v_cvt_pk_bf16_f32 v183, v166, v167
 buffer_store_dwordx4 v[180:183], v2, s[36:39], s34 offen offset:1024 sc1
 s_add_u32 s34, s44, 36864
 v_accvgpr_read_b32 v24, a80
 v_accvgpr_read_b32 v25, a81
 v_cvt_pk_bf16_f32 v26, v24, v25
 v_lshlrev_b32 v24, 16, v26
 v_and_b32 v25, 0xffff0000, v26
 v_lshlrev_b32 v26, 16, v136
 v_and_b32 v27, 0xffff0000, v136
 v_add_f32 v24, v24, v26
 v_add_f32 v25, v25, v27
 v_cvt_pk_bf16_f32 v26, v24, v25
 v_lshlrev_b32 v160, 16, v26
 v_and_b32 v161, 0xffff0000, v26
 v_accvgpr_read_b32 v24, a82
 v_accvgpr_read_b32 v25, a83
 v_cvt_pk_bf16_f32 v26, v24, v25
 v_lshlrev_b32 v24, 16, v26
 v_and_b32 v25, 0xffff0000, v26
 v_lshlrev_b32 v26, 16, v137
 v_and_b32 v27, 0xffff0000, v137
 v_add_f32 v24, v24, v26
 v_add_f32 v25, v25, v27
 v_cvt_pk_bf16_f32 v26, v24, v25
 v_lshlrev_b32 v162, 16, v26
 v_and_b32 v163, 0xffff0000, v26
 v_accvgpr_read_b32 v24, a84
 v_accvgpr_read_b32 v25, a85
 v_cvt_pk_bf16_f32 v26, v24, v25
 v_lshlrev_b32 v24, 16, v26
 v_and_b32 v25, 0xffff0000, v26
 v_lshlrev_b32 v26, 16, v138
 v_and_b32 v27, 0xffff0000, v138
 v_add_f32 v24, v24, v26
 v_add_f32 v25, v25, v27
 v_cvt_pk_bf16_f32 v26, v24, v25
 v_lshlrev_b32 v164, 16, v26
 v_and_b32 v165, 0xffff0000, v26
 v_accvgpr_read_b32 v24, a86
 v_accvgpr_read_b32 v25, a87
 v_cvt_pk_bf16_f32 v26, v24, v25
 v_lshlrev_b32 v24, 16, v26
 v_and_b32 v25, 0xffff0000, v26
 v_lshlrev_b32 v26, 16, v139
 v_and_b32 v27, 0xffff0000, v139
 v_add_f32 v24, v24, v26
 v_add_f32 v25, v25, v27
 v_cvt_pk_bf16_f32 v26, v24, v25
 v_lshlrev_b32 v166, 16, v26
 v_and_b32 v167, 0xffff0000, v26
 v_mul_f32 v168, s3, v160
 v_mul_f32 v169, s3, v161
 v_mul_f32 v170, s3, v162
 v_mul_f32 v171, s3, v163
 v_mul_f32 v172, s3, v164
 v_mul_f32 v173, s3, v165
 v_mul_f32 v174, s3, v166
 v_mul_f32 v175, s3, v167
 v_exp_f32 v168, v168
 v_exp_f32 v169, v169
 v_exp_f32 v170, v170
 v_exp_f32 v171, v171
 v_exp_f32 v172, v172
 v_exp_f32 v173, v173
 v_exp_f32 v174, v174
 v_exp_f32 v175, v175
 v_add_f32 v168, 1.0, v168
 v_add_f32 v169, 1.0, v169
 v_add_f32 v170, 1.0, v170
 v_add_f32 v171, 1.0, v171
 v_add_f32 v172, 1.0, v172
 v_add_f32 v173, 1.0, v173
 v_add_f32 v174, 1.0, v174
 v_add_f32 v175, 1.0, v175
 v_rcp_f32 v168, v168
 v_rcp_f32 v169, v169
 v_rcp_f32 v170, v170
 v_rcp_f32 v171, v171
 v_rcp_f32 v172, v172
 v_rcp_f32 v173, v173
 v_rcp_f32 v174, v174
 v_rcp_f32 v175, v175
 v_mul_f32 v160, v160, v168
 v_mul_f32 v161, v161, v169
 v_mul_f32 v162, v162, v170
 v_mul_f32 v163, v163, v171
 v_mul_f32 v164, v164, v172
 v_mul_f32 v165, v165, v173
 v_mul_f32 v166, v166, v174
 v_mul_f32 v167, v167, v175
 v_cvt_pk_bf16_f32 v176, v160, v161
 v_cvt_pk_bf16_f32 v177, v162, v163
 v_cvt_pk_bf16_f32 v178, v164, v165
 v_cvt_pk_bf16_f32 v179, v166, v167
 buffer_store_dwordx4 v[176:179], v2, s[36:39], s34 offen offset:0 sc1
 v_accvgpr_read_b32 v24, a88
 v_accvgpr_read_b32 v25, a89
 v_cvt_pk_bf16_f32 v26, v24, v25
 v_lshlrev_b32 v24, 16, v26
 v_and_b32 v25, 0xffff0000, v26
 v_lshlrev_b32 v26, 16, v140
 v_and_b32 v27, 0xffff0000, v140
 v_add_f32 v24, v24, v26
 v_add_f32 v25, v25, v27
 v_cvt_pk_bf16_f32 v26, v24, v25
 v_lshlrev_b32 v160, 16, v26
 v_and_b32 v161, 0xffff0000, v26
 v_accvgpr_read_b32 v24, a90
 v_accvgpr_read_b32 v25, a91
 v_cvt_pk_bf16_f32 v26, v24, v25
 v_lshlrev_b32 v24, 16, v26
 v_and_b32 v25, 0xffff0000, v26
 v_lshlrev_b32 v26, 16, v141
 v_and_b32 v27, 0xffff0000, v141
 v_add_f32 v24, v24, v26
 v_add_f32 v25, v25, v27
 v_cvt_pk_bf16_f32 v26, v24, v25
 v_lshlrev_b32 v162, 16, v26
 v_and_b32 v163, 0xffff0000, v26
 v_accvgpr_read_b32 v24, a92
 v_accvgpr_read_b32 v25, a93
 v_cvt_pk_bf16_f32 v26, v24, v25
 v_lshlrev_b32 v24, 16, v26
 v_and_b32 v25, 0xffff0000, v26
 v_lshlrev_b32 v26, 16, v142
 v_and_b32 v27, 0xffff0000, v142
 v_add_f32 v24, v24, v26
 v_add_f32 v25, v25, v27
 v_cvt_pk_bf16_f32 v26, v24, v25
 v_lshlrev_b32 v164, 16, v26
 v_and_b32 v165, 0xffff0000, v26
 v_accvgpr_read_b32 v24, a94
 v_accvgpr_read_b32 v25, a95
 v_cvt_pk_bf16_f32 v26, v24, v25
 v_lshlrev_b32 v24, 16, v26
 v_and_b32 v25, 0xffff0000, v26
 v_lshlrev_b32 v26, 16, v143
 v_and_b32 v27, 0xffff0000, v143
 v_add_f32 v24, v24, v26
 v_add_f32 v25, v25, v27
 v_cvt_pk_bf16_f32 v26, v24, v25
 v_lshlrev_b32 v166, 16, v26
 v_and_b32 v167, 0xffff0000, v26
 v_mul_f32 v168, s3, v160
 v_mul_f32 v169, s3, v161
 v_mul_f32 v170, s3, v162
 v_mul_f32 v171, s3, v163
 v_mul_f32 v172, s3, v164
 v_mul_f32 v173, s3, v165
 v_mul_f32 v174, s3, v166
 v_mul_f32 v175, s3, v167
 v_exp_f32 v168, v168
 v_exp_f32 v169, v169
 v_exp_f32 v170, v170
 v_exp_f32 v171, v171
 v_exp_f32 v172, v172
 v_exp_f32 v173, v173
 v_exp_f32 v174, v174
 v_exp_f32 v175, v175
 v_add_f32 v168, 1.0, v168
 v_add_f32 v169, 1.0, v169
 v_add_f32 v170, 1.0, v170
 v_add_f32 v171, 1.0, v171
 v_add_f32 v172, 1.0, v172
 v_add_f32 v173, 1.0, v173
 v_add_f32 v174, 1.0, v174
 v_add_f32 v175, 1.0, v175
 v_rcp_f32 v168, v168
 v_rcp_f32 v169, v169
 v_rcp_f32 v170, v170
 v_rcp_f32 v171, v171
 v_rcp_f32 v172, v172
 v_rcp_f32 v173, v173
 v_rcp_f32 v174, v174
 v_rcp_f32 v175, v175
 v_mul_f32 v160, v160, v168
 v_mul_f32 v161, v161, v169
 v_mul_f32 v162, v162, v170
 v_mul_f32 v163, v163, v171
 v_mul_f32 v164, v164, v172
 v_mul_f32 v165, v165, v173
 v_mul_f32 v166, v166, v174
 v_mul_f32 v167, v167, v175
 v_cvt_pk_bf16_f32 v180, v160, v161
 v_cvt_pk_bf16_f32 v181, v162, v163
 v_cvt_pk_bf16_f32 v182, v164, v165
 v_cvt_pk_bf16_f32 v183, v166, v167
 buffer_store_dwordx4 v[180:183], v2, s[36:39], s34 offen offset:1024 sc1
 s_add_u32 s34, s44, 6144
 v_accvgpr_read_b32 v24, a96
 v_accvgpr_read_b32 v25, a97
 v_cvt_pk_bf16_f32 v26, v24, v25
 v_lshlrev_b32 v24, 16, v26
 v_and_b32 v25, 0xffff0000, v26
 v_lshlrev_b32 v26, 16, v144
 v_and_b32 v27, 0xffff0000, v144
 v_add_f32 v24, v24, v26
 v_add_f32 v25, v25, v27
 v_cvt_pk_bf16_f32 v26, v24, v25
 v_lshlrev_b32 v160, 16, v26
 v_and_b32 v161, 0xffff0000, v26
 v_accvgpr_read_b32 v24, a98
 v_accvgpr_read_b32 v25, a99
 v_cvt_pk_bf16_f32 v26, v24, v25
 v_lshlrev_b32 v24, 16, v26
 v_and_b32 v25, 0xffff0000, v26
 v_lshlrev_b32 v26, 16, v145
 v_and_b32 v27, 0xffff0000, v145
 v_add_f32 v24, v24, v26
 v_add_f32 v25, v25, v27
 v_cvt_pk_bf16_f32 v26, v24, v25
 v_lshlrev_b32 v162, 16, v26
 v_and_b32 v163, 0xffff0000, v26
 v_accvgpr_read_b32 v24, a100
 v_accvgpr_read_b32 v25, a101
 v_cvt_pk_bf16_f32 v26, v24, v25
 v_lshlrev_b32 v24, 16, v26
 v_and_b32 v25, 0xffff0000, v26
 v_lshlrev_b32 v26, 16, v146
 v_and_b32 v27, 0xffff0000, v146
 v_add_f32 v24, v24, v26
 v_add_f32 v25, v25, v27
 v_cvt_pk_bf16_f32 v26, v24, v25
 v_lshlrev_b32 v164, 16, v26
 v_and_b32 v165, 0xffff0000, v26
 v_accvgpr_read_b32 v24, a102
 v_accvgpr_read_b32 v25, a103
 v_cvt_pk_bf16_f32 v26, v24, v25
 v_lshlrev_b32 v24, 16, v26
 v_and_b32 v25, 0xffff0000, v26
 v_lshlrev_b32 v26, 16, v147
 v_and_b32 v27, 0xffff0000, v147
 v_add_f32 v24, v24, v26
 v_add_f32 v25, v25, v27
 v_cvt_pk_bf16_f32 v26, v24, v25
 v_lshlrev_b32 v166, 16, v26
 v_and_b32 v167, 0xffff0000, v26
 v_mul_f32 v168, s3, v160
 v_mul_f32 v169, s3, v161
 v_mul_f32 v170, s3, v162
 v_mul_f32 v171, s3, v163
 v_mul_f32 v172, s3, v164
 v_mul_f32 v173, s3, v165
 v_mul_f32 v174, s3, v166
 v_mul_f32 v175, s3, v167
 v_exp_f32 v168, v168
 v_exp_f32 v169, v169
 v_exp_f32 v170, v170
 v_exp_f32 v171, v171
 v_exp_f32 v172, v172
 v_exp_f32 v173, v173
 v_exp_f32 v174, v174
 v_exp_f32 v175, v175
 v_add_f32 v168, 1.0, v168
 v_add_f32 v169, 1.0, v169
 v_add_f32 v170, 1.0, v170
 v_add_f32 v171, 1.0, v171
 v_add_f32 v172, 1.0, v172
 v_add_f32 v173, 1.0, v173
 v_add_f32 v174, 1.0, v174
 v_add_f32 v175, 1.0, v175
 v_rcp_f32 v168, v168
 v_rcp_f32 v169, v169
 v_rcp_f32 v170, v170
 v_rcp_f32 v171, v171
 v_rcp_f32 v172, v172
 v_rcp_f32 v173, v173
 v_rcp_f32 v174, v174
 v_rcp_f32 v175, v175
 v_mul_f32 v160, v160, v168
 v_mul_f32 v161, v161, v169
 v_mul_f32 v162, v162, v170
 v_mul_f32 v163, v163, v171
 v_mul_f32 v164, v164, v172
 v_mul_f32 v165, v165, v173
 v_mul_f32 v166, v166, v174
 v_mul_f32 v167, v167, v175
 v_cvt_pk_bf16_f32 v176, v160, v161
 v_cvt_pk_bf16_f32 v177, v162, v163
 v_cvt_pk_bf16_f32 v178, v164, v165
 v_cvt_pk_bf16_f32 v179, v166, v167
 buffer_store_dwordx4 v[176:179], v2, s[36:39], s34 offen offset:0 sc1
 v_accvgpr_read_b32 v24, a104
 v_accvgpr_read_b32 v25, a105
 v_cvt_pk_bf16_f32 v26, v24, v25
 v_lshlrev_b32 v24, 16, v26
 v_and_b32 v25, 0xffff0000, v26
 v_lshlrev_b32 v26, 16, v148
 v_and_b32 v27, 0xffff0000, v148
 v_add_f32 v24, v24, v26
 v_add_f32 v25, v25, v27
 v_cvt_pk_bf16_f32 v26, v24, v25
 v_lshlrev_b32 v160, 16, v26
 v_and_b32 v161, 0xffff0000, v26
 v_accvgpr_read_b32 v24, a106
 v_accvgpr_read_b32 v25, a107
 v_cvt_pk_bf16_f32 v26, v24, v25
 v_lshlrev_b32 v24, 16, v26
 v_and_b32 v25, 0xffff0000, v26
 v_lshlrev_b32 v26, 16, v149
 v_and_b32 v27, 0xffff0000, v149
 v_add_f32 v24, v24, v26
 v_add_f32 v25, v25, v27
 v_cvt_pk_bf16_f32 v26, v24, v25
 v_lshlrev_b32 v162, 16, v26
 v_and_b32 v163, 0xffff0000, v26
 v_accvgpr_read_b32 v24, a108
 v_accvgpr_read_b32 v25, a109
 v_cvt_pk_bf16_f32 v26, v24, v25
 v_lshlrev_b32 v24, 16, v26
 v_and_b32 v25, 0xffff0000, v26
 v_lshlrev_b32 v26, 16, v150
 v_and_b32 v27, 0xffff0000, v150
 v_add_f32 v24, v24, v26
 v_add_f32 v25, v25, v27
 v_cvt_pk_bf16_f32 v26, v24, v25
 v_lshlrev_b32 v164, 16, v26
 v_and_b32 v165, 0xffff0000, v26
 v_accvgpr_read_b32 v24, a110
 v_accvgpr_read_b32 v25, a111
 v_cvt_pk_bf16_f32 v26, v24, v25
 v_lshlrev_b32 v24, 16, v26
 v_and_b32 v25, 0xffff0000, v26
 v_lshlrev_b32 v26, 16, v151
 v_and_b32 v27, 0xffff0000, v151
 v_add_f32 v24, v24, v26
 v_add_f32 v25, v25, v27
 v_cvt_pk_bf16_f32 v26, v24, v25
 v_lshlrev_b32 v166, 16, v26
 v_and_b32 v167, 0xffff0000, v26
 v_mul_f32 v168, s3, v160
 v_mul_f32 v169, s3, v161
 v_mul_f32 v170, s3, v162
 v_mul_f32 v171, s3, v163
 v_mul_f32 v172, s3, v164
 v_mul_f32 v173, s3, v165
 v_mul_f32 v174, s3, v166
 v_mul_f32 v175, s3, v167
 v_exp_f32 v168, v168
 v_exp_f32 v169, v169
 v_exp_f32 v170, v170
 v_exp_f32 v171, v171
 v_exp_f32 v172, v172
 v_exp_f32 v173, v173
 v_exp_f32 v174, v174
 v_exp_f32 v175, v175
 v_add_f32 v168, 1.0, v168
 v_add_f32 v169, 1.0, v169
 v_add_f32 v170, 1.0, v170
 v_add_f32 v171, 1.0, v171
 v_add_f32 v172, 1.0, v172
 v_add_f32 v173, 1.0, v173
 v_add_f32 v174, 1.0, v174
 v_add_f32 v175, 1.0, v175
 v_rcp_f32 v168, v168
 v_rcp_f32 v169, v169
 v_rcp_f32 v170, v170
 v_rcp_f32 v171, v171
 v_rcp_f32 v172, v172
 v_rcp_f32 v173, v173
 v_rcp_f32 v174, v174
 v_rcp_f32 v175, v175
 v_mul_f32 v160, v160, v168
 v_mul_f32 v161, v161, v169
 v_mul_f32 v162, v162, v170
 v_mul_f32 v163, v163, v171
 v_mul_f32 v164, v164, v172
 v_mul_f32 v165, v165, v173
 v_mul_f32 v166, v166, v174
 v_mul_f32 v167, v167, v175
 v_cvt_pk_bf16_f32 v180, v160, v161
 v_cvt_pk_bf16_f32 v181, v162, v163
 v_cvt_pk_bf16_f32 v182, v164, v165
 v_cvt_pk_bf16_f32 v183, v166, v167
 buffer_store_dwordx4 v[180:183], v2, s[36:39], s34 offen offset:1024 sc1
 s_add_u32 s34, s44, 38912
 v_accvgpr_read_b32 v24, a112
 v_accvgpr_read_b32 v25, a113
 v_cvt_pk_bf16_f32 v26, v24, v25
 v_lshlrev_b32 v24, 16, v26
 v_and_b32 v25, 0xffff0000, v26
 v_lshlrev_b32 v26, 16, v152
 v_and_b32 v27, 0xffff0000, v152
 v_add_f32 v24, v24, v26
 v_add_f32 v25, v25, v27
 v_cvt_pk_bf16_f32 v26, v24, v25
 v_lshlrev_b32 v160, 16, v26
 v_and_b32 v161, 0xffff0000, v26
 v_accvgpr_read_b32 v24, a114
 v_accvgpr_read_b32 v25, a115
 v_cvt_pk_bf16_f32 v26, v24, v25
 v_lshlrev_b32 v24, 16, v26
 v_and_b32 v25, 0xffff0000, v26
 v_lshlrev_b32 v26, 16, v153
 v_and_b32 v27, 0xffff0000, v153
 v_add_f32 v24, v24, v26
 v_add_f32 v25, v25, v27
 v_cvt_pk_bf16_f32 v26, v24, v25
 v_lshlrev_b32 v162, 16, v26
 v_and_b32 v163, 0xffff0000, v26
 v_accvgpr_read_b32 v24, a116
 v_accvgpr_read_b32 v25, a117
 v_cvt_pk_bf16_f32 v26, v24, v25
 v_lshlrev_b32 v24, 16, v26
 v_and_b32 v25, 0xffff0000, v26
 v_lshlrev_b32 v26, 16, v154
 v_and_b32 v27, 0xffff0000, v154
 v_add_f32 v24, v24, v26
 v_add_f32 v25, v25, v27
 v_cvt_pk_bf16_f32 v26, v24, v25
 v_lshlrev_b32 v164, 16, v26
 v_and_b32 v165, 0xffff0000, v26
 v_accvgpr_read_b32 v24, a118
 v_accvgpr_read_b32 v25, a119
 v_cvt_pk_bf16_f32 v26, v24, v25
 v_lshlrev_b32 v24, 16, v26
 v_and_b32 v25, 0xffff0000, v26
 v_lshlrev_b32 v26, 16, v155
 v_and_b32 v27, 0xffff0000, v155
 v_add_f32 v24, v24, v26
 v_add_f32 v25, v25, v27
 v_cvt_pk_bf16_f32 v26, v24, v25
 v_lshlrev_b32 v166, 16, v26
 v_and_b32 v167, 0xffff0000, v26
 v_mul_f32 v168, s3, v160
 v_mul_f32 v169, s3, v161
 v_mul_f32 v170, s3, v162
 v_mul_f32 v171, s3, v163
 v_mul_f32 v172, s3, v164
 v_mul_f32 v173, s3, v165
 v_mul_f32 v174, s3, v166
 v_mul_f32 v175, s3, v167
 v_exp_f32 v168, v168
 v_exp_f32 v169, v169
 v_exp_f32 v170, v170
 v_exp_f32 v171, v171
 v_exp_f32 v172, v172
 v_exp_f32 v173, v173
 v_exp_f32 v174, v174
 v_exp_f32 v175, v175
 v_add_f32 v168, 1.0, v168
 v_add_f32 v169, 1.0, v169
 v_add_f32 v170, 1.0, v170
 v_add_f32 v171, 1.0, v171
 v_add_f32 v172, 1.0, v172
 v_add_f32 v173, 1.0, v173
 v_add_f32 v174, 1.0, v174
 v_add_f32 v175, 1.0, v175
 v_rcp_f32 v168, v168
 v_rcp_f32 v169, v169
 v_rcp_f32 v170, v170
 v_rcp_f32 v171, v171
 v_rcp_f32 v172, v172
 v_rcp_f32 v173, v173
 v_rcp_f32 v174, v174
 v_rcp_f32 v175, v175
 v_mul_f32 v160, v160, v168
 v_mul_f32 v161, v161, v169
 v_mul_f32 v162, v162, v170
 v_mul_f32 v163, v163, v171
 v_mul_f32 v164, v164, v172
 v_mul_f32 v165, v165, v173
 v_mul_f32 v166, v166, v174
 v_mul_f32 v167, v167, v175
 v_cvt_pk_bf16_f32 v176, v160, v161
 v_cvt_pk_bf16_f32 v177, v162, v163
 v_cvt_pk_bf16_f32 v178, v164, v165
 v_cvt_pk_bf16_f32 v179, v166, v167
 buffer_store_dwordx4 v[176:179], v2, s[36:39], s34 offen offset:0 sc1
 v_accvgpr_read_b32 v24, a120
 v_accvgpr_read_b32 v25, a121
 v_cvt_pk_bf16_f32 v26, v24, v25
 v_lshlrev_b32 v24, 16, v26
 v_and_b32 v25, 0xffff0000, v26
 v_lshlrev_b32 v26, 16, v156
 v_and_b32 v27, 0xffff0000, v156
 v_add_f32 v24, v24, v26
 v_add_f32 v25, v25, v27
 v_cvt_pk_bf16_f32 v26, v24, v25
 v_lshlrev_b32 v160, 16, v26
 v_and_b32 v161, 0xffff0000, v26
 v_accvgpr_read_b32 v24, a122
 v_accvgpr_read_b32 v25, a123
 v_cvt_pk_bf16_f32 v26, v24, v25
 v_lshlrev_b32 v24, 16, v26
 v_and_b32 v25, 0xffff0000, v26
 v_lshlrev_b32 v26, 16, v157
 v_and_b32 v27, 0xffff0000, v157
 v_add_f32 v24, v24, v26
 v_add_f32 v25, v25, v27
 v_cvt_pk_bf16_f32 v26, v24, v25
 v_lshlrev_b32 v162, 16, v26
 v_and_b32 v163, 0xffff0000, v26
 v_accvgpr_read_b32 v24, a124
 v_accvgpr_read_b32 v25, a125
 v_cvt_pk_bf16_f32 v26, v24, v25
 v_lshlrev_b32 v24, 16, v26
 v_and_b32 v25, 0xffff0000, v26
 v_lshlrev_b32 v26, 16, v158
 v_and_b32 v27, 0xffff0000, v158
 v_add_f32 v24, v24, v26
 v_add_f32 v25, v25, v27
 v_cvt_pk_bf16_f32 v26, v24, v25
 v_lshlrev_b32 v164, 16, v26
 v_and_b32 v165, 0xffff0000, v26
 v_accvgpr_read_b32 v24, a126
 v_accvgpr_read_b32 v25, a127
 v_cvt_pk_bf16_f32 v26, v24, v25
 v_lshlrev_b32 v24, 16, v26
 v_and_b32 v25, 0xffff0000, v26
 v_lshlrev_b32 v26, 16, v159
 v_and_b32 v27, 0xffff0000, v159
 v_add_f32 v24, v24, v26
 v_add_f32 v25, v25, v27
 v_cvt_pk_bf16_f32 v26, v24, v25
 v_lshlrev_b32 v166, 16, v26
 v_and_b32 v167, 0xffff0000, v26
 v_mul_f32 v168, s3, v160
 v_mul_f32 v169, s3, v161
 v_mul_f32 v170, s3, v162
 v_mul_f32 v171, s3, v163
 v_mul_f32 v172, s3, v164
 v_mul_f32 v173, s3, v165
 v_mul_f32 v174, s3, v166
 v_mul_f32 v175, s3, v167
 v_exp_f32 v168, v168
 v_exp_f32 v169, v169
 v_exp_f32 v170, v170
 v_exp_f32 v171, v171
 v_exp_f32 v172, v172
 v_exp_f32 v173, v173
 v_exp_f32 v174, v174
 v_exp_f32 v175, v175
 v_add_f32 v168, 1.0, v168
 v_add_f32 v169, 1.0, v169
 v_add_f32 v170, 1.0, v170
 v_add_f32 v171, 1.0, v171
 v_add_f32 v172, 1.0, v172
 v_add_f32 v173, 1.0, v173
 v_add_f32 v174, 1.0, v174
 v_add_f32 v175, 1.0, v175
 v_rcp_f32 v168, v168
 v_rcp_f32 v169, v169
 v_rcp_f32 v170, v170
 v_rcp_f32 v171, v171
 v_rcp_f32 v172, v172
 v_rcp_f32 v173, v173
 v_rcp_f32 v174, v174
 v_rcp_f32 v175, v175
 v_mul_f32 v160, v160, v168
 v_mul_f32 v161, v161, v169
 v_mul_f32 v162, v162, v170
 v_mul_f32 v163, v163, v171
 v_mul_f32 v164, v164, v172
 v_mul_f32 v165, v165, v173
 v_mul_f32 v166, v166, v174
 v_mul_f32 v167, v167, v175
 v_cvt_pk_bf16_f32 v180, v160, v161
 v_cvt_pk_bf16_f32 v181, v162, v163
 v_cvt_pk_bf16_f32 v182, v164, v165
 v_cvt_pk_bf16_f32 v183, v166, v167
 buffer_store_dwordx4 v[180:183], v2, s[36:39], s34 offen offset:1024 sc1
 s_waitcnt vmcnt(0)
 s_barrier
 s_cmp_lg_u32 s47, 0
 s_cbranch_scc1 L_DONE
 v_mov_b32 v20, 0
 v_mov_b32 v21, 1
 s_lshl_b32 s3, s41, 2
 s_add_u32 s3, s3, 6144
 s_mov_b64 exec, 1
 buffer_store_dword v21, v20, s[36:39], s3 offen sc1
 s_mov_b64 exec, -1
 s_branch L_DONE
R_CHAIN:
 v_and_b32 v65, 63, v0
 v_lshrrev_b32 v66, 6, v0
 s_nop 0
 v_readfirstlane_b32 s47, v66
 v_and_b32 v67, 15, v65
 v_lshrrev_b32 v68, 4, v65
 v_lshlrev_b32 v117, 4, v65
 v_add_u32 v118, 0x10000, v117
 v_add_u32 v119, 0x20000, v117
 v_lshlrev_b32 v123, 2, v65
 v_lshlrev_b32 v69, 4, v67
 v_lshl_add_u32 v78, v68, 2, v69
 v_and_b32 v69, 3, v67
 v_lshrrev_b32 v70, 2, v67
 v_lshl_add_u32 v69, v69, 2, v70
 v_lshlrev_b32 v69, 4, v69
 v_lshl_add_u32 v64, v68, 2, v69
 v_lshrrev_b32 v69, 2, v67
 v_lshlrev_b32 v69, 6, v69
 v_and_b32 v70, 3, v67
 v_lshl_add_u32 v69, v70, 2, v69
 v_lshl_add_u32 v127, v68, 4, v69
 s_mov_b32 s36, s32
 s_mov_b32 s37, s33
 s_mov_b32 s38, 268435456
 s_mov_b32 s39, 0x20000
 v_lshrrev_b32 v69, 1, v67
 v_lshlrev_b32 v69, 10, v69
 v_and_b32 v70, 1, v67
 v_lshlrev_b32 v70, 2, v70
 v_lshl_add_u32 v70, v68, 3, v70
 v_add_u32 v69, v69, v70
 s_lshl_b32 s3, s40, 5
 v_add_u32 v69, s3, v69
 global_load_dword v76, v69, s[6:7]
 v_mov_b32 v72, -1
 v_mov_b32 v73, -1
 v_mov_b32 v74, -1
 v_mov_b32 v75, -1
 s_mul_i32 s3, s40, 8448
 s_add_u32 s45, s3, 1048576
 s_lshl_b32 s3, s47, 11
 s_add_u32 s3, s3, s45
 s_add_u32 s34, s3, 270336
 buffer_store_dwordx4 v[72:75], v117, s[36:39], s3 offen
 buffer_store_dwordx4 v[72:75], v117, s[36:39], s3 offen offset:1024
 buffer_store_dwordx4 v[72:75], v117, s[36:39], s34 offen
 buffer_store_dwordx4 v[72:75], v117, s[36:39], s34 offen offset:1024
 s_add_u32 s34, s34, 270336
 buffer_store_dwordx4 v[72:75], v117, s[36:39], s34 offen
 buffer_store_dwordx4 v[72:75], v117, s[36:39], s34 offen offset:1024
 s_lshl_b32 s3, s40, 8
 s_add_u32 s44, s3, 65536
 s_add_u32 s3, s44, 8192
 buffer_store_dword v72, v123, s[36:39], s3 offen
 s_add_u32 s78, s44, 16384
 buffer_store_dword v72, v123, s[36:39], s78 offen
 v_lshlrev_b32 v69, 13, v68
 v_lshl_add_u32 v69, v67, 4, v69
 s_lshl_b32 s3, s47, 17
 v_add_u32 v69, s3, v69
 v_mov_b32 v71, 0x7fffffff
 v_cmp_gt_u32 vcc, 0x2000, v69
 s_nop 1
 v_cndmask_b32 v70, v69, v71, vcc
 s_lshl_b32 s3, s40, 8
 s_add_u32 s60, s3, 2097152
 buffer_store_dwordx4 v[72:75], v70, s[36:39], s60 offen sc1
 v_add_u32 v69, 0x8000, v69
 buffer_store_dwordx4 v[72:75], v69, s[36:39], s60 offen sc1
 v_add_u32 v69, 0x8000, v69
 buffer_store_dwordx4 v[72:75], v69, s[36:39], s60 offen sc1
 v_add_u32 v69, 0x8000, v69
 buffer_store_dwordx4 v[72:75], v69, s[36:39], s60 offen sc1
 v_lshlrev_b32 v69, 1, v68
 v_xor_b32 v69, v69, v67
 v_lshlrev_b32 v69, 4, v69
 v_lshl_add_u32 v80, v68, 13, v69
 v_xor_b32 v81, 0x80, v80
 s_lshr_b32 s3, s47, 1
 s_lshl_b32 s3, s3, 7
 v_xor_b32 v82, s3, v117
 v_xor_b32 v83, 0x20, v82
 v_xor_b32 v84, 0x40, v82
 v_xor_b32 v85, 0x60, v82
 v_lshrrev_b32 v69, 2, v67
 v_and_b32 v70, 3, v67
 v_and_b32 v71, 1, v68
 v_lshl_add_u32 v71, v71, 2, v69
 v_lshlrev_b32 v71, 5, v71
 v_lshl_add_u32 v71, v70, 3, v71
 v_lshl_add_u32 v69, v68, 3, v69
 v_lshl_add_u32 v86, v69, 8, v71
 s_lshl_b32 s3, s47, 6
 v_xor_b32 v86, s3, v86
 v_xor_b32 v87, 0x20, v86
 v_add_u32 v86, 32768, v86
 v_add_u32 v87, 32768, v87
 v_lshrrev_b32 v69, 2, v67
 v_and_b32 v71, 1, v69
 v_lshrrev_b32 v69, 1, v69
 v_lshl_add_u32 v69, v69, 2, v71
 v_lshl_add_u32 v69, v68, 3, v69
 v_and_b32 v90, 1, v68
 v_lshl_add_u32 v71, v90, 2, v71
 v_lshlrev_b32 v71, 5, v71
 v_lshl_add_u32 v71, v70, 3, v71
 v_lshl_add_u32 v88, v69, 10, v71
 s_lshl_b32 s3, s47, 5
 v_xor_b32 v88, s3, v88
 v_xor_b32 v89, 0x80, v88
 v_xor_b32 v90, 0x40, v88
 v_xor_b32 v91, 0xc0, v88
 v_add_u32 v88, 32768, v88
 v_add_u32 v89, 32768, v89
 v_add_u32 v90, 32768, v90
 v_add_u32 v91, 32768, v91
 s_lshl_b32 s66, s47, 12
 s_add_u32 s66, s66, 32768
 s_mov_b32 s70, 0x400000
 s_mov_b32 s71, 0x20000
 s_mov_b32 s68, s14
 s_mov_b32 s69, s15
 s_lshl_b32 s67, s40, 17
 s_lshl_b32 s3, s47, 12
 s_add_u32 s67, s67, s3
 s_add_u32 m0, s66, 0
 s_add_u32 s3, s67, 65536
 buffer_load_dwordx4 v82, s[68:71], s3 offen lds
 s_add_u32 m0, s66, 1024
 s_add_u32 s3, s67, 66560
 buffer_load_dwordx4 v83, s[68:71], s3 offen lds
 s_add_u32 m0, s66, 2048
 s_add_u32 s3, s67, 67584
 buffer_load_dwordx4 v84, s[68:71], s3 offen lds
 s_add_u32 m0, s66, 3072
 s_add_u32 s3, s67, 68608
 buffer_load_dwordx4 v85, s[68:71], s3 offen lds
 s_add_u32 m0, s66, 16384
 s_add_u32 s3, s67, 81920
 buffer_load_dwordx4 v82, s[68:71], s3 offen lds
 s_add_u32 m0, s66, 17408
 s_add_u32 s3, s67, 82944
 buffer_load_dwordx4 v83, s[68:71], s3 offen lds
 s_add_u32 m0, s66, 18432
 s_add_u32 s3, s67, 83968
 buffer_load_dwordx4 v84, s[68:71], s3 offen lds
 s_add_u32 m0, s66, 19456
 s_add_u32 s3, s67, 84992
 buffer_load_dwordx4 v85, s[68:71], s3 offen lds
 s_add_u32 m0, s66, 32768
 s_add_u32 s3, s67, 98304
 buffer_load_dwordx4 v82, s[68:71], s3 offen lds
 s_add_u32 m0, s66, 33792
 s_add_u32 s3, s67, 99328
 buffer_load_dwordx4 v83, s[68:71], s3 offen lds
 s_add_u32 m0, s66, 34816
 s_add_u32 s3, s67, 100352
 buffer_load_dwordx4 v84, s[68:71], s3 offen lds
 s_add_u32 m0, s66, 35840
 s_add_u32 s3, s67, 101376
 buffer_load_dwordx4 v85, s[68:71], s3 offen lds
 s_add_u32 m0, s66, 49152
 s_add_u32 s3, s67, 114688
 buffer_load_dwordx4 v82, s[68:71], s3 offen lds
 s_add_u32 m0, s66, 50176
 s_add_u32 s3, s67, 115712
 buffer_load_dwordx4 v83, s[68:71], s3 offen lds
 s_add_u32 m0, s66, 51200
 s_add_u32 s3, s67, 116736
 buffer_load_dwordx4 v84, s[68:71], s3 offen lds
 s_add_u32 m0, s66, 52224
 s_add_u32 s3, s67, 117760
 buffer_load_dwordx4 v85, s[68:71], s3 offen lds
 s_add_u32 m0, s66, 65536
 s_add_u32 s3, s67, 0
 buffer_load_dwordx4 v82, s[68:71], s3 offen lds
 s_add_u32 m0, s66, 66560
 s_add_u32 s3, s67, 1024
 buffer_load_dwordx4 v83, s[68:71], s3 offen lds
 s_add_u32 m0, s66, 67584
 s_add_u32 s3, s67, 2048
 buffer_load_dwordx4 v84, s[68:71], s3 offen lds
 s_add_u32 m0, s66, 68608
 s_add_u32 s3, s67, 3072
 buffer_load_dwordx4 v85, s[68:71], s3 offen lds
 s_add_u32 m0, s66, 81920
 s_add_u32 s3, s67, 16384
 buffer_load_dwordx4 v82, s[68:71], s3 offen lds
 s_add_u32 m0, s66, 82944
 s_add_u32 s3, s67, 17408
 buffer_load_dwordx4 v83, s[68:71], s3 offen lds
 s_add_u32 m0, s66, 83968
 s_add_u32 s3, s67, 18432
 buffer_load_dwordx4 v84, s[68:71], s3 offen lds
 s_add_u32 m0, s66, 84992
 s_add_u32 s3, s67, 19456
 buffer_load_dwordx4 v85, s[68:71], s3 offen lds
 s_add_u32 m0, s66, 98304
 s_add_u32 s3, s67, 32768
 buffer_load_dwordx4 v82, s[68:71], s3 offen lds
 s_add_u32 m0, s66, 99328
 s_add_u32 s3, s67, 33792
 buffer_load_dwordx4 v83, s[68:71], s3 offen lds
 s_add_u32 m0, s66, 100352
 s_add_u32 s3, s67, 34816
 buffer_load_dwordx4 v84, s[68:71], s3 offen lds
 s_add_u32 m0, s66, 101376
 s_add_u32 s3, s67, 35840
 buffer_load_dwordx4 v85, s[68:71], s3 offen lds
 s_add_u32 m0, s66, 114688
 s_add_u32 s3, s67, 49152
 buffer_load_dwordx4 v82, s[68:71], s3 offen lds
 s_add_u32 m0, s66, 115712
 s_add_u32 s3, s67, 50176
 buffer_load_dwordx4 v83, s[68:71], s3 offen lds
 s_add_u32 m0, s66, 116736
 s_add_u32 s3, s67, 51200
 buffer_load_dwordx4 v84, s[68:71], s3 offen lds
 s_add_u32 m0, s66, 117760
 s_add_u32 s3, s67, 52224
 buffer_load_dwordx4 v85, s[68:71], s3 offen lds
 v_and_b32 v69, 1, v67
 v_mov_b32 v70, 0x4444
 v_mov_b32 v71, 0xeeee
 v_cmp_eq_u32 s[62:63], 1, v69
 s_nop 1
 v_cndmask_b32 v116, v70, v71, s[62:63]
 v_lshrrev_b32 v69, 1, v68
 v_lshlrev_b32 v69, 4, v69
 v_and_b32 v70, 1, v68
 v_lshl_add_u32 v69, v70, 2, v69
 v_lshrrev_b32 v70, 2, v67
 v_add_u32 v69, v69, v70
 v_and_b32 v70, 3, v67
 v_and_b32 v71, 1, v68
 v_lshlrev_b32 v71, 1, v71
 v_xor_b32 v70, v70, v71
 v_lshlrev_b32 v70, 3, v70
 v_mul_u32_u24 v69, 32, v69
 v_add_u32 v120, v69, v70
 v_mul_u32_u24 v69, 32, v67
 v_lshrrev_b32 v70, 1, v67
 v_and_b32 v70, 2, v70
 v_xor_b32 v70, v70, v68
 v_lshl_add_u32 v121, v70, 3, v69
 v_lshrrev_b32 v69, 2, v67
 v_and_b32 v70, 1, v67
 v_lshl_add_u32 v69, v69, 1, v70
 v_lshrrev_b32 v70, 2, v69
 v_xor_b32 v70, v70, v68
 v_and_b32 v70, 1, v70
 v_lshlrev_b32 v69, 5, v69
 v_lshl_add_u32 v69, v70, 4, v69
 v_lshrrev_b32 v70, 1, v68
 v_lshl_add_u32 v69, v70, 3, v69
 v_add_u32 v70, 24576, v69
 v_xor_b32 v71, 8, v69
 v_add_u32 v71, 30720, v71
 v_and_b32 v69, 2, v67
 v_cmp_eq_u32 vcc, 0, v69
 s_lshl_b32 s3, s47, 9
 v_add_u32 v70, s3, v70
 v_cndmask_b32 v122, v71, v70, vcc
 v_lshrrev_b32 v69, 3, v67
 v_xor_b32 v69, v69, v67
 v_and_b32 v69, 7, v69
 v_and_b32 v70, 3, v69
 v_cmp_eq_u32 vcc, 3, v70
 v_mov_b32 v71, 0x3f80
 v_mov_b32 v77, 0x3f800000
 v_cndmask_b32 v71, v71, v77, vcc
 v_cndmask_b32 v70, v70, 0, vcc
 v_or_b32 v70, 12, v70
 v_mul_u32_u24 v70, 0x1111, v70
 ds_write_b32 v123, v70 offset:31744
 v_cmp_gt_u32 vcc, 4, v69
 s_nop 1
 v_cndmask_b32 v92, 0, v71, vcc
 v_cndmask_b32 v93, v71, 0, vcc
 v_mov_b32 v94, v92
 v_mov_b32 v95, v93
 ds_write_b128 v117, v[92:95] offset:28672
 s_waitcnt lgkmcnt(0)
 v_mov_b32 v92, 0x3f803f80
 v_mov_b32 v93, 0x3f803f80
 v_mov_b32 v94, 0x3f803f80
 v_mov_b32 v95, 0x3f803f80
 ds_write_b128 v117, v[92:95] offset:29696
 s_mov_b32 s88, 0x53800000
 v_mov_b32 v125, 0
 s_mov_b32 s86, 0x33333333
 s_mov_b32 s87, 0x33333333
 s_mov_b32 s62, 0
 s_mov_b32 s63, -1
 s_mov_b32 s64, 0x3e0293ee
 s_waitcnt vmcnt(16)
 v_min_u32 v76, -2, v76
 buffer_store_dword v76, v78, s[36:39], s44 offen
 buffer_store_dword v76, v78, s[36:39], s60 offen sc1
 v_mov_b32 v79, v0
 s_barrier
 ds_read_b64_tr_b16 v[0:1], v88 offset:0
 ds_read_b64_tr_b16 v[2:3], v90 offset:2048
 ds_read_b64_tr_b16 v[4:5], v88 offset:32768
 ds_read_b64_tr_b16 v[6:7], v90 offset:34816
 ds_read_b64_tr_b16 v[8:9], v89 offset:0
 ds_read_b64_tr_b16 v[10:11], v91 offset:2048
 ds_read_b64_tr_b16 v[12:13], v89 offset:32768
 ds_read_b64_tr_b16 v[14:15], v91 offset:34816
 s_waitcnt lgkmcnt(0)
 ds_read_b64_tr_b16 v[16:17], v88 offset:256
 ds_read_b64_tr_b16 v[18:19], v90 offset:2304
 ds_read_b64_tr_b16 v[20:21], v88 offset:33024
 ds_read_b64_tr_b16 v[22:23], v90 offset:35072
 ds_read_b64_tr_b16 v[24:25], v89 offset:256
 ds_read_b64_tr_b16 v[26:27], v91 offset:2304
 ds_read_b64_tr_b16 v[28:29], v89 offset:33024
 ds_read_b64_tr_b16 v[30:31], v91 offset:35072
 s_waitcnt lgkmcnt(0)
 ds_read_b64_tr_b16 v[32:33], v88 offset:512
 ds_read_b64_tr_b16 v[34:35], v90 offset:2560
 ds_read_b64_tr_b16 v[36:37], v88 offset:33280
 ds_read_b64_tr_b16 v[38:39], v90 offset:35328
 ds_read_b64_tr_b16 v[40:41], v89 offset:512
 ds_read_b64_tr_b16 v[42:43], v91 offset:2560
 ds_read_b64_tr_b16 v[44:45], v89 offset:33280
 ds_read_b64_tr_b16 v[46:47], v91 offset:35328
 s_waitcnt lgkmcnt(0)
 ds_read_b64_tr_b16 v[48:49], v88 offset:768
 ds_read_b64_tr_b16 v[50:51], v90 offset:2816
 ds_read_b64_tr_b16 v[52:53], v88 offset:33536
 ds_read_b64_tr_b16 v[54:55], v90 offset:35584
 ds_read_b64_tr_b16 v[56:57], v89 offset:768
 ds_read_b64_tr_b16 v[58:59], v91 offset:2816
 ds_read_b64_tr_b16 v[60:61], v89 offset:33536
 ds_read_b64_tr_b16 v[62:63], v91 offset:35584
 s_waitcnt lgkmcnt(0)
 s_barrier
 v_add_u32 v88, 0x10000, v88
 v_add_u32 v89, 0x10000, v89
 v_add_u32 v90, 0x10000, v90
 v_add_u32 v91, 0x10000, v91
 s_mov_b32 s68, s8
 s_mov_b32 s69, s9
 s_lshl_b32 s67, s40, 8
 s_lshl_b32 s3, s47, 17
 s_add_u32 s67, s67, s3
 s_add_u32 m0, s66, 0
 s_add_u32 s3, s67, 0
 buffer_load_dwordx4 v80, s[68:71], s3 offen lds
 s_add_u32 m0, s66, 1024
 s_add_u32 s3, s67, 32768
 buffer_load_dwordx4 v80, s[68:71], s3 offen lds
 s_add_u32 m0, s66, 2048
 s_add_u32 s3, s67, 65536
 buffer_load_dwordx4 v81, s[68:71], s3 offen lds
 s_add_u32 m0, s66, 3072
 s_add_u32 s3, s67, 98304
 buffer_load_dwordx4 v81, s[68:71], s3 offen lds
 s_add_u32 m0, s66, 16384
 s_add_u32 s3, s67, 524288
 buffer_load_dwordx4 v80, s[68:71], s3 offen lds
 s_add_u32 m0, s66, 17408
 s_add_u32 s3, s67, 557056
 buffer_load_dwordx4 v80, s[68:71], s3 offen lds
 s_add_u32 m0, s66, 18432
 s_add_u32 s3, s67, 589824
 buffer_load_dwordx4 v81, s[68:71], s3 offen lds
 s_add_u32 m0, s66, 19456
 s_add_u32 s3, s67, 622592
 buffer_load_dwordx4 v81, s[68:71], s3 offen lds
 s_add_u32 m0, s66, 32768
 s_add_u32 s3, s67, 1048576
 buffer_load_dwordx4 v80, s[68:71], s3 offen lds
 s_add_u32 m0, s66, 33792
 s_add_u32 s3, s67, 1081344
 buffer_load_dwordx4 v80, s[68:71], s3 offen lds
 s_add_u32 m0, s66, 34816
 s_add_u32 s3, s67, 1114112
 buffer_load_dwordx4 v81, s[68:71], s3 offen lds
 s_add_u32 m0, s66, 35840
 s_add_u32 s3, s67, 1146880
 buffer_load_dwordx4 v81, s[68:71], s3 offen lds
 s_add_u32 m0, s66, 49152
 s_add_u32 s3, s67, 1572864
 buffer_load_dwordx4 v80, s[68:71], s3 offen lds
 s_add_u32 m0, s66, 50176
 s_add_u32 s3, s67, 1605632
 buffer_load_dwordx4 v80, s[68:71], s3 offen lds
 s_add_u32 m0, s66, 51200
 s_add_u32 s3, s67, 1638400
 buffer_load_dwordx4 v81, s[68:71], s3 offen lds
 s_add_u32 m0, s66, 52224
 s_add_u32 s3, s67, 1671168
 buffer_load_dwordx4 v81, s[68:71], s3 offen lds
 s_waitcnt vmcnt(16)
 s_barrier
 ds_read_b64_tr_b16 v[192:193], v88 offset:0
 ds_read_b64_tr_b16 v[194:195], v90 offset:2048
 ds_read_b64_tr_b16 v[196:197], v88 offset:32768
 ds_read_b64_tr_b16 v[198:199], v90 offset:34816
 ds_read_b64_tr_b16 v[200:201], v89 offset:0
 ds_read_b64_tr_b16 v[202:203], v91 offset:2048
 ds_read_b64_tr_b16 v[204:205], v89 offset:32768
 ds_read_b64_tr_b16 v[206:207], v91 offset:34816
 s_waitcnt lgkmcnt(0)
 ds_read_b64_tr_b16 v[208:209], v88 offset:256
 ds_read_b64_tr_b16 v[210:211], v90 offset:2304
 ds_read_b64_tr_b16 v[212:213], v88 offset:33024
 ds_read_b64_tr_b16 v[214:215], v90 offset:35072
 ds_read_b64_tr_b16 v[216:217], v89 offset:256
 ds_read_b64_tr_b16 v[218:219], v91 offset:2304
 ds_read_b64_tr_b16 v[220:221], v89 offset:33024
 ds_read_b64_tr_b16 v[222:223], v91 offset:35072
 s_waitcnt lgkmcnt(0)
 ds_read_b64_tr_b16 v[224:225], v88 offset:512
 ds_read_b64_tr_b16 v[226:227], v90 offset:2560
 ds_read_b64_tr_b16 v[228:229], v88 offset:33280
 ds_read_b64_tr_b16 v[230:231], v90 offset:35328
 ds_read_b64_tr_b16 v[232:233], v89 offset:512
 ds_read_b64_tr_b16 v[234:235], v91 offset:2560
 ds_read_b64_tr_b16 v[236:237], v89 offset:33280
 ds_read_b64_tr_b16 v[238:239], v91 offset:35328
 s_waitcnt lgkmcnt(0)
 ds_read_b64_tr_b16 v[240:241], v88 offset:768
 ds_read_b64_tr_b16 v[242:243], v90 offset:2816
 ds_read_b64_tr_b16 v[244:245], v88 offset:33536
 ds_read_b64_tr_b16 v[246:247], v90 offset:35584
 ds_read_b64_tr_b16 v[248:249], v89 offset:768
 ds_read_b64_tr_b16 v[250:251], v91 offset:2816
 ds_read_b64_tr_b16 v[252:253], v89 offset:33536
 ds_read_b64_tr_b16 v[254:255], v91 offset:35584
 s_waitcnt lgkmcnt(0)
 s_barrier
 s_add_u32 m0, s66, 65536
 s_add_u32 s3, s67, 2097152
 buffer_load_dwordx4 v80, s[68:71], s3 offen lds
 s_add_u32 m0, s66, 66560
 s_add_u32 s3, s67, 2129920
 buffer_load_dwordx4 v80, s[68:71], s3 offen lds
 s_add_u32 m0, s66, 67584
 s_add_u32 s3, s67, 2162688
 buffer_load_dwordx4 v81, s[68:71], s3 offen lds
 s_add_u32 m0, s66, 68608
 s_add_u32 s3, s67, 2195456
 buffer_load_dwordx4 v81, s[68:71], s3 offen lds
 s_add_u32 m0, s66, 81920
 s_add_u32 s3, s67, 2621440
 buffer_load_dwordx4 v80, s[68:71], s3 offen lds
 s_add_u32 m0, s66, 82944
 s_add_u32 s3, s67, 2654208
 buffer_load_dwordx4 v80, s[68:71], s3 offen lds
 s_add_u32 m0, s66, 83968
 s_add_u32 s3, s67, 2686976
 buffer_load_dwordx4 v81, s[68:71], s3 offen lds
 s_add_u32 m0, s66, 84992
 s_add_u32 s3, s67, 2719744
 buffer_load_dwordx4 v81, s[68:71], s3 offen lds
 s_add_u32 m0, s66, 98304
 s_add_u32 s3, s67, 3145728
 buffer_load_dwordx4 v80, s[68:71], s3 offen lds
 s_add_u32 m0, s66, 99328
 s_add_u32 s3, s67, 3178496
 buffer_load_dwordx4 v80, s[68:71], s3 offen lds
 s_add_u32 m0, s66, 100352
 s_add_u32 s3, s67, 3211264
 buffer_load_dwordx4 v81, s[68:71], s3 offen lds
 s_add_u32 m0, s66, 101376
 s_add_u32 s3, s67, 3244032
 buffer_load_dwordx4 v81, s[68:71], s3 offen lds
 s_add_u32 m0, s66, 114688
 s_add_u32 s3, s67, 3670016
 buffer_load_dwordx4 v80, s[68:71], s3 offen lds
 s_add_u32 m0, s66, 115712
 s_add_u32 s3, s67, 3702784
 buffer_load_dwordx4 v80, s[68:71], s3 offen lds
 s_add_u32 m0, s66, 116736
 s_add_u32 s3, s67, 3735552
 buffer_load_dwordx4 v81, s[68:71], s3 offen lds
 s_add_u32 m0, s66, 117760
 s_add_u32 s3, s67, 3768320
 buffer_load_dwordx4 v81, s[68:71], s3 offen lds
 s_waitcnt vmcnt(28)
 s_barrier
 ds_read_b64_tr_b16 a[0:1], v86 offset:0
 ds_read_b64_tr_b16 a[2:3], v86 offset:1024
 ds_read_b64_tr_b16 a[4:5], v86 offset:8192
 ds_read_b64_tr_b16 a[6:7], v86 offset:9216
 ds_read_b64_tr_b16 a[64:65], v87 offset:0
 ds_read_b64_tr_b16 a[66:67], v87 offset:1024
 ds_read_b64_tr_b16 a[68:69], v87 offset:8192
 ds_read_b64_tr_b16 a[70:71], v87 offset:9216
 s_waitcnt lgkmcnt(0)
 s_barrier
 s_mov_b32 s68, s10
 s_mov_b32 s69, s11
 s_lshl_b32 s67, s40, 8
 s_lshl_b32 s3, s47, 17
 s_add_u32 s67, s67, s3
 s_add_u32 m0, s66, 0
 s_add_u32 s3, s67, 0
 buffer_load_dwordx4 v80, s[68:71], s3 offen lds
 s_add_u32 m0, s66, 1024
 s_add_u32 s3, s67, 32768
 buffer_load_dwordx4 v80, s[68:71], s3 offen lds
 s_add_u32 m0, s66, 2048
 s_add_u32 s3, s67, 65536
 buffer_load_dwordx4 v81, s[68:71], s3 offen lds
 s_add_u32 m0, s66, 3072
 s_add_u32 s3, s67, 98304
 buffer_load_dwordx4 v81, s[68:71], s3 offen lds
 s_waitcnt vmcnt(28)
 s_barrier
 v_mov_b32 v69, 4
 v_mov_b32 v70, 1
 v_cmp_eq_u32 vcc, 0, v79
 s_nop 0
 s_and_saveexec_b64 s[34:35], vcc
 s_cbranch_execz L_noinc
 global_atomic_add v69, v70, s[30:31]
L_noinc:
 s_mov_b64 exec, s[34:35]
 ds_read_b64_tr_b16 a[8:9], v86 offset:16384
 ds_read_b64_tr_b16 a[10:11], v86 offset:17408
 ds_read_b64_tr_b16 a[12:13], v86 offset:24576
 ds_read_b64_tr_b16 a[14:15], v86 offset:25600
 ds_read_b64_tr_b16 a[72:73], v87 offset:16384
 ds_read_b64_tr_b16 a[74:75], v87 offset:17408
 ds_read_b64_tr_b16 a[76:77], v87 offset:24576
 ds_read_b64_tr_b16 a[78:79], v87 offset:25600
 s_waitcnt lgkmcnt(0)
 s_barrier
 s_add_u32 m0, s66, 16384
 s_add_u32 s3, s67, 524288
 buffer_load_dwordx4 v80, s[68:71], s3 offen lds
 s_add_u32 m0, s66, 17408
 s_add_u32 s3, s67, 557056
 buffer_load_dwordx4 v80, s[68:71], s3 offen lds
 s_add_u32 m0, s66, 18432
 s_add_u32 s3, s67, 589824
 buffer_load_dwordx4 v81, s[68:71], s3 offen lds
 s_add_u32 m0, s66, 19456
 s_add_u32 s3, s67, 622592
 buffer_load_dwordx4 v81, s[68:71], s3 offen lds
 s_waitcnt vmcnt(28)
 s_barrier
 ds_read_b64_tr_b16 a[16:17], v86 offset:32768
 ds_read_b64_tr_b16 a[18:19], v86 offset:33792
 ds_read_b64_tr_b16 a[20:21], v86 offset:40960
 ds_read_b64_tr_b16 a[22:23], v86 offset:41984
 ds_read_b64_tr_b16 a[80:81], v87 offset:32768
 ds_read_b64_tr_b16 a[82:83], v87 offset:33792
 ds_read_b64_tr_b16 a[84:85], v87 offset:40960
 ds_read_b64_tr_b16 a[86:87], v87 offset:41984
 s_waitcnt lgkmcnt(0)
 s_barrier
 s_add_u32 m0, s66, 32768
 s_add_u32 s3, s67, 1048576
 buffer_load_dwordx4 v80, s[68:71], s3 offen lds
 s_add_u32 m0, s66, 33792
 s_add_u32 s3, s67, 1081344
 buffer_load_dwordx4 v80, s[68:71], s3 offen lds
 s_add_u32 m0, s66, 34816
 s_add_u32 s3, s67, 1114112
 buffer_load_dwordx4 v81, s[68:71], s3 offen lds
 s_add_u32 m0, s66, 35840
 s_add_u32 s3, s67, 1146880
 buffer_load_dwordx4 v81, s[68:71], s3 offen lds
 s_waitcnt vmcnt(28)
 s_barrier
 ds_read_b64_tr_b16 a[24:25], v86 offset:49152
 ds_read_b64_tr_b16 a[26:27], v86 offset:50176
 ds_read_b64_tr_b16 a[28:29], v86 offset:57344
 ds_read_b64_tr_b16 a[30:31], v86 offset:58368
 ds_read_b64_tr_b16 a[88:89], v87 offset:49152
 ds_read_b64_tr_b16 a[90:91], v87 offset:50176
 ds_read_b64_tr_b16 a[92:93], v87 offset:57344
 ds_read_b64_tr_b16 a[94:95], v87 offset:58368
 s_waitcnt lgkmcnt(0)
 s_barrier
 v_add_u32 v86, 0x10000, v86
 v_add_u32 v87, 0x10000, v87
 s_add_u32 m0, s66, 49152
 s_add_u32 s3, s67, 1572864
 buffer_load_dwordx4 v80, s[68:71], s3 offen lds
 s_add_u32 m0, s66, 50176
 s_add_u32 s3, s67, 1605632
 buffer_load_dwordx4 v80, s[68:71], s3 offen lds
 s_add_u32 m0, s66, 51200
 s_add_u32 s3, s67, 1638400
 buffer_load_dwordx4 v81, s[68:71], s3 offen lds
 s_add_u32 m0, s66, 52224
 s_add_u32 s3, s67, 1671168
 buffer_load_dwordx4 v81, s[68:71], s3 offen lds
 s_waitcnt vmcnt(28)
 s_barrier
 ds_read_b64_tr_b16 a[32:33], v86 offset:0
 ds_read_b64_tr_b16 a[34:35], v86 offset:1024
 ds_read_b64_tr_b16 a[36:37], v86 offset:8192
 ds_read_b64_tr_b16 a[38:39], v86 offset:9216
 ds_read_b64_tr_b16 a[96:97], v87 offset:0
 ds_read_b64_tr_b16 a[98:99], v87 offset:1024
 ds_read_b64_tr_b16 a[100:101], v87 offset:8192
 ds_read_b64_tr_b16 a[102:103], v87 offset:9216
 s_waitcnt lgkmcnt(0)
 s_barrier
 s_add_u32 m0, s66, 65536
 s_add_u32 s3, s67, 2097152
 buffer_load_dwordx4 v80, s[68:71], s3 offen lds
 s_add_u32 m0, s66, 66560
 s_add_u32 s3, s67, 2129920
 buffer_load_dwordx4 v80, s[68:71], s3 offen lds
 s_add_u32 m0, s66, 67584
 s_add_u32 s3, s67, 2162688
 buffer_load_dwordx4 v81, s[68:71], s3 offen lds
 s_add_u32 m0, s66, 68608
 s_add_u32 s3, s67, 2195456
 buffer_load_dwordx4 v81, s[68:71], s3 offen lds
 s_waitcnt vmcnt(28)
 s_barrier
 ds_read_b64_tr_b16 a[40:41], v86 offset:16384
 ds_read_b64_tr_b16 a[42:43], v86 offset:17408
 ds_read_b64_tr_b16 a[44:45], v86 offset:24576
 ds_read_b64_tr_b16 a[46:47], v86 offset:25600
 ds_read_b64_tr_b16 a[104:105], v87 offset:16384
 ds_read_b64_tr_b16 a[106:107], v87 offset:17408
 ds_read_b64_tr_b16 a[108:109], v87 offset:24576
 ds_read_b64_tr_b16 a[110:111], v87 offset:25600
 s_waitcnt lgkmcnt(0)
 s_barrier
 s_add_u32 m0, s66, 81920
 s_add_u32 s3, s67, 2621440
 buffer_load_dwordx4 v80, s[68:71], s3 offen lds
 s_add_u32 m0, s66, 82944
 s_add_u32 s3, s67, 2654208
 buffer_load_dwordx4 v80, s[68:71], s3 offen lds
 s_add_u32 m0, s66, 83968
 s_add_u32 s3, s67, 2686976
 buffer_load_dwordx4 v81, s[68:71], s3 offen lds
 s_add_u32 m0, s66, 84992
 s_add_u32 s3, s67, 2719744
 buffer_load_dwordx4 v81, s[68:71], s3 offen lds
 s_waitcnt vmcnt(28)
 s_barrier
 ds_read_b64_tr_b16 a[48:49], v86 offset:32768
 ds_read_b64_tr_b16 a[50:51], v86 offset:33792
 ds_read_b64_tr_b16 a[52:53], v86 offset:40960
 ds_read_b64_tr_b16 a[54:55], v86 offset:41984
 ds_read_b64_tr_b16 a[112:113], v87 offset:32768
 ds_read_b64_tr_b16 a[114:115], v87 offset:33792
 ds_read_b64_tr_b16 a[116:117], v87 offset:40960
 ds_read_b64_tr_b16 a[118:119], v87 offset:41984
 s_waitcnt lgkmcnt(0)
 s_barrier
 s_add_u32 m0, s66, 98304
 s_add_u32 s3, s67, 3145728
 buffer_load_dwordx4 v80, s[68:71], s3 offen lds
 s_add_u32 m0, s66, 99328
 s_add_u32 s3, s67, 3178496
 buffer_load_dwordx4 v80, s[68:71], s3 offen lds
 s_add_u32 m0, s66, 100352
 s_add_u32 s3, s67, 3211264
 buffer_load_dwordx4 v81, s[68:71], s3 offen lds
 s_add_u32 m0, s66, 101376
 s_add_u32 s3, s67, 3244032
 buffer_load_dwordx4 v81, s[68:71], s3 offen lds
 s_waitcnt vmcnt(28)
 s_barrier
 ds_read_b64_tr_b16 a[56:57], v86 offset:49152
 ds_read_b64_tr_b16 a[58:59], v86 offset:50176
 ds_read_b64_tr_b16 a[60:61], v86 offset:57344
 ds_read_b64_tr_b16 a[62:63], v86 offset:58368
 ds_read_b64_tr_b16 a[120:121], v87 offset:49152
 ds_read_b64_tr_b16 a[122:123], v87 offset:50176
 ds_read_b64_tr_b16 a[124:125], v87 offset:57344
 ds_read_b64_tr_b16 a[126:127], v87 offset:58368
 s_waitcnt lgkmcnt(0)
 s_barrier
 v_subrev_u32 v86, 0x10000, v86
 v_subrev_u32 v87, 0x10000, v87
 s_add_u32 m0, s66, 114688
 s_add_u32 s3, s67, 3670016
 buffer_load_dwordx4 v80, s[68:71], s3 offen lds
 s_add_u32 m0, s66, 115712
 s_add_u32 s3, s67, 3702784
 buffer_load_dwordx4 v80, s[68:71], s3 offen lds
 s_add_u32 m0, s66, 116736
 s_add_u32 s3, s67, 3735552
 buffer_load_dwordx4 v81, s[68:71], s3 offen lds
 s_add_u32 m0, s66, 117760
 s_add_u32 s3, s67, 3768320
 buffer_load_dwordx4 v81, s[68:71], s3 offen lds
 s_waitcnt vmcnt(28)
 s_barrier
 v_mov_b32 v69, 36
 global_load_dword v67, v69, s[30:31] sc1
 ds_read_b64_tr_b16 a[128:129], v86 offset:0
 ds_read_b64_tr_b16 a[130:131], v86 offset:1024
 ds_read_b64_tr_b16 a[132:133], v86 offset:8192
 ds_read_b64_tr_b16 a[134:135], v86 offset:9216
 ds_read_b64_tr_b16 a[192:193], v87 offset:0
 ds_read_b64_tr_b16 a[194:195], v87 offset:1024
 ds_read_b64_tr_b16 a[196:197], v87 offset:8192
 ds_read_b64_tr_b16 a[198:199], v87 offset:9216
 s_waitcnt lgkmcnt(0)
 s_barrier
 s_mov_b32 s68, s12
 s_mov_b32 s69, s13
 s_lshl_b32 s67, s40, 8
 s_lshl_b32 s3, s47, 17
 s_add_u32 s67, s67, s3
 s_add_u32 m0, s66, 0
 s_add_u32 s3, s67, 0
 buffer_load_dwordx4 v80, s[68:71], s3 offen lds
 s_add_u32 m0, s66, 1024
 s_add_u32 s3, s67, 32768
 buffer_load_dwordx4 v80, s[68:71], s3 offen lds
 s_add_u32 m0, s66, 2048
 s_add_u32 s3, s67, 65536
 buffer_load_dwordx4 v81, s[68:71], s3 offen lds
 s_add_u32 m0, s66, 3072
 s_add_u32 s3, s67, 98304
 buffer_load_dwordx4 v81, s[68:71], s3 offen lds
 s_waitcnt vmcnt(28)
 s_barrier
 ds_read_b64_tr_b16 a[136:137], v86 offset:16384
 ds_read_b64_tr_b16 a[138:139], v86 offset:17408
 ds_read_b64_tr_b16 a[140:141], v86 offset:24576
 ds_read_b64_tr_b16 a[142:143], v86 offset:25600
 ds_read_b64_tr_b16 a[200:201], v87 offset:16384
 ds_read_b64_tr_b16 a[202:203], v87 offset:17408
 ds_read_b64_tr_b16 a[204:205], v87 offset:24576
 ds_read_b64_tr_b16 a[206:207], v87 offset:25600
 s_waitcnt lgkmcnt(0)
 s_barrier
 s_add_u32 m0, s66, 16384
 s_add_u32 s3, s67, 524288
 buffer_load_dwordx4 v80, s[68:71], s3 offen lds
 s_add_u32 m0, s66, 17408
 s_add_u32 s3, s67, 557056
 buffer_load_dwordx4 v80, s[68:71], s3 offen lds
 s_add_u32 m0, s66, 18432
 s_add_u32 s3, s67, 589824
 buffer_load_dwordx4 v81, s[68:71], s3 offen lds
 s_add_u32 m0, s66, 19456
 s_add_u32 s3, s67, 622592
 buffer_load_dwordx4 v81, s[68:71], s3 offen lds
 s_waitcnt vmcnt(28)
 s_barrier
 ds_read_b64_tr_b16 a[144:145], v86 offset:32768
 ds_read_b64_tr_b16 a[146:147], v86 offset:33792
 ds_read_b64_tr_b16 a[148:149], v86 offset:40960
 ds_read_b64_tr_b16 a[150:151], v86 offset:41984
 ds_read_b64_tr_b16 a[208:209], v87 offset:32768
 ds_read_b64_tr_b16 a[210:211], v87 offset:33792
 ds_read_b64_tr_b16 a[212:213], v87 offset:40960
 ds_read_b64_tr_b16 a[214:215], v87 offset:41984
 s_waitcnt lgkmcnt(0)
 s_barrier
 s_add_u32 m0, s66, 32768
 s_add_u32 s3, s67, 1048576
 buffer_load_dwordx4 v80, s[68:71], s3 offen lds
 s_add_u32 m0, s66, 33792
 s_add_u32 s3, s67, 1081344
 buffer_load_dwordx4 v80, s[68:71], s3 offen lds
 s_add_u32 m0, s66, 34816
 s_add_u32 s3, s67, 1114112
 buffer_load_dwordx4 v81, s[68:71], s3 offen lds
 s_add_u32 m0, s66, 35840
 s_add_u32 s3, s67, 1146880
 buffer_load_dwordx4 v81, s[68:71], s3 offen lds
 s_waitcnt vmcnt(28)
 s_barrier
 ds_read_b64_tr_b16 a[152:153], v86 offset:49152
 ds_read_b64_tr_b16 a[154:155], v86 offset:50176
 ds_read_b64_tr_b16 a[156:157], v86 offset:57344
 ds_read_b64_tr_b16 a[158:159], v86 offset:58368
 ds_read_b64_tr_b16 a[216:217], v87 offset:49152
 ds_read_b64_tr_b16 a[218:219], v87 offset:50176
 ds_read_b64_tr_b16 a[220:221], v87 offset:57344
 ds_read_b64_tr_b16 a[222:223], v87 offset:58368
 s_waitcnt lgkmcnt(0)
 s_barrier
 v_add_u32 v86, 0x10000, v86
 v_add_u32 v87, 0x10000, v87
 s_add_u32 m0, s66, 49152
 s_add_u32 s3, s67, 1572864
 buffer_load_dwordx4 v80, s[68:71], s3 offen lds
 s_add_u32 m0, s66, 50176
 s_add_u32 s3, s67, 1605632
 buffer_load_dwordx4 v80, s[68:71], s3 offen lds
 s_add_u32 m0, s66, 51200
 s_add_u32 s3, s67, 1638400
 buffer_load_dwordx4 v81, s[68:71], s3 offen lds
 s_add_u32 m0, s66, 52224
 s_add_u32 s3, s67, 1671168
 buffer_load_dwordx4 v81, s[68:71], s3 offen lds
 s_waitcnt vmcnt(28)
 s_barrier
 ds_read_b64_tr_b16 a[160:161], v86 offset:0
 ds_read_b64_tr_b16 a[162:163], v86 offset:1024
 ds_read_b64_tr_b16 a[164:165], v86 offset:8192
 ds_read_b64_tr_b16 a[166:167], v86 offset:9216
 ds_read_b64_tr_b16 a[224:225], v87 offset:0
 ds_read_b64_tr_b16 a[226:227], v87 offset:1024
 ds_read_b64_tr_b16 a[228:229], v87 offset:8192
 ds_read_b64_tr_b16 a[230:231], v87 offset:9216
 s_waitcnt lgkmcnt(0)
 s_barrier
 s_add_u32 m0, s66, 65536
 s_add_u32 s3, s67, 2097152
 buffer_load_dwordx4 v80, s[68:71], s3 offen lds
 s_add_u32 m0, s66, 66560
 s_add_u32 s3, s67, 2129920
 buffer_load_dwordx4 v80, s[68:71], s3 offen lds
 s_add_u32 m0, s66, 67584
 s_add_u32 s3, s67, 2162688
 buffer_load_dwordx4 v81, s[68:71], s3 offen lds
 s_add_u32 m0, s66, 68608
 s_add_u32 s3, s67, 2195456
 buffer_load_dwordx4 v81, s[68:71], s3 offen lds
 s_waitcnt vmcnt(28)
 s_barrier
 ds_read_b64_tr_b16 a[168:169], v86 offset:16384
 ds_read_b64_tr_b16 a[170:171], v86 offset:17408
 ds_read_b64_tr_b16 a[172:173], v86 offset:24576
 ds_read_b64_tr_b16 a[174:175], v86 offset:25600
 ds_read_b64_tr_b16 a[232:233], v87 offset:16384
 ds_read_b64_tr_b16 a[234:235], v87 offset:17408
 ds_read_b64_tr_b16 a[236:237], v87 offset:24576
 ds_read_b64_tr_b16 a[238:239], v87 offset:25600
 s_waitcnt lgkmcnt(0)
 s_barrier
 s_add_u32 m0, s66, 81920
 s_add_u32 s3, s67, 2621440
 buffer_load_dwordx4 v80, s[68:71], s3 offen lds
 s_add_u32 m0, s66, 82944
 s_add_u32 s3, s67, 2654208
 buffer_load_dwordx4 v80, s[68:71], s3 offen lds
 s_add_u32 m0, s66, 83968
 s_add_u32 s3, s67, 2686976
 buffer_load_dwordx4 v81, s[68:71], s3 offen lds
 s_add_u32 m0, s66, 84992
 s_add_u32 s3, s67, 2719744
 buffer_load_dwordx4 v81, s[68:71], s3 offen lds
 s_waitcnt vmcnt(28)
 s_barrier
 ds_read_b64_tr_b16 a[176:177], v86 offset:32768
 ds_read_b64_tr_b16 a[178:179], v86 offset:33792
 ds_read_b64_tr_b16 a[180:181], v86 offset:40960
 ds_read_b64_tr_b16 a[182:183], v86 offset:41984
 ds_read_b64_tr_b16 a[240:241], v87 offset:32768
 ds_read_b64_tr_b16 a[242:243], v87 offset:33792
 ds_read_b64_tr_b16 a[244:245], v87 offset:40960
 ds_read_b64_tr_b16 a[246:247], v87 offset:41984
 s_waitcnt lgkmcnt(0)
 s_barrier
 s_add_u32 m0, s66, 98304
 s_add_u32 s3, s67, 3145728
 buffer_load_dwordx4 v80, s[68:71], s3 offen lds
 s_add_u32 m0, s66, 99328
 s_add_u32 s3, s67, 3178496
 buffer_load_dwordx4 v80, s[68:71], s3 offen lds
 s_add_u32 m0, s66, 100352
 s_add_u32 s3, s67, 3211264
 buffer_load_dwordx4 v81, s[68:71], s3 offen lds
 s_add_u32 m0, s66, 101376
 s_add_u32 s3, s67, 3244032
 buffer_load_dwordx4 v81, s[68:71], s3 offen lds
 s_waitcnt vmcnt(28)
 s_barrier
 v_mov_b32 v69, 4
 v_and_b32 v70, 63, v123
 s_lshl_b32 s3, s40, 6
 s_add_u32 s3, s3, 1024
 global_load_dword v66, v69, s[30:31] sc1
 buffer_load_dword v68, v70, s[36:39], s3 offen sc1
 ds_read_b64_tr_b16 a[184:185], v86 offset:49152
 ds_read_b64_tr_b16 a[186:187], v86 offset:50176
 ds_read_b64_tr_b16 a[188:189], v86 offset:57344
 ds_read_b64_tr_b16 a[190:191], v86 offset:58368
 ds_read_b64_tr_b16 a[248:249], v87 offset:49152
 ds_read_b64_tr_b16 a[250:251], v87 offset:50176
 ds_read_b64_tr_b16 a[252:253], v87 offset:57344
 ds_read_b64_tr_b16 a[254:255], v87 offset:58368
 s_waitcnt lgkmcnt(0)
 s_barrier
 v_subrev_u32 v86, 0x10000, v86
 v_subrev_u32 v87, 0x10000, v87
 s_add_u32 m0, s66, 114688
 s_add_u32 s3, s67, 3670016
 buffer_load_dwordx4 v80, s[68:71], s3 offen lds
 s_add_u32 m0, s66, 115712
 s_add_u32 s3, s67, 3702784
 buffer_load_dwordx4 v80, s[68:71], s3 offen lds
 s_add_u32 m0, s66, 116736
 s_add_u32 s3, s67, 3735552
 buffer_load_dwordx4 v81, s[68:71], s3 offen lds
 s_add_u32 m0, s66, 117760
 s_add_u32 s3, s67, 3768320
 buffer_load_dwordx4 v81, s[68:71], s3 offen lds
 s_waitcnt vmcnt(28)
 s_barrier
 ds_read_b64_tr_b16 v[128:129], v86 offset:0
 ds_read_b64_tr_b16 v[130:131], v86 offset:1024
 ds_read_b64_tr_b16 v[132:133], v86 offset:8192
 ds_read_b64_tr_b16 v[134:135], v86 offset:9216
 ds_read_b64_tr_b16 v[96:97], v87 offset:0
 ds_read_b64_tr_b16 v[98:99], v87 offset:1024
 ds_read_b64_tr_b16 v[100:101], v87 offset:8192
 ds_read_b64_tr_b16 v[102:103], v87 offset:9216
 s_waitcnt lgkmcnt(0)
 s_barrier
 v_add_u32 v90, s66, v117
 ds_write_b128 v90, v[96:99] offset:0
 ds_write_b128 v90, v[100:103] offset:1024
 ds_write_b128 v90, v[0:3] offset:2048
 ds_write_b128 v90, v[4:7] offset:3072
 s_waitcnt lgkmcnt(0)
 s_waitcnt vmcnt(24)
 s_barrier
 ds_read_b64_tr_b16 v[136:137], v86 offset:16384
 ds_read_b64_tr_b16 v[138:139], v86 offset:17408
 ds_read_b64_tr_b16 v[140:141], v86 offset:24576
 ds_read_b64_tr_b16 v[142:143], v86 offset:25600
 ds_read_b64_tr_b16 v[96:97], v87 offset:16384
 ds_read_b64_tr_b16 v[98:99], v87 offset:17408
 ds_read_b64_tr_b16 v[100:101], v87 offset:24576
 ds_read_b64_tr_b16 v[102:103], v87 offset:25600
 s_waitcnt lgkmcnt(0)
 s_barrier
 ds_write_b128 v90, v[96:99] offset:16384
 ds_write_b128 v90, v[100:103] offset:17408
 ds_write_b128 v90, v[8:11] offset:18432
 ds_write_b128 v90, v[12:15] offset:19456
 s_waitcnt lgkmcnt(0)
 s_waitcnt vmcnt(20)
 s_barrier
 ds_read_b64_tr_b16 v[144:145], v86 offset:32768
 ds_read_b64_tr_b16 v[146:147], v86 offset:33792
 ds_read_b64_tr_b16 v[148:149], v86 offset:40960
 ds_read_b64_tr_b16 v[150:151], v86 offset:41984
 ds_read_b64_tr_b16 v[96:97], v87 offset:32768
 ds_read_b64_tr_b16 v[98:99], v87 offset:33792
 ds_read_b64_tr_b16 v[100:101], v87 offset:40960
 ds_read_b64_tr_b16 v[102:103], v87 offset:41984
 s_waitcnt lgkmcnt(0)
 s_barrier
 ds_write_b128 v90, v[96:99] offset:32768
 ds_write_b128 v90, v[100:103] offset:33792
 ds_write_b128 v90, v[16:19] offset:34816
 ds_write_b128 v90, v[20:23] offset:35840
 s_waitcnt lgkmcnt(0)
 s_waitcnt vmcnt(16)
 s_barrier
 v_lshlrev_b32 v69, 3, v117
 s_mul_i32 s3, s47, 270336
 s_add_u32 s3, s3, s45
 s_cmp_eq_u32 s47, 3
 s_cselect_b32 s3, 65536, s3
 buffer_load_dword v65, v69, s[36:39], s3 offen sc1
 s_and_b32 s3, s47, 1
 s_lshl_b32 s3, s3, 13
 s_add_u32 s3, s3, 73728
 buffer_load_dword v65, v69, s[36:39], s3 offen sc1
 s_getpc_b64 s[34:35]
C_pc:
 s_add_u32 s34, s34, C_code - C_pc
 s_addc_u32 s35, s35, 0
 s_lshl_b32 s3, s47, 13
 v_add_u32 v69, s3, v69
 v_min_u32 v69, L_DONE - C_code - 4, v69
 global_load_dword v65, v69, s[34:35]
 ds_read_b64_tr_b16 v[152:153], v86 offset:49152
 ds_read_b64_tr_b16 v[154:155], v86 offset:50176
 ds_read_b64_tr_b16 v[156:157], v86 offset:57344
 ds_read_b64_tr_b16 v[158:159], v86 offset:58368
 ds_read_b64_tr_b16 v[96:97], v87 offset:49152
 ds_read_b64_tr_b16 v[98:99], v87 offset:50176
 ds_read_b64_tr_b16 v[100:101], v87 offset:57344
 ds_read_b64_tr_b16 v[102:103], v87 offset:58368
 s_waitcnt lgkmcnt(0)
 s_barrier
 v_add_u32 v86, 0x10000, v86
 v_add_u32 v87, 0x10000, v87
 ds_write_b128 v90, v[96:99] offset:49152
 ds_write_b128 v90, v[100:103] offset:50176
 ds_write_b128 v90, v[24:27] offset:51200
 ds_write_b128 v90, v[28:31] offset:52224
 s_waitcnt lgkmcnt(0)
 s_waitcnt vmcnt(15)
 s_barrier
 ds_read_b64_tr_b16 v[160:161], v86 offset:0
 ds_read_b64_tr_b16 v[162:163], v86 offset:1024
 ds_read_b64_tr_b16 v[164:165], v86 offset:8192
 ds_read_b64_tr_b16 v[166:167], v86 offset:9216
 ds_read_b64_tr_b16 v[96:97], v87 offset:0
 ds_read_b64_tr_b16 v[98:99], v87 offset:1024
 ds_read_b64_tr_b16 v[100:101], v87 offset:8192
 ds_read_b64_tr_b16 v[102:103], v87 offset:9216
 s_waitcnt lgkmcnt(0)
 s_barrier
 v_add_u32 v90, 0x10000, v90
 ds_write_b128 v90, v[96:99] offset:0
 ds_write_b128 v90, v[100:103] offset:1024
 ds_write_b128 v90, v[32:35] offset:2048
 ds_write_b128 v90, v[36:39] offset:3072
 s_waitcnt lgkmcnt(0)
 s_waitcnt vmcnt(11)
 s_barrier
 ds_read_b64_tr_b16 v[168:169], v86 offset:16384
 ds_read_b64_tr_b16 v[170:171], v86 offset:17408
 ds_read_b64_tr_b16 v[172:173], v86 offset:24576
 ds_read_b64_tr_b16 v[174:175], v86 offset:25600
 ds_read_b64_tr_b16 v[96:97], v87 offset:16384
 ds_read_b64_tr_b16 v[98:99], v87 offset:17408
 ds_read_b64_tr_b16 v[100:101], v87 offset:24576
 ds_read_b64_tr_b16 v[102:103], v87 offset:25600
 s_waitcnt lgkmcnt(0)
 s_barrier
 ds_write_b128 v90, v[96:99] offset:16384
 ds_write_b128 v90, v[100:103] offset:17408
 ds_write_b128 v90, v[40:43] offset:18432
 ds_write_b128 v90, v[44:47] offset:19456
 s_waitcnt lgkmcnt(0)
 s_waitcnt vmcnt(7)
 s_barrier
 s_mov_b32 s77, 0
 v_cmp_gt_u32 vcc, 32, v66
 s_cbranch_vccnz C_late
 v_cmp_gt_u32 vcc, 1, v67
 s_cbranch_vccnz C_late
 v_cmp_gt_u32 vcc, 1, v68
 s_cbranch_vccnz C_late
 s_mov_b32 s77, 1
 s_lshl_b32 s3, s40, 14
 s_lshl_b32 s34, s47, 11
 s_add_u32 s35, s3, 16785408
 s_add_u32 s3, s3, s34
 s_add_u32 s3, s3, 16777216
 s_add_u32 m0, s34, 0
 v_lshlrev_b32 v69, 3, v117
 buffer_load_dwordx4 v117, s[36:39], s3 offen sc1 lds
 buffer_load_dwordx4 v117, s[36:39], s3 offen offset:1024 sc1 lds
 buffer_load_dword v65, v69, s[36:39], s35 offen sc1
C_late:
 ds_read_b64_tr_b16 v[176:177], v86 offset:32768
 ds_read_b64_tr_b16 v[178:179], v86 offset:33792
 ds_read_b64_tr_b16 v[180:181], v86 offset:40960
 ds_read_b64_tr_b16 v[182:183], v86 offset:41984
 ds_read_b64_tr_b16 v[96:97], v87 offset:32768
 ds_read_b64_tr_b16 v[98:99], v87 offset:33792
 ds_read_b64_tr_b16 v[100:101], v87 offset:40960
 ds_read_b64_tr_b16 v[102:103], v87 offset:41984
 s_waitcnt lgkmcnt(0)
 s_barrier
 ds_write_b128 v90, v[96:99] offset:32768
 ds_write_b128 v90, v[100:103] offset:33792
 ds_write_b128 v90, v[128:131] offset:34816
 ds_write_b128 v90, v[132:135] offset:35840
 s_waitcnt lgkmcnt(0)
 v_mov_b64 v[128:129], v[48:49]
 v_mov_b64 v[130:131], v[50:51]
 v_mov_b64 v[132:133], v[52:53]
 v_mov_b64 v[134:135], v[54:55]
 s_waitcnt vmcnt(3)
 s_barrier
 ds_read_b64_tr_b16 v[184:185], v86 offset:49152
 ds_read_b64_tr_b16 v[186:187], v86 offset:50176
 ds_read_b64_tr_b16 v[188:189], v86 offset:57344
 ds_read_b64_tr_b16 v[190:191], v86 offset:58368
 ds_read_b64_tr_b16 v[96:97], v87 offset:49152
 ds_read_b64_tr_b16 v[98:99], v87 offset:50176
 ds_read_b64_tr_b16 v[100:101], v87 offset:57344
 ds_read_b64_tr_b16 v[102:103], v87 offset:58368
 s_waitcnt lgkmcnt(0)
 s_barrier
 v_subrev_u32 v86, 0x10000, v86
 v_subrev_u32 v87, 0x10000, v87
 ds_write_b128 v90, v[96:99] offset:49152
 ds_write_b128 v90, v[100:103] offset:50176
 ds_write_b128 v90, v[136:139] offset:51200
 ds_write_b128 v90, v[140:143] offset:52224
 s_waitcnt lgkmcnt(0)
 v_mov_b64 v[136:137], v[56:57]
 v_mov_b64 v[138:139], v[58:59]
 v_mov_b64 v[140:141], v[60:61]
 v_mov_b64 v[142:143], v[62:63]
 s_mov_b32 s41, 0
 s_mov_b32 s42, 65536
 s_mov_b32 s43, 69632
 s_add_u32 s44, s44, 8192
 s_mov_b32 s92, 0
 s_mov_b32 s73, 270336
 s_lshl_b32 s3, s47, 11
 s_add_u32 s3, s3, s45
 s_mov_b32 s66, 8192
 s_add_u32 s59, s3, 540672
 s_add_u32 s46, s45, 4096
 s_mul_i32 s3, s47, 8448
 s_lshl_b32 s34, s40, 8
 s_add_u32 s3, s3, s34
 s_add_u32 s48, s3, 1048576
 s_add_u32 s49, s48, 33792
 s_add_u32 s50, s48, 67584
 s_add_u32 s51, s48, 101376
 s_add_u32 s52, s48, 135168
 s_add_u32 s53, s48, 168960
 s_add_u32 s54, s48, 202752
 s_add_u32 s55, s48, 236544
 s_lshl_b32 s3, s40, 14
 s_add_u32 s56, s3, 16777216
 s_add_u32 s57, s56, 4096
 s_lshl_b32 s34, s47, 11
 s_add_u32 s58, s56, 8192
 s_add_u32 s74, s56, 524288
 s_add_u32 s75, s58, 524288
 s_cmp_eq_u32 s47, 2
 s_cselect_b32 s74, s75, s74
 s_add_u32 s58, s58, s34
 s_lshl_b32 s3, s40, 6
 s_add_u32 s90, s3, 1024
 s_mov_b32 s65, 0
 s_mov_b32 s61, 0
 v_mov_b64 v[80:81], 0
 v_mov_b64 v[82:83], 0
 v_mov_b64 v[84:85], 0
 v_mov_b64 v[86:87], 0
 v_mov_b64 v[88:89], 0
 v_mov_b64 v[90:91], 0
 v_mov_b64 v[92:93], 0
 v_mov_b64 v[94:95], 0
 v_mov_b64 v[96:97], 0
 v_mov_b64 v[98:99], 0
 v_mov_b64 v[100:101], 0
 v_mov_b64 v[102:103], 0
 s_cmp_eq_u32 s77, 1
 s_cbranch_scc1 C_go
 v_mov_b32 v1, 4
 s_mov_b32 s3, 0
C_init:
 global_load_dword v2, v1, s[30:31] sc1
 s_add_u32 s3, s3, 1
 s_cmp_gt_u32 s3, 131072
 s_cbranch_scc1 L_ABORT
 s_waitcnt vmcnt(0)
 v_readfirstlane_b32 s34, v2
 s_nop 0
 s_cmp_lt_u32 s34, 32
 s_cbranch_scc1 C_init
 v_mov_b32 v1, 36
 s_mov_b32 s3, 0
C_init2:
 global_load_dword v2, v1, s[30:31] sc1
 s_add_u32 s3, s3, 1
 s_cmp_gt_u32 s3, 131072
 s_cbranch_scc1 L_ABORT
 s_waitcnt vmcnt(0)
 v_readfirstlane_b32 s34, v2
 s_nop 0
 s_cmp_lt_u32 s34, 1
 s_cbranch_scc1 C_init2
 v_and_b32 v126, 63, v123
 s_mov_b32 s3, 0
 s_branch C_kv_go
C_kv:
 s_sleep 1
C_kv_go:
 buffer_load_dword v124, v126, s[36:39], s90 offen sc1
 s_add_u32 s3, s3, 1
 s_cmp_gt_u32 s3, 131072
 s_cbranch_scc1 L_ABORT
 s_waitcnt vmcnt(0)
 v_cmp_gt_u32 vcc, 1, v124
 s_cbranch_vccnz C_kv
 s_lshl_b32 s3, s47, 11
 s_add_u32 m0, s3, 0
 s_add_u32 s3, s3, s56
 buffer_load_dwordx4 v117, s[36:39], s3 offen sc1 lds
 buffer_load_dwordx4 v117, s[36:39], s3 offen offset:1024 sc1 lds
 s_waitcnt vmcnt(0)
C_go:
 s_waitcnt vmcnt(1)
 s_barrier
 s_add_u32 s56, s56, 524288
 s_add_u32 s57, s56, 4096
 s_cmp_eq_u32 s47, 1
 s_cbranch_scc1 CE1
 s_cmp_eq_u32 s47, 2
 s_cbranch_scc1 CE2
 s_cmp_eq_u32 s47, 3
 s_cbranch_scc1 CE3
 s_branch CE0v0
 .p2align 7
C_code:
 .p2align 6
HA0v0:
 buffer_load_dwordx4 v[104:107], v117, s[36:39], s42 offen offset:3072 sc1
 s_add_u32 s65, s65, 1
 s_cmp_gt_u32 s65, 131072
 s_cbranch_scc1 L_ABORT
 s_add_u32 s59, s45, 0
 s_add_u32 s45, s45, s93
 s_add_u32 s46, s46, s93
 s_mov_b32 s44, s78
 s_mov_b32 s78, s76
 s_waitcnt vmcnt(2)
 ds_read_b128 v[32:35], v117 offset:32768
 ds_read_b128 v[36:39], v117 offset:33792
 ds_read_b128 v[40:43], v117 offset:49152
 ds_read_b128 v[44:47], v117 offset:50176
 ds_read_b128 v[48:51], v118 offset:0
 ds_read_b128 v[52:55], v118 offset:1024
 ds_read_b128 v[56:59], v118 offset:16384
 ds_read_b128 v[60:63], v118 offset:17408
 ds_read_b128 v[16:19], v119 offset:2048
 ds_read_b128 v[20:23], v119 offset:3072
 ds_read_b128 v[24:27], v119 offset:18432
 ds_read_b128 v[28:31], v119 offset:19456
 buffer_load_dwordx4 v[108:111], v117, s[36:39], s42 offen offset:3072 sc1
 s_sleep 1
 s_nop 7
HL0v0:
 buffer_load_dwordx4 v[112:115], v117, s[36:39], s42 offen offset:3072 sc1
 s_waitcnt vmcnt(2)
 ds_write_b128 v117, v[104:107] offset:11264
 v_max3_u32 v124, v104, v105, v106
 v_max_u32 v124, v124, v107
 v_cmp_eq_u32 vcc, -1, v124
 v_mov_b64 v[12:13], v[104:105]
 v_mov_b64 v[14:15], v[106:107]
 s_cbranch_vccz HK0v0
 buffer_load_dwordx4 v[104:107], v117, s[36:39], s42 offen offset:3072 sc1
 s_waitcnt vmcnt(2)
 ds_write_b128 v117, v[108:111] offset:11264
 v_max3_u32 v124, v108, v109, v110
 v_max_u32 v124, v124, v111
 v_cmp_eq_u32 vcc, -1, v124
 v_mov_b64 v[12:13], v[108:109]
 v_mov_b64 v[14:15], v[110:111]
 s_cbranch_vccz HK0v0
 buffer_load_dwordx4 v[108:111], v117, s[36:39], s42 offen offset:3072 sc1
 s_waitcnt vmcnt(2)
 ds_write_b128 v117, v[112:115] offset:11264
 v_max3_u32 v124, v112, v113, v114
 v_max_u32 v124, v124, v115
 v_cmp_eq_u32 vcc, -1, v124
 v_mov_b64 v[12:13], v[112:113]
 v_mov_b64 v[14:15], v[114:115]
 s_cbranch_vccnz HR0v0
HK0v0:
 s_waitcnt lgkmcnt(1)
 v_smfmac_f32_16x16x64_bf16 v[80:83], v[12:15], a[24:31], v116
 buffer_load_dwordx4 v[68:71], v117, s[36:39], s43 offen offset:3072 sc1
 v_smfmac_f32_16x16x64_bf16 v[100:103], v[12:15], v[56:63], v116
 ds_read_b128 v[56:59], v119 offset:16384
 v_smfmac_f32_16x16x64_bf16 v[84:87], v[12:15], a[88:95], v116
 ds_read_b128 v[60:63], v119 offset:17408
 v_smfmac_f32_16x16x64_bf16 v[88:91], v[12:15], a[152:159], v116
 s_waitcnt lgkmcnt(2)
 s_barrier
 ds_read_b128 v[0:3], v117 offset:8192
 ds_read_b128 v[4:7], v117 offset:9216
 ds_read_b128 v[8:11], v117 offset:10240
 v_smfmac_f32_16x16x64_bf16 v[92:95], v[12:15], a[216:223], v116
 v_smfmac_f32_16x16x64_bf16 v[96:99], v[12:15], v[152:159], v116
 buffer_store_dword v76, v123, s[36:39], s78 offen
 s_waitcnt lgkmcnt(2)
 v_smfmac_f32_16x16x64_bf16 v[80:83], v[0:3], a[0:7], v116
 v_smfmac_f32_16x16x64_bf16 v[100:103], v[0:3], v[32:39], v116
 ds_read_b128 v[32:35], v118 offset:32768
 v_smfmac_f32_16x16x64_bf16 v[84:87], v[0:3], a[64:71], v116
 ds_read_b128 v[36:39], v118 offset:33792
 v_smfmac_f32_16x16x64_bf16 v[88:91], v[0:3], a[128:135], v116
 buffer_store_dwordx4 v[76:79], v117, s[36:39], s59 offen offset:0
 v_smfmac_f32_16x16x64_bf16 v[96:99], v[0:3], v[16:23], v116
 s_waitcnt lgkmcnt(3)
 v_smfmac_f32_16x16x64_bf16 v[80:83], v[4:7], a[8:15], v116
 buffer_store_dwordx4 v[76:79], v117, s[36:39], s59 offen offset:1024
 v_smfmac_f32_16x16x64_bf16 v[100:103], v[4:7], v[40:47], v116
 ds_read_b128 v[40:43], v118 offset:49152
 v_smfmac_f32_16x16x64_bf16 v[84:87], v[4:7], a[72:79], v116
 ds_read_b128 v[44:47], v118 offset:50176
 v_smfmac_f32_16x16x64_bf16 v[88:91], v[4:7], a[136:143], v116
 v_smfmac_f32_16x16x64_bf16 v[96:99], v[4:7], v[24:31], v116
 s_waitcnt vmcnt(3)
 ds_write_b128 v117, v[68:71] offset:23552
 s_waitcnt lgkmcnt(5)
 v_smfmac_f32_16x16x64_bf16 v[80:83], v[8:11], a[16:23], v116
 v_max3_u32 v124, v68, v69, v70
 v_smfmac_f32_16x16x64_bf16 v[100:103], v[8:11], v[48:55], v116
 v_max_u32 v124, v124, v71
 v_smfmac_f32_16x16x64_bf16 v[84:87], v[8:11], a[80:87], v116
 v_cmp_eq_u32 vcc, -1, v124
 v_smfmac_f32_16x16x64_bf16 v[88:91], v[8:11], a[144:151], v116
 v_smfmac_f32_16x16x64_bf16 v[92:95], v[8:11], a[208:215], v116
 s_cbranch_vccnz SB0v0
SBR0v0:
 s_waitcnt lgkmcnt(0)
 s_barrier
 ds_read_b128 v[16:19], v117 offset:20480
 v_smfmac_f32_16x16x64_bf16 v[92:95], v[0:3], a[192:199], v116
 ds_read_b128 v[20:23], v117 offset:21504
 v_smfmac_f32_16x16x64_bf16 v[92:95], v[4:7], a[200:207], v116
 ds_read_b128 v[24:27], v117 offset:22528
 buffer_load_dwordx4 v[12:15], v117, s[36:39], s58 offen sc1
 s_waitcnt lgkmcnt(2)
 v_smfmac_f32_16x16x64_bf16 v[80:83], v[16:19], a[32:39], v116
 ds_read_b128 v[28:31], v117 offset:23552
 buffer_load_dwordx4 v[0:3], v117, s[36:39], s58 offen offset:1024 sc1
 v_smfmac_f32_16x16x64_bf16 v[100:103], v[16:19], v[32:39], v116
 ds_read_b128 v[48:51], v119 offset:0
 v_smfmac_f32_16x16x64_bf16 v[84:87], v[16:19], a[96:103], v116
 ds_read_b128 v[52:55], v119 offset:1024
 s_waitcnt lgkmcnt(4)
 v_smfmac_f32_16x16x64_bf16 v[80:83], v[20:23], a[40:47], v116
 ds_read_b128 v[32:35], v117 offset:0
 v_smfmac_f32_16x16x64_bf16 v[100:103], v[20:23], v[40:47], v116
 ds_read_b128 v[36:39], v117 offset:1024
 ds_read_b128 v[40:43], v117 offset:2048
 v_smfmac_f32_16x16x64_bf16 v[84:87], v[20:23], a[104:111], v116
 buffer_store_dword v64, v127, s[36:39], s60 offen sc1
 ds_read_b128 v[44:47], v117 offset:3072
 s_waitcnt lgkmcnt(7)
 v_smfmac_f32_16x16x64_bf16 v[80:83], v[24:27], a[48:55], v116
 s_waitcnt lgkmcnt(4)
 v_smfmac_f32_16x16x64_bf16 v[100:103], v[24:27], v[48:55], v116
 ds_read_b128 v[48:51], v117 offset:4096
 v_smfmac_f32_16x16x64_bf16 v[84:87], v[24:27], a[112:119], v116
 ds_read_b128 v[52:55], v117 offset:5120
 v_smfmac_f32_16x16x64_bf16 v[80:83], v[28:31], a[56:63], v116
 v_smfmac_f32_16x16x64_bf16 v[100:103], v[28:31], v[56:63], v116
 ds_read_b128 v[56:59], v117 offset:6144
 v_smfmac_f32_16x16x64_bf16 v[84:87], v[28:31], a[120:127], v116
 ds_read_b128 v[60:63], v117 offset:7168
 v_smfmac_f32_16x16x64_bf16 v[88:91], v[16:19], a[160:167], v116
 v_add_f32 v80, v80, v81
 v_add_f32 v82, v82, v83
 v_smfmac_f32_16x16x64_bf16 v[88:91], v[20:23], a[168:175], v116
 v_mul_f32 v80, s64, v80
 v_mul_f32 v82, s64, v82
 v_smfmac_f32_16x16x64_bf16 v[88:91], v[24:27], a[176:183], v116
 v_cvt_pk_bf16_f32 v80, v80, v82
 v_add_f32 v84, v84, v85
 v_smfmac_f32_16x16x64_bf16 v[88:91], v[28:31], a[184:191], v116
 ds_write_b32 v121, v80 offset:8192
 v_add_f32 v86, v86, v87
 v_smfmac_f32_16x16x64_bf16 v[96:99], v[8:11], v[144:151], v116
 v_mul_f32 v84, s64, v84
 v_mul_f32 v86, s64, v86
 v_smfmac_f32_16x16x64_bf16 v[92:95], v[16:19], a[224:231], v116
 v_cvt_pk_bf16_f32 v84, v84, v86
 v_smfmac_f32_16x16x64_bf16 v[92:95], v[20:23], a[232:239], v116
 ds_write_b32 v121, v84 offset:8704
 v_smfmac_f32_16x16x64_bf16 v[92:95], v[24:27], a[240:247], v116
 v_add_f32 v88, v88, v89
 v_add_f32 v90, v90, v91
 v_smfmac_f32_16x16x64_bf16 v[92:95], v[28:31], a[248:255], v116
 v_cvt_pk_bf16_f32 v88, v88, v90
 v_smfmac_f32_16x16x64_bf16 v[96:99], v[16:19], v[160:167], v116
 ds_write_b32 v121, v88 offset:14336
 v_smfmac_f32_16x16x64_bf16 v[96:99], v[20:23], v[168:175], v116
 s_waitcnt lgkmcnt(1)
 s_barrier
 v_add_f32 v92, v92, v93
 v_add_f32 v94, v94, v95
 v_smfmac_f32_16x16x64_bf16 v[96:99], v[24:27], v[176:183], v116
 ds_read_b64_tr_b16 v[64:65], v120 offset:8192
 ds_read_b64_tr_b16 v[66:67], v120 offset:8448
 v_cvt_pk_bf16_f32 v92, v92, v94
 ds_write_b32 v121, v92 offset:14848
 v_smfmac_f32_16x16x64_bf16 v[96:99], v[28:31], v[184:191], v116
 ds_read_b64_tr_b16 v[68:69], v120 offset:9216
 ds_read_b64_tr_b16 v[70:71], v120 offset:9472
 ds_read_b64_tr_b16 v[72:73], v120 offset:10240
 ds_read_b64_tr_b16 v[74:75], v120 offset:10496
 s_waitcnt lgkmcnt(5)
 v_mfma_f32_16x16x32_bf16 v[104:107], v[32:35], v[64:67], 0
 ds_read_b64_tr_b16 v[76:77], v120 offset:11264
 v_mfma_f32_16x16x32_bf16 v[108:111], v[48:51], v[64:67], 0
 ds_read_b64_tr_b16 v[78:79], v120 offset:11520
 s_waitcnt lgkmcnt(4)
 v_mfma_f32_16x16x32_bf16 v[104:107], v[36:39], v[68:71], v[104:107]
 v_add_f32 v100, v100, v101
 v_add_f32 v102, v102, v103
 v_mfma_f32_16x16x32_bf16 v[108:111], v[52:55], v[68:71], v[108:111]
 s_waitcnt lgkmcnt(6)
 s_barrier
 s_waitcnt lgkmcnt(2)
 v_mfma_f32_16x16x32_bf16 v[104:107], v[40:43], v[72:75], v[104:107]
 ds_read_b64_tr_b16 v[80:81], v120 offset:14336
 ds_read_b64_tr_b16 v[82:83], v120 offset:14592
 s_waitcnt lgkmcnt(2)
 v_mfma_f32_16x16x32_bf16 v[104:107], v[44:47], v[76:79], v[104:107]
 ds_read_b64_tr_b16 v[84:85], v120 offset:15360
 ds_read_b64_tr_b16 v[86:87], v120 offset:15616
 v_mfma_f32_16x16x32_bf16 v[108:111], v[56:59], v[72:75], v[108:111]
 ds_read_b64_tr_b16 v[88:89], v120 offset:16384
 ds_read_b64_tr_b16 v[90:91], v120 offset:16640
 v_mfma_f32_16x16x32_bf16 v[108:111], v[60:63], v[76:79], v[108:111]
 ds_read_b64_tr_b16 v[92:93], v120 offset:17408
 ds_read_b64_tr_b16 v[94:95], v120 offset:17664
 ds_read_b128 v[20:23], v117 offset:29696
 s_waitcnt lgkmcnt(7)
 v_mfma_f32_16x16x32_bf16 v[112:115], v[80:83], v[64:67], 0
 s_waitcnt lgkmcnt(5)
 v_exp_f32 v28, v104
 v_mfma_f32_16x16x32_bf16 v[112:115], v[84:87], v[68:71], v[112:115]
 s_waitcnt lgkmcnt(3)
 v_exp_f32 v29, v105
 v_mfma_f32_16x16x32_bf16 v[112:115], v[88:91], v[72:75], v[112:115]
 s_waitcnt lgkmcnt(1)
 v_exp_f32 v30, v106
 v_mfma_f32_16x16x32_bf16 v[112:115], v[92:95], v[76:79], v[112:115]
 v_exp_f32 v31, v107
 v_cvt_pk_bf16_f32 v24, v28, v29
 v_exp_f32 v28, v108
 v_cvt_pk_bf16_f32 v25, v30, v31
 v_exp_f32 v29, v109
 v_exp_f32 v30, v110
 v_exp_f32 v31, v111
 v_cvt_pk_bf16_f32 v26, v28, v29
 v_exp_f32 v28, v112
 v_cvt_pk_bf16_f32 v27, v30, v31
 v_exp_f32 v29, v113
 v_cvt_pk_bf16_f32 v100, v100, v102
 s_waitcnt lgkmcnt(0)
 v_mfma_f32_16x16x32_bf16 v[16:19], v[20:23], v[24:27], 0
 s_waitcnt vmcnt(2)
 v_cvt_pk_bf16_f32 v124, v28, v29
 v_add_f32 v96, v96, v97
 v_mfma_f32_16x16x32_bf16 v[4:7], v[12:15], v[24:27], 0
 s_waitcnt vmcnt(1)
 v_add_f32 v98, v98, v99
 v_mov_b32 v101, 0
 v_mfma_f32_16x16x32_bf16 v[8:11], v[0:3], v[24:27], 0
 v_cvt_pk_bf16_f32 v96, v96, v98
 v_mov_b32 v97, 0
 v_mfma_f32_16x16x16_bf16 v[16:19], v[20:21], v[124:125], v[16:19]
 v_mov_b64 v[82:83], 0
 v_mov_b64 v[84:85], 0
 v_mfma_f32_16x16x16_bf16 v[4:7], v[96:97], v[124:125], v[4:7]
 v_mov_b64 v[86:87], 0
 v_mov_b64 v[88:89], 0
 v_mfma_f32_16x16x16_bf16 v[8:11], v[100:101], v[124:125], v[8:11]
 v_rcp_f32 v126, v16
 v_mov_b64 v[80:81], 0
 v_max_f32 v28, v126, v16
 v_cmp_nge_f32 vcc, s88, v28
 v_mul_f32 v4, v4, v126
 v_mul_f32 v5, v5, v126
 v_mul_f32 v6, v6, v126
 v_mul_f32 v7, v7, v126
FBC0v0:
 s_and_b64 s[34:35], vcc, s[86:87]
 s_cbranch_scc1 FB0v0
 v_cvt_pk_bf16_f32 v4, v4, v5
 v_cvt_pk_bf16_f32 v5, v6, v7
 ds_write_b64 v122, v[4:5]
 v_pk_mul_f32 v[8:9], v[8:9], v[126:127] op_sel_hi:[1,0]
 v_pk_mul_f32 v[10:11], v[10:11], v[126:127] op_sel_hi:[1,0]
 v_cvt_pk_bf16_f32 v8, v8, v9
 v_cvt_pk_bf16_f32 v9, v10, v11
 ds_write_b64 v122, v[8:9] offset:256
 v_mov_b64 v[90:91], 0
 v_mov_b64 v[92:93], 0
 v_mov_b64 v[94:95], 0
 v_mov_b64 v[16:17], 0
 v_mov_b64 v[18:19], 0
 v_mov_b64 v[20:21], 0
 v_mov_b64 v[22:23], 0
 v_mov_b64 v[24:25], 0
 v_mov_b64 v[26:27], 0
 v_mov_b64 v[28:29], 0
 v_mov_b64 v[30:31], 0
 v_lshrrev_b32 v124, 3, v117
 v_bitop3_b32 v124, v117, v124, 16 bitop3:0x78
 ds_read_b128 v[32:35], v117 offset:34816
 ds_read_b128 v[36:39], v117 offset:35840
 s_waitcnt lgkmcnt(2)
 s_barrier
 ds_read_b128 v[64:67], v124 offset:24576
 ds_read_b128 v[68:71], v124 offset:25600
 ds_read_b128 v[40:43], v117 offset:51200
 ds_read_b128 v[44:47], v117 offset:52224
 ds_read_b128 v[48:51], v118 offset:2048
 ds_read_b128 v[52:55], v118 offset:3072
 s_waitcnt lgkmcnt(5)
 v_smfmac_f32_16x16x64_bf16 v[80:83], v[64:67], v[192:199], v116
 ds_read_b128 v[56:59], v118 offset:18432
 s_waitcnt lgkmcnt(5)
 v_smfmac_f32_16x16x64_bf16 v[80:83], v[68:71], v[32:39], v116
 ds_read_b128 v[60:63], v118 offset:19456
 v_smfmac_f32_16x16x64_bf16 v[84:87], v[64:67], v[200:207], v116
 ds_read_b128 v[0:3], v118 offset:34816
 s_waitcnt lgkmcnt(5)
 v_smfmac_f32_16x16x64_bf16 v[84:87], v[68:71], v[40:47], v116
 ds_read_b128 v[4:7], v118 offset:35840
 v_add_f32 v80, v80, v81
 v_add_f32 v82, v82, v83
 v_smfmac_f32_16x16x64_bf16 v[88:91], v[64:67], v[208:215], v116
 ds_read_b128 v[72:75], v118 offset:51200
 s_waitcnt lgkmcnt(5)
 v_cvt_pk_bf16_f32 v80, v80, v82
 v_smfmac_f32_16x16x64_bf16 v[88:91], v[68:71], v[48:55], v116
 buffer_store_dword v80, v123, s[36:39], s48 offen
 ds_read_b128 v[76:79], v118 offset:52224
 v_add_f32 v84, v84, v85
 v_add_f32 v86, v86, v87
 v_smfmac_f32_16x16x64_bf16 v[92:95], v[64:67], v[216:223], v116
 s_add_u32 s41, s41, 1
 s_waitcnt lgkmcnt(4)
 v_cvt_pk_bf16_f32 v84, v84, v86
 v_smfmac_f32_16x16x64_bf16 v[92:95], v[68:71], v[56:63], v116
 buffer_store_dword v84, v123, s[36:39], s49 offen
 s_add_u32 s92, s92, 1
 v_add_f32 v88, v88, v89
 v_add_f32 v90, v90, v91
 v_smfmac_f32_16x16x64_bf16 v[16:19], v[64:67], v[224:231], v116
 s_cmp_eq_u32 s92, 3
 s_waitcnt lgkmcnt(2)
 v_cvt_pk_bf16_f32 v88, v88, v90
 v_smfmac_f32_16x16x64_bf16 v[16:19], v[68:71], v[0:7], v116
 buffer_store_dword v88, v123, s[36:39], s50 offen
 s_cselect_b32 s93, 4294426624, s73
 v_add_f32 v92, v92, v93
 v_add_f32 v94, v94, v95
 v_smfmac_f32_16x16x64_bf16 v[20:23], v[64:67], v[232:239], v116
 s_cselect_b32 s79, 4294950912, s66
 s_waitcnt lgkmcnt(0)
 v_cvt_pk_bf16_f32 v92, v92, v94
 v_smfmac_f32_16x16x64_bf16 v[20:23], v[68:71], v[72:79], v116
 buffer_store_dword v92, v123, s[36:39], s51 offen
 s_cselect_b32 s92, 0, s92
 v_add_f32 v16, v16, v17
 v_add_f32 v18, v18, v19
 v_smfmac_f32_16x16x64_bf16 v[24:27], v[64:67], v[240:247], v116
 s_lshl_b32 s3, s40, 8
 s_add_u32 s76, s3, s42
 v_cvt_pk_bf16_f32 v16, v16, v18
 v_smfmac_f32_16x16x64_bf16 v[24:27], v[68:71], v[128:135], v116
 buffer_store_dword v16, v123, s[36:39], s52 offen
 s_add_u32 s42, s42, s79
 v_add_f32 v20, v20, v21
 v_add_f32 v22, v22, v23
 v_smfmac_f32_16x16x64_bf16 v[28:31], v[64:67], v[248:255], v116
 s_add_u32 s43, s43, s79
 v_cvt_pk_bf16_f32 v20, v20, v22
 v_smfmac_f32_16x16x64_bf16 v[28:31], v[68:71], v[136:143], v116
 buffer_store_dword v20, v123, s[36:39], s53 offen
 s_add_u32 s58, s58, 524288
 v_add_f32 v24, v24, v25
 v_add_f32 v26, v26, v27
 v_cvt_pk_bf16_f32 v24, v24, v26
 buffer_store_dword v24, v123, s[36:39], s54 offen
 s_nop 1
 v_add_f32 v28, v28, v29
 v_add_f32 v30, v30, v31
 v_cvt_pk_bf16_f32 v28, v28, v30
 buffer_store_dword v28, v123, s[36:39], s55 offen
 ds_read_b128 v[104:107], v117 offset:28672
 ds_read_b32 v108, v123 offset:31744
 v_mov_b64 v[112:113], 0
 v_mov_b64 v[114:115], 0
 s_lshl_b32 s3, s41, 13
 s_add_u32 s60, s3, s89
 s_add_u32 s48, s48, s93
 v_mov_b64 v[80:81], 0
 s_add_u32 s49, s49, s93
 v_mov_b64 v[82:83], 0
 s_add_u32 s50, s50, s93
 v_mov_b64 v[84:85], 0
 s_add_u32 s51, s51, s93
 v_mov_b64 v[86:87], 0
 s_add_u32 s52, s52, s93
 v_mov_b64 v[88:89], 0
 s_add_u32 s53, s53, s93
 v_mov_b64 v[90:91], 0
 s_add_u32 s54, s54, s93
 v_mov_b64 v[92:93], 0
 s_add_u32 s55, s55, s93
 v_mov_b64 v[94:95], 0
 buffer_load_dwordx4 v[0:3], v117, s[36:39], s45 offen offset:0 sc1
 buffer_load_dwordx4 v[4:7], v117, s[36:39], s45 offen offset:1024 sc1
 buffer_load_dwordx4 v[8:11], v117, s[36:39], s45 offen offset:2048 sc1
 buffer_load_dwordx4 v[12:15], v117, s[36:39], s45 offen offset:3072 sc1
 buffer_load_dwordx4 v[16:19], v117, s[36:39], s46 offen offset:0 sc1
 buffer_load_dwordx4 v[20:23], v117, s[36:39], s46 offen offset:1024 sc1
 buffer_load_dwordx4 v[24:27], v117, s[36:39], s46 offen offset:2048 sc1
 buffer_load_dwordx4 v[28:31], v117, s[36:39], s46 offen offset:3072 sc1
 v_mov_b64 v[96:97], 0
 v_mov_b64 v[98:99], 0
 v_mov_b64 v[100:101], 0
 v_mov_b64 v[102:103], 0
 v_mov_b64 v[76:77], -1
 v_mov_b64 v[78:79], -1
 s_sleep 1
 s_nop 11
 buffer_load_dwordx4 v[32:35], v117, s[36:39], s45 offen offset:0 sc1
 buffer_load_dwordx4 v[36:39], v117, s[36:39], s45 offen offset:1024 sc1
 buffer_load_dwordx4 v[40:43], v117, s[36:39], s45 offen offset:2048 sc1
 buffer_load_dwordx4 v[44:47], v117, s[36:39], s45 offen offset:3072 sc1
 buffer_load_dwordx4 v[48:51], v117, s[36:39], s46 offen offset:0 sc1
 buffer_load_dwordx4 v[52:55], v117, s[36:39], s46 offen offset:1024 sc1
 buffer_load_dwordx4 v[56:59], v117, s[36:39], s46 offen offset:2048 sc1
 buffer_load_dwordx4 v[60:63], v117, s[36:39], s46 offen offset:3072 sc1
RBR0v0:
 s_waitcnt vmcnt(14) lgkmcnt(0)
 v_smfmac_f32_16x16x64_bf16 v[112:115], v[104:107], v[0:7], v108
 s_waitcnt vmcnt(12)
 v_smfmac_f32_16x16x64_bf16 v[112:115], v[104:107], v[8:15], v108
 s_waitcnt vmcnt(10)
 v_smfmac_f32_16x16x64_bf16 v[112:115], v[104:107], v[16:23], v108
 s_waitcnt vmcnt(8)
 v_smfmac_f32_16x16x64_bf16 v[112:115], v[104:107], v[24:31], v108
 s_nop 7
 v_cmp_u_f32 vcc, v112, v112
 v_cvt_pk_bf16_f32 v112, v112, v114
 s_cbranch_vccnz RBC0v0
RBD0v0:
 buffer_store_dword v112, v127, s[36:39], s44 offen
 s_barrier
RBX0v0:
 v_mov_b32 v64, v112
 s_cmp_lt_u32 s41, 63
 s_cbranch_scc1 HA0v0
 s_branch FIN0
HR0v0:
 s_add_u32 s65, s65, 1
 s_cmp_gt_u32 s65, 131072
 s_cbranch_scc1 L_ABORT
 s_branch HL0v0
FB0v0:
 s_nop 7
 v_max3_f32 v126, v104, v105, v106
 v_max3_f32 v126, v126, v107, v108
 v_max3_f32 v126, v126, v109, v110
 v_max3_f32 v126, v126, v111, v112
 v_max_f32 v126, v126, v113
 v_mov_b32 v28, v126
 s_nop 1
 v_permlane16_swap_b32 v126, v28
 v_max_f32 v126, v126, v28
 v_mov_b32 v28, v126
 s_nop 1
 v_permlane32_swap_b32 v126, v28
 v_max_f32 v126, v126, v28
 v_sub_f32 v28, v104, v126
 v_sub_f32 v29, v105, v126
 v_exp_f32 v28, v28
 v_exp_f32 v29, v29
 s_nop 0
 v_cvt_pk_bf16_f32 v24, v28, v29
 v_sub_f32 v28, v106, v126
 v_sub_f32 v29, v107, v126
 v_exp_f32 v28, v28
 v_exp_f32 v29, v29
 s_nop 0
 v_cvt_pk_bf16_f32 v25, v28, v29
 v_sub_f32 v28, v108, v126
 v_sub_f32 v29, v109, v126
 v_exp_f32 v28, v28
 v_exp_f32 v29, v29
 s_nop 0
 v_cvt_pk_bf16_f32 v26, v28, v29
 v_sub_f32 v28, v110, v126
 v_sub_f32 v29, v111, v126
 v_exp_f32 v28, v28
 v_exp_f32 v29, v29
 s_nop 0
 v_cvt_pk_bf16_f32 v27, v28, v29
 v_sub_f32 v28, v112, v126
 v_sub_f32 v29, v113, v126
 v_exp_f32 v28, v28
 v_exp_f32 v29, v29
 s_nop 0
 v_cvt_pk_bf16_f32 v124, v28, v29
 v_mfma_f32_16x16x32_bf16 v[16:19], v[20:23], v[24:27], 0
 v_mfma_f32_16x16x32_bf16 v[4:7], v[12:15], v[24:27], 0
 v_mfma_f32_16x16x32_bf16 v[8:11], v[0:3], v[24:27], 0
 v_mfma_f32_16x16x16_bf16 v[16:19], v[20:21], v[124:125], v[16:19]
 v_mfma_f32_16x16x16_bf16 v[4:7], v[96:97], v[124:125], v[4:7]
 v_mfma_f32_16x16x16_bf16 v[8:11], v[100:101], v[124:125], v[8:11]
 v_rcp_f32 v126, v16
 s_nop 1
 v_mul_f32 v4, v4, v126
 v_mul_f32 v5, v5, v126
 v_mul_f32 v6, v6, v126
 v_mul_f32 v7, v7, v126
 s_mov_b64 vcc, 0
 s_nop 7
 s_branch FBC0v0
RBC0v0:
 s_barrier
 v_mov_b64 v[112:113], 0
 v_mov_b64 v[114:115], 0
 s_waitcnt vmcnt(6)
 s_nop 0
 v_smfmac_f32_16x16x64_bf16 v[112:115], v[104:107], v[32:39], v108
 s_waitcnt vmcnt(4)
 v_smfmac_f32_16x16x64_bf16 v[112:115], v[104:107], v[40:47], v108
 s_waitcnt vmcnt(2)
 v_smfmac_f32_16x16x64_bf16 v[112:115], v[104:107], v[48:55], v108
 s_waitcnt vmcnt(0)
 v_smfmac_f32_16x16x64_bf16 v[112:115], v[104:107], v[56:63], v108
 s_nop 7
 v_cmp_u_f32 vcc, v112, v112
 v_cvt_pk_bf16_f32 v112, v112, v114
 s_cbranch_vccz RBP0v0
 buffer_load_dwordx4 v[32:35], v117, s[36:39], s45 offen offset:0 sc1
 buffer_load_dwordx4 v[36:39], v117, s[36:39], s45 offen offset:1024 sc1
 buffer_load_dwordx4 v[40:43], v117, s[36:39], s45 offen offset:2048 sc1
 buffer_load_dwordx4 v[44:47], v117, s[36:39], s45 offen offset:3072 sc1
 buffer_load_dwordx4 v[48:51], v117, s[36:39], s46 offen offset:0 sc1
 buffer_load_dwordx4 v[52:55], v117, s[36:39], s46 offen offset:1024 sc1
 buffer_load_dwordx4 v[56:59], v117, s[36:39], s46 offen offset:2048 sc1
 buffer_load_dwordx4 v[60:63], v117, s[36:39], s46 offen offset:3072 sc1
 s_sleep 1
RB0v0:
 buffer_load_dwordx4 v[0:3], v117, s[36:39], s45 offen offset:0 sc1
 buffer_load_dwordx4 v[4:7], v117, s[36:39], s45 offen offset:1024 sc1
 buffer_load_dwordx4 v[8:11], v117, s[36:39], s45 offen offset:2048 sc1
 buffer_load_dwordx4 v[12:15], v117, s[36:39], s45 offen offset:3072 sc1
 buffer_load_dwordx4 v[16:19], v117, s[36:39], s46 offen offset:0 sc1
 buffer_load_dwordx4 v[20:23], v117, s[36:39], s46 offen offset:1024 sc1
 buffer_load_dwordx4 v[24:27], v117, s[36:39], s46 offen offset:2048 sc1
 buffer_load_dwordx4 v[28:31], v117, s[36:39], s46 offen offset:3072 sc1
 v_mov_b64 v[112:113], 0
 v_mov_b64 v[114:115], 0
 s_waitcnt vmcnt(14)
 s_nop 0
 v_smfmac_f32_16x16x64_bf16 v[112:115], v[104:107], v[32:39], v108
 s_waitcnt vmcnt(12)
 v_smfmac_f32_16x16x64_bf16 v[112:115], v[104:107], v[40:47], v108
 s_waitcnt vmcnt(10)
 v_smfmac_f32_16x16x64_bf16 v[112:115], v[104:107], v[48:55], v108
 s_waitcnt vmcnt(8)
 v_smfmac_f32_16x16x64_bf16 v[112:115], v[104:107], v[56:63], v108
 s_nop 7
 v_cmp_u_f32 vcc, v112, v112
 v_cvt_pk_bf16_f32 v112, v112, v114
 s_cbranch_vccz RBP0v0
 v_max3_u32 v124, v32, v33, v34
 v_max_u32 v124, v124, v35
 v_max3_u32 v124, v124, v36, v37
 v_max3_u32 v124, v124, v38, v39
 v_max3_u32 v124, v124, v40, v41
 v_max3_u32 v124, v124, v42, v43
 v_max3_u32 v124, v124, v44, v45
 v_max3_u32 v124, v124, v46, v47
 v_max3_u32 v124, v124, v48, v49
 v_max3_u32 v124, v124, v50, v51
 v_max3_u32 v124, v124, v52, v53
 v_max3_u32 v124, v124, v54, v55
 v_max3_u32 v124, v124, v56, v57
 v_max3_u32 v124, v124, v58, v59
 v_max3_u32 v124, v124, v60, v61
 v_max3_u32 v124, v124, v62, v63
 v_cmp_eq_u32 vcc, -1, v124
 s_cbranch_vccz RBP0v0
 s_add_u32 s61, s61, 1
 s_cmp_gt_u32 s61, 131072
 s_cbranch_scc1 L_ABORT
 buffer_load_dwordx4 v[32:35], v117, s[36:39], s45 offen offset:0 sc1
 buffer_load_dwordx4 v[36:39], v117, s[36:39], s45 offen offset:1024 sc1
 buffer_load_dwordx4 v[40:43], v117, s[36:39], s45 offen offset:2048 sc1
 buffer_load_dwordx4 v[44:47], v117, s[36:39], s45 offen offset:3072 sc1
 buffer_load_dwordx4 v[48:51], v117, s[36:39], s46 offen offset:0 sc1
 buffer_load_dwordx4 v[52:55], v117, s[36:39], s46 offen offset:1024 sc1
 buffer_load_dwordx4 v[56:59], v117, s[36:39], s46 offen offset:2048 sc1
 buffer_load_dwordx4 v[60:63], v117, s[36:39], s46 offen offset:3072 sc1
 v_mov_b64 v[112:113], 0
 v_mov_b64 v[114:115], 0
 s_waitcnt vmcnt(14)
 s_nop 0
 v_smfmac_f32_16x16x64_bf16 v[112:115], v[104:107], v[0:7], v108
 s_waitcnt vmcnt(12)
 v_smfmac_f32_16x16x64_bf16 v[112:115], v[104:107], v[8:15], v108
 s_waitcnt vmcnt(10)
 v_smfmac_f32_16x16x64_bf16 v[112:115], v[104:107], v[16:23], v108
 s_waitcnt vmcnt(8)
 v_smfmac_f32_16x16x64_bf16 v[112:115], v[104:107], v[24:31], v108
 s_nop 7
 v_cmp_u_f32 vcc, v112, v112
 v_cvt_pk_bf16_f32 v112, v112, v114
 s_cbranch_vccz RBP0v0
 v_max3_u32 v124, v0, v1, v2
 v_max_u32 v124, v124, v3
 v_max3_u32 v124, v124, v4, v5
 v_max3_u32 v124, v124, v6, v7
 v_max3_u32 v124, v124, v8, v9
 v_max3_u32 v124, v124, v10, v11
 v_max3_u32 v124, v124, v12, v13
 v_max3_u32 v124, v124, v14, v15
 v_max3_u32 v124, v124, v16, v17
 v_max3_u32 v124, v124, v18, v19
 v_max3_u32 v124, v124, v20, v21
 v_max3_u32 v124, v124, v22, v23
 v_max3_u32 v124, v124, v24, v25
 v_max3_u32 v124, v124, v26, v27
 v_max3_u32 v124, v124, v28, v29
 v_max3_u32 v124, v124, v30, v31
 v_cmp_eq_u32 vcc, -1, v124
 s_cbranch_vccz RBP0v0
 s_add_u32 s61, s61, 1
 s_cmp_gt_u32 s61, 131072
 s_cbranch_scc1 L_ABORT
 s_branch RB0v0
RBP0v0:
 buffer_store_dword v112, v127, s[36:39], s44 offen
 s_add_u32 s61, s61, 1
 s_branch RBX0v0
SB0v0:
 buffer_load_dwordx4 v[68:71], v117, s[36:39], s43 offen offset:3072 sc1
 s_add_u32 s61, s61, 1
 s_cmp_gt_u32 s61, 131072
 s_cbranch_scc1 L_ABORT
 s_nop 15
SL0v0:
 buffer_load_dwordx4 v[104:107], v117, s[36:39], s43 offen offset:3072 sc1
 s_waitcnt vmcnt(1)
 ds_write_b128 v117, v[68:71] offset:23552
 v_max3_u32 v124, v68, v69, v70
 v_max_u32 v124, v124, v71
 v_cmp_eq_u32 vcc, -1, v124
 s_cbranch_vccz SK0v0
 buffer_load_dwordx4 v[68:71], v117, s[36:39], s43 offen offset:3072 sc1
 s_waitcnt vmcnt(1)
 ds_write_b128 v117, v[104:107] offset:23552
 v_max3_u32 v124, v104, v105, v106
 v_max_u32 v124, v124, v107
 v_cmp_eq_u32 vcc, -1, v124
 s_cbranch_vccz SK0v0
 s_add_u32 s61, s61, 1
 s_cmp_gt_u32 s61, 131072
 s_cbranch_scc1 L_ABORT
 s_branch SL0v0
SK0v0:
 s_waitcnt lgkmcnt(0) vmcnt(0)
 s_branch SBR0v0
CE0v0:
 s_mov_b32 s89, s60
 s_mov_b32 s60, 0x7f000000
 v_mov_b64 v[96:97], 0
 v_mov_b64 v[98:99], 0
 v_mov_b64 v[100:101], 0
 v_mov_b64 v[102:103], 0
 v_mov_b64 v[76:77], -1
 v_mov_b64 v[78:79], -1
 s_mov_b32 s93, 4294426624
 s_add_u32 s45, s45, 540672
 s_add_u32 s46, s46, 540672
 s_mov_b32 s76, s78
 s_mov_b32 s78, s44
 s_branch HA0v0
FIN0:
 buffer_store_dword v64, v127, s[36:39], s60 offen sc1
 s_branch L_DONE
 .p2align 6
HA1:
 s_sleep 1
 s_nop 7
 buffer_load_dwordx4 v[104:107], v117, s[36:39], s42 offen offset:0 sc1
 s_add_u32 s65, s65, 1
 s_cmp_gt_u32 s65, 131072
 s_cbranch_scc1 L_ABORT
 s_sleep 1
 s_nop 4
 buffer_load_dwordx4 v[108:111], v117, s[36:39], s42 offen offset:0 sc1
 s_sleep 1
 s_nop 7
HL1:
 buffer_load_dwordx4 v[112:115], v117, s[36:39], s42 offen offset:0 sc1
 s_waitcnt vmcnt(2)
 ds_write_b128 v117, v[104:107] offset:8192
 v_max3_u32 v124, v104, v105, v106
 v_max_u32 v124, v124, v107
 v_cmp_eq_u32 vcc, -1, v124
 v_mov_b64 v[0:1], v[104:105]
 v_mov_b64 v[2:3], v[106:107]
 s_cbranch_vccz HK1
 buffer_load_dwordx4 v[104:107], v117, s[36:39], s42 offen offset:0 sc1
 s_waitcnt vmcnt(2)
 ds_write_b128 v117, v[108:111] offset:8192
 v_max3_u32 v124, v108, v109, v110
 v_max_u32 v124, v124, v111
 v_cmp_eq_u32 vcc, -1, v124
 v_mov_b64 v[0:1], v[108:109]
 v_mov_b64 v[2:3], v[110:111]
 s_cbranch_vccz HK1
 buffer_load_dwordx4 v[108:111], v117, s[36:39], s42 offen offset:0 sc1
 s_waitcnt vmcnt(2)
 ds_write_b128 v117, v[112:115] offset:8192
 v_max3_u32 v124, v112, v113, v114
 v_max_u32 v124, v124, v115
 v_cmp_eq_u32 vcc, -1, v124
 v_mov_b64 v[0:1], v[112:113]
 v_mov_b64 v[2:3], v[114:115]
 s_cbranch_vccnz HR1
HK1:
 s_waitcnt lgkmcnt(1)
 v_smfmac_f32_16x16x64_bf16 v[80:83], v[0:3], a[0:7], v116
 buffer_load_dwordx4 v[68:71], v117, s[36:39], s43 offen offset:0 sc1
 v_smfmac_f32_16x16x64_bf16 v[100:103], v[0:3], v[32:39], v116
 ds_read_b128 v[32:35], v118 offset:36864
 v_smfmac_f32_16x16x64_bf16 v[84:87], v[0:3], a[64:71], v116
 ds_read_b128 v[36:39], v118 offset:37888
 v_smfmac_f32_16x16x64_bf16 v[88:91], v[0:3], a[128:135], v116
 s_waitcnt lgkmcnt(2)
 s_barrier
 ds_read_b128 v[4:7], v117 offset:9216
 ds_read_b128 v[8:11], v117 offset:10240
 ds_read_b128 v[12:15], v117 offset:11264
 v_smfmac_f32_16x16x64_bf16 v[92:95], v[0:3], a[192:199], v116
 v_smfmac_f32_16x16x64_bf16 v[96:99], v[0:3], v[16:23], v116
 s_waitcnt lgkmcnt(2)
 v_lshlrev_b32 v126, 3, v117
 v_smfmac_f32_16x16x64_bf16 v[80:83], v[4:7], a[8:15], v116
 buffer_store_dwordx4 v[76:79], v117, s[36:39], s59 offen offset:0
 v_smfmac_f32_16x16x64_bf16 v[100:103], v[4:7], v[40:47], v116
 ds_read_b128 v[40:43], v118 offset:53248
 v_smfmac_f32_16x16x64_bf16 v[84:87], v[4:7], a[72:79], v116
 ds_read_b128 v[44:47], v118 offset:54272
 v_smfmac_f32_16x16x64_bf16 v[88:91], v[4:7], a[136:143], v116
 v_smfmac_f32_16x16x64_bf16 v[96:99], v[4:7], v[24:31], v116
 buffer_store_dwordx4 v[76:79], v117, s[36:39], s59 offen offset:1024
 s_waitcnt lgkmcnt(3)
 v_smfmac_f32_16x16x64_bf16 v[80:83], v[8:11], a[16:23], v116
 v_smfmac_f32_16x16x64_bf16 v[100:103], v[8:11], v[48:55], v116
 ds_read_b128 v[48:51], v119 offset:4096
 v_smfmac_f32_16x16x64_bf16 v[84:87], v[8:11], a[80:87], v116
 ds_read_b128 v[52:55], v119 offset:5120
 v_smfmac_f32_16x16x64_bf16 v[88:91], v[8:11], a[144:151], v116
 v_smfmac_f32_16x16x64_bf16 v[92:95], v[8:11], a[208:215], v116
 s_waitcnt vmcnt(2)
 ds_write_b128 v117, v[68:71] offset:20480
 s_waitcnt lgkmcnt(5)
 v_smfmac_f32_16x16x64_bf16 v[80:83], v[12:15], a[24:31], v116
 v_max3_u32 v124, v68, v69, v70
 v_smfmac_f32_16x16x64_bf16 v[100:103], v[12:15], v[56:63], v116
 v_max_u32 v124, v124, v71
 v_smfmac_f32_16x16x64_bf16 v[84:87], v[12:15], a[88:95], v116
 v_cmp_eq_u32 vcc, -1, v124
 v_smfmac_f32_16x16x64_bf16 v[88:91], v[12:15], a[152:159], v116
 v_smfmac_f32_16x16x64_bf16 v[92:95], v[12:15], a[216:223], v116
 s_cbranch_vccnz SB1
SBR1:
 s_waitcnt lgkmcnt(0)
 s_barrier
 ds_read_b128 v[16:19], v117 offset:20480
 v_smfmac_f32_16x16x64_bf16 v[92:95], v[4:7], a[200:207], v116
 ds_read_b128 v[20:23], v117 offset:21504
 v_smfmac_f32_16x16x64_bf16 v[96:99], v[8:11], v[144:151], v116
 ds_read_b128 v[24:27], v117 offset:22528
 buffer_load_dwordx4 v[0:3], v117, s[36:39], s58 offen sc1
 s_waitcnt lgkmcnt(2)
 v_smfmac_f32_16x16x64_bf16 v[80:83], v[16:19], a[32:39], v116
 ds_read_b128 v[28:31], v117 offset:23552
 buffer_load_dwordx4 v[4:7], v117, s[36:39], s58 offen offset:1024 sc1
 v_smfmac_f32_16x16x64_bf16 v[100:103], v[16:19], v[32:39], v116
 ds_read_b128 v[56:59], v119 offset:20480
 v_smfmac_f32_16x16x64_bf16 v[84:87], v[16:19], a[96:103], v116
 ds_read_b128 v[60:63], v119 offset:21504
 buffer_load_dword v127, v126, s[36:39], s74 offen sc1
 s_waitcnt lgkmcnt(4)
 v_smfmac_f32_16x16x64_bf16 v[80:83], v[20:23], a[40:47], v116
 ds_read_b128 v[32:35], v117 offset:0
 v_smfmac_f32_16x16x64_bf16 v[100:103], v[20:23], v[40:47], v116
 ds_read_b128 v[36:39], v117 offset:1024
 ds_read_b128 v[40:43], v117 offset:2048
 v_smfmac_f32_16x16x64_bf16 v[84:87], v[20:23], a[104:111], v116
 ds_read_b128 v[44:47], v117 offset:3072
 s_waitcnt lgkmcnt(7)
 v_smfmac_f32_16x16x64_bf16 v[80:83], v[24:27], a[48:55], v116
 v_smfmac_f32_16x16x64_bf16 v[100:103], v[24:27], v[48:55], v116
 ds_read_b128 v[48:51], v117 offset:4096
 v_smfmac_f32_16x16x64_bf16 v[84:87], v[24:27], a[112:119], v116
 ds_read_b128 v[52:55], v117 offset:5120
 s_waitcnt lgkmcnt(8)
 v_smfmac_f32_16x16x64_bf16 v[80:83], v[28:31], a[56:63], v116
 s_waitcnt lgkmcnt(6)
 v_smfmac_f32_16x16x64_bf16 v[100:103], v[28:31], v[56:63], v116
 ds_read_b128 v[56:59], v117 offset:6144
 v_smfmac_f32_16x16x64_bf16 v[84:87], v[28:31], a[120:127], v116
 ds_read_b128 v[60:63], v117 offset:7168
 v_smfmac_f32_16x16x64_bf16 v[88:91], v[16:19], a[160:167], v116
 v_add_f32 v80, v80, v81
 v_add_f32 v82, v82, v83
 v_smfmac_f32_16x16x64_bf16 v[88:91], v[20:23], a[168:175], v116
 v_mul_f32 v80, s64, v80
 v_mul_f32 v82, s64, v82
 v_smfmac_f32_16x16x64_bf16 v[88:91], v[24:27], a[176:183], v116
 v_cvt_pk_bf16_f32 v80, v80, v82
 v_add_f32 v84, v84, v85
 v_smfmac_f32_16x16x64_bf16 v[88:91], v[28:31], a[184:191], v116
 ds_write_b32 v121, v80 offset:9216
 v_add_f32 v86, v86, v87
 v_smfmac_f32_16x16x64_bf16 v[96:99], v[12:15], v[152:159], v116
 v_mul_f32 v84, s64, v84
 v_mul_f32 v86, s64, v86
 v_smfmac_f32_16x16x64_bf16 v[92:95], v[16:19], a[224:231], v116
 v_cvt_pk_bf16_f32 v84, v84, v86
 v_smfmac_f32_16x16x64_bf16 v[92:95], v[20:23], a[232:239], v116
 ds_write_b32 v121, v84 offset:9728
 v_smfmac_f32_16x16x64_bf16 v[92:95], v[24:27], a[240:247], v116
 v_add_f32 v88, v88, v89
 v_add_f32 v90, v90, v91
 v_smfmac_f32_16x16x64_bf16 v[92:95], v[28:31], a[248:255], v116
 v_cvt_pk_bf16_f32 v88, v88, v90
 v_smfmac_f32_16x16x64_bf16 v[96:99], v[16:19], v[160:167], v116
 ds_write_b32 v121, v88 offset:15360
 v_smfmac_f32_16x16x64_bf16 v[96:99], v[20:23], v[168:175], v116
 s_waitcnt lgkmcnt(1)
 s_barrier
 v_add_f32 v92, v92, v93
 v_add_f32 v94, v94, v95
 v_smfmac_f32_16x16x64_bf16 v[96:99], v[24:27], v[176:183], v116
 ds_read_b64_tr_b16 v[64:65], v120 offset:8192
 ds_read_b64_tr_b16 v[66:67], v120 offset:8448
 v_cvt_pk_bf16_f32 v92, v92, v94
 ds_write_b32 v121, v92 offset:15872
 v_smfmac_f32_16x16x64_bf16 v[96:99], v[28:31], v[184:191], v116
 ds_read_b64_tr_b16 v[68:69], v120 offset:9216
 ds_read_b64_tr_b16 v[70:71], v120 offset:9472
 ds_read_b64_tr_b16 v[72:73], v120 offset:10240
 ds_read_b64_tr_b16 v[74:75], v120 offset:10496
 s_waitcnt lgkmcnt(5)
 v_mfma_f32_16x16x32_bf16 v[104:107], v[32:35], v[64:67], 0
 ds_read_b64_tr_b16 v[76:77], v120 offset:11264
 v_mfma_f32_16x16x32_bf16 v[108:111], v[48:51], v[64:67], 0
 ds_read_b64_tr_b16 v[78:79], v120 offset:11520
 s_waitcnt lgkmcnt(4)
 v_mfma_f32_16x16x32_bf16 v[104:107], v[36:39], v[68:71], v[104:107]
 v_add_f32 v100, v100, v101
 v_add_f32 v102, v102, v103
 v_mfma_f32_16x16x32_bf16 v[108:111], v[52:55], v[68:71], v[108:111]
 s_waitcnt lgkmcnt(6)
 s_barrier
 s_waitcnt lgkmcnt(2)
 v_mfma_f32_16x16x32_bf16 v[104:107], v[40:43], v[72:75], v[104:107]
 ds_read_b64_tr_b16 v[80:81], v120 offset:14336
 ds_read_b64_tr_b16 v[82:83], v120 offset:14592
 s_waitcnt lgkmcnt(2)
 v_mfma_f32_16x16x32_bf16 v[104:107], v[44:47], v[76:79], v[104:107]
 ds_read_b64_tr_b16 v[84:85], v120 offset:15360
 ds_read_b64_tr_b16 v[86:87], v120 offset:15616
 v_mfma_f32_16x16x32_bf16 v[108:111], v[56:59], v[72:75], v[108:111]
 ds_read_b64_tr_b16 v[88:89], v120 offset:16384
 ds_read_b64_tr_b16 v[90:91], v120 offset:16640
 v_mfma_f32_16x16x32_bf16 v[108:111], v[60:63], v[76:79], v[108:111]
 ds_read_b64_tr_b16 v[92:93], v120 offset:17408
 ds_read_b64_tr_b16 v[94:95], v120 offset:17664
 ds_read_b128 v[20:23], v117 offset:29696
 s_waitcnt lgkmcnt(7)
 v_mfma_f32_16x16x32_bf16 v[112:115], v[80:83], v[64:67], 0
 s_waitcnt lgkmcnt(5)
 v_exp_f32 v28, v104
 v_mfma_f32_16x16x32_bf16 v[112:115], v[84:87], v[68:71], v[112:115]
 s_waitcnt lgkmcnt(3)
 v_exp_f32 v29, v105
 v_mfma_f32_16x16x32_bf16 v[112:115], v[88:91], v[72:75], v[112:115]
 s_waitcnt lgkmcnt(1)
 v_exp_f32 v30, v106
 v_mfma_f32_16x16x32_bf16 v[112:115], v[92:95], v[76:79], v[112:115]
 v_exp_f32 v31, v107
 v_cvt_pk_bf16_f32 v24, v28, v29
 v_exp_f32 v28, v108
 v_cvt_pk_bf16_f32 v25, v30, v31
 v_exp_f32 v29, v109
 v_exp_f32 v30, v110
 v_exp_f32 v31, v111
 v_cvt_pk_bf16_f32 v26, v28, v29
 v_exp_f32 v28, v112
 v_cvt_pk_bf16_f32 v27, v30, v31
 v_exp_f32 v29, v113
 v_cvt_pk_bf16_f32 v100, v100, v102
 s_waitcnt lgkmcnt(0)
 v_mfma_f32_16x16x32_bf16 v[16:19], v[20:23], v[24:27], 0
 s_waitcnt vmcnt(2)
 v_cvt_pk_bf16_f32 v124, v28, v29
 v_add_f32 v96, v96, v97
 v_mfma_f32_16x16x32_bf16 v[8:11], v[0:3], v[24:27], 0
 s_waitcnt vmcnt(1)
 v_add_f32 v98, v98, v99
 v_mov_b32 v101, 0
 v_mfma_f32_16x16x32_bf16 v[12:15], v[4:7], v[24:27], 0
 v_cvt_pk_bf16_f32 v96, v96, v98
 v_mov_b32 v97, 0
 v_mfma_f32_16x16x16_bf16 v[16:19], v[20:21], v[124:125], v[16:19]
 v_mov_b64 v[82:83], 0
 v_mov_b64 v[84:85], 0
 v_mfma_f32_16x16x16_bf16 v[8:11], v[96:97], v[124:125], v[8:11]
 v_mov_b64 v[86:87], 0
 v_mov_b64 v[88:89], 0
 v_mfma_f32_16x16x16_bf16 v[12:15], v[100:101], v[124:125], v[12:15]
 v_rcp_f32 v126, v16
 v_mov_b64 v[80:81], 0
 v_max_f32 v28, v126, v16
 v_cmp_nge_f32 vcc, s88, v28
 v_mul_f32 v8, v8, v126
 v_mul_f32 v9, v9, v126
 v_mul_f32 v10, v10, v126
 v_mul_f32 v11, v11, v126
FBC1:
 s_and_b64 s[34:35], vcc, s[86:87]
 s_cbranch_scc1 FB1
 v_cvt_pk_bf16_f32 v8, v8, v9
 v_cvt_pk_bf16_f32 v9, v10, v11
 ds_write_b64 v122, v[8:9]
 v_pk_mul_f32 v[12:13], v[12:13], v[126:127] op_sel_hi:[1,0]
 v_pk_mul_f32 v[14:15], v[14:15], v[126:127] op_sel_hi:[1,0]
 v_cvt_pk_bf16_f32 v12, v12, v13
 v_cvt_pk_bf16_f32 v13, v14, v15
 ds_write_b64 v122, v[12:13] offset:256
 v_mov_b64 v[90:91], 0
 v_mov_b64 v[92:93], 0
 v_mov_b64 v[94:95], 0
 v_mov_b64 v[16:17], 0
 v_mov_b64 v[18:19], 0
 v_mov_b64 v[20:21], 0
 v_mov_b64 v[22:23], 0
 v_mov_b64 v[24:25], 0
 v_mov_b64 v[26:27], 0
 v_mov_b64 v[28:29], 0
 v_mov_b64 v[30:31], 0
 v_lshrrev_b32 v124, 3, v117
 v_bitop3_b32 v124, v117, v124, 16 bitop3:0x78
 ds_read_b128 v[32:35], v117 offset:38912
 ds_read_b128 v[36:39], v117 offset:39936
 s_waitcnt lgkmcnt(2)
 s_barrier
 ds_read_b128 v[64:67], v124 offset:24576
 ds_read_b128 v[68:71], v124 offset:25600
 ds_read_b128 v[40:43], v117 offset:55296
 ds_read_b128 v[44:47], v117 offset:56320
 ds_read_b128 v[48:51], v118 offset:6144
 ds_read_b128 v[52:55], v118 offset:7168
 s_waitcnt lgkmcnt(5)
 v_smfmac_f32_16x16x64_bf16 v[80:83], v[64:67], v[192:199], v116
 ds_read_b128 v[56:59], v118 offset:22528
 s_waitcnt lgkmcnt(5)
 v_smfmac_f32_16x16x64_bf16 v[80:83], v[68:71], v[32:39], v116
 ds_read_b128 v[60:63], v118 offset:23552
 v_smfmac_f32_16x16x64_bf16 v[84:87], v[64:67], v[200:207], v116
 ds_read_b128 v[0:3], v118 offset:38912
 s_waitcnt lgkmcnt(5)
 v_smfmac_f32_16x16x64_bf16 v[84:87], v[68:71], v[40:47], v116
 ds_read_b128 v[4:7], v118 offset:39936
 v_add_f32 v80, v80, v81
 v_add_f32 v82, v82, v83
 v_smfmac_f32_16x16x64_bf16 v[88:91], v[64:67], v[208:215], v116
 ds_read_b128 v[72:75], v118 offset:55296
 s_waitcnt lgkmcnt(5)
 v_cvt_pk_bf16_f32 v80, v80, v82
 v_smfmac_f32_16x16x64_bf16 v[88:91], v[68:71], v[48:55], v116
 buffer_store_dword v80, v123, s[36:39], s48 offen
 ds_read_b128 v[76:79], v118 offset:56320
 v_add_f32 v84, v84, v85
 v_add_f32 v86, v86, v87
 v_smfmac_f32_16x16x64_bf16 v[92:95], v[64:67], v[216:223], v116
 s_add_u32 s41, s41, 1
 s_waitcnt lgkmcnt(4)
 v_cvt_pk_bf16_f32 v84, v84, v86
 v_smfmac_f32_16x16x64_bf16 v[92:95], v[68:71], v[56:63], v116
 buffer_store_dword v84, v123, s[36:39], s49 offen
 s_add_u32 s92, s92, 1
 v_add_f32 v88, v88, v89
 v_add_f32 v90, v90, v91
 v_smfmac_f32_16x16x64_bf16 v[16:19], v[64:67], v[224:231], v116
 s_cmp_eq_u32 s92, 3
 s_waitcnt lgkmcnt(2)
 v_cvt_pk_bf16_f32 v88, v88, v90
 v_smfmac_f32_16x16x64_bf16 v[16:19], v[68:71], v[0:7], v116
 buffer_store_dword v88, v123, s[36:39], s50 offen
 s_cselect_b32 s93, 4294426624, s73
 v_add_f32 v92, v92, v93
 v_add_f32 v94, v94, v95
 v_smfmac_f32_16x16x64_bf16 v[20:23], v[64:67], v[232:239], v116
 s_cselect_b32 s79, 4294950912, s66
 s_waitcnt lgkmcnt(0)
 v_cvt_pk_bf16_f32 v92, v92, v94
 v_smfmac_f32_16x16x64_bf16 v[20:23], v[68:71], v[72:79], v116
 buffer_store_dword v92, v123, s[36:39], s51 offen
 s_cselect_b32 s92, 0, s92
 v_add_f32 v16, v16, v17
 v_add_f32 v18, v18, v19
 v_smfmac_f32_16x16x64_bf16 v[24:27], v[64:67], v[240:247], v116
 s_add_u32 s42, s42, s79
 v_cvt_pk_bf16_f32 v16, v16, v18
 v_smfmac_f32_16x16x64_bf16 v[24:27], v[68:71], v[128:135], v116
 buffer_store_dword v16, v123, s[36:39], s52 offen
 s_add_u32 s43, s43, s79
 v_add_f32 v20, v20, v21
 v_add_f32 v22, v22, v23
 v_smfmac_f32_16x16x64_bf16 v[28:31], v[64:67], v[248:255], v116
 s_add_u32 s58, s58, 524288
 v_cvt_pk_bf16_f32 v20, v20, v22
 v_smfmac_f32_16x16x64_bf16 v[28:31], v[68:71], v[136:143], v116
 buffer_store_dword v20, v123, s[36:39], s53 offen
 s_add_u32 s74, s74, 524288
 v_add_f32 v24, v24, v25
 v_add_f32 v26, v26, v27
 v_cvt_pk_bf16_f32 v24, v24, v26
 buffer_store_dword v24, v123, s[36:39], s54 offen
 s_nop 1
 v_add_f32 v28, v28, v29
 v_add_f32 v30, v30, v31
 v_cvt_pk_bf16_f32 v28, v28, v30
 buffer_store_dword v28, v123, s[36:39], s55 offen
 s_add_u32 s48, s48, s93
 v_mov_b64 v[80:81], 0
 s_add_u32 s49, s49, s93
 v_mov_b64 v[82:83], 0
 s_add_u32 s50, s50, s93
 v_mov_b64 v[84:85], 0
 s_add_u32 s51, s51, s93
 v_mov_b64 v[86:87], 0
 s_add_u32 s52, s52, s93
 v_mov_b64 v[88:89], 0
 s_add_u32 s53, s53, s93
 v_mov_b64 v[90:91], 0
 s_add_u32 s54, s54, s93
 v_mov_b64 v[92:93], 0
 s_add_u32 s55, s55, s93
 v_mov_b64 v[94:95], 0
 ds_read_b128 v[32:35], v117 offset:36864
 v_mov_b64 v[96:97], 0
 ds_read_b128 v[36:39], v117 offset:37888
 v_mov_b64 v[98:99], 0
 ds_read_b128 v[40:43], v117 offset:53248
 v_mov_b64 v[100:101], 0
 ds_read_b128 v[44:47], v117 offset:54272
 v_mov_b64 v[102:103], 0
 ds_read_b128 v[48:51], v118 offset:4096
 v_mov_b64 v[76:77], -1
 ds_read_b128 v[52:55], v118 offset:5120
 v_mov_b64 v[78:79], -1
 ds_read_b128 v[56:59], v118 offset:20480
 ds_read_b128 v[60:63], v118 offset:21504
 ds_read_b128 v[16:19], v119 offset:6144
 ds_read_b128 v[20:23], v119 offset:7168
 ds_read_b128 v[24:27], v119 offset:22528
 ds_read_b128 v[28:31], v119 offset:23552
 s_sleep 3
 s_nop 7
 s_mov_b32 m0, 0
 s_nop 0
 buffer_load_dwordx4 v117, s[36:39], s56 offen offset:0 sc1 lds
 buffer_load_dwordx4 v117, s[36:39], s56 offen offset:1024 sc1 lds
 buffer_load_dwordx4 v117, s[36:39], s56 offen offset:2048 sc1 lds
 s_barrier
 s_add_u32 s59, s45, 2048
 s_add_u32 s45, s45, s93
 s_add_u32 s56, s56, 524288
 s_add_u32 s57, s57, 524288
 s_cmp_lt_u32 s41, 63
 s_cbranch_scc1 HA1
 s_branch FIN1
HR1:
 s_add_u32 s65, s65, 1
 s_cmp_gt_u32 s65, 131072
 s_cbranch_scc1 L_ABORT
 s_branch HL1
FB1:
 s_nop 7
 v_max3_f32 v126, v104, v105, v106
 v_max3_f32 v126, v126, v107, v108
 v_max3_f32 v126, v126, v109, v110
 v_max3_f32 v126, v126, v111, v112
 v_max_f32 v126, v126, v113
 v_mov_b32 v28, v126
 s_nop 1
 v_permlane16_swap_b32 v126, v28
 v_max_f32 v126, v126, v28
 v_mov_b32 v28, v126
 s_nop 1
 v_permlane32_swap_b32 v126, v28
 v_max_f32 v126, v126, v28
 v_sub_f32 v28, v104, v126
 v_sub_f32 v29, v105, v126
 v_exp_f32 v28, v28
 v_exp_f32 v29, v29
 s_nop 0
 v_cvt_pk_bf16_f32 v24, v28, v29
 v_sub_f32 v28, v106, v126
 v_sub_f32 v29, v107, v126
 v_exp_f32 v28, v28
 v_exp_f32 v29, v29
 s_nop 0
 v_cvt_pk_bf16_f32 v25, v28, v29
 v_sub_f32 v28, v108, v126
 v_sub_f32 v29, v109, v126
 v_exp_f32 v28, v28
 v_exp_f32 v29, v29
 s_nop 0
 v_cvt_pk_bf16_f32 v26, v28, v29
 v_sub_f32 v28, v110, v126
 v_sub_f32 v29, v111, v126
 v_exp_f32 v28, v28
 v_exp_f32 v29, v29
 s_nop 0
 v_cvt_pk_bf16_f32 v27, v28, v29
 v_sub_f32 v28, v112, v126
 v_sub_f32 v29, v113, v126
 v_exp_f32 v28, v28
 v_exp_f32 v29, v29
 s_nop 0
 v_cvt_pk_bf16_f32 v124, v28, v29
 v_mfma_f32_16x16x32_bf16 v[16:19], v[20:23], v[24:27], 0
 v_mfma_f32_16x16x32_bf16 v[8:11], v[0:3], v[24:27], 0
 v_mfma_f32_16x16x32_bf16 v[12:15], v[4:7], v[24:27], 0
 v_mfma_f32_16x16x16_bf16 v[16:19], v[20:21], v[124:125], v[16:19]
 v_mfma_f32_16x16x16_bf16 v[8:11], v[96:97], v[124:125], v[8:11]
 v_mfma_f32_16x16x16_bf16 v[12:15], v[100:101], v[124:125], v[12:15]
 v_rcp_f32 v126, v16
 s_nop 1
 v_mul_f32 v8, v8, v126
 v_mul_f32 v9, v9, v126
 v_mul_f32 v10, v10, v126
 v_mul_f32 v11, v11, v126
 s_mov_b64 vcc, 0
 s_nop 7
 s_branch FBC1
SB1:
 buffer_load_dwordx4 v[68:71], v117, s[36:39], s43 offen offset:0 sc1
 s_add_u32 s61, s61, 1
 s_cmp_gt_u32 s61, 131072
 s_cbranch_scc1 L_ABORT
 s_nop 15
SL1:
 buffer_load_dwordx4 v[104:107], v117, s[36:39], s43 offen offset:0 sc1
 s_waitcnt vmcnt(1)
 ds_write_b128 v117, v[68:71] offset:20480
 v_max3_u32 v124, v68, v69, v70
 v_max_u32 v124, v124, v71
 v_cmp_eq_u32 vcc, -1, v124
 s_cbranch_vccz SK1
 buffer_load_dwordx4 v[68:71], v117, s[36:39], s43 offen offset:0 sc1
 s_waitcnt vmcnt(1)
 ds_write_b128 v117, v[104:107] offset:20480
 v_max3_u32 v124, v104, v105, v106
 v_max_u32 v124, v124, v107
 v_cmp_eq_u32 vcc, -1, v124
 s_cbranch_vccz SK1
 s_add_u32 s61, s61, 1
 s_cmp_gt_u32 s61, 131072
 s_cbranch_scc1 L_ABORT
 s_branch SL1
SK1:
 v_lshlrev_b32 v126, 3, v117
 s_waitcnt lgkmcnt(0) vmcnt(0)
 s_branch SBR1
CE1:
 ds_read_b128 v[32:35], v117 offset:36864
 v_mov_b64 v[96:97], 0
 ds_read_b128 v[36:39], v117 offset:37888
 v_mov_b64 v[98:99], 0
 ds_read_b128 v[40:43], v117 offset:53248
 v_mov_b64 v[100:101], 0
 ds_read_b128 v[44:47], v117 offset:54272
 v_mov_b64 v[102:103], 0
 ds_read_b128 v[48:51], v118 offset:4096
 v_mov_b64 v[76:77], -1
 ds_read_b128 v[52:55], v118 offset:5120
 v_mov_b64 v[78:79], -1
 ds_read_b128 v[56:59], v118 offset:20480
 ds_read_b128 v[60:63], v118 offset:21504
 ds_read_b128 v[16:19], v119 offset:6144
 ds_read_b128 v[20:23], v119 offset:7168
 ds_read_b128 v[24:27], v119 offset:22528
 ds_read_b128 v[28:31], v119 offset:23552
 s_branch HA1
FIN1:
 s_branch L_DONE
 .p2align 6
HA2:
 s_sleep 1
 s_nop 7
 buffer_load_dwordx4 v[104:107], v117, s[36:39], s42 offen offset:1024 sc1
 s_add_u32 s65, s65, 1
 s_cmp_gt_u32 s65, 131072
 s_cbranch_scc1 L_ABORT
 s_sleep 1
 s_nop 4
 buffer_load_dwordx4 v[108:111], v117, s[36:39], s42 offen offset:1024 sc1
 s_sleep 1
 s_nop 7
HL2:
 buffer_load_dwordx4 v[112:115], v117, s[36:39], s42 offen offset:1024 sc1
 s_waitcnt vmcnt(2)
 ds_write_b128 v117, v[104:107] offset:9216
 v_max3_u32 v124, v104, v105, v106
 v_max_u32 v124, v124, v107
 v_cmp_eq_u32 vcc, -1, v124
 v_mov_b64 v[4:5], v[104:105]
 v_mov_b64 v[6:7], v[106:107]
 s_cbranch_vccz HK2
 buffer_load_dwordx4 v[104:107], v117, s[36:39], s42 offen offset:1024 sc1
 s_waitcnt vmcnt(2)
 ds_write_b128 v117, v[108:111] offset:9216
 v_max3_u32 v124, v108, v109, v110
 v_max_u32 v124, v124, v111
 v_cmp_eq_u32 vcc, -1, v124
 v_mov_b64 v[4:5], v[108:109]
 v_mov_b64 v[6:7], v[110:111]
 s_cbranch_vccz HK2
 buffer_load_dwordx4 v[108:111], v117, s[36:39], s42 offen offset:1024 sc1
 s_waitcnt vmcnt(2)
 ds_write_b128 v117, v[112:115] offset:9216
 v_max3_u32 v124, v112, v113, v114
 v_max_u32 v124, v124, v115
 v_cmp_eq_u32 vcc, -1, v124
 v_mov_b64 v[4:5], v[112:113]
 v_mov_b64 v[6:7], v[114:115]
 s_cbranch_vccnz HR2
HK2:
 s_waitcnt lgkmcnt(1)
 v_smfmac_f32_16x16x64_bf16 v[80:83], v[4:7], a[8:15], v116
 buffer_load_dwordx4 v[68:71], v117, s[36:39], s43 offen offset:1024 sc1
 v_smfmac_f32_16x16x64_bf16 v[100:103], v[4:7], v[40:47], v116
 ds_read_b128 v[40:43], v118 offset:57344
 v_smfmac_f32_16x16x64_bf16 v[84:87], v[4:7], a[72:79], v116
 ds_read_b128 v[44:47], v118 offset:58368
 v_smfmac_f32_16x16x64_bf16 v[88:91], v[4:7], a[136:143], v116
 s_waitcnt lgkmcnt(2)
 s_barrier
 ds_read_b128 v[0:3], v117 offset:8192
 ds_read_b128 v[8:11], v117 offset:10240
 ds_read_b128 v[12:15], v117 offset:11264
 v_smfmac_f32_16x16x64_bf16 v[92:95], v[4:7], a[200:207], v116
 v_smfmac_f32_16x16x64_bf16 v[96:99], v[4:7], v[24:31], v116
 s_waitcnt lgkmcnt(2)
 v_lshlrev_b32 v126, 3, v117
 v_smfmac_f32_16x16x64_bf16 v[80:83], v[0:3], a[0:7], v116
 v_smfmac_f32_16x16x64_bf16 v[100:103], v[0:3], v[32:39], v116
 ds_read_b128 v[32:35], v118 offset:40960
 v_smfmac_f32_16x16x64_bf16 v[84:87], v[0:3], a[64:71], v116
 ds_read_b128 v[36:39], v118 offset:41984
 v_smfmac_f32_16x16x64_bf16 v[88:91], v[0:3], a[128:135], v116
 v_smfmac_f32_16x16x64_bf16 v[96:99], v[0:3], v[16:23], v116
 s_waitcnt lgkmcnt(3)
 v_smfmac_f32_16x16x64_bf16 v[80:83], v[8:11], a[16:23], v116
 v_smfmac_f32_16x16x64_bf16 v[100:103], v[8:11], v[48:55], v116
 ds_read_b128 v[48:51], v119 offset:8192
 v_smfmac_f32_16x16x64_bf16 v[84:87], v[8:11], a[80:87], v116
 ds_read_b128 v[52:55], v119 offset:9216
 v_smfmac_f32_16x16x64_bf16 v[88:91], v[8:11], a[144:151], v116
 v_smfmac_f32_16x16x64_bf16 v[92:95], v[8:11], a[208:215], v116
 s_waitcnt vmcnt(0)
 ds_write_b128 v117, v[68:71] offset:21504
 s_waitcnt lgkmcnt(5)
 v_smfmac_f32_16x16x64_bf16 v[80:83], v[12:15], a[24:31], v116
 v_max3_u32 v124, v68, v69, v70
 buffer_store_dwordx4 v[76:79], v117, s[36:39], s59 offen offset:0
 v_smfmac_f32_16x16x64_bf16 v[100:103], v[12:15], v[56:63], v116
 v_max_u32 v124, v124, v71
 v_smfmac_f32_16x16x64_bf16 v[84:87], v[12:15], a[88:95], v116
 v_cmp_eq_u32 vcc, -1, v124
 buffer_store_dwordx4 v[76:79], v117, s[36:39], s59 offen offset:1024
 v_smfmac_f32_16x16x64_bf16 v[88:91], v[12:15], a[152:159], v116
 v_smfmac_f32_16x16x64_bf16 v[92:95], v[12:15], a[216:223], v116
 s_cbranch_vccnz SB2
SBR2:
 s_waitcnt lgkmcnt(0)
 s_barrier
 ds_read_b128 v[16:19], v117 offset:20480
 v_smfmac_f32_16x16x64_bf16 v[92:95], v[0:3], a[192:199], v116
 ds_read_b128 v[20:23], v117 offset:21504
 v_smfmac_f32_16x16x64_bf16 v[96:99], v[8:11], v[144:151], v116
 ds_read_b128 v[24:27], v117 offset:22528
 buffer_load_dwordx4 v[4:7], v117, s[36:39], s58 offen sc1
 s_waitcnt lgkmcnt(2)
 v_smfmac_f32_16x16x64_bf16 v[80:83], v[16:19], a[32:39], v116
 ds_read_b128 v[28:31], v117 offset:23552
 buffer_load_dwordx4 v[0:3], v117, s[36:39], s58 offen offset:1024 sc1
 v_smfmac_f32_16x16x64_bf16 v[100:103], v[16:19], v[32:39], v116
 ds_read_b128 v[56:59], v119 offset:24576
 v_smfmac_f32_16x16x64_bf16 v[84:87], v[16:19], a[96:103], v116
 ds_read_b128 v[60:63], v119 offset:25600
 s_waitcnt lgkmcnt(4)
 v_smfmac_f32_16x16x64_bf16 v[80:83], v[20:23], a[40:47], v116
 ds_read_b128 v[32:35], v117 offset:0
 v_smfmac_f32_16x16x64_bf16 v[100:103], v[20:23], v[40:47], v116
 ds_read_b128 v[36:39], v117 offset:1024
 ds_read_b128 v[40:43], v117 offset:2048
 v_smfmac_f32_16x16x64_bf16 v[84:87], v[20:23], a[104:111], v116
 ds_read_b128 v[44:47], v117 offset:3072
 s_waitcnt lgkmcnt(7)
 v_smfmac_f32_16x16x64_bf16 v[80:83], v[24:27], a[48:55], v116
 buffer_load_dword v127, v126, s[36:39], s74 offen sc1
 v_smfmac_f32_16x16x64_bf16 v[100:103], v[24:27], v[48:55], v116
 ds_read_b128 v[48:51], v117 offset:4096
 v_smfmac_f32_16x16x64_bf16 v[84:87], v[24:27], a[112:119], v116
 ds_read_b128 v[52:55], v117 offset:5120
 s_waitcnt lgkmcnt(8)
 v_smfmac_f32_16x16x64_bf16 v[80:83], v[28:31], a[56:63], v116
 s_waitcnt lgkmcnt(6)
 v_smfmac_f32_16x16x64_bf16 v[100:103], v[28:31], v[56:63], v116
 ds_read_b128 v[56:59], v117 offset:6144
 v_smfmac_f32_16x16x64_bf16 v[84:87], v[28:31], a[120:127], v116
 ds_read_b128 v[60:63], v117 offset:7168
 v_smfmac_f32_16x16x64_bf16 v[88:91], v[16:19], a[160:167], v116
 v_add_f32 v80, v80, v81
 v_add_f32 v82, v82, v83
 v_smfmac_f32_16x16x64_bf16 v[88:91], v[20:23], a[168:175], v116
 v_mul_f32 v80, s64, v80
 v_mul_f32 v82, s64, v82
 v_smfmac_f32_16x16x64_bf16 v[88:91], v[24:27], a[176:183], v116
 v_cvt_pk_bf16_f32 v80, v80, v82
 v_add_f32 v84, v84, v85
 v_smfmac_f32_16x16x64_bf16 v[88:91], v[28:31], a[184:191], v116
 ds_write_b32 v121, v80 offset:10240
 v_add_f32 v86, v86, v87
 v_smfmac_f32_16x16x64_bf16 v[96:99], v[12:15], v[152:159], v116
 v_mul_f32 v84, s64, v84
 v_mul_f32 v86, s64, v86
 v_smfmac_f32_16x16x64_bf16 v[92:95], v[16:19], a[224:231], v116
 v_cvt_pk_bf16_f32 v84, v84, v86
 v_smfmac_f32_16x16x64_bf16 v[92:95], v[20:23], a[232:239], v116
 ds_write_b32 v121, v84 offset:10752
 v_smfmac_f32_16x16x64_bf16 v[92:95], v[24:27], a[240:247], v116
 v_add_f32 v88, v88, v89
 v_add_f32 v90, v90, v91
 v_smfmac_f32_16x16x64_bf16 v[92:95], v[28:31], a[248:255], v116
 v_cvt_pk_bf16_f32 v88, v88, v90
 v_smfmac_f32_16x16x64_bf16 v[96:99], v[16:19], v[160:167], v116
 ds_write_b32 v121, v88 offset:16384
 v_smfmac_f32_16x16x64_bf16 v[96:99], v[20:23], v[168:175], v116
 s_waitcnt lgkmcnt(1)
 s_barrier
 v_add_f32 v92, v92, v93
 v_add_f32 v94, v94, v95
 v_smfmac_f32_16x16x64_bf16 v[96:99], v[24:27], v[176:183], v116
 ds_read_b64_tr_b16 v[64:65], v120 offset:8192
 ds_read_b64_tr_b16 v[66:67], v120 offset:8448
 v_cvt_pk_bf16_f32 v92, v92, v94
 ds_write_b32 v121, v92 offset:16896
 v_smfmac_f32_16x16x64_bf16 v[96:99], v[28:31], v[184:191], v116
 ds_read_b64_tr_b16 v[68:69], v120 offset:9216
 ds_read_b64_tr_b16 v[70:71], v120 offset:9472
 ds_read_b64_tr_b16 v[72:73], v120 offset:10240
 ds_read_b64_tr_b16 v[74:75], v120 offset:10496
 s_waitcnt lgkmcnt(5)
 v_mfma_f32_16x16x32_bf16 v[104:107], v[32:35], v[64:67], 0
 ds_read_b64_tr_b16 v[76:77], v120 offset:11264
 v_mfma_f32_16x16x32_bf16 v[108:111], v[48:51], v[64:67], 0
 ds_read_b64_tr_b16 v[78:79], v120 offset:11520
 s_waitcnt lgkmcnt(4)
 v_mfma_f32_16x16x32_bf16 v[104:107], v[36:39], v[68:71], v[104:107]
 v_add_f32 v100, v100, v101
 v_add_f32 v102, v102, v103
 v_mfma_f32_16x16x32_bf16 v[108:111], v[52:55], v[68:71], v[108:111]
 s_waitcnt lgkmcnt(6)
 s_barrier
 s_waitcnt lgkmcnt(2)
 v_mfma_f32_16x16x32_bf16 v[104:107], v[40:43], v[72:75], v[104:107]
 ds_read_b64_tr_b16 v[80:81], v120 offset:14336
 ds_read_b64_tr_b16 v[82:83], v120 offset:14592
 s_waitcnt lgkmcnt(2)
 v_mfma_f32_16x16x32_bf16 v[104:107], v[44:47], v[76:79], v[104:107]
 ds_read_b64_tr_b16 v[84:85], v120 offset:15360
 ds_read_b64_tr_b16 v[86:87], v120 offset:15616
 v_mfma_f32_16x16x32_bf16 v[108:111], v[56:59], v[72:75], v[108:111]
 ds_read_b64_tr_b16 v[88:89], v120 offset:16384
 ds_read_b64_tr_b16 v[90:91], v120 offset:16640
 v_mfma_f32_16x16x32_bf16 v[108:111], v[60:63], v[76:79], v[108:111]
 ds_read_b64_tr_b16 v[92:93], v120 offset:17408
 ds_read_b64_tr_b16 v[94:95], v120 offset:17664
 ds_read_b128 v[20:23], v117 offset:29696
 s_waitcnt lgkmcnt(7)
 v_mfma_f32_16x16x32_bf16 v[112:115], v[80:83], v[64:67], 0
 s_waitcnt lgkmcnt(5)
 v_exp_f32 v28, v104
 v_mfma_f32_16x16x32_bf16 v[112:115], v[84:87], v[68:71], v[112:115]
 s_waitcnt lgkmcnt(3)
 v_exp_f32 v29, v105
 v_mfma_f32_16x16x32_bf16 v[112:115], v[88:91], v[72:75], v[112:115]
 s_waitcnt lgkmcnt(1)
 v_exp_f32 v30, v106
 v_mfma_f32_16x16x32_bf16 v[112:115], v[92:95], v[76:79], v[112:115]
 v_exp_f32 v31, v107
 v_cvt_pk_bf16_f32 v24, v28, v29
 v_exp_f32 v28, v108
 v_cvt_pk_bf16_f32 v25, v30, v31
 v_exp_f32 v29, v109
 v_exp_f32 v30, v110
 v_exp_f32 v31, v111
 v_cvt_pk_bf16_f32 v26, v28, v29
 v_exp_f32 v28, v112
 v_cvt_pk_bf16_f32 v27, v30, v31
 v_exp_f32 v29, v113
 v_cvt_pk_bf16_f32 v100, v100, v102
 s_waitcnt lgkmcnt(0)
 v_mfma_f32_16x16x32_bf16 v[16:19], v[20:23], v[24:27], 0
 s_waitcnt vmcnt(2)
 v_cvt_pk_bf16_f32 v124, v28, v29
 v_add_f32 v96, v96, v97
 v_mfma_f32_16x16x32_bf16 v[8:11], v[4:7], v[24:27], 0
 s_waitcnt vmcnt(1)
 v_add_f32 v98, v98, v99
 v_mov_b32 v101, 0
 v_mfma_f32_16x16x32_bf16 v[12:15], v[0:3], v[24:27], 0
 v_cvt_pk_bf16_f32 v96, v96, v98
 v_mov_b32 v97, 0
 v_mfma_f32_16x16x16_bf16 v[16:19], v[20:21], v[124:125], v[16:19]
 v_mov_b64 v[82:83], 0
 v_mov_b64 v[84:85], 0
 v_mfma_f32_16x16x16_bf16 v[8:11], v[96:97], v[124:125], v[8:11]
 v_mov_b64 v[86:87], 0
 v_mov_b64 v[88:89], 0
 v_mfma_f32_16x16x16_bf16 v[12:15], v[100:101], v[124:125], v[12:15]
 v_rcp_f32 v126, v16
 v_mov_b64 v[80:81], 0
 v_max_f32 v28, v126, v16
 v_cmp_nge_f32 vcc, s88, v28
 v_mul_f32 v8, v8, v126
 v_mul_f32 v9, v9, v126
 v_mul_f32 v10, v10, v126
 v_mul_f32 v11, v11, v126
FBC2:
 s_and_b64 s[34:35], vcc, s[86:87]
 s_cbranch_scc1 FB2
 v_cvt_pk_bf16_f32 v8, v8, v9
 v_cvt_pk_bf16_f32 v9, v10, v11
 ds_write_b64 v122, v[8:9]
 v_pk_mul_f32 v[12:13], v[12:13], v[126:127] op_sel_hi:[1,0]
 v_pk_mul_f32 v[14:15], v[14:15], v[126:127] op_sel_hi:[1,0]
 v_cvt_pk_bf16_f32 v12, v12, v13
 v_cvt_pk_bf16_f32 v13, v14, v15
 ds_write_b64 v122, v[12:13] offset:256
 v_mov_b64 v[90:91], 0
 v_mov_b64 v[92:93], 0
 v_mov_b64 v[94:95], 0
 v_mov_b64 v[16:17], 0
 v_mov_b64 v[18:19], 0
 v_mov_b64 v[20:21], 0
 v_mov_b64 v[22:23], 0
 v_mov_b64 v[24:25], 0
 v_mov_b64 v[26:27], 0
 v_mov_b64 v[28:29], 0
 v_mov_b64 v[30:31], 0
 v_lshrrev_b32 v124, 3, v117
 v_bitop3_b32 v124, v117, v124, 16 bitop3:0x78
 ds_read_b128 v[32:35], v117 offset:43008
 ds_read_b128 v[36:39], v117 offset:44032
 s_waitcnt lgkmcnt(2)
 s_barrier
 ds_read_b128 v[64:67], v124 offset:24576
 ds_read_b128 v[68:71], v124 offset:25600
 ds_read_b128 v[40:43], v117 offset:59392
 ds_read_b128 v[44:47], v117 offset:60416
 ds_read_b128 v[48:51], v118 offset:10240
 ds_read_b128 v[52:55], v118 offset:11264
 s_waitcnt lgkmcnt(5)
 v_smfmac_f32_16x16x64_bf16 v[80:83], v[64:67], v[192:199], v116
 ds_read_b128 v[56:59], v118 offset:26624
 s_waitcnt lgkmcnt(5)
 v_smfmac_f32_16x16x64_bf16 v[80:83], v[68:71], v[32:39], v116
 ds_read_b128 v[60:63], v118 offset:27648
 v_smfmac_f32_16x16x64_bf16 v[84:87], v[64:67], v[200:207], v116
 ds_read_b128 v[0:3], v118 offset:43008
 s_waitcnt lgkmcnt(5)
 v_smfmac_f32_16x16x64_bf16 v[84:87], v[68:71], v[40:47], v116
 ds_read_b128 v[4:7], v118 offset:44032
 v_add_f32 v80, v80, v81
 v_add_f32 v82, v82, v83
 v_smfmac_f32_16x16x64_bf16 v[88:91], v[64:67], v[208:215], v116
 ds_read_b128 v[72:75], v118 offset:59392
 s_waitcnt lgkmcnt(5)
 v_cvt_pk_bf16_f32 v80, v80, v82
 v_smfmac_f32_16x16x64_bf16 v[88:91], v[68:71], v[48:55], v116
 buffer_store_dword v80, v123, s[36:39], s48 offen
 ds_read_b128 v[76:79], v118 offset:60416
 v_add_f32 v84, v84, v85
 v_add_f32 v86, v86, v87
 v_smfmac_f32_16x16x64_bf16 v[92:95], v[64:67], v[216:223], v116
 s_add_u32 s41, s41, 1
 s_waitcnt lgkmcnt(4)
 v_cvt_pk_bf16_f32 v84, v84, v86
 v_smfmac_f32_16x16x64_bf16 v[92:95], v[68:71], v[56:63], v116
 buffer_store_dword v84, v123, s[36:39], s49 offen
 s_add_u32 s92, s92, 1
 v_add_f32 v88, v88, v89
 v_add_f32 v90, v90, v91
 v_smfmac_f32_16x16x64_bf16 v[16:19], v[64:67], v[224:231], v116
 s_cmp_eq_u32 s92, 3
 s_waitcnt lgkmcnt(2)
 v_cvt_pk_bf16_f32 v88, v88, v90
 v_smfmac_f32_16x16x64_bf16 v[16:19], v[68:71], v[0:7], v116
 buffer_store_dword v88, v123, s[36:39], s50 offen
 s_cselect_b32 s93, 4294426624, s73
 v_add_f32 v92, v92, v93
 v_add_f32 v94, v94, v95
 v_smfmac_f32_16x16x64_bf16 v[20:23], v[64:67], v[232:239], v116
 s_cselect_b32 s79, 4294950912, s66
 s_waitcnt lgkmcnt(0)
 v_cvt_pk_bf16_f32 v92, v92, v94
 v_smfmac_f32_16x16x64_bf16 v[20:23], v[68:71], v[72:79], v116
 buffer_store_dword v92, v123, s[36:39], s51 offen
 s_cselect_b32 s92, 0, s92
 v_add_f32 v16, v16, v17
 v_add_f32 v18, v18, v19
 v_smfmac_f32_16x16x64_bf16 v[24:27], v[64:67], v[240:247], v116
 s_add_u32 s42, s42, s79
 v_cvt_pk_bf16_f32 v16, v16, v18
 v_smfmac_f32_16x16x64_bf16 v[24:27], v[68:71], v[128:135], v116
 buffer_store_dword v16, v123, s[36:39], s52 offen
 s_add_u32 s43, s43, s79
 v_add_f32 v20, v20, v21
 v_add_f32 v22, v22, v23
 v_smfmac_f32_16x16x64_bf16 v[28:31], v[64:67], v[248:255], v116
 s_add_u32 s58, s58, 524288
 v_cvt_pk_bf16_f32 v20, v20, v22
 v_smfmac_f32_16x16x64_bf16 v[28:31], v[68:71], v[136:143], v116
 buffer_store_dword v20, v123, s[36:39], s53 offen
 s_add_u32 s74, s74, 524288
 v_add_f32 v24, v24, v25
 v_add_f32 v26, v26, v27
 v_cvt_pk_bf16_f32 v24, v24, v26
 buffer_store_dword v24, v123, s[36:39], s54 offen
 s_nop 1
 v_add_f32 v28, v28, v29
 v_add_f32 v30, v30, v31
 v_cvt_pk_bf16_f32 v28, v28, v30
 buffer_store_dword v28, v123, s[36:39], s55 offen
 s_add_u32 s48, s48, s93
 v_mov_b64 v[80:81], 0
 s_add_u32 s49, s49, s93
 v_mov_b64 v[82:83], 0
 s_add_u32 s50, s50, s93
 v_mov_b64 v[84:85], 0
 s_add_u32 s51, s51, s93
 v_mov_b64 v[86:87], 0
 s_add_u32 s52, s52, s93
 v_mov_b64 v[88:89], 0
 s_add_u32 s53, s53, s93
 v_mov_b64 v[90:91], 0
 s_add_u32 s54, s54, s93
 v_mov_b64 v[92:93], 0
 s_add_u32 s55, s55, s93
 v_mov_b64 v[94:95], 0
 ds_read_b128 v[32:35], v117 offset:40960
 v_mov_b64 v[96:97], 0
 ds_read_b128 v[36:39], v117 offset:41984
 v_mov_b64 v[98:99], 0
 ds_read_b128 v[40:43], v117 offset:57344
 v_mov_b64 v[100:101], 0
 ds_read_b128 v[44:47], v117 offset:58368
 v_mov_b64 v[102:103], 0
 ds_read_b128 v[48:51], v118 offset:8192
 v_mov_b64 v[76:77], -1
 ds_read_b128 v[52:55], v118 offset:9216
 v_mov_b64 v[78:79], -1
 ds_read_b128 v[56:59], v118 offset:24576
 ds_read_b128 v[60:63], v118 offset:25600
 ds_read_b128 v[16:19], v119 offset:10240
 ds_read_b128 v[20:23], v119 offset:11264
 ds_read_b128 v[24:27], v119 offset:26624
 ds_read_b128 v[28:31], v119 offset:27648
 s_sleep 3
 s_nop 7
 s_mov_b32 m0, 0
 s_nop 0
 buffer_load_dwordx4 v117, s[36:39], s56 offen offset:3072 sc1 lds
 s_mov_b32 m0, 4096
 s_nop 0
 buffer_load_dwordx4 v117, s[36:39], s57 offen offset:0 sc1 lds
 buffer_load_dwordx4 v117, s[36:39], s57 offen offset:1024 sc1 lds
 s_barrier
 s_add_u32 s59, s45, 4096
 s_add_u32 s45, s45, s93
 s_add_u32 s56, s56, 524288
 s_add_u32 s57, s57, 524288
 s_cmp_lt_u32 s41, 63
 s_cbranch_scc1 HA2
 s_branch FIN2
HR2:
 s_add_u32 s65, s65, 1
 s_cmp_gt_u32 s65, 131072
 s_cbranch_scc1 L_ABORT
 s_branch HL2
FB2:
 s_nop 7
 v_max3_f32 v126, v104, v105, v106
 v_max3_f32 v126, v126, v107, v108
 v_max3_f32 v126, v126, v109, v110
 v_max3_f32 v126, v126, v111, v112
 v_max_f32 v126, v126, v113
 v_mov_b32 v28, v126
 s_nop 1
 v_permlane16_swap_b32 v126, v28
 v_max_f32 v126, v126, v28
 v_mov_b32 v28, v126
 s_nop 1
 v_permlane32_swap_b32 v126, v28
 v_max_f32 v126, v126, v28
 v_sub_f32 v28, v104, v126
 v_sub_f32 v29, v105, v126
 v_exp_f32 v28, v28
 v_exp_f32 v29, v29
 s_nop 0
 v_cvt_pk_bf16_f32 v24, v28, v29
 v_sub_f32 v28, v106, v126
 v_sub_f32 v29, v107, v126
 v_exp_f32 v28, v28
 v_exp_f32 v29, v29
 s_nop 0
 v_cvt_pk_bf16_f32 v25, v28, v29
 v_sub_f32 v28, v108, v126
 v_sub_f32 v29, v109, v126
 v_exp_f32 v28, v28
 v_exp_f32 v29, v29
 s_nop 0
 v_cvt_pk_bf16_f32 v26, v28, v29
 v_sub_f32 v28, v110, v126
 v_sub_f32 v29, v111, v126
 v_exp_f32 v28, v28
 v_exp_f32 v29, v29
 s_nop 0
 v_cvt_pk_bf16_f32 v27, v28, v29
 v_sub_f32 v28, v112, v126
 v_sub_f32 v29, v113, v126
 v_exp_f32 v28, v28
 v_exp_f32 v29, v29
 s_nop 0
 v_cvt_pk_bf16_f32 v124, v28, v29
 v_mfma_f32_16x16x32_bf16 v[16:19], v[20:23], v[24:27], 0
 v_mfma_f32_16x16x32_bf16 v[8:11], v[4:7], v[24:27], 0
 v_mfma_f32_16x16x32_bf16 v[12:15], v[0:3], v[24:27], 0
 v_mfma_f32_16x16x16_bf16 v[16:19], v[20:21], v[124:125], v[16:19]
 v_mfma_f32_16x16x16_bf16 v[8:11], v[96:97], v[124:125], v[8:11]
 v_mfma_f32_16x16x16_bf16 v[12:15], v[100:101], v[124:125], v[12:15]
 v_rcp_f32 v126, v16
 s_nop 1
 v_mul_f32 v8, v8, v126
 v_mul_f32 v9, v9, v126
 v_mul_f32 v10, v10, v126
 v_mul_f32 v11, v11, v126
 s_mov_b64 vcc, 0
 s_nop 7
 s_branch FBC2
SB2:
 buffer_load_dwordx4 v[68:71], v117, s[36:39], s43 offen offset:1024 sc1
 s_add_u32 s61, s61, 1
 s_cmp_gt_u32 s61, 131072
 s_cbranch_scc1 L_ABORT
 s_nop 15
SL2:
 buffer_load_dwordx4 v[104:107], v117, s[36:39], s43 offen offset:1024 sc1
 s_waitcnt vmcnt(1)
 ds_write_b128 v117, v[68:71] offset:21504
 v_max3_u32 v124, v68, v69, v70
 v_max_u32 v124, v124, v71
 v_cmp_eq_u32 vcc, -1, v124
 s_cbranch_vccz SK2
 buffer_load_dwordx4 v[68:71], v117, s[36:39], s43 offen offset:1024 sc1
 s_waitcnt vmcnt(1)
 ds_write_b128 v117, v[104:107] offset:21504
 v_max3_u32 v124, v104, v105, v106
 v_max_u32 v124, v124, v107
 v_cmp_eq_u32 vcc, -1, v124
 s_cbranch_vccz SK2
 s_add_u32 s61, s61, 1
 s_cmp_gt_u32 s61, 131072
 s_cbranch_scc1 L_ABORT
 s_branch SL2
SK2:
 v_lshlrev_b32 v126, 3, v117
 s_waitcnt lgkmcnt(0) vmcnt(0)
 s_branch SBR2
CE2:
 ds_read_b128 v[32:35], v117 offset:40960
 v_mov_b64 v[96:97], 0
 ds_read_b128 v[36:39], v117 offset:41984
 v_mov_b64 v[98:99], 0
 ds_read_b128 v[40:43], v117 offset:57344
 v_mov_b64 v[100:101], 0
 ds_read_b128 v[44:47], v117 offset:58368
 v_mov_b64 v[102:103], 0
 ds_read_b128 v[48:51], v118 offset:8192
 v_mov_b64 v[76:77], -1
 ds_read_b128 v[52:55], v118 offset:9216
 v_mov_b64 v[78:79], -1
 ds_read_b128 v[56:59], v118 offset:24576
 ds_read_b128 v[60:63], v118 offset:25600
 ds_read_b128 v[16:19], v119 offset:10240
 ds_read_b128 v[20:23], v119 offset:11264
 ds_read_b128 v[24:27], v119 offset:26624
 ds_read_b128 v[28:31], v119 offset:27648
 s_branch HA2
FIN2:
 s_branch L_DONE
 .p2align 6
HA3:
 s_sleep 1
 s_nop 7
 buffer_load_dwordx4 v[104:107], v117, s[36:39], s42 offen offset:2048 sc1
 s_add_u32 s65, s65, 1
 s_cmp_gt_u32 s65, 131072
 s_cbranch_scc1 L_ABORT
 s_sleep 1
 s_nop 4
 buffer_load_dwordx4 v[108:111], v117, s[36:39], s42 offen offset:2048 sc1
 s_sleep 1
 s_nop 7
HL3:
 buffer_load_dwordx4 v[112:115], v117, s[36:39], s42 offen offset:2048 sc1
 s_waitcnt vmcnt(2)
 ds_write_b128 v117, v[104:107] offset:10240
 v_max3_u32 v124, v104, v105, v106
 v_max_u32 v124, v124, v107
 v_cmp_eq_u32 vcc, -1, v124
 v_mov_b64 v[8:9], v[104:105]
 v_mov_b64 v[10:11], v[106:107]
 s_cbranch_vccz HK3
 buffer_load_dwordx4 v[104:107], v117, s[36:39], s42 offen offset:2048 sc1
 s_waitcnt vmcnt(2)
 ds_write_b128 v117, v[108:111] offset:10240
 v_max3_u32 v124, v108, v109, v110
 v_max_u32 v124, v124, v111
 v_cmp_eq_u32 vcc, -1, v124
 v_mov_b64 v[8:9], v[108:109]
 v_mov_b64 v[10:11], v[110:111]
 s_cbranch_vccz HK3
 buffer_load_dwordx4 v[108:111], v117, s[36:39], s42 offen offset:2048 sc1
 s_waitcnt vmcnt(2)
 ds_write_b128 v117, v[112:115] offset:10240
 v_max3_u32 v124, v112, v113, v114
 v_max_u32 v124, v124, v115
 v_cmp_eq_u32 vcc, -1, v124
 v_mov_b64 v[8:9], v[112:113]
 v_mov_b64 v[10:11], v[114:115]
 s_cbranch_vccnz HR3
HK3:
 s_waitcnt lgkmcnt(1)
 v_smfmac_f32_16x16x64_bf16 v[80:83], v[8:11], a[16:23], v116
 buffer_load_dwordx4 v[68:71], v117, s[36:39], s43 offen offset:2048 sc1
 v_smfmac_f32_16x16x64_bf16 v[100:103], v[8:11], v[48:55], v116
 ds_read_b128 v[48:51], v119 offset:12288
 v_smfmac_f32_16x16x64_bf16 v[84:87], v[8:11], a[80:87], v116
 ds_read_b128 v[52:55], v119 offset:13312
 v_smfmac_f32_16x16x64_bf16 v[88:91], v[8:11], a[144:151], v116
 s_waitcnt lgkmcnt(2)
 s_barrier
 ds_read_b128 v[0:3], v117 offset:8192
 ds_read_b128 v[4:7], v117 offset:9216
 ds_read_b128 v[12:15], v117 offset:11264
 v_smfmac_f32_16x16x64_bf16 v[92:95], v[8:11], a[208:215], v116
 v_smfmac_f32_16x16x64_bf16 v[96:99], v[8:11], v[144:151], v116
 s_waitcnt lgkmcnt(2)
 v_smfmac_f32_16x16x64_bf16 v[80:83], v[0:3], a[0:7], v116
 v_smfmac_f32_16x16x64_bf16 v[100:103], v[0:3], v[32:39], v116
 ds_read_b128 v[32:35], v118 offset:45056
 v_smfmac_f32_16x16x64_bf16 v[84:87], v[0:3], a[64:71], v116
 ds_read_b128 v[36:39], v118 offset:46080
 v_smfmac_f32_16x16x64_bf16 v[88:91], v[0:3], a[128:135], v116
 v_smfmac_f32_16x16x64_bf16 v[96:99], v[0:3], v[16:23], v116
 s_waitcnt lgkmcnt(3)
 v_smfmac_f32_16x16x64_bf16 v[80:83], v[4:7], a[8:15], v116
 v_smfmac_f32_16x16x64_bf16 v[100:103], v[4:7], v[40:47], v116
 ds_read_b128 v[40:43], v118 offset:61440
 v_smfmac_f32_16x16x64_bf16 v[84:87], v[4:7], a[72:79], v116
 ds_read_b128 v[44:47], v118 offset:62464
 v_smfmac_f32_16x16x64_bf16 v[88:91], v[4:7], a[136:143], v116
 v_smfmac_f32_16x16x64_bf16 v[96:99], v[4:7], v[24:31], v116
 s_waitcnt vmcnt(0)
 ds_write_b128 v117, v[68:71] offset:22528
 buffer_store_dwordx4 v[76:79], v117, s[36:39], s59 offen offset:0
 s_waitcnt lgkmcnt(5)
 v_smfmac_f32_16x16x64_bf16 v[80:83], v[12:15], a[24:31], v116
 v_max3_u32 v124, v68, v69, v70
 v_smfmac_f32_16x16x64_bf16 v[100:103], v[12:15], v[56:63], v116
 v_max_u32 v124, v124, v71
 buffer_store_dwordx4 v[76:79], v117, s[36:39], s59 offen offset:1024
 v_smfmac_f32_16x16x64_bf16 v[84:87], v[12:15], a[88:95], v116
 v_cmp_eq_u32 vcc, -1, v124
 v_smfmac_f32_16x16x64_bf16 v[88:91], v[12:15], a[152:159], v116
 v_smfmac_f32_16x16x64_bf16 v[92:95], v[12:15], a[216:223], v116
 s_cbranch_vccnz SB3
SBR3:
 s_waitcnt lgkmcnt(0)
 s_barrier
 ds_read_b128 v[16:19], v117 offset:20480
 v_smfmac_f32_16x16x64_bf16 v[92:95], v[0:3], a[192:199], v116
 ds_read_b128 v[20:23], v117 offset:21504
 v_smfmac_f32_16x16x64_bf16 v[92:95], v[4:7], a[200:207], v116
 ds_read_b128 v[24:27], v117 offset:22528
 buffer_load_dwordx4 v[8:11], v117, s[36:39], s58 offen sc1
 s_waitcnt lgkmcnt(2)
 v_smfmac_f32_16x16x64_bf16 v[80:83], v[16:19], a[32:39], v116
 ds_read_b128 v[28:31], v117 offset:23552
 buffer_load_dwordx4 v[0:3], v117, s[36:39], s58 offen offset:1024 sc1
 v_smfmac_f32_16x16x64_bf16 v[100:103], v[16:19], v[32:39], v116
 ds_read_b128 v[56:59], v119 offset:28672
 v_and_b32 v126, 63, v123
 buffer_load_dword v127, v126, s[36:39], s90 offen sc1
 v_smfmac_f32_16x16x64_bf16 v[84:87], v[16:19], a[96:103], v116
 ds_read_b128 v[60:63], v119 offset:29696
 s_waitcnt lgkmcnt(4)
 v_smfmac_f32_16x16x64_bf16 v[80:83], v[20:23], a[40:47], v116
 ds_read_b128 v[32:35], v117 offset:0
 v_smfmac_f32_16x16x64_bf16 v[100:103], v[20:23], v[40:47], v116
 ds_read_b128 v[36:39], v117 offset:1024
 ds_read_b128 v[40:43], v117 offset:2048
 v_smfmac_f32_16x16x64_bf16 v[84:87], v[20:23], a[104:111], v116
 ds_read_b128 v[44:47], v117 offset:3072
 s_waitcnt lgkmcnt(7)
 v_smfmac_f32_16x16x64_bf16 v[80:83], v[24:27], a[48:55], v116
 v_smfmac_f32_16x16x64_bf16 v[100:103], v[24:27], v[48:55], v116
 ds_read_b128 v[48:51], v117 offset:4096
 v_smfmac_f32_16x16x64_bf16 v[84:87], v[24:27], a[112:119], v116
 ds_read_b128 v[52:55], v117 offset:5120
 s_waitcnt lgkmcnt(8)
 v_smfmac_f32_16x16x64_bf16 v[80:83], v[28:31], a[56:63], v116
 s_waitcnt lgkmcnt(6)
 v_smfmac_f32_16x16x64_bf16 v[100:103], v[28:31], v[56:63], v116
 ds_read_b128 v[56:59], v117 offset:6144
 v_smfmac_f32_16x16x64_bf16 v[84:87], v[28:31], a[120:127], v116
 ds_read_b128 v[60:63], v117 offset:7168
 v_smfmac_f32_16x16x64_bf16 v[88:91], v[16:19], a[160:167], v116
 v_add_f32 v80, v80, v81
 v_add_f32 v82, v82, v83
 v_smfmac_f32_16x16x64_bf16 v[88:91], v[20:23], a[168:175], v116
 v_mul_f32 v80, s64, v80
 v_mul_f32 v82, s64, v82
 v_smfmac_f32_16x16x64_bf16 v[88:91], v[24:27], a[176:183], v116
 v_cvt_pk_bf16_f32 v80, v80, v82
 v_add_f32 v84, v84, v85
 v_smfmac_f32_16x16x64_bf16 v[88:91], v[28:31], a[184:191], v116
 ds_write_b32 v121, v80 offset:11264
 v_add_f32 v86, v86, v87
 v_smfmac_f32_16x16x64_bf16 v[96:99], v[12:15], v[152:159], v116
 v_mul_f32 v84, s64, v84
 v_mul_f32 v86, s64, v86
 v_smfmac_f32_16x16x64_bf16 v[92:95], v[16:19], a[224:231], v116
 v_cvt_pk_bf16_f32 v84, v84, v86
 v_smfmac_f32_16x16x64_bf16 v[92:95], v[20:23], a[232:239], v116
 ds_write_b32 v121, v84 offset:11776
 v_smfmac_f32_16x16x64_bf16 v[92:95], v[24:27], a[240:247], v116
 v_add_f32 v88, v88, v89
 v_add_f32 v90, v90, v91
 v_smfmac_f32_16x16x64_bf16 v[92:95], v[28:31], a[248:255], v116
 v_cvt_pk_bf16_f32 v88, v88, v90
 v_smfmac_f32_16x16x64_bf16 v[96:99], v[16:19], v[160:167], v116
 ds_write_b32 v121, v88 offset:17408
 v_smfmac_f32_16x16x64_bf16 v[96:99], v[20:23], v[168:175], v116
 s_waitcnt lgkmcnt(1)
 s_barrier
 v_add_f32 v92, v92, v93
 v_add_f32 v94, v94, v95
 v_smfmac_f32_16x16x64_bf16 v[96:99], v[24:27], v[176:183], v116
 ds_read_b64_tr_b16 v[64:65], v120 offset:8192
 ds_read_b64_tr_b16 v[66:67], v120 offset:8448
 v_cvt_pk_bf16_f32 v92, v92, v94
 ds_write_b32 v121, v92 offset:17920
 v_smfmac_f32_16x16x64_bf16 v[96:99], v[28:31], v[184:191], v116
 ds_read_b64_tr_b16 v[68:69], v120 offset:9216
 ds_read_b64_tr_b16 v[70:71], v120 offset:9472
 ds_read_b64_tr_b16 v[72:73], v120 offset:10240
 ds_read_b64_tr_b16 v[74:75], v120 offset:10496
 s_waitcnt lgkmcnt(5)
 v_mfma_f32_16x16x32_bf16 v[104:107], v[32:35], v[64:67], 0
 ds_read_b64_tr_b16 v[76:77], v120 offset:11264
 v_mfma_f32_16x16x32_bf16 v[108:111], v[48:51], v[64:67], 0
 ds_read_b64_tr_b16 v[78:79], v120 offset:11520
 s_waitcnt lgkmcnt(4)
 v_mfma_f32_16x16x32_bf16 v[104:107], v[36:39], v[68:71], v[104:107]
 v_add_f32 v100, v100, v101
 v_add_f32 v102, v102, v103
 v_mfma_f32_16x16x32_bf16 v[108:111], v[52:55], v[68:71], v[108:111]
 s_waitcnt lgkmcnt(6)
 s_barrier
 s_waitcnt lgkmcnt(2)
 v_mfma_f32_16x16x32_bf16 v[104:107], v[40:43], v[72:75], v[104:107]
 ds_read_b64_tr_b16 v[80:81], v120 offset:14336
 ds_read_b64_tr_b16 v[82:83], v120 offset:14592
 s_waitcnt lgkmcnt(2)
 v_mfma_f32_16x16x32_bf16 v[104:107], v[44:47], v[76:79], v[104:107]
 ds_read_b64_tr_b16 v[84:85], v120 offset:15360
 ds_read_b64_tr_b16 v[86:87], v120 offset:15616
 v_mfma_f32_16x16x32_bf16 v[108:111], v[56:59], v[72:75], v[108:111]
 ds_read_b64_tr_b16 v[88:89], v120 offset:16384
 ds_read_b64_tr_b16 v[90:91], v120 offset:16640
 v_mfma_f32_16x16x32_bf16 v[108:111], v[60:63], v[76:79], v[108:111]
 ds_read_b64_tr_b16 v[92:93], v120 offset:17408
 ds_read_b64_tr_b16 v[94:95], v120 offset:17664
 ds_read_b128 v[20:23], v117 offset:29696
 s_waitcnt lgkmcnt(7)
 v_mfma_f32_16x16x32_bf16 v[112:115], v[80:83], v[64:67], 0
 s_waitcnt lgkmcnt(5)
 v_exp_f32 v28, v104
 v_mfma_f32_16x16x32_bf16 v[112:115], v[84:87], v[68:71], v[112:115]
 s_waitcnt lgkmcnt(3)
 v_exp_f32 v29, v105
 v_mfma_f32_16x16x32_bf16 v[112:115], v[88:91], v[72:75], v[112:115]
 s_waitcnt lgkmcnt(1)
 v_exp_f32 v30, v106
 v_mfma_f32_16x16x32_bf16 v[112:115], v[92:95], v[76:79], v[112:115]
 v_exp_f32 v31, v107
 v_cvt_pk_bf16_f32 v24, v28, v29
 v_exp_f32 v28, v108
 v_cvt_pk_bf16_f32 v25, v30, v31
 v_exp_f32 v29, v109
 v_exp_f32 v30, v110
 v_exp_f32 v31, v111
 v_cvt_pk_bf16_f32 v26, v28, v29
 v_exp_f32 v28, v112
 v_cvt_pk_bf16_f32 v27, v30, v31
 v_exp_f32 v29, v113
 v_cvt_pk_bf16_f32 v100, v100, v102
 s_waitcnt lgkmcnt(0)
 v_mfma_f32_16x16x32_bf16 v[16:19], v[20:23], v[24:27], 0
 s_waitcnt vmcnt(2)
 v_cvt_pk_bf16_f32 v124, v28, v29
 v_add_f32 v96, v96, v97
 v_mfma_f32_16x16x32_bf16 v[4:7], v[8:11], v[24:27], 0
 s_waitcnt vmcnt(1)
 v_add_f32 v98, v98, v99
 v_mov_b32 v101, 0
 v_mfma_f32_16x16x32_bf16 v[12:15], v[0:3], v[24:27], 0
 v_cvt_pk_bf16_f32 v96, v96, v98
 v_mov_b32 v97, 0
 v_mfma_f32_16x16x16_bf16 v[16:19], v[20:21], v[124:125], v[16:19]
 v_mov_b64 v[82:83], 0
 v_mov_b64 v[84:85], 0
 v_mfma_f32_16x16x16_bf16 v[4:7], v[96:97], v[124:125], v[4:7]
 v_mov_b64 v[86:87], 0
 v_mov_b64 v[88:89], 0
 v_mfma_f32_16x16x16_bf16 v[12:15], v[100:101], v[124:125], v[12:15]
 v_rcp_f32 v126, v16
 v_mov_b64 v[80:81], 0
 v_max_f32 v28, v126, v16
 v_cmp_nge_f32 vcc, s88, v28
 v_mul_f32 v4, v4, v126
 v_mul_f32 v5, v5, v126
 v_mul_f32 v6, v6, v126
 v_mul_f32 v7, v7, v126
FBC3:
 s_and_b64 s[34:35], vcc, s[86:87]
 s_cbranch_scc1 FB3
 v_cvt_pk_bf16_f32 v4, v4, v5
 v_cvt_pk_bf16_f32 v5, v6, v7
 ds_write_b64 v122, v[4:5]
 v_pk_mul_f32 v[12:13], v[12:13], v[126:127] op_sel_hi:[1,0]
 v_pk_mul_f32 v[14:15], v[14:15], v[126:127] op_sel_hi:[1,0]
 v_cvt_pk_bf16_f32 v12, v12, v13
 v_cvt_pk_bf16_f32 v13, v14, v15
 ds_write_b64 v122, v[12:13] offset:256
 v_mov_b64 v[90:91], 0
 v_mov_b64 v[92:93], 0
 v_mov_b64 v[94:95], 0
 v_mov_b64 v[16:17], 0
 v_mov_b64 v[18:19], 0
 v_mov_b64 v[20:21], 0
 v_mov_b64 v[22:23], 0
 v_mov_b64 v[24:25], 0
 v_mov_b64 v[26:27], 0
 v_mov_b64 v[28:29], 0
 v_mov_b64 v[30:31], 0
 v_lshrrev_b32 v124, 3, v117
 v_bitop3_b32 v124, v117, v124, 16 bitop3:0x78
 ds_read_b128 v[32:35], v117 offset:47104
 ds_read_b128 v[36:39], v117 offset:48128
 s_waitcnt lgkmcnt(2)
 s_barrier
 ds_read_b128 v[64:67], v124 offset:24576
 ds_read_b128 v[68:71], v124 offset:25600
 ds_read_b128 v[40:43], v117 offset:63488
 ds_read_b128 v[44:47], v117 offset:64512
 ds_read_b128 v[48:51], v118 offset:14336
 ds_read_b128 v[52:55], v118 offset:15360
 s_waitcnt lgkmcnt(5)
 v_smfmac_f32_16x16x64_bf16 v[80:83], v[64:67], v[192:199], v116
 ds_read_b128 v[56:59], v118 offset:30720
 s_waitcnt lgkmcnt(5)
 v_smfmac_f32_16x16x64_bf16 v[80:83], v[68:71], v[32:39], v116
 ds_read_b128 v[60:63], v118 offset:31744
 v_smfmac_f32_16x16x64_bf16 v[84:87], v[64:67], v[200:207], v116
 ds_read_b128 v[0:3], v118 offset:47104
 s_waitcnt lgkmcnt(5)
 v_smfmac_f32_16x16x64_bf16 v[84:87], v[68:71], v[40:47], v116
 ds_read_b128 v[4:7], v118 offset:48128
 v_add_f32 v80, v80, v81
 v_add_f32 v82, v82, v83
 v_smfmac_f32_16x16x64_bf16 v[88:91], v[64:67], v[208:215], v116
 ds_read_b128 v[72:75], v118 offset:63488
 s_waitcnt lgkmcnt(5)
 v_cvt_pk_bf16_f32 v80, v80, v82
 v_smfmac_f32_16x16x64_bf16 v[88:91], v[68:71], v[48:55], v116
 buffer_store_dword v80, v123, s[36:39], s48 offen
 ds_read_b128 v[76:79], v118 offset:64512
 v_add_f32 v84, v84, v85
 v_add_f32 v86, v86, v87
 v_smfmac_f32_16x16x64_bf16 v[92:95], v[64:67], v[216:223], v116
 s_add_u32 s41, s41, 1
 s_waitcnt lgkmcnt(4)
 v_cvt_pk_bf16_f32 v84, v84, v86
 v_smfmac_f32_16x16x64_bf16 v[92:95], v[68:71], v[56:63], v116
 buffer_store_dword v84, v123, s[36:39], s49 offen
 s_add_u32 s92, s92, 1
 v_add_f32 v88, v88, v89
 v_add_f32 v90, v90, v91
 v_smfmac_f32_16x16x64_bf16 v[16:19], v[64:67], v[224:231], v116
 s_cmp_eq_u32 s92, 3
 s_waitcnt lgkmcnt(2)
 v_cvt_pk_bf16_f32 v88, v88, v90
 v_smfmac_f32_16x16x64_bf16 v[16:19], v[68:71], v[0:7], v116
 buffer_store_dword v88, v123, s[36:39], s50 offen
 s_cselect_b32 s93, 4294426624, s73
 v_add_f32 v92, v92, v93
 v_add_f32 v94, v94, v95
 v_smfmac_f32_16x16x64_bf16 v[20:23], v[64:67], v[232:239], v116
 s_cselect_b32 s79, 4294950912, s66
 s_waitcnt lgkmcnt(0)
 v_cvt_pk_bf16_f32 v92, v92, v94
 v_smfmac_f32_16x16x64_bf16 v[20:23], v[68:71], v[72:79], v116
 buffer_store_dword v92, v123, s[36:39], s51 offen
 s_cselect_b32 s92, 0, s92
 v_add_f32 v16, v16, v17
 v_add_f32 v18, v18, v19
 v_smfmac_f32_16x16x64_bf16 v[24:27], v[64:67], v[240:247], v116
 s_add_u32 s42, s42, s79
 v_cvt_pk_bf16_f32 v16, v16, v18
 v_smfmac_f32_16x16x64_bf16 v[24:27], v[68:71], v[128:135], v116
 buffer_store_dword v16, v123, s[36:39], s52 offen
 s_add_u32 s43, s43, s79
 v_add_f32 v20, v20, v21
 v_add_f32 v22, v22, v23
 v_smfmac_f32_16x16x64_bf16 v[28:31], v[64:67], v[248:255], v116
 s_add_u32 s58, s58, 524288
 v_cvt_pk_bf16_f32 v20, v20, v22
 v_smfmac_f32_16x16x64_bf16 v[28:31], v[68:71], v[136:143], v116
 buffer_store_dword v20, v123, s[36:39], s53 offen
 v_add_f32 v24, v24, v25
 v_add_f32 v26, v26, v27
 v_cvt_pk_bf16_f32 v24, v24, v26
 buffer_store_dword v24, v123, s[36:39], s54 offen
 s_nop 1
 v_add_f32 v28, v28, v29
 v_add_f32 v30, v30, v31
 v_cvt_pk_bf16_f32 v28, v28, v30
 buffer_store_dword v28, v123, s[36:39], s55 offen
 s_add_u32 s91, s41, 2
 s_lshr_b32 s91, s91, 2
 s_add_u32 s91, s91, 1
 s_min_u32 s91, s91, 16
 s_add_u32 s48, s48, s93
 v_mov_b64 v[80:81], 0
 s_add_u32 s49, s49, s93
 v_mov_b64 v[82:83], 0
 s_add_u32 s50, s50, s93
 v_mov_b64 v[84:85], 0
 s_add_u32 s51, s51, s93
 v_mov_b64 v[86:87], 0
 s_add_u32 s52, s52, s93
 v_mov_b64 v[88:89], 0
 s_add_u32 s53, s53, s93
 v_mov_b64 v[90:91], 0
 s_add_u32 s54, s54, s93
 v_mov_b64 v[92:93], 0
 s_add_u32 s55, s55, s93
 v_mov_b64 v[94:95], 0
 ds_read_b128 v[32:35], v117 offset:45056
 v_mov_b64 v[96:97], 0
 ds_read_b128 v[36:39], v117 offset:46080
 v_mov_b64 v[98:99], 0
 ds_read_b128 v[40:43], v117 offset:61440
 v_mov_b64 v[100:101], 0
 ds_read_b128 v[44:47], v117 offset:62464
 v_mov_b64 v[102:103], 0
 ds_read_b128 v[48:51], v118 offset:12288
 v_mov_b64 v[76:77], -1
 ds_read_b128 v[52:55], v118 offset:13312
 v_mov_b64 v[78:79], -1
 ds_read_b128 v[56:59], v118 offset:28672
 ds_read_b128 v[60:63], v118 offset:29696
 ds_read_b128 v[16:19], v119 offset:14336
 ds_read_b128 v[20:23], v119 offset:15360
 ds_read_b128 v[24:27], v119 offset:30720
 ds_read_b128 v[28:31], v119 offset:31744
 s_sleep 3
 s_nop 7
 s_mov_b32 m0, 4096
 s_nop 0
 buffer_load_dwordx4 v117, s[36:39], s57 offen offset:2048 sc1 lds
 buffer_load_dwordx4 v117, s[36:39], s57 offen offset:3072 sc1 lds
 s_waitcnt vmcnt(10)
 v_cmp_gt_u32 vcc, s91, v127
 s_cbranch_vccnz KVW
KVR:
 s_barrier
 s_add_u32 s59, s45, 6144
 s_add_u32 s45, s45, s93
 s_add_u32 s56, s56, 524288
 s_add_u32 s57, s57, 524288
 s_cmp_lt_u32 s41, 63
 s_cbranch_scc1 HA3
 s_branch FIN3
HR3:
 s_add_u32 s65, s65, 1
 s_cmp_gt_u32 s65, 131072
 s_cbranch_scc1 L_ABORT
 s_branch HL3
FB3:
 s_nop 7
 v_max3_f32 v126, v104, v105, v106
 v_max3_f32 v126, v126, v107, v108
 v_max3_f32 v126, v126, v109, v110
 v_max3_f32 v126, v126, v111, v112
 v_max_f32 v126, v126, v113
 v_mov_b32 v28, v126
 s_nop 1
 v_permlane16_swap_b32 v126, v28
 v_max_f32 v126, v126, v28
 v_mov_b32 v28, v126
 s_nop 1
 v_permlane32_swap_b32 v126, v28
 v_max_f32 v126, v126, v28
 v_sub_f32 v28, v104, v126
 v_sub_f32 v29, v105, v126
 v_exp_f32 v28, v28
 v_exp_f32 v29, v29
 s_nop 0
 v_cvt_pk_bf16_f32 v24, v28, v29
 v_sub_f32 v28, v106, v126
 v_sub_f32 v29, v107, v126
 v_exp_f32 v28, v28
 v_exp_f32 v29, v29
 s_nop 0
 v_cvt_pk_bf16_f32 v25, v28, v29
 v_sub_f32 v28, v108, v126
 v_sub_f32 v29, v109, v126
 v_exp_f32 v28, v28
 v_exp_f32 v29, v29
 s_nop 0
 v_cvt_pk_bf16_f32 v26, v28, v29
 v_sub_f32 v28, v110, v126
 v_sub_f32 v29, v111, v126
 v_exp_f32 v28, v28
 v_exp_f32 v29, v29
 s_nop 0
 v_cvt_pk_bf16_f32 v27, v28, v29
 v_sub_f32 v28, v112, v126
 v_sub_f32 v29, v113, v126
 v_exp_f32 v28, v28
 v_exp_f32 v29, v29
 s_nop 0
 v_cvt_pk_bf16_f32 v124, v28, v29
 v_mfma_f32_16x16x32_bf16 v[16:19], v[20:23], v[24:27], 0
 v_mfma_f32_16x16x32_bf16 v[4:7], v[8:11], v[24:27], 0
 v_mfma_f32_16x16x32_bf16 v[12:15], v[0:3], v[24:27], 0
 v_mfma_f32_16x16x16_bf16 v[16:19], v[20:21], v[124:125], v[16:19]
 v_mfma_f32_16x16x16_bf16 v[4:7], v[96:97], v[124:125], v[4:7]
 v_mfma_f32_16x16x16_bf16 v[12:15], v[100:101], v[124:125], v[12:15]
 v_rcp_f32 v126, v16
 s_nop 1
 v_mul_f32 v4, v4, v126
 v_mul_f32 v5, v5, v126
 v_mul_f32 v6, v6, v126
 v_mul_f32 v7, v7, v126
 s_mov_b64 vcc, 0
 s_nop 7
 s_branch FBC3
KVW:
 v_and_b32 v126, 63, v123
 s_mov_b32 s3, 0
 s_branch KVL_go
KVL:
 s_sleep 1
KVL_go:
 buffer_load_dword v127, v126, s[36:39], s90 offen sc1
 s_add_u32 s3, s3, 1
 s_cmp_gt_u32 s3, 131072
 s_cbranch_scc1 L_ABORT
 s_waitcnt vmcnt(0)
 v_cmp_gt_u32 vcc, s91, v127
 s_cbranch_vccnz KVL
 s_branch KVR
SB3:
 buffer_load_dwordx4 v[68:71], v117, s[36:39], s43 offen offset:2048 sc1
 s_add_u32 s61, s61, 1
 s_cmp_gt_u32 s61, 131072
 s_cbranch_scc1 L_ABORT
 s_nop 15
SL3:
 buffer_load_dwordx4 v[104:107], v117, s[36:39], s43 offen offset:2048 sc1
 s_waitcnt vmcnt(1)
 ds_write_b128 v117, v[68:71] offset:22528
 v_max3_u32 v124, v68, v69, v70
 v_max_u32 v124, v124, v71
 v_cmp_eq_u32 vcc, -1, v124
 s_cbranch_vccz SK3
 buffer_load_dwordx4 v[68:71], v117, s[36:39], s43 offen offset:2048 sc1
 s_waitcnt vmcnt(1)
 ds_write_b128 v117, v[104:107] offset:22528
 v_max3_u32 v124, v104, v105, v106
 v_max_u32 v124, v124, v107
 v_cmp_eq_u32 vcc, -1, v124
 s_cbranch_vccz SK3
 s_add_u32 s61, s61, 1
 s_cmp_gt_u32 s61, 131072
 s_cbranch_scc1 L_ABORT
 s_branch SL3
SK3:
 s_waitcnt lgkmcnt(0) vmcnt(0)
 s_branch SBR3
CE3:
 ds_read_b128 v[32:35], v117 offset:45056
 v_mov_b64 v[96:97], 0
 ds_read_b128 v[36:39], v117 offset:46080
 v_mov_b64 v[98:99], 0
 ds_read_b128 v[40:43], v117 offset:61440
 v_mov_b64 v[100:101], 0
 ds_read_b128 v[44:47], v117 offset:62464
 v_mov_b64 v[102:103], 0
 ds_read_b128 v[48:51], v118 offset:12288
 v_mov_b64 v[76:77], -1
 ds_read_b128 v[52:55], v118 offset:13312
 v_mov_b64 v[78:79], -1
 ds_read_b128 v[56:59], v118 offset:28672
 ds_read_b128 v[60:63], v118 offset:29696
 ds_read_b128 v[16:19], v119 offset:14336
 ds_read_b128 v[20:23], v119 offset:15360
 ds_read_b128 v[24:27], v119 offset:30720
 ds_read_b128 v[28:31], v119 offset:31744
 s_branch HA3
FIN3:
 s_branch L_DONE
L_ABORT:
L_DONE:
L_EXIT:
 s_endpgm
.section .rodata,"a"
.p2align 6
.amdhsa_kernel recurrent_scan__memory_aug_recurrent_mem_tr__mixer_s_mlp__prompt_kernel
  .amdhsa_next_free_vgpr 512
  .amdhsa_next_free_sgpr 102
  .amdhsa_accum_offset 256
  .amdhsa_group_segment_fixed_size 0
  .amdhsa_kernarg_size 120
  .amdhsa_user_sgpr_count 2
  .amdhsa_user_sgpr_kernarg_segment_ptr 1
  .amdhsa_system_sgpr_workgroup_id_x 1
  .amdhsa_float_denorm_mode_32 3
.end_amdhsa_kernel
```
